```python
import torch

def _softmax(x, axis=-1):
    return torch.softmax(x, dim=axis)
def _gelu(x):
    return torch.nn.functional.gelu(x, approximate="tanh")
def _silu(x):
    return torch.nn.functional.silu(x)
def _sigmoid(x):
    return torch.sigmoid(x)
def _layernorm(x, axis=-1, eps=1e-5):
    m = x.mean(dim=axis, keepdim=True)
    v = x.var(dim=axis, keepdim=True, unbiased=False)
    return (x - m) / torch.sqrt(v + eps)
def _scatter_add(tgt, idx, src, axis=0):
    return tgt.clone().index_add_(axis, idx, src)
def _segment_sum(src, seg, n):
    out = torch.zeros((n,) + src.shape[1:], dtype=src.dtype)
    return out.index_add_(0, seg, src)
def _pad(x, pw):
    flat = tuple(v for pair in reversed(pw) for v in pair)
    return torch.nn.functional.pad(x, flat)

kernel_name = 'standalone__seq2seq_rnn_t_joint__speech'

def setup_inputs():

    _w = (lambda a: (lambda t: t.to(torch.bfloat16) if t.is_floating_point() else t)(torch.as_tensor(a)))
    B, T, D, K = 2, 16000, 256, 15
    U = 8
    sc = (1.0 / (K * D)) ** 0.5
    sd = (1.0 / D) ** 0.5
    return {
        "x": _w((lambda *s: torch.randn(*s, dtype=torch.bfloat16) * 0.2)(B, T, D) * 0.5),
        "w1": _w((lambda *s: torch.randn(*s, dtype=torch.bfloat16) * 3.2)(K, D, D) * sc),
        "w2": _w((lambda *s: torch.randn(*s, dtype=torch.bfloat16) * 3.2)(K, D, D) * sc),
        "g": _w((lambda *s: torch.randn(*s, dtype=torch.bfloat16) * 3.2)(B, U, D) * 0.5),
        "w_f": _w((lambda *s: torch.randn(*s, dtype=torch.bfloat16) * 3.2)(D, D) * sd),
        "w_g": _w((lambda *s: torch.randn(*s, dtype=torch.bfloat16) * 3.2)(D, D) * sd),
        "w_o": _w((lambda *s: torch.randn(*s, dtype=torch.bfloat16) * 3.2)(D, D) * sd),
    }

def reference(x, w1, w2, g, w_f, w_g, w_o):
    B, T, D = x.shape
    K = w1.shape[0]
    pad = K // 2
    xp = _pad(x, ((0,0),(pad,pad),(0,0)))
    h = torch.zeros_like(x)
    for i in range(K):
        h = h + torch.einsum("btc,cd->btd", xp[:, i:i+T, :], w1[i])
    h = _gelu(h)[:, ::2, :]
    T1 = h.shape[1]
    hp = _pad(h, ((0,0),(pad,pad),(0,0)))
    f = torch.zeros_like(h)
    for i in range(K):
        f = f + torch.einsum("btc,cd->btd", hp[:, i:i+T1, :], w2[i])
    f = _gelu(f)[:, ::2, :]
    fe = torch.einsum("btd,de->bte", f, w_f)
    ge = torch.einsum("bud,de->bue", g, w_g)
    j = torch.tanh(fe[:, :, None, :] + ge[:, None, :, :])
    return torch.einsum("btud,dv->btuv", j, w_o)
```

```asm
; @launch grid=(256,1,1) block=(512,1,1) lds=163840
.amdgcn_target "amdgcn-amd-amdhsa--gfx950"
.text
.globl standalone__seq2seq_rnn_t_joint__speech_kernel
.p2align 8
.type standalone__seq2seq_rnn_t_joint__speech_kernel,@function
standalone__seq2seq_rnn_t_joint__speech_kernel:
    s_cmp_ge_u32 s2, 256
    s_cbranch_scc1 L_exit
    s_load_dwordx4 s[4:7], s[0:1], 0
    s_load_dwordx8 s[8:15], s[0:1], 16
    s_load_dwordx8 s[16:23], s[0:1], 48
    v_lshrrev_b32 v1, 6, v0
    s_and_b32 s70, s2, 7
    s_lshr_b32 s71, s2, 3
    v_readfirstlane_b32 s24, v1
    v_and_b32 v0, 63, v0
    s_bitcmp1_b32 s2, 0
    s_cselect_b32 s72, 0, 31
    s_xor_b32 s71, s71, s72
    s_lshl_b32 s72, s70, 3
    s_lshr_b32 s73, s71, 2
    s_add_u32 s26, s72, s73
    s_and_b32 s27, s71, 3
    v_lshrrev_b32 v240, 3, v0
    v_and_b32 v241, 7, v0
    s_and_b32 s25, s24, 3
    s_lshl_b32 s31, s25, 10
    s_mov_b32 s68, 874517250
    s_mov_b32 s69, 1952470599
    s_and_b32 s78, s25, 1
    v_xor_b32 v242, s78, v240
    s_lshr_b32 s79, s24, 2
    s_xor_b32 s79, s79, 1
    s_lshl_b32 s75, s79, 3
    s_add_u32 s75, s75, s25
    s_lshl_b32 s67, s26, 8
    s_lshl_b32 s74, s75, 2
    s_lshr_b64 s[76:77], s[68:69], s74
    s_and_b32 s76, s76, 7
    s_lshl_b32 s74, s75, 4
    s_add_u32 s74, s74, s67
    s_sub_u32 s74, s74, 7
    v_lshl_add_u32 v243, v242, 1, s74
    v_xor_b32 v244, s76, v241
    v_lshlrev_b32 v244, 4, v244
    v_lshl_add_u32 v1, v243, 9, v244
    s_add_u32 s66, s75, 4
    s_lshl_b32 s74, s66, 2
    s_lshr_b64 s[76:77], s[68:69], s74
    s_and_b32 s76, s76, 7
    s_lshl_b32 s74, s66, 4
    s_add_u32 s74, s74, s67
    s_sub_u32 s74, s74, 7
    v_lshl_add_u32 v243, v242, 1, s74
    v_xor_b32 v244, s76, v241
    v_lshlrev_b32 v244, 4, v244
    v_lshl_add_u32 v2, v243, 9, v244
    v_and_b32 v243, 2, v240
    s_lshl_b32 s78, s78, 2
    v_or_b32 v243, s78, v243
    v_xor_b32 v243, v243, v241
    s_lshl_b32 s73, s25, 12
    s_lshl_b32 s74, s27, 7
    s_add_u32 s73, s73, s74
    v_lshlrev_b32 v244, 9, v240
    v_lshl_add_u32 v244, v243, 4, v244
    v_add_u32 v21, s73, v244
    v_lshlrev_b32 v245, 1, v240
    v_add_u32 v245, 249, v245
    v_xor_b32 v246, 2, v241
    v_lshlrev_b32 v246, 4, v246
    v_add_u32 v243, s67, v245
    v_lshl_add_u32 v5, v243, 9, v246
    s_lshl_b32 s74, s24, 3
    s_mov_b64 s[76:77], 0xff
    s_lshl_b64 s[76:77], s[76:77], s74
    s_lshl_b32 s75, s75, 10
    s_lshl_b32 s65, s79, 14
    s_add_u32 s65, s65, s31
    s_lshl_b32 s64, s79, 20
    s_waitcnt lgkmcnt(0)
    s_mov_b32 s32, s4
    s_mov_b32 s33, s5
    s_mov_b32 s34, 8192000
    s_mov_b32 s35, 0x20000
    s_mov_b32 s36, s6
    s_mov_b32 s37, s7
    s_mov_b32 s38, 1966080
    s_mov_b32 s39, 0x20000
    s_add_u32 m0, s75, 144384
    s_nop 0
    buffer_load_dwordx4 v1, s[32:35], 0 offen lds
    s_add_u32 m0, s75, 148480
    s_nop 0
    buffer_load_dwordx4 v2, s[32:35], 0 offen lds
    s_mov_b32 m0, 160768
    s_mov_b64 exec, s[76:77]
    buffer_load_dwordx4 v5, s[32:35], 0 offen lds
    s_mov_b64 exec, -1
    s_add_u32 m0, s65, 61440
    s_add_u32 s66, s64, 0
    buffer_load_dwordx4 v21, s[36:39], s66 offen lds
    s_add_u32 m0, s65, 65536
    s_add_u32 s66, s64, 262144
    buffer_load_dwordx4 v21, s[36:39], s66 offen lds
    s_add_u32 m0, s65, 69632
    s_add_u32 s66, s64, 524288
    buffer_load_dwordx4 v21, s[36:39], s66 offen lds
    s_add_u32 m0, s65, 73728
    s_add_u32 s66, s64, 786432
    buffer_load_dwordx4 v21, s[36:39], s66 offen lds
    s_add_u32 s32, s4, 8192000
    s_addc_u32 s33, s5, 0
    s_add_u32 m0, s75, 126976
    s_nop 0
    buffer_load_dwordx4 v1, s[32:35], 0 offen lds
    s_add_u32 m0, s75, 131072
    s_nop 0
    buffer_load_dwordx4 v2, s[32:35], 0 offen lds
    s_mov_b32 m0, 143360
    s_mov_b64 exec, s[76:77]
    buffer_load_dwordx4 v5, s[32:35], 0 offen lds
    s_mov_b64 exec, -1
    s_lshl_b32 s72, s70, 2
    s_lshr_b32 s73, s71, 3
    s_add_u32 s28, s72, s73
    s_and_b32 s29, s71, 7
    s_lshl_b32 s72, s70, 5
    s_add_u32 s30, s72, s71
    s_mov_b32 s40, s22
    s_mov_b32 s41, s23
    s_mov_b32 s42, 19922944
    s_mov_b32 s43, 0x20000
    s_getpc_b64 s[80:81]
L_pc:
    s_lshl_b32 s72, s71, 3
    s_add_u32 s72, s72, s24
    s_lshl_b32 s72, s72, 6
    s_add_u32 s80, s80, s72
    s_addc_u32 s81, s81, 0
    s_load_dword s82, s[80:81], 0
    s_load_dword s82, s[80:81], 16384
    s_load_dword s82, s[80:81], 32768
    s_and_b32 s72, s26, 7
    s_lshl_b32 s72, s72, 18
    s_lshl_b32 s73, s24, 11
    s_add_u32 s72, s72, s73
    s_lshl_b32 s73, s27, 7
    s_add_u32 s72, s72, s73
    s_add_u32 s62, s6, s72
    s_addc_u32 s63, s7, 0
    s_load_dword s82, s[62:63], 0
    s_load_dword s82, s[62:63], 64
    s_load_dword s82, s[62:63], 512
    s_load_dword s82, s[62:63], 576
    s_load_dword s82, s[62:63], 1024
    s_load_dword s82, s[62:63], 1088
    s_load_dword s82, s[62:63], 1536
    s_load_dword s82, s[62:63], 1600
    s_load_dword s82, s[62:63], 16384
    s_load_dword s82, s[62:63], 16448
    s_load_dword s82, s[62:63], 16896
    s_load_dword s82, s[62:63], 16960
    s_lshl_b32 s72, s2, 3
    s_add_u32 s72, s72, s24
    s_lshr_b32 s73, s72, 7
    s_min_u32 s73, s73, 14
    s_lshl_b32 s73, s73, 17
    s_and_b32 s72, s72, 127
    s_lshl_b32 s72, s72, 8
    s_add_u32 s72, s72, s73
    s_add_u32 s64, s6, s72
    s_addc_u32 s65, s7, 0
    s_cmp_lt_u32 s24, 4
    s_cbranch_scc1 L_compute
    s_lshl_b32 s73, s25, 4
    s_mov_b64 s[76:77], 0xffff
    s_lshl_b64 s[58:59], s[76:77], s73
    s_mov_b64 s[60:61], s[64:65]
    s_mov_b32 s68, 874517250
    s_mov_b32 s69, 1952470599
    s_add_u32 s73, s25, 8
    s_lshl_b32 s74, s73, 2
    s_lshr_b64 s[76:77], s[68:69], s74
    s_and_b32 s76, s76, 7
    s_lshl_b32 s74, s73, 4
    s_add_u32 s74, s74, s67
    s_sub_u32 s74, s74, 7
    v_lshl_add_u32 v227, v242, 1, s74
    v_xor_b32 v228, s76, v241
    v_lshlrev_b32 v228, 4, v228
    v_lshl_add_u32 v3, v227, 9, v228
    s_add_u32 s73, s25, 12
    s_lshl_b32 s74, s73, 2
    s_lshr_b64 s[76:77], s[68:69], s74
    s_and_b32 s76, s76, 7
    s_lshl_b32 s74, s73, 4
    s_add_u32 s74, s74, s67
    s_sub_u32 s74, s74, 7
    v_lshl_add_u32 v227, v242, 1, s74
    v_xor_b32 v228, s76, v241
    v_lshlrev_b32 v228, 4, v228
    v_lshl_add_u32 v4, v227, 9, v228
    v_add_u32 v6, 512, v1
    v_add_u32 v7, 512, v2
    v_add_u32 v8, 512, v3
    v_add_u32 v9, 512, v4
    v_add_u32 v10, 512, v5
    s_lshl_b32 s68, s27, 2
    s_add_u32 s68, s68, s25
    s_mul_i32 s68, s68, 18
    s_add_u32 s68, s68, s67
    s_sub_u32 s68, s68, 7
    s_max_i32 s68, s68, 0
    s_min_i32 s68, s68, 15982
    s_lshl_b32 s68, s68, 9
    s_add_u32 s74, s4, s68
    s_addc_u32 s75, s5, 0
    s_add_u32 s76, s74, 8192000
    s_addc_u32 s77, s75, 0
    v_and_b32 v230, 15, v0
    v_lshrrev_b32 v231, 4, v0
    v_lshlrev_b32 v31, 4, v0
    v_mov_b32 v35, 0xbdd2d3e8
    s_mov_b32 s49, 0xc0135761
    s_mov_b32 s50, 0x05040100
    s_mov_b32 s51, 0x07060302
    v_mov_b32 v38, 1
    v_mov_b32 v40, 0
    s_lshl_b32 s68, s26, 2
    s_add_u32 s68, s68, s27
    s_lshl_b32 s68, s68, 5
    s_add_u32 s68, s68, s25
    s_lshl_b32 s68, s68, 2
    s_add_u32 s68, s68, 15728640
    s_lshl_b32 s69, s28, 3
    s_add_u32 s69, s69, s29
    s_lshl_b32 s69, s69, 2
    s_add_u32 s69, s69, s25
    s_lshl_b32 s69, s69, 7
    s_add_u32 s69, s69, 15990784
    v_mov_b32 v232, s68
    v_mov_b32 v233, s69
    v_cmp_gt_u32 vcc, 2, v0
    v_and_b32 v234, 1, v0
    s_nop 0
    v_cndmask_b32 v232, v233, v232, vcc
    v_lshl_add_u32 v32, v234, 17, v232
    s_mov_b32 s92, s20
    s_mov_b32 s93, s21
    s_mov_b32 s94, 256
    s_mov_b32 s95, 0x20000
    s_lshl_b32 s68, s2, 2
    s_add_u32 s68, s68, s25
    v_lshlrev_b32 v232, 3, v230
    s_mov_b32 s44, s8
    s_mov_b32 s45, s9
    s_mov_b32 s46, 1966080
    s_mov_b32 s47, 0x20000
    s_cmp_lt_u32 s68, 480
    s_cbranch_scc1 L_prep_w2
    s_cmp_lt_u32 s68, 544
    s_cbranch_scc1 L_prep_fo
    s_mov_b32 s64, 2147483648
    s_mov_b32 s48, 0
    v_mov_b32 v233, 2147483648
    s_mov_b32 s70, 0
    s_mov_b32 s71, 0
    s_mov_b32 s72, 0
    s_mov_b32 s73, 0
L_prep_done:
    v_mov_b32 v16, v233
    s_mov_b32 s55, s70
    s_mov_b32 s65, s71
    s_mov_b32 s66, s72
    v_or_b32 v232, s25, v0
    v_cmp_eq_u32 vcc, 0, v232
    v_mov_b32 v233, 2147483648
    s_nop 0
    v_cndmask_b32 v47, v233, v232, vcc
    v_mov_b32 v12, -1
    v_mov_b32 v13, -1
    v_mov_b32 v14, -1
    v_mov_b32 v15, -1
    s_and_b32 s70, s25, 1
    s_lshl_b32 s71, s70, 3
    s_lshr_b32 s72, s25, 1
    v_lshlrev_b32 v233, 1, v241
    v_or_b32 v233, 0, v233
    v_or_b32 v234, s71, v240
    v_xor_b32 v233, v233, v234
    v_lshlrev_b32 v234, 8, v234
    v_lshl_add_u32 v233, v233, 4, v234
    s_xor_b32 s68, s72, 1
    s_lshl_b32 s68, s68, 12
    v_add_u32 v22, s68, v233
    v_lshlrev_b32 v233, 1, v241
    v_or_b32 v233, 1, v233
    v_or_b32 v234, s71, v240
    v_xor_b32 v233, v233, v234
    v_lshlrev_b32 v234, 8, v234
    v_lshl_add_u32 v233, v233, 4, v234
    s_xor_b32 s68, s72, 1
    s_lshl_b32 s68, s68, 12
    v_add_u32 v23, s68, v233
    s_lshl_b32 s68, s26, 14
    s_lshl_b32 s69, s72, 7
    s_add_u32 s68, s68, s69
    s_lshl_b32 s69, s70, 13
    s_add_u32 s68, s68, s69
    v_lshlrev_b32 v233, 10, v240
    v_lshl_add_u32 v233, v241, 4, v233
    v_add_u32 v26, s68, v233
    s_mul_i32 s68, s25, 2080
    v_and_b32 v236, 7, v230
    v_lshl_add_u32 v235, v230, 7, s68
    v_or_b32 v237, 0, v231
    v_xor_b32 v237, v237, v236
    v_lshl_add_u32 v27, v237, 4, v235
    v_or_b32 v237, 4, v231
    v_xor_b32 v237, v237, v236
    v_lshl_add_u32 v28, v237, 4, v235
    s_cmp_eq_u32 s25, 0
    s_cselect_b64 s[62:63], -1, 0
    s_cselect_b32 s71, 0, 2147483648
    v_mov_b32 v41, s71
    s_lshl_b32 s68, s28, 1
    s_sub_u32 s68, s68, 1
    v_add_u32 v233, s68, v231
    v_cmp_gt_u32 vcc, 64, v233
    v_lshlrev_b32 v233, 9, v233
    v_lshrrev_b32 v234, 2, v230
    v_lshl_add_u32 v233, v234, 7, v233
    v_and_b32 v234, 3, v230
    v_lshl_add_u32 v233, v234, 2, v233
    s_add_u32 s68, s71, 15728640
    v_add_u32 v33, s68, v233
    s_and_b64 s[56:57], vcc, s[62:63]
    s_lshl_b32 s68, s25, 8
    s_add_u32 s68, s68, 62464
    v_lshl_add_u32 v36, v231, 6, s68
    s_lshl_b32 s68, s25, 11
    v_add_u32 v39, s68, v31
    v_add_u32 v46, 78848, v39
    s_lshr_b32 s68, s2, 3
    s_mul_i32 s68, s68, 3
    s_lshr_b32 s79, s68, 5
    s_cmp_eq_u32 s2, 255
    s_cbranch_scc1 L_h_ge
    s_branch L_hmain
.p2align 12
L_compute:
    v_and_b32 v224, 15, v0
    v_lshrrev_b32 v225, 4, v0
    v_lshlrev_b32 v3, 4, v0
    v_mov_b32 v250, v1
    v_mov_b32 v251, v2
    v_mov_b32 v252, v5
    v_mov_b32 v118, v21
    s_lshl_b32 s74, s25, 2
    s_lshr_b64 s[76:77], s[68:69], s74
    s_and_b32 s76, s76, 7
    s_lshl_b32 s74, s25, 4
    s_add_u32 s74, s74, s67
    s_sub_u32 s74, s74, 7
    v_lshl_add_u32 v232, v242, 1, s74
    v_xor_b32 v233, s76, v241
    v_lshlrev_b32 v233, 4, v233
    v_lshl_add_u32 v248, v232, 9, v233
    s_add_u32 s73, s25, 4
    s_lshl_b32 s74, s73, 2
    s_lshr_b64 s[76:77], s[68:69], s74
    s_and_b32 s76, s76, 7
    s_lshl_b32 s74, s73, 4
    s_add_u32 s74, s74, s67
    s_sub_u32 s74, s74, 7
    v_lshl_add_u32 v232, v242, 1, s74
    v_xor_b32 v233, s76, v241
    v_lshlrev_b32 v233, 4, v233
    v_lshl_add_u32 v249, v232, 9, v233
    v_add_u32 v253, 512, v248
    v_add_u32 v254, 512, v249
    v_add_u32 v255, 512, v250
    v_add_u32 v116, 512, v251
    v_add_u32 v117, 512, v252
    s_lshl_b32 s73, s25, 4
    s_mov_b64 s[76:77], 0xffff
    s_lshl_b64 s[62:63], s[76:77], s73
    s_sub_u32 s61, s28, s26
    s_lshl_b32 s61, s61, 15
    s_mov_b32 s44, s20
    s_mov_b32 s45, s21
    s_mov_b32 s46, 256
    s_mov_b32 s47, 0x20000
    v_or_b32 v232, s25, v0
    v_cmp_eq_u32 vcc, 0, v232
    v_mov_b32 v233, 2147483648
    v_mov_b32 v217, 1
    v_cndmask_b32 v216, v233, v232, vcc
    v_lshlrev_b32 v226, 2, v224
    s_mov_b32 s48, 874517250
    s_mov_b32 s49, 1952470599
    s_mov_b32 s50, 1933705520
    s_mov_b32 s51, 658900324
    v_lshrrev_b64 v[228:229], v226, s[48:49]
    v_lshrrev_b64 v[230:231], v226, s[50:51]
    v_and_b32 v228, 7, v228
    v_and_b32 v230, 7, v230
    s_lshr_b32 s52, s25, 1
    s_and_b32 s53, s25, 1
    s_lshl_b32 s54, s52, 2
    v_add_u32 v232, 0, v224
    v_and_b32 v233, 1, v232
    v_lshlrev_b32 v232, 10, v232
    v_add_u32 v232, 92160, v232
    v_xor_b32 v234, 0, v233
    v_lshl_add_u32 v234, v234, 7, v232
    v_or_b32 v235, 0, v225
    v_xor_b32 v235, v235, v228
    v_lshl_add_u32 v12, v235, 4, v234
    v_or_b32 v235, 4, v225
    v_xor_b32 v235, v235, v228
    v_lshl_add_u32 v13, v235, 4, v234
    v_or_b32 v235, s54, v225
    v_xor_b32 v235, v235, v228
    v_lshl_add_u32 v8, v235, 4, v234
    v_xor_b32 v234, 1, v233
    v_lshl_add_u32 v234, v234, 7, v232
    v_or_b32 v235, 0, v225
    v_xor_b32 v235, v235, v228
    v_lshl_add_u32 v14, v235, 4, v234
    v_or_b32 v235, 4, v225
    v_xor_b32 v235, v235, v228
    v_lshl_add_u32 v15, v235, 4, v234
    v_or_b32 v235, s54, v225
    v_xor_b32 v235, v235, v228
    v_lshl_add_u32 v9, v235, 4, v234
    v_add_u32 v232, 1, v224
    v_and_b32 v233, 1, v232
    v_lshlrev_b32 v232, 10, v232
    v_add_u32 v232, 92160, v232
    v_xor_b32 v234, 0, v233
    v_lshl_add_u32 v234, v234, 7, v232
    v_or_b32 v235, 0, v225
    v_xor_b32 v235, v235, v230
    v_lshl_add_u32 v16, v235, 4, v234
    v_or_b32 v235, 4, v225
    v_xor_b32 v235, v235, v230
    v_lshl_add_u32 v17, v235, 4, v234
    v_or_b32 v235, s54, v225
    v_xor_b32 v235, v235, v230
    v_lshl_add_u32 v10, v235, 4, v234
    v_xor_b32 v234, 1, v233
    v_lshl_add_u32 v234, v234, 7, v232
    v_or_b32 v235, 0, v225
    v_xor_b32 v235, v235, v230
    v_lshl_add_u32 v18, v235, 4, v234
    v_or_b32 v235, 4, v225
    v_xor_b32 v235, v235, v230
    v_lshl_add_u32 v19, v235, 4, v234
    v_or_b32 v235, s54, v225
    v_xor_b32 v235, v235, v230
    v_lshl_add_u32 v11, v235, 4, v234
    v_lshrrev_b32 v232, 2, v224
    v_and_b32 v233, 3, v224
    v_and_b32 v234, 2, v232
    v_and_b32 v235, 1, v225
    v_lshl_add_u32 v234, v235, 2, v234
    s_lshl_b32 s55, s25, 1
    v_lshrrev_b32 v235, 1, v233
    v_add_u32 v235, s55, v235
    v_xor_b32 v235, v235, v234
    v_lshlrev_b32 v236, 10, v225
    v_lshl_add_u32 v236, v232, 7, v236
    v_lshl_add_u32 v236, v235, 4, v236
    v_and_b32 v233, 1, v233
    v_lshl_add_u32 v20, v233, 3, v236
    v_add_u32 v21, 61440, v20
    v_subrev_u32 v184, 48128, v12
    v_subrev_u32 v185, 48128, v13
    v_subrev_u32 v186, 48128, v14
    v_subrev_u32 v187, 48128, v15
    v_subrev_u32 v188, 48128, v16
    v_subrev_u32 v189, 48128, v17
    v_subrev_u32 v190, 48128, v18
    v_subrev_u32 v191, 48128, v19
    s_lshl_b32 s55, s25, 2
    v_add_u32 v232, s55, v225
    v_xor_b32 v232, v232, v224
    v_lshlrev_b32 v233, 8, v224
    v_lshl_add_u32 v22, v232, 4, v233
    s_lshl_b32 s55, s53, 2
    v_add_u32 v232, s55, v225
    v_and_b32 v233, 7, v224
    v_xor_b32 v232, v232, v233
    v_lshlrev_b32 v233, 7, v224
    v_lshl_add_u32 v232, v232, 4, v233
    s_mul_i32 s55, s52, 16640
    v_add_u32 v1, s55, v232
    v_add_u32 v4, 78848, v3
    s_lshl_b32 s55, s29, 1
    s_add_u32 s55, s55, s53
    s_lshl_b32 s55, s55, 3
    s_add_u32 s55, s55, s52
    s_lshl_b32 s55, s55, 14
    s_add_u32 s55, s55, 12582912
    v_add_u32 v23, s55, v3
    s_lshl_b32 s55, s25, 15
    s_add_u32 s55, s55, 14811136
    v_add_u32 v2, s55, v3
    s_lshl_b32 s55, s28, 19
    s_lshl_b32 s56, s25, 7
    s_add_u32 s55, s55, s56
    s_lshl_b32 s56, s29, 12
    s_add_u32 s55, s55, s56
    v_lshlrev_b32 v232, 17, v225
    v_lshl_add_u32 v232, v224, 3, v232
    v_add_u32 v5, s55, v232
    s_mov_b32 s56, 0
    s_mov_b32 s57, 32768
    s_mov_b32 s58, 65536
    s_mov_b32 s59, 98304
    s_cmp_eq_u32 s2, 255
    s_cbranch_scc1 L_c_ge
    s_waitcnt lgkmcnt(0)
    s_waitcnt vmcnt(3)
    s_barrier
    ds_read_b64_tr_b16 v[120:121], v21 offset:0
    ds_read_b64_tr_b16 v[122:123], v21 offset:512
    ds_read_b128 v[56:59], v12 offset:52224
    ds_read_b64_tr_b16 v[124:125], v21 offset:4096
    ds_read_b64_tr_b16 v[126:127], v21 offset:4608
    ds_read_b128 v[60:63], v14 offset:52224
    ds_read_b64_tr_b16 v[128:129], v21 offset:8192
    ds_read_b64_tr_b16 v[130:131], v21 offset:8704
    ds_read_b128 v[64:67], v12 offset:52480
    ds_read_b64_tr_b16 v[132:133], v21 offset:12288
    ds_read_b64_tr_b16 v[134:135], v21 offset:12800
    ds_read_b128 v[68:71], v14 offset:52480
    ds_read_b64_tr_b16 v[136:137], v21 offset:16384
    ds_read_b64_tr_b16 v[138:139], v21 offset:16896
    ds_read_b128 v[72:75], v12 offset:52736
    ds_read_b64_tr_b16 v[140:141], v21 offset:20480
    ds_read_b64_tr_b16 v[142:143], v21 offset:20992
    ds_read_b128 v[76:79], v14 offset:52736
    ds_read_b64_tr_b16 v[144:145], v21 offset:24576
    ds_read_b64_tr_b16 v[146:147], v21 offset:25088
    ds_read_b128 v[80:83], v12 offset:52992
    ds_read_b64_tr_b16 v[148:149], v21 offset:28672
    ds_read_b64_tr_b16 v[150:151], v21 offset:29184
    ds_read_b128 v[84:87], v14 offset:52992
    s_waitcnt lgkmcnt(15)
    v_mfma_f32_16x16x32_bf16 v[216:219], v[120:123], v[56:59], 0
    ds_read_b128 v[88:91], v16 offset:52224
    v_mfma_f32_16x16x32_bf16 v[216:219], v[124:127], v[60:63], v[216:219]
    v_mfma_f32_16x16x32_bf16 v[216:219], v[128:131], v[64:67], v[216:219]
    s_waitcnt lgkmcnt(13)
    v_mfma_f32_16x16x32_bf16 v[216:219], v[132:135], v[68:71], v[216:219]
    ds_read_b128 v[92:95], v18 offset:52224
    s_waitcnt lgkmcnt(11)
    v_mfma_f32_16x16x32_bf16 v[216:219], v[136:139], v[72:75], v[216:219]
    s_waitcnt lgkmcnt(8)
    v_mfma_f32_16x16x32_bf16 v[216:219], v[140:143], v[76:79], v[216:219]
    s_waitcnt lgkmcnt(5)
    v_mfma_f32_16x16x32_bf16 v[216:219], v[144:147], v[80:83], v[216:219]
    ds_read_b128 v[96:99], v16 offset:52480
    s_waitcnt lgkmcnt(3)
    v_mfma_f32_16x16x32_bf16 v[216:219], v[148:151], v[84:87], v[216:219]
    v_mfma_f32_16x16x32_bf16 v[220:223], v[120:123], v[60:63], 0
    v_mfma_f32_16x16x32_bf16 v[220:223], v[124:127], v[64:67], v[220:223]
    ds_read_b128 v[100:103], v18 offset:52480
    v_mfma_f32_16x16x32_bf16 v[220:223], v[128:131], v[68:71], v[220:223]
    v_mfma_f32_16x16x32_bf16 v[220:223], v[132:135], v[72:75], v[220:223]
    v_mfma_f32_16x16x32_bf16 v[220:223], v[136:139], v[76:79], v[220:223]
    ds_read_b128 v[104:107], v16 offset:52736
    v_mfma_f32_16x16x32_bf16 v[220:223], v[140:143], v[80:83], v[220:223]
    v_mfma_f32_16x16x32_bf16 v[220:223], v[144:147], v[84:87], v[220:223]
    s_waitcnt lgkmcnt(3)
    v_mfma_f32_16x16x32_bf16 v[220:223], v[148:151], v[88:91], v[220:223]
    ds_read_b128 v[108:111], v18 offset:52736
    v_mfma_f32_16x16x32_bf16 v[224:227], v[120:123], v[64:67], 0
    v_mfma_f32_16x16x32_bf16 v[224:227], v[124:127], v[68:71], v[224:227]
    v_mfma_f32_16x16x32_bf16 v[224:227], v[128:131], v[72:75], v[224:227]
    ds_read_b128 v[112:115], v16 offset:52992
    v_mfma_f32_16x16x32_bf16 v[224:227], v[132:135], v[76:79], v[224:227]
    v_mfma_f32_16x16x32_bf16 v[224:227], v[136:139], v[80:83], v[224:227]
    v_mfma_f32_16x16x32_bf16 v[224:227], v[140:143], v[84:87], v[224:227]
    v_mfma_f32_16x16x32_bf16 v[224:227], v[144:147], v[88:91], v[224:227]
    v_mfma_f32_16x16x32_bf16 v[224:227], v[148:151], v[92:95], v[224:227]
    v_mfma_f32_16x16x32_bf16 v[228:231], v[120:123], v[68:71], 0
    v_mfma_f32_16x16x32_bf16 v[228:231], v[124:127], v[72:75], v[228:231]
    v_mfma_f32_16x16x32_bf16 v[228:231], v[128:131], v[76:79], v[228:231]
    v_mfma_f32_16x16x32_bf16 v[228:231], v[132:135], v[80:83], v[228:231]
    v_mfma_f32_16x16x32_bf16 v[228:231], v[136:139], v[84:87], v[228:231]
    v_mfma_f32_16x16x32_bf16 v[228:231], v[140:143], v[88:91], v[228:231]
    v_mfma_f32_16x16x32_bf16 v[228:231], v[144:147], v[92:95], v[228:231]
    s_waitcnt lgkmcnt(0)
    v_mfma_f32_16x16x32_bf16 v[228:231], v[148:151], v[96:99], v[228:231]
    s_waitcnt vmcnt(0)
    s_barrier
    v_mfma_f32_16x16x32_bf16 v[232:235], v[120:123], v[72:75], 0
    ds_read_b128 v[56:59], v12 offset:34816
    v_mfma_f32_16x16x32_bf16 v[232:235], v[124:127], v[76:79], v[232:235]
    v_mfma_f32_16x16x32_bf16 v[232:235], v[128:131], v[80:83], v[232:235]
    ds_read_b128 v[60:63], v14 offset:34816
    v_mfma_f32_16x16x32_bf16 v[232:235], v[132:135], v[84:87], v[232:235]
    v_mfma_f32_16x16x32_bf16 v[232:235], v[136:139], v[88:91], v[232:235]
    ds_read_b128 v[64:67], v12 offset:35072
    v_mfma_f32_16x16x32_bf16 v[232:235], v[140:143], v[92:95], v[232:235]
    v_mfma_f32_16x16x32_bf16 v[232:235], v[144:147], v[96:99], v[232:235]
    v_mfma_f32_16x16x32_bf16 v[232:235], v[148:151], v[100:103], v[232:235]
    v_mfma_f32_16x16x32_bf16 v[236:239], v[120:123], v[76:79], 0
    ds_read_b128 v[68:71], v14 offset:35072
    v_mfma_f32_16x16x32_bf16 v[236:239], v[124:127], v[80:83], v[236:239]
    v_mfma_f32_16x16x32_bf16 v[236:239], v[128:131], v[84:87], v[236:239]
    ds_read_b128 v[72:75], v12 offset:35328
    v_mfma_f32_16x16x32_bf16 v[236:239], v[132:135], v[88:91], v[236:239]
    v_mfma_f32_16x16x32_bf16 v[236:239], v[136:139], v[92:95], v[236:239]
    ds_read_b128 v[76:79], v14 offset:35328
    v_mfma_f32_16x16x32_bf16 v[236:239], v[140:143], v[96:99], v[236:239]
    v_mfma_f32_16x16x32_bf16 v[236:239], v[144:147], v[100:103], v[236:239]
    v_mfma_f32_16x16x32_bf16 v[236:239], v[148:151], v[104:107], v[236:239]
    v_mfma_f32_16x16x32_bf16 v[240:243], v[120:123], v[80:83], 0
    v_mfma_f32_16x16x32_bf16 v[240:243], v[124:127], v[84:87], v[240:243]
    v_mfma_f32_16x16x32_bf16 v[240:243], v[128:131], v[88:91], v[240:243]
    ds_read_b128 v[80:83], v12 offset:35584
    v_mfma_f32_16x16x32_bf16 v[240:243], v[132:135], v[92:95], v[240:243]
    v_mfma_f32_16x16x32_bf16 v[240:243], v[136:139], v[96:99], v[240:243]
    v_mfma_f32_16x16x32_bf16 v[240:243], v[140:143], v[100:103], v[240:243]
    v_mfma_f32_16x16x32_bf16 v[240:243], v[144:147], v[104:107], v[240:243]
    v_mfma_f32_16x16x32_bf16 v[240:243], v[148:151], v[108:111], v[240:243]
    v_mfma_f32_16x16x32_bf16 v[244:247], v[120:123], v[84:87], 0
    v_mfma_f32_16x16x32_bf16 v[244:247], v[124:127], v[88:91], v[244:247]
    ds_read_b128 v[84:87], v14 offset:35584
    v_mfma_f32_16x16x32_bf16 v[244:247], v[128:131], v[92:95], v[244:247]
    v_mfma_f32_16x16x32_bf16 v[244:247], v[132:135], v[96:99], v[244:247]
    v_mfma_f32_16x16x32_bf16 v[244:247], v[136:139], v[100:103], v[244:247]
    v_mfma_f32_16x16x32_bf16 v[244:247], v[140:143], v[104:107], v[244:247]
    v_mfma_f32_16x16x32_bf16 v[244:247], v[144:147], v[108:111], v[244:247]
    v_mfma_f32_16x16x32_bf16 v[244:247], v[148:151], v[112:115], v[244:247]
    s_waitcnt lgkmcnt(1)
    v_mfma_f32_16x16x32_bf16 v[24:27], v[120:123], v[56:59], 0
    ds_read_b128 v[88:91], v16 offset:34816
    v_mfma_f32_16x16x32_bf16 v[24:27], v[124:127], v[60:63], v[24:27]
    v_mfma_f32_16x16x32_bf16 v[24:27], v[128:131], v[64:67], v[24:27]
    v_mfma_f32_16x16x32_bf16 v[24:27], v[132:135], v[68:71], v[24:27]
    ds_read_b128 v[92:95], v18 offset:34816
    v_mfma_f32_16x16x32_bf16 v[24:27], v[136:139], v[72:75], v[24:27]
    v_mfma_f32_16x16x32_bf16 v[24:27], v[140:143], v[76:79], v[24:27]
    v_mfma_f32_16x16x32_bf16 v[24:27], v[144:147], v[80:83], v[24:27]
    ds_read_b128 v[96:99], v16 offset:35072
    s_waitcnt lgkmcnt(3)
    v_mfma_f32_16x16x32_bf16 v[24:27], v[148:151], v[84:87], v[24:27]
    v_mfma_f32_16x16x32_bf16 v[28:31], v[120:123], v[60:63], 0
    v_mfma_f32_16x16x32_bf16 v[28:31], v[124:127], v[64:67], v[28:31]
    ds_read_b128 v[100:103], v18 offset:35072
    v_mfma_f32_16x16x32_bf16 v[28:31], v[128:131], v[68:71], v[28:31]
    v_mfma_f32_16x16x32_bf16 v[28:31], v[132:135], v[72:75], v[28:31]
    v_mfma_f32_16x16x32_bf16 v[28:31], v[136:139], v[76:79], v[28:31]
    ds_read_b128 v[104:107], v16 offset:35328
    v_mfma_f32_16x16x32_bf16 v[28:31], v[140:143], v[80:83], v[28:31]
    v_mfma_f32_16x16x32_bf16 v[28:31], v[144:147], v[84:87], v[28:31]
    s_waitcnt lgkmcnt(3)
    v_mfma_f32_16x16x32_bf16 v[28:31], v[148:151], v[88:91], v[28:31]
    ds_read_b128 v[108:111], v18 offset:35328
    v_mfma_f32_16x16x32_bf16 v[32:35], v[120:123], v[64:67], 0
    v_mfma_f32_16x16x32_bf16 v[32:35], v[124:127], v[68:71], v[32:35]
    v_mfma_f32_16x16x32_bf16 v[32:35], v[128:131], v[72:75], v[32:35]
    ds_read_b128 v[112:115], v16 offset:35584
    v_mfma_f32_16x16x32_bf16 v[32:35], v[132:135], v[76:79], v[32:35]
    v_mfma_f32_16x16x32_bf16 v[32:35], v[136:139], v[80:83], v[32:35]
    v_mfma_f32_16x16x32_bf16 v[32:35], v[140:143], v[84:87], v[32:35]
    v_mfma_f32_16x16x32_bf16 v[32:35], v[144:147], v[88:91], v[32:35]
    v_mfma_f32_16x16x32_bf16 v[32:35], v[148:151], v[92:95], v[32:35]
    v_mfma_f32_16x16x32_bf16 v[36:39], v[120:123], v[68:71], 0
    v_mfma_f32_16x16x32_bf16 v[36:39], v[124:127], v[72:75], v[36:39]
    v_mfma_f32_16x16x32_bf16 v[36:39], v[128:131], v[76:79], v[36:39]
    v_mfma_f32_16x16x32_bf16 v[36:39], v[132:135], v[80:83], v[36:39]
    v_mfma_f32_16x16x32_bf16 v[36:39], v[136:139], v[84:87], v[36:39]
    v_mfma_f32_16x16x32_bf16 v[36:39], v[140:143], v[88:91], v[36:39]
    v_mfma_f32_16x16x32_bf16 v[36:39], v[144:147], v[92:95], v[36:39]
    s_waitcnt lgkmcnt(0)
    v_mfma_f32_16x16x32_bf16 v[36:39], v[148:151], v[96:99], v[36:39]
    s_barrier
    v_mfma_f32_16x16x32_bf16 v[40:43], v[120:123], v[72:75], 0
    ds_read_b64_tr_b16 v[152:153], v21 offset:32768
    v_mfma_f32_16x16x32_bf16 v[40:43], v[124:127], v[76:79], v[40:43]
    ds_read_b64_tr_b16 v[154:155], v21 offset:33280
    v_mfma_f32_16x16x32_bf16 v[40:43], v[128:131], v[80:83], v[40:43]
    ds_read_b128 v[56:59], v13 offset:52224
    v_mfma_f32_16x16x32_bf16 v[40:43], v[132:135], v[84:87], v[40:43]
    ds_read_b64_tr_b16 v[156:157], v21 offset:36864
    v_mfma_f32_16x16x32_bf16 v[40:43], v[136:139], v[88:91], v[40:43]
    ds_read_b64_tr_b16 v[158:159], v21 offset:37376
    v_mfma_f32_16x16x32_bf16 v[40:43], v[140:143], v[92:95], v[40:43]
    ds_read_b128 v[60:63], v15 offset:52224
    v_mfma_f32_16x16x32_bf16 v[40:43], v[144:147], v[96:99], v[40:43]
    ds_read_b64_tr_b16 v[160:161], v21 offset:40960
    v_mfma_f32_16x16x32_bf16 v[40:43], v[148:151], v[100:103], v[40:43]
    ds_read_b64_tr_b16 v[162:163], v21 offset:41472
    v_mfma_f32_16x16x32_bf16 v[44:47], v[120:123], v[76:79], 0
    ds_read_b128 v[64:67], v13 offset:52480
    v_mfma_f32_16x16x32_bf16 v[44:47], v[124:127], v[80:83], v[44:47]
    ds_read_b64_tr_b16 v[164:165], v21 offset:45056
    v_mfma_f32_16x16x32_bf16 v[44:47], v[128:131], v[84:87], v[44:47]
    ds_read_b64_tr_b16 v[166:167], v21 offset:45568
    v_mfma_f32_16x16x32_bf16 v[44:47], v[132:135], v[88:91], v[44:47]
    ds_read_b128 v[68:71], v15 offset:52480
    v_mfma_f32_16x16x32_bf16 v[44:47], v[136:139], v[92:95], v[44:47]
    ds_read_b64_tr_b16 v[168:169], v21 offset:49152
    v_mfma_f32_16x16x32_bf16 v[44:47], v[140:143], v[96:99], v[44:47]
    ds_read_b64_tr_b16 v[170:171], v21 offset:49664
    v_mfma_f32_16x16x32_bf16 v[44:47], v[144:147], v[100:103], v[44:47]
    ds_read_b128 v[72:75], v13 offset:52736
    v_mfma_f32_16x16x32_bf16 v[44:47], v[148:151], v[104:107], v[44:47]
    ds_read_b64_tr_b16 v[172:173], v21 offset:53248
    v_mfma_f32_16x16x32_bf16 v[48:51], v[120:123], v[80:83], 0
    ds_read_b64_tr_b16 v[174:175], v21 offset:53760
    v_mfma_f32_16x16x32_bf16 v[48:51], v[124:127], v[84:87], v[48:51]
    ds_read_b128 v[76:79], v15 offset:52736
    v_mfma_f32_16x16x32_bf16 v[48:51], v[128:131], v[88:91], v[48:51]
    ds_read_b64_tr_b16 v[176:177], v21 offset:57344
    v_mfma_f32_16x16x32_bf16 v[48:51], v[132:135], v[92:95], v[48:51]
    ds_read_b64_tr_b16 v[178:179], v21 offset:57856
    v_mfma_f32_16x16x32_bf16 v[48:51], v[136:139], v[96:99], v[48:51]
    ds_read_b128 v[80:83], v13 offset:52992
    v_mfma_f32_16x16x32_bf16 v[48:51], v[140:143], v[100:103], v[48:51]
    ds_read_b64_tr_b16 v[180:181], v21 offset:61440
    v_mfma_f32_16x16x32_bf16 v[48:51], v[144:147], v[104:107], v[48:51]
    ds_read_b64_tr_b16 v[182:183], v21 offset:61952
    v_mfma_f32_16x16x32_bf16 v[48:51], v[148:151], v[108:111], v[48:51]
    v_mfma_f32_16x16x32_bf16 v[52:55], v[120:123], v[84:87], 0
    v_mfma_f32_16x16x32_bf16 v[52:55], v[124:127], v[88:91], v[52:55]
    ds_read_b128 v[84:87], v15 offset:52992
    v_mfma_f32_16x16x32_bf16 v[52:55], v[128:131], v[92:95], v[52:55]
    v_mfma_f32_16x16x32_bf16 v[52:55], v[132:135], v[96:99], v[52:55]
    v_mfma_f32_16x16x32_bf16 v[52:55], v[136:139], v[100:103], v[52:55]
    v_mfma_f32_16x16x32_bf16 v[52:55], v[140:143], v[104:107], v[52:55]
    v_mfma_f32_16x16x32_bf16 v[52:55], v[144:147], v[108:111], v[52:55]
    v_mfma_f32_16x16x32_bf16 v[52:55], v[148:151], v[112:115], v[52:55]
    s_waitcnt lgkmcnt(2)
    v_mfma_f32_16x16x32_bf16 v[216:219], v[152:155], v[56:59], v[216:219]
    ds_read_b128 v[88:91], v17 offset:52224
    v_mfma_f32_16x16x32_bf16 v[216:219], v[156:159], v[60:63], v[216:219]
    v_mfma_f32_16x16x32_bf16 v[216:219], v[160:163], v[64:67], v[216:219]
    v_mfma_f32_16x16x32_bf16 v[216:219], v[164:167], v[68:71], v[216:219]
    ds_read_b128 v[92:95], v19 offset:52224
    v_mfma_f32_16x16x32_bf16 v[216:219], v[168:171], v[72:75], v[216:219]
    v_mfma_f32_16x16x32_bf16 v[216:219], v[172:175], v[76:79], v[216:219]
    v_mfma_f32_16x16x32_bf16 v[216:219], v[176:179], v[80:83], v[216:219]
    ds_read_b128 v[96:99], v17 offset:52480
    s_waitcnt lgkmcnt(3)
    v_mfma_f32_16x16x32_bf16 v[216:219], v[180:183], v[84:87], v[216:219]
    v_mfma_f32_16x16x32_bf16 v[220:223], v[152:155], v[60:63], v[220:223]
    v_mfma_f32_16x16x32_bf16 v[220:223], v[156:159], v[64:67], v[220:223]
    ds_read_b128 v[100:103], v19 offset:52480
    v_mfma_f32_16x16x32_bf16 v[220:223], v[160:163], v[68:71], v[220:223]
    v_mfma_f32_16x16x32_bf16 v[220:223], v[164:167], v[72:75], v[220:223]
    v_mfma_f32_16x16x32_bf16 v[220:223], v[168:171], v[76:79], v[220:223]
    ds_read_b128 v[104:107], v17 offset:52736
    v_mfma_f32_16x16x32_bf16 v[220:223], v[172:175], v[80:83], v[220:223]
    v_mfma_f32_16x16x32_bf16 v[220:223], v[176:179], v[84:87], v[220:223]
    s_waitcnt lgkmcnt(3)
    v_mfma_f32_16x16x32_bf16 v[220:223], v[180:183], v[88:91], v[220:223]
    ds_read_b128 v[108:111], v19 offset:52736
    v_mfma_f32_16x16x32_bf16 v[224:227], v[152:155], v[64:67], v[224:227]
    v_mfma_f32_16x16x32_bf16 v[224:227], v[156:159], v[68:71], v[224:227]
    v_mfma_f32_16x16x32_bf16 v[224:227], v[160:163], v[72:75], v[224:227]
    ds_read_b128 v[112:115], v17 offset:52992
    v_mfma_f32_16x16x32_bf16 v[224:227], v[164:167], v[76:79], v[224:227]
    v_mfma_f32_16x16x32_bf16 v[224:227], v[168:171], v[80:83], v[224:227]
    v_mfma_f32_16x16x32_bf16 v[224:227], v[172:175], v[84:87], v[224:227]
    v_mfma_f32_16x16x32_bf16 v[224:227], v[176:179], v[88:91], v[224:227]
    v_mfma_f32_16x16x32_bf16 v[224:227], v[180:183], v[92:95], v[224:227]
    v_mfma_f32_16x16x32_bf16 v[228:231], v[152:155], v[68:71], v[228:231]
    v_mfma_f32_16x16x32_bf16 v[228:231], v[156:159], v[72:75], v[228:231]
    v_mfma_f32_16x16x32_bf16 v[228:231], v[160:163], v[76:79], v[228:231]
    v_mfma_f32_16x16x32_bf16 v[228:231], v[164:167], v[80:83], v[228:231]
    v_mfma_f32_16x16x32_bf16 v[228:231], v[168:171], v[84:87], v[228:231]
    v_mfma_f32_16x16x32_bf16 v[228:231], v[172:175], v[88:91], v[228:231]
    v_mfma_f32_16x16x32_bf16 v[228:231], v[176:179], v[92:95], v[228:231]
    s_waitcnt lgkmcnt(0)
    v_mfma_f32_16x16x32_bf16 v[228:231], v[180:183], v[96:99], v[228:231]
    s_barrier
    v_mfma_f32_16x16x32_bf16 v[232:235], v[152:155], v[72:75], v[232:235]
    ds_read_b128 v[56:59], v13 offset:34816
    v_mfma_f32_16x16x32_bf16 v[232:235], v[156:159], v[76:79], v[232:235]
    v_mfma_f32_16x16x32_bf16 v[232:235], v[160:163], v[80:83], v[232:235]
    ds_read_b128 v[60:63], v15 offset:34816
    v_mfma_f32_16x16x32_bf16 v[232:235], v[164:167], v[84:87], v[232:235]
    v_mfma_f32_16x16x32_bf16 v[232:235], v[168:171], v[88:91], v[232:235]
    ds_read_b128 v[64:67], v13 offset:35072
    v_mfma_f32_16x16x32_bf16 v[232:235], v[172:175], v[92:95], v[232:235]
    v_mfma_f32_16x16x32_bf16 v[232:235], v[176:179], v[96:99], v[232:235]
    v_mfma_f32_16x16x32_bf16 v[232:235], v[180:183], v[100:103], v[232:235]
    v_mfma_f32_16x16x32_bf16 v[236:239], v[152:155], v[76:79], v[236:239]
    ds_read_b128 v[68:71], v15 offset:35072
    v_mfma_f32_16x16x32_bf16 v[236:239], v[156:159], v[80:83], v[236:239]
    v_mfma_f32_16x16x32_bf16 v[236:239], v[160:163], v[84:87], v[236:239]
    ds_read_b128 v[72:75], v13 offset:35328
    v_mfma_f32_16x16x32_bf16 v[236:239], v[164:167], v[88:91], v[236:239]
    v_mfma_f32_16x16x32_bf16 v[236:239], v[168:171], v[92:95], v[236:239]
    ds_read_b128 v[76:79], v15 offset:35328
    v_mfma_f32_16x16x32_bf16 v[236:239], v[172:175], v[96:99], v[236:239]
    v_mfma_f32_16x16x32_bf16 v[236:239], v[176:179], v[100:103], v[236:239]
    v_mfma_f32_16x16x32_bf16 v[236:239], v[180:183], v[104:107], v[236:239]
    v_mfma_f32_16x16x32_bf16 v[240:243], v[152:155], v[80:83], v[240:243]
    v_mfma_f32_16x16x32_bf16 v[240:243], v[156:159], v[84:87], v[240:243]
    v_mfma_f32_16x16x32_bf16 v[240:243], v[160:163], v[88:91], v[240:243]
    ds_read_b128 v[80:83], v13 offset:35584
    v_mfma_f32_16x16x32_bf16 v[240:243], v[164:167], v[92:95], v[240:243]
    v_mfma_f32_16x16x32_bf16 v[240:243], v[168:171], v[96:99], v[240:243]
    v_mfma_f32_16x16x32_bf16 v[240:243], v[172:175], v[100:103], v[240:243]
    v_mfma_f32_16x16x32_bf16 v[240:243], v[176:179], v[104:107], v[240:243]
    v_mfma_f32_16x16x32_bf16 v[240:243], v[180:183], v[108:111], v[240:243]
    v_mfma_f32_16x16x32_bf16 v[244:247], v[152:155], v[84:87], v[244:247]
    v_mfma_f32_16x16x32_bf16 v[244:247], v[156:159], v[88:91], v[244:247]
    ds_read_b128 v[84:87], v15 offset:35584
    v_mfma_f32_16x16x32_bf16 v[244:247], v[160:163], v[92:95], v[244:247]
    v_mfma_f32_16x16x32_bf16 v[244:247], v[164:167], v[96:99], v[244:247]
    v_mfma_f32_16x16x32_bf16 v[244:247], v[168:171], v[100:103], v[244:247]
    v_mfma_f32_16x16x32_bf16 v[244:247], v[172:175], v[104:107], v[244:247]
    v_mfma_f32_16x16x32_bf16 v[244:247], v[176:179], v[108:111], v[244:247]
    v_mfma_f32_16x16x32_bf16 v[244:247], v[180:183], v[112:115], v[244:247]
    s_waitcnt lgkmcnt(1)
    v_mfma_f32_16x16x32_bf16 v[24:27], v[152:155], v[56:59], v[24:27]
    ds_read_b128 v[88:91], v17 offset:34816
    v_mfma_f32_16x16x32_bf16 v[24:27], v[156:159], v[60:63], v[24:27]
    v_mfma_f32_16x16x32_bf16 v[24:27], v[160:163], v[64:67], v[24:27]
    v_mfma_f32_16x16x32_bf16 v[24:27], v[164:167], v[68:71], v[24:27]
    ds_read_b128 v[92:95], v19 offset:34816
    v_mfma_f32_16x16x32_bf16 v[24:27], v[168:171], v[72:75], v[24:27]
    v_mfma_f32_16x16x32_bf16 v[24:27], v[172:175], v[76:79], v[24:27]
    v_mfma_f32_16x16x32_bf16 v[24:27], v[176:179], v[80:83], v[24:27]
    ds_read_b128 v[96:99], v17 offset:35072
    s_waitcnt lgkmcnt(3)
    v_mfma_f32_16x16x32_bf16 v[24:27], v[180:183], v[84:87], v[24:27]
    v_mfma_f32_16x16x32_bf16 v[28:31], v[152:155], v[60:63], v[28:31]
    v_mfma_f32_16x16x32_bf16 v[28:31], v[156:159], v[64:67], v[28:31]
    ds_read_b128 v[100:103], v19 offset:35072
    v_mfma_f32_16x16x32_bf16 v[28:31], v[160:163], v[68:71], v[28:31]
    v_mfma_f32_16x16x32_bf16 v[28:31], v[164:167], v[72:75], v[28:31]
    v_mfma_f32_16x16x32_bf16 v[28:31], v[168:171], v[76:79], v[28:31]
    ds_read_b128 v[104:107], v17 offset:35328
    v_mfma_f32_16x16x32_bf16 v[28:31], v[172:175], v[80:83], v[28:31]
    v_mfma_f32_16x16x32_bf16 v[28:31], v[176:179], v[84:87], v[28:31]
    s_waitcnt lgkmcnt(3)
    v_mfma_f32_16x16x32_bf16 v[28:31], v[180:183], v[88:91], v[28:31]
    ds_read_b128 v[108:111], v19 offset:35328
    v_mfma_f32_16x16x32_bf16 v[32:35], v[152:155], v[64:67], v[32:35]
    v_mfma_f32_16x16x32_bf16 v[32:35], v[156:159], v[68:71], v[32:35]
    v_mfma_f32_16x16x32_bf16 v[32:35], v[160:163], v[72:75], v[32:35]
    ds_read_b128 v[112:115], v17 offset:35584
    v_mfma_f32_16x16x32_bf16 v[32:35], v[164:167], v[76:79], v[32:35]
    v_mfma_f32_16x16x32_bf16 v[32:35], v[168:171], v[80:83], v[32:35]
    v_mfma_f32_16x16x32_bf16 v[32:35], v[172:175], v[84:87], v[32:35]
    v_mfma_f32_16x16x32_bf16 v[32:35], v[176:179], v[88:91], v[32:35]
    v_mfma_f32_16x16x32_bf16 v[32:35], v[180:183], v[92:95], v[32:35]
    v_mfma_f32_16x16x32_bf16 v[36:39], v[152:155], v[68:71], v[36:39]
    v_mfma_f32_16x16x32_bf16 v[36:39], v[156:159], v[72:75], v[36:39]
    v_mfma_f32_16x16x32_bf16 v[36:39], v[160:163], v[76:79], v[36:39]
    v_mfma_f32_16x16x32_bf16 v[36:39], v[164:167], v[80:83], v[36:39]
    v_mfma_f32_16x16x32_bf16 v[36:39], v[168:171], v[84:87], v[36:39]
    v_mfma_f32_16x16x32_bf16 v[36:39], v[172:175], v[88:91], v[36:39]
    v_mfma_f32_16x16x32_bf16 v[36:39], v[176:179], v[92:95], v[36:39]
    s_waitcnt lgkmcnt(0)
    v_mfma_f32_16x16x32_bf16 v[36:39], v[180:183], v[96:99], v[36:39]
    s_barrier
    v_mfma_f32_16x16x32_bf16 v[40:43], v[152:155], v[72:75], v[40:43]
    ds_read_b64_tr_b16 v[120:121], v20 offset:0
    v_mfma_f32_16x16x32_bf16 v[40:43], v[156:159], v[76:79], v[40:43]
    ds_read_b64_tr_b16 v[122:123], v20 offset:512
    v_mfma_f32_16x16x32_bf16 v[40:43], v[160:163], v[80:83], v[40:43]
    ds_read_b128 v[56:59], v184 offset:0
    v_mfma_f32_16x16x32_bf16 v[40:43], v[164:167], v[84:87], v[40:43]
    ds_read_b64_tr_b16 v[124:125], v20 offset:4096
    v_mfma_f32_16x16x32_bf16 v[40:43], v[168:171], v[88:91], v[40:43]
    ds_read_b64_tr_b16 v[126:127], v20 offset:4608
    v_mfma_f32_16x16x32_bf16 v[40:43], v[172:175], v[92:95], v[40:43]
    ds_read_b128 v[60:63], v186 offset:0
    v_mfma_f32_16x16x32_bf16 v[40:43], v[176:179], v[96:99], v[40:43]
    ds_read_b64_tr_b16 v[128:129], v20 offset:8192
    v_mfma_f32_16x16x32_bf16 v[40:43], v[180:183], v[100:103], v[40:43]
    ds_read_b64_tr_b16 v[130:131], v20 offset:8704
    v_mfma_f32_16x16x32_bf16 v[44:47], v[152:155], v[76:79], v[44:47]
    ds_read_b128 v[64:67], v184 offset:256
    v_mfma_f32_16x16x32_bf16 v[44:47], v[156:159], v[80:83], v[44:47]
    ds_read_b64_tr_b16 v[132:133], v20 offset:12288
    v_mfma_f32_16x16x32_bf16 v[44:47], v[160:163], v[84:87], v[44:47]
    ds_read_b64_tr_b16 v[134:135], v20 offset:12800
    v_mfma_f32_16x16x32_bf16 v[44:47], v[164:167], v[88:91], v[44:47]
    ds_read_b128 v[68:71], v186 offset:256
    v_mfma_f32_16x16x32_bf16 v[44:47], v[168:171], v[92:95], v[44:47]
    ds_read_b64_tr_b16 v[136:137], v20 offset:16384
    v_mfma_f32_16x16x32_bf16 v[44:47], v[172:175], v[96:99], v[44:47]
    ds_read_b64_tr_b16 v[138:139], v20 offset:16896
    v_mfma_f32_16x16x32_bf16 v[44:47], v[176:179], v[100:103], v[44:47]
    ds_read_b128 v[72:75], v184 offset:512
    v_mfma_f32_16x16x32_bf16 v[44:47], v[180:183], v[104:107], v[44:47]
    ds_read_b64_tr_b16 v[140:141], v20 offset:20480
    v_mfma_f32_16x16x32_bf16 v[48:51], v[152:155], v[80:83], v[48:51]
    ds_read_b64_tr_b16 v[142:143], v20 offset:20992
    v_mfma_f32_16x16x32_bf16 v[48:51], v[156:159], v[84:87], v[48:51]
    ds_read_b128 v[76:79], v186 offset:512
    v_mfma_f32_16x16x32_bf16 v[48:51], v[160:163], v[88:91], v[48:51]
    ds_read_b64_tr_b16 v[144:145], v20 offset:24576
    v_mfma_f32_16x16x32_bf16 v[48:51], v[164:167], v[92:95], v[48:51]
    ds_read_b64_tr_b16 v[146:147], v20 offset:25088
    v_mfma_f32_16x16x32_bf16 v[48:51], v[168:171], v[96:99], v[48:51]
    ds_read_b128 v[80:83], v184 offset:768
    v_mfma_f32_16x16x32_bf16 v[48:51], v[172:175], v[100:103], v[48:51]
    v_mfma_f32_16x16x32_bf16 v[48:51], v[176:179], v[104:107], v[48:51]
    v_mfma_f32_16x16x32_bf16 v[48:51], v[180:183], v[108:111], v[48:51]
    v_mfma_f32_16x16x32_bf16 v[52:55], v[152:155], v[84:87], v[52:55]
    v_mfma_f32_16x16x32_bf16 v[52:55], v[156:159], v[88:91], v[52:55]
    ds_read_b128 v[84:87], v186 offset:768
    v_mfma_f32_16x16x32_bf16 v[52:55], v[160:163], v[92:95], v[52:55]
    v_mfma_f32_16x16x32_bf16 v[52:55], v[164:167], v[96:99], v[52:55]
    v_mfma_f32_16x16x32_bf16 v[52:55], v[168:171], v[100:103], v[52:55]
    v_mfma_f32_16x16x32_bf16 v[52:55], v[172:175], v[104:107], v[52:55]
    v_mfma_f32_16x16x32_bf16 v[52:55], v[176:179], v[108:111], v[52:55]
    v_mfma_f32_16x16x32_bf16 v[52:55], v[180:183], v[112:115], v[52:55]
    s_waitcnt lgkmcnt(1)
    v_mfma_f32_16x16x32_bf16 v[216:219], v[120:123], v[56:59], v[216:219]
    ds_read_b128 v[88:91], v188 offset:0
    v_mfma_f32_16x16x32_bf16 v[216:219], v[124:127], v[60:63], v[216:219]
    v_mfma_f32_16x16x32_bf16 v[216:219], v[128:131], v[64:67], v[216:219]
    v_mfma_f32_16x16x32_bf16 v[216:219], v[132:135], v[68:71], v[216:219]
    ds_read_b128 v[92:95], v190 offset:0
    v_mfma_f32_16x16x32_bf16 v[216:219], v[136:139], v[72:75], v[216:219]
    v_mfma_f32_16x16x32_bf16 v[216:219], v[140:143], v[76:79], v[216:219]
    v_mfma_f32_16x16x32_bf16 v[216:219], v[144:147], v[80:83], v[216:219]
    ds_read_b128 v[96:99], v188 offset:256
    v_mfma_f32_16x16x32_bf16 v[220:223], v[120:123], v[60:63], v[220:223]
L_pg1:
    s_cbranch_execz L_pb1
    v_mfma_f32_16x16x32_bf16 v[220:223], v[124:127], v[64:67], v[220:223]
    v_mfma_f32_16x16x32_bf16 v[220:223], v[128:131], v[68:71], v[220:223]
    ds_read_b128 v[100:103], v190 offset:256
    v_mfma_f32_16x16x32_bf16 v[220:223], v[132:135], v[72:75], v[220:223]
    v_mfma_f32_16x16x32_bf16 v[220:223], v[136:139], v[76:79], v[220:223]
    v_mfma_f32_16x16x32_bf16 v[220:223], v[140:143], v[80:83], v[220:223]
    ds_read_b128 v[104:107], v188 offset:512
    s_waitcnt lgkmcnt(4)
    v_mfma_f32_16x16x32_bf16 v[220:223], v[144:147], v[84:87], v[220:223]
    v_mfma_f32_16x16x32_bf16 v[224:227], v[120:123], v[64:67], v[224:227]
    v_mfma_f32_16x16x32_bf16 v[224:227], v[124:127], v[68:71], v[224:227]
    ds_read_b128 v[108:111], v190 offset:512
    v_mfma_f32_16x16x32_bf16 v[224:227], v[128:131], v[72:75], v[224:227]
    v_mfma_f32_16x16x32_bf16 v[224:227], v[132:135], v[76:79], v[224:227]
    v_mfma_f32_16x16x32_bf16 v[224:227], v[136:139], v[80:83], v[224:227]
    v_mfma_f32_16x16x32_bf16 v[224:227], v[140:143], v[84:87], v[224:227]
    v_mfma_f32_16x16x32_bf16 v[224:227], v[144:147], v[88:91], v[224:227]
    v_mfma_f32_16x16x32_bf16 v[228:231], v[120:123], v[68:71], v[228:231]
    v_mfma_f32_16x16x32_bf16 v[228:231], v[124:127], v[72:75], v[228:231]
    v_mfma_f32_16x16x32_bf16 v[228:231], v[128:131], v[76:79], v[228:231]
    v_mfma_f32_16x16x32_bf16 v[228:231], v[132:135], v[80:83], v[228:231]
    v_mfma_f32_16x16x32_bf16 v[228:231], v[136:139], v[84:87], v[228:231]
    v_mfma_f32_16x16x32_bf16 v[228:231], v[140:143], v[88:91], v[228:231]
    s_waitcnt lgkmcnt(0)
    v_mfma_f32_16x16x32_bf16 v[228:231], v[144:147], v[92:95], v[228:231]
    s_barrier
    v_mfma_f32_16x16x32_bf16 v[232:235], v[120:123], v[72:75], v[232:235]
    ds_read_b128 v[56:59], v12 offset:52224
    v_mfma_f32_16x16x32_bf16 v[232:235], v[124:127], v[76:79], v[232:235]
    v_mfma_f32_16x16x32_bf16 v[232:235], v[128:131], v[80:83], v[232:235]
    ds_read_b128 v[60:63], v14 offset:52224
    v_mfma_f32_16x16x32_bf16 v[232:235], v[132:135], v[84:87], v[232:235]
    v_mfma_f32_16x16x32_bf16 v[232:235], v[136:139], v[88:91], v[232:235]
    ds_read_b128 v[64:67], v12 offset:52480
    v_mfma_f32_16x16x32_bf16 v[232:235], v[140:143], v[92:95], v[232:235]
    v_mfma_f32_16x16x32_bf16 v[232:235], v[144:147], v[96:99], v[232:235]
    v_mfma_f32_16x16x32_bf16 v[236:239], v[120:123], v[76:79], v[236:239]
    ds_read_b128 v[68:71], v14 offset:52480
    v_mfma_f32_16x16x32_bf16 v[236:239], v[124:127], v[80:83], v[236:239]
    v_mfma_f32_16x16x32_bf16 v[236:239], v[128:131], v[84:87], v[236:239]
    ds_read_b128 v[72:75], v12 offset:52736
    v_mfma_f32_16x16x32_bf16 v[236:239], v[132:135], v[88:91], v[236:239]
    v_mfma_f32_16x16x32_bf16 v[236:239], v[136:139], v[92:95], v[236:239]
    ds_read_b128 v[76:79], v14 offset:52736
    v_mfma_f32_16x16x32_bf16 v[236:239], v[140:143], v[96:99], v[236:239]
    v_mfma_f32_16x16x32_bf16 v[236:239], v[144:147], v[100:103], v[236:239]
    v_mfma_f32_16x16x32_bf16 v[240:243], v[120:123], v[80:83], v[240:243]
    v_mfma_f32_16x16x32_bf16 v[240:243], v[124:127], v[84:87], v[240:243]
    v_mfma_f32_16x16x32_bf16 v[240:243], v[128:131], v[88:91], v[240:243]
    ds_read_b128 v[80:83], v12 offset:52992
    v_mfma_f32_16x16x32_bf16 v[240:243], v[132:135], v[92:95], v[240:243]
    v_mfma_f32_16x16x32_bf16 v[240:243], v[136:139], v[96:99], v[240:243]
    v_mfma_f32_16x16x32_bf16 v[240:243], v[140:143], v[100:103], v[240:243]
    v_mfma_f32_16x16x32_bf16 v[240:243], v[144:147], v[104:107], v[240:243]
    v_mfma_f32_16x16x32_bf16 v[244:247], v[120:123], v[84:87], v[244:247]
    v_mfma_f32_16x16x32_bf16 v[244:247], v[124:127], v[88:91], v[244:247]
    ds_read_b128 v[84:87], v14 offset:52992
    v_mfma_f32_16x16x32_bf16 v[244:247], v[128:131], v[92:95], v[244:247]
    v_mfma_f32_16x16x32_bf16 v[244:247], v[132:135], v[96:99], v[244:247]
    v_mfma_f32_16x16x32_bf16 v[244:247], v[136:139], v[100:103], v[244:247]
    v_mfma_f32_16x16x32_bf16 v[244:247], v[140:143], v[104:107], v[244:247]
    v_mfma_f32_16x16x32_bf16 v[244:247], v[144:147], v[108:111], v[244:247]
    s_waitcnt lgkmcnt(1)
    v_mfma_f32_16x16x32_bf16 v[24:27], v[120:123], v[56:59], v[24:27]
    ds_read_b128 v[88:91], v16 offset:52224
    v_mfma_f32_16x16x32_bf16 v[24:27], v[124:127], v[60:63], v[24:27]
    v_mfma_f32_16x16x32_bf16 v[24:27], v[128:131], v[64:67], v[24:27]
    v_mfma_f32_16x16x32_bf16 v[24:27], v[132:135], v[68:71], v[24:27]
    ds_read_b128 v[92:95], v18 offset:52224
    v_mfma_f32_16x16x32_bf16 v[24:27], v[136:139], v[72:75], v[24:27]
    v_mfma_f32_16x16x32_bf16 v[24:27], v[140:143], v[76:79], v[24:27]
    v_mfma_f32_16x16x32_bf16 v[24:27], v[144:147], v[80:83], v[24:27]
    ds_read_b128 v[96:99], v16 offset:52480
    v_mfma_f32_16x16x32_bf16 v[28:31], v[120:123], v[60:63], v[28:31]
    v_mfma_f32_16x16x32_bf16 v[28:31], v[124:127], v[64:67], v[28:31]
    v_mfma_f32_16x16x32_bf16 v[28:31], v[128:131], v[68:71], v[28:31]
    ds_read_b128 v[100:103], v18 offset:52480
    v_mfma_f32_16x16x32_bf16 v[28:31], v[132:135], v[72:75], v[28:31]
    v_mfma_f32_16x16x32_bf16 v[28:31], v[136:139], v[76:79], v[28:31]
    v_mfma_f32_16x16x32_bf16 v[28:31], v[140:143], v[80:83], v[28:31]
    ds_read_b128 v[104:107], v16 offset:52736
    s_waitcnt lgkmcnt(4)
    v_mfma_f32_16x16x32_bf16 v[28:31], v[144:147], v[84:87], v[28:31]
    v_mfma_f32_16x16x32_bf16 v[32:35], v[120:123], v[64:67], v[32:35]
    v_mfma_f32_16x16x32_bf16 v[32:35], v[124:127], v[68:71], v[32:35]
    ds_read_b128 v[108:111], v18 offset:52736
    v_mfma_f32_16x16x32_bf16 v[32:35], v[128:131], v[72:75], v[32:35]
    v_mfma_f32_16x16x32_bf16 v[32:35], v[132:135], v[76:79], v[32:35]
    v_mfma_f32_16x16x32_bf16 v[32:35], v[136:139], v[80:83], v[32:35]
    v_mfma_f32_16x16x32_bf16 v[32:35], v[140:143], v[84:87], v[32:35]
    v_mfma_f32_16x16x32_bf16 v[32:35], v[144:147], v[88:91], v[32:35]
    v_mfma_f32_16x16x32_bf16 v[36:39], v[120:123], v[68:71], v[36:39]
    v_mfma_f32_16x16x32_bf16 v[36:39], v[124:127], v[72:75], v[36:39]
    v_mfma_f32_16x16x32_bf16 v[36:39], v[128:131], v[76:79], v[36:39]
    v_mfma_f32_16x16x32_bf16 v[36:39], v[132:135], v[80:83], v[36:39]
    v_mfma_f32_16x16x32_bf16 v[36:39], v[136:139], v[84:87], v[36:39]
    v_mfma_f32_16x16x32_bf16 v[36:39], v[140:143], v[88:91], v[36:39]
    s_waitcnt lgkmcnt(0)
    v_mfma_f32_16x16x32_bf16 v[36:39], v[144:147], v[92:95], v[36:39]
    s_barrier
    v_mfma_f32_16x16x32_bf16 v[40:43], v[120:123], v[72:75], v[40:43]
    ds_read_b64_tr_b16 v[152:153], v21 offset:0
    v_mfma_f32_16x16x32_bf16 v[40:43], v[124:127], v[76:79], v[40:43]
    ds_read_b64_tr_b16 v[154:155], v21 offset:512
    v_mfma_f32_16x16x32_bf16 v[40:43], v[128:131], v[80:83], v[40:43]
    ds_read_b128 v[56:59], v185 offset:0
    v_mfma_f32_16x16x32_bf16 v[40:43], v[132:135], v[84:87], v[40:43]
    ds_read_b64_tr_b16 v[156:157], v21 offset:4096
    v_mfma_f32_16x16x32_bf16 v[40:43], v[136:139], v[88:91], v[40:43]
    ds_read_b64_tr_b16 v[158:159], v21 offset:4608
    v_mfma_f32_16x16x32_bf16 v[40:43], v[140:143], v[92:95], v[40:43]
    ds_read_b128 v[60:63], v187 offset:0
    v_mfma_f32_16x16x32_bf16 v[40:43], v[144:147], v[96:99], v[40:43]
    ds_read_b64_tr_b16 v[160:161], v21 offset:8192
    v_mfma_f32_16x16x32_bf16 v[44:47], v[120:123], v[76:79], v[44:47]
    ds_read_b64_tr_b16 v[162:163], v21 offset:8704
    v_mfma_f32_16x16x32_bf16 v[44:47], v[124:127], v[80:83], v[44:47]
    ds_read_b128 v[64:67], v185 offset:256
    v_mfma_f32_16x16x32_bf16 v[44:47], v[128:131], v[84:87], v[44:47]
    ds_read_b64_tr_b16 v[164:165], v21 offset:12288
    v_mfma_f32_16x16x32_bf16 v[44:47], v[132:135], v[88:91], v[44:47]
    ds_read_b64_tr_b16 v[166:167], v21 offset:12800
    v_mfma_f32_16x16x32_bf16 v[44:47], v[136:139], v[92:95], v[44:47]
    ds_read_b128 v[68:71], v187 offset:256
    v_mfma_f32_16x16x32_bf16 v[44:47], v[140:143], v[96:99], v[44:47]
    ds_read_b64_tr_b16 v[168:169], v21 offset:16384
    v_mfma_f32_16x16x32_bf16 v[44:47], v[144:147], v[100:103], v[44:47]
    ds_read_b64_tr_b16 v[170:171], v21 offset:16896
    v_mfma_f32_16x16x32_bf16 v[48:51], v[120:123], v[80:83], v[48:51]
    ds_read_b128 v[72:75], v185 offset:512
    v_mfma_f32_16x16x32_bf16 v[48:51], v[124:127], v[84:87], v[48:51]
    ds_read_b64_tr_b16 v[172:173], v21 offset:20480
    v_mfma_f32_16x16x32_bf16 v[48:51], v[128:131], v[88:91], v[48:51]
    ds_read_b64_tr_b16 v[174:175], v21 offset:20992
    v_mfma_f32_16x16x32_bf16 v[48:51], v[132:135], v[92:95], v[48:51]
    ds_read_b128 v[76:79], v187 offset:512
    v_mfma_f32_16x16x32_bf16 v[48:51], v[136:139], v[96:99], v[48:51]
    ds_read_b64_tr_b16 v[176:177], v21 offset:24576
    v_mfma_f32_16x16x32_bf16 v[48:51], v[140:143], v[100:103], v[48:51]
    ds_read_b64_tr_b16 v[178:179], v21 offset:25088
    v_mfma_f32_16x16x32_bf16 v[48:51], v[144:147], v[104:107], v[48:51]
    ds_read_b128 v[80:83], v185 offset:768
    v_mfma_f32_16x16x32_bf16 v[52:55], v[120:123], v[84:87], v[52:55]
    v_mfma_f32_16x16x32_bf16 v[52:55], v[124:127], v[88:91], v[52:55]
    ds_read_b128 v[84:87], v187 offset:768
    v_mfma_f32_16x16x32_bf16 v[52:55], v[128:131], v[92:95], v[52:55]
    v_mfma_f32_16x16x32_bf16 v[52:55], v[132:135], v[96:99], v[52:55]
    v_mfma_f32_16x16x32_bf16 v[52:55], v[136:139], v[100:103], v[52:55]
    v_mfma_f32_16x16x32_bf16 v[52:55], v[140:143], v[104:107], v[52:55]
    v_mfma_f32_16x16x32_bf16 v[52:55], v[144:147], v[108:111], v[52:55]
    s_waitcnt lgkmcnt(4)
    v_mfma_f32_16x16x32_bf16 v[216:219], v[152:155], v[56:59], v[216:219]
    ds_read_b128 v[88:91], v189 offset:0
    v_mfma_f32_16x16x32_bf16 v[216:219], v[156:159], v[60:63], v[216:219]
    v_mfma_f32_16x16x32_bf16 v[216:219], v[160:163], v[64:67], v[216:219]
    v_mfma_f32_16x16x32_bf16 v[216:219], v[164:167], v[68:71], v[216:219]
    ds_read_b128 v[92:95], v191 offset:0
    v_mfma_f32_16x16x32_bf16 v[216:219], v[168:171], v[72:75], v[216:219]
    v_mfma_f32_16x16x32_bf16 v[216:219], v[172:175], v[76:79], v[216:219]
    s_waitcnt lgkmcnt(2)
    v_mfma_f32_16x16x32_bf16 v[216:219], v[176:179], v[80:83], v[216:219]
    ds_read_b128 v[96:99], v189 offset:256
    v_mfma_f32_16x16x32_bf16 v[220:223], v[152:155], v[60:63], v[220:223]
    v_mfma_f32_16x16x32_bf16 v[220:223], v[156:159], v[64:67], v[220:223]
    v_mfma_f32_16x16x32_bf16 v[220:223], v[160:163], v[68:71], v[220:223]
    ds_read_b128 v[100:103], v191 offset:256
    v_mfma_f32_16x16x32_bf16 v[220:223], v[164:167], v[72:75], v[220:223]
    v_mfma_f32_16x16x32_bf16 v[220:223], v[168:171], v[76:79], v[220:223]
    v_mfma_f32_16x16x32_bf16 v[220:223], v[172:175], v[80:83], v[220:223]
    ds_read_b128 v[104:107], v189 offset:512
    v_mfma_f32_16x16x32_bf16 v[220:223], v[176:179], v[84:87], v[220:223]
    v_mfma_f32_16x16x32_bf16 v[224:227], v[152:155], v[64:67], v[224:227]
    v_mfma_f32_16x16x32_bf16 v[224:227], v[156:159], v[68:71], v[224:227]
    ds_read_b128 v[108:111], v191 offset:512
    v_mfma_f32_16x16x32_bf16 v[224:227], v[160:163], v[72:75], v[224:227]
    v_mfma_f32_16x16x32_bf16 v[224:227], v[164:167], v[76:79], v[224:227]
    v_mfma_f32_16x16x32_bf16 v[224:227], v[168:171], v[80:83], v[224:227]
    v_mfma_f32_16x16x32_bf16 v[224:227], v[172:175], v[84:87], v[224:227]
    s_waitcnt lgkmcnt(2)
    v_mfma_f32_16x16x32_bf16 v[224:227], v[176:179], v[88:91], v[224:227]
    v_mfma_f32_16x16x32_bf16 v[228:231], v[152:155], v[68:71], v[228:231]
    v_mfma_f32_16x16x32_bf16 v[228:231], v[156:159], v[72:75], v[228:231]
    v_mfma_f32_16x16x32_bf16 v[228:231], v[160:163], v[76:79], v[228:231]
    v_mfma_f32_16x16x32_bf16 v[228:231], v[164:167], v[80:83], v[228:231]
    v_mfma_f32_16x16x32_bf16 v[228:231], v[168:171], v[84:87], v[228:231]
    v_mfma_f32_16x16x32_bf16 v[228:231], v[172:175], v[88:91], v[228:231]
    v_mfma_f32_16x16x32_bf16 v[228:231], v[176:179], v[92:95], v[228:231]
    s_waitcnt lgkmcnt(0)
    s_barrier
    v_mfma_f32_16x16x32_bf16 v[232:235], v[152:155], v[72:75], v[232:235]
    ds_read_b128 v[56:59], v13 offset:52224
    v_mfma_f32_16x16x32_bf16 v[232:235], v[156:159], v[76:79], v[232:235]
    v_mfma_f32_16x16x32_bf16 v[232:235], v[160:163], v[80:83], v[232:235]
    ds_read_b128 v[60:63], v15 offset:52224
    v_mfma_f32_16x16x32_bf16 v[232:235], v[164:167], v[84:87], v[232:235]
    v_mfma_f32_16x16x32_bf16 v[232:235], v[168:171], v[88:91], v[232:235]
    ds_read_b128 v[64:67], v13 offset:52480
    v_mfma_f32_16x16x32_bf16 v[232:235], v[172:175], v[92:95], v[232:235]
    v_mfma_f32_16x16x32_bf16 v[232:235], v[176:179], v[96:99], v[232:235]
    v_mfma_f32_16x16x32_bf16 v[236:239], v[152:155], v[76:79], v[236:239]
    ds_read_b128 v[68:71], v15 offset:52480
    v_mfma_f32_16x16x32_bf16 v[236:239], v[156:159], v[80:83], v[236:239]
    v_mfma_f32_16x16x32_bf16 v[236:239], v[160:163], v[84:87], v[236:239]
    ds_read_b128 v[72:75], v13 offset:52736
    v_mfma_f32_16x16x32_bf16 v[236:239], v[164:167], v[88:91], v[236:239]
    v_mfma_f32_16x16x32_bf16 v[236:239], v[168:171], v[92:95], v[236:239]
    ds_read_b128 v[76:79], v15 offset:52736
    v_mfma_f32_16x16x32_bf16 v[236:239], v[172:175], v[96:99], v[236:239]
    v_mfma_f32_16x16x32_bf16 v[236:239], v[176:179], v[100:103], v[236:239]
    v_mfma_f32_16x16x32_bf16 v[240:243], v[152:155], v[80:83], v[240:243]
    v_mfma_f32_16x16x32_bf16 v[240:243], v[156:159], v[84:87], v[240:243]
    v_mfma_f32_16x16x32_bf16 v[240:243], v[160:163], v[88:91], v[240:243]
    ds_read_b128 v[80:83], v13 offset:52992
    v_mfma_f32_16x16x32_bf16 v[240:243], v[164:167], v[92:95], v[240:243]
    v_mfma_f32_16x16x32_bf16 v[240:243], v[168:171], v[96:99], v[240:243]
    v_mfma_f32_16x16x32_bf16 v[240:243], v[172:175], v[100:103], v[240:243]
    v_mfma_f32_16x16x32_bf16 v[240:243], v[176:179], v[104:107], v[240:243]
    v_mfma_f32_16x16x32_bf16 v[244:247], v[152:155], v[84:87], v[244:247]
    v_mfma_f32_16x16x32_bf16 v[244:247], v[156:159], v[88:91], v[244:247]
    ds_read_b128 v[84:87], v15 offset:52992
    v_mfma_f32_16x16x32_bf16 v[244:247], v[160:163], v[92:95], v[244:247]
    v_mfma_f32_16x16x32_bf16 v[244:247], v[164:167], v[96:99], v[244:247]
    v_mfma_f32_16x16x32_bf16 v[244:247], v[168:171], v[100:103], v[244:247]
    v_mfma_f32_16x16x32_bf16 v[244:247], v[172:175], v[104:107], v[244:247]
    v_mfma_f32_16x16x32_bf16 v[244:247], v[176:179], v[108:111], v[244:247]
    s_waitcnt lgkmcnt(1)
    v_mfma_f32_16x16x32_bf16 v[24:27], v[152:155], v[56:59], v[24:27]
    ds_read_b128 v[88:91], v17 offset:52224
    v_mfma_f32_16x16x32_bf16 v[24:27], v[156:159], v[60:63], v[24:27]
    v_mfma_f32_16x16x32_bf16 v[24:27], v[160:163], v[64:67], v[24:27]
    v_mfma_f32_16x16x32_bf16 v[24:27], v[164:167], v[68:71], v[24:27]
    ds_read_b128 v[92:95], v19 offset:52224
    v_mfma_f32_16x16x32_bf16 v[24:27], v[168:171], v[72:75], v[24:27]
    v_mfma_f32_16x16x32_bf16 v[24:27], v[172:175], v[76:79], v[24:27]
    v_mfma_f32_16x16x32_bf16 v[24:27], v[176:179], v[80:83], v[24:27]
    ds_read_b128 v[96:99], v17 offset:52480
    v_mfma_f32_16x16x32_bf16 v[28:31], v[152:155], v[60:63], v[28:31]
    v_mfma_f32_16x16x32_bf16 v[28:31], v[156:159], v[64:67], v[28:31]
    v_mfma_f32_16x16x32_bf16 v[28:31], v[160:163], v[68:71], v[28:31]
    ds_read_b128 v[100:103], v19 offset:52480
    v_mfma_f32_16x16x32_bf16 v[28:31], v[164:167], v[72:75], v[28:31]
    v_mfma_f32_16x16x32_bf16 v[28:31], v[168:171], v[76:79], v[28:31]
    v_mfma_f32_16x16x32_bf16 v[28:31], v[172:175], v[80:83], v[28:31]
    ds_read_b128 v[104:107], v17 offset:52736
    s_waitcnt lgkmcnt(4)
    v_mfma_f32_16x16x32_bf16 v[28:31], v[176:179], v[84:87], v[28:31]
    v_mfma_f32_16x16x32_bf16 v[32:35], v[152:155], v[64:67], v[32:35]
    v_mfma_f32_16x16x32_bf16 v[32:35], v[156:159], v[68:71], v[32:35]
    ds_read_b128 v[108:111], v19 offset:52736
    v_mfma_f32_16x16x32_bf16 v[32:35], v[160:163], v[72:75], v[32:35]
    v_mfma_f32_16x16x32_bf16 v[32:35], v[164:167], v[76:79], v[32:35]
    v_mfma_f32_16x16x32_bf16 v[32:35], v[168:171], v[80:83], v[32:35]
    v_mfma_f32_16x16x32_bf16 v[32:35], v[172:175], v[84:87], v[32:35]
    v_mfma_f32_16x16x32_bf16 v[32:35], v[176:179], v[88:91], v[32:35]
    v_mfma_f32_16x16x32_bf16 v[36:39], v[152:155], v[68:71], v[36:39]
    v_mfma_f32_16x16x32_bf16 v[36:39], v[156:159], v[72:75], v[36:39]
    v_mfma_f32_16x16x32_bf16 v[36:39], v[160:163], v[76:79], v[36:39]
    v_mfma_f32_16x16x32_bf16 v[36:39], v[164:167], v[80:83], v[36:39]
    v_mfma_f32_16x16x32_bf16 v[36:39], v[168:171], v[84:87], v[36:39]
    v_mfma_f32_16x16x32_bf16 v[36:39], v[172:175], v[88:91], v[36:39]
    s_waitcnt lgkmcnt(0)
    v_mfma_f32_16x16x32_bf16 v[36:39], v[176:179], v[92:95], v[36:39]
    s_barrier
    v_mfma_f32_16x16x32_bf16 v[40:43], v[152:155], v[72:75], v[40:43]
    ds_read_b64_tr_b16 v[120:121], v21 offset:32768
    v_mfma_f32_16x16x32_bf16 v[40:43], v[156:159], v[76:79], v[40:43]
    ds_read_b64_tr_b16 v[122:123], v21 offset:33280
    v_mfma_f32_16x16x32_bf16 v[40:43], v[160:163], v[80:83], v[40:43]
    ds_read_b128 v[56:59], v12 offset:34816
    v_mfma_f32_16x16x32_bf16 v[40:43], v[164:167], v[84:87], v[40:43]
    ds_read_b64_tr_b16 v[124:125], v21 offset:36864
    v_mfma_f32_16x16x32_bf16 v[40:43], v[168:171], v[88:91], v[40:43]
    ds_read_b64_tr_b16 v[126:127], v21 offset:37376
    v_mfma_f32_16x16x32_bf16 v[40:43], v[172:175], v[92:95], v[40:43]
    ds_read_b128 v[60:63], v14 offset:34816
    v_mfma_f32_16x16x32_bf16 v[40:43], v[176:179], v[96:99], v[40:43]
    ds_read_b64_tr_b16 v[128:129], v21 offset:40960
    v_mfma_f32_16x16x32_bf16 v[44:47], v[152:155], v[76:79], v[44:47]
    ds_read_b64_tr_b16 v[130:131], v21 offset:41472
    v_mfma_f32_16x16x32_bf16 v[44:47], v[156:159], v[80:83], v[44:47]
    ds_read_b128 v[64:67], v12 offset:35072
    v_mfma_f32_16x16x32_bf16 v[44:47], v[160:163], v[84:87], v[44:47]
    ds_read_b64_tr_b16 v[132:133], v21 offset:45056
    v_mfma_f32_16x16x32_bf16 v[44:47], v[164:167], v[88:91], v[44:47]
    ds_read_b64_tr_b16 v[134:135], v21 offset:45568
    v_mfma_f32_16x16x32_bf16 v[44:47], v[168:171], v[92:95], v[44:47]
    ds_read_b128 v[68:71], v14 offset:35072
    v_mfma_f32_16x16x32_bf16 v[44:47], v[172:175], v[96:99], v[44:47]
    ds_read_b64_tr_b16 v[136:137], v21 offset:49152
    v_mfma_f32_16x16x32_bf16 v[44:47], v[176:179], v[100:103], v[44:47]
    ds_read_b64_tr_b16 v[138:139], v21 offset:49664
    v_mfma_f32_16x16x32_bf16 v[48:51], v[152:155], v[80:83], v[48:51]
    ds_read_b128 v[72:75], v12 offset:35328
    v_mfma_f32_16x16x32_bf16 v[48:51], v[156:159], v[84:87], v[48:51]
    ds_read_b64_tr_b16 v[140:141], v21 offset:53248
    v_mfma_f32_16x16x32_bf16 v[48:51], v[160:163], v[88:91], v[48:51]
    ds_read_b64_tr_b16 v[142:143], v21 offset:53760
    v_mfma_f32_16x16x32_bf16 v[48:51], v[164:167], v[92:95], v[48:51]
    ds_read_b128 v[76:79], v14 offset:35328
    v_mfma_f32_16x16x32_bf16 v[48:51], v[168:171], v[96:99], v[48:51]
    ds_read_b64_tr_b16 v[144:145], v21 offset:57344
    v_mfma_f32_16x16x32_bf16 v[48:51], v[172:175], v[100:103], v[48:51]
    ds_read_b64_tr_b16 v[146:147], v21 offset:57856
    v_mfma_f32_16x16x32_bf16 v[48:51], v[176:179], v[104:107], v[48:51]
    ds_read_b128 v[80:83], v12 offset:35584
    v_mfma_f32_16x16x32_bf16 v[52:55], v[152:155], v[84:87], v[52:55]
    ds_read_b64_tr_b16 v[148:149], v21 offset:61440
    v_mfma_f32_16x16x32_bf16 v[52:55], v[156:159], v[88:91], v[52:55]
    ds_read_b64_tr_b16 v[150:151], v21 offset:61952
    v_mfma_f32_16x16x32_bf16 v[52:55], v[160:163], v[92:95], v[52:55]
    ds_read_b128 v[84:87], v14 offset:35584
    v_mfma_f32_16x16x32_bf16 v[52:55], v[164:167], v[96:99], v[52:55]
    v_mfma_f32_16x16x32_bf16 v[52:55], v[168:171], v[100:103], v[52:55]
    v_mfma_f32_16x16x32_bf16 v[52:55], v[172:175], v[104:107], v[52:55]
    v_mfma_f32_16x16x32_bf16 v[52:55], v[176:179], v[108:111], v[52:55]
    s_waitcnt lgkmcnt(6)
    v_mfma_f32_16x16x32_bf16 v[216:219], v[120:123], v[56:59], v[216:219]
    ds_read_b128 v[88:91], v16 offset:34816
    v_mfma_f32_16x16x32_bf16 v[216:219], v[124:127], v[60:63], v[216:219]
    v_mfma_f32_16x16x32_bf16 v[216:219], v[128:131], v[64:67], v[216:219]
    v_mfma_f32_16x16x32_bf16 v[216:219], v[132:135], v[68:71], v[216:219]
    ds_read_b128 v[92:95], v18 offset:34816
    v_mfma_f32_16x16x32_bf16 v[216:219], v[136:139], v[72:75], v[216:219]
    v_mfma_f32_16x16x32_bf16 v[216:219], v[140:143], v[76:79], v[216:219]
    s_waitcnt lgkmcnt(2)
    v_mfma_f32_16x16x32_bf16 v[216:219], v[144:147], v[80:83], v[216:219]
    ds_read_b128 v[96:99], v16 offset:35072
    v_mfma_f32_16x16x32_bf16 v[216:219], v[148:151], v[84:87], v[216:219]
    v_mfma_f32_16x16x32_bf16 v[220:223], v[120:123], v[60:63], v[220:223]
    v_mfma_f32_16x16x32_bf16 v[220:223], v[124:127], v[64:67], v[220:223]
    ds_read_b128 v[100:103], v18 offset:35072
    v_mfma_f32_16x16x32_bf16 v[220:223], v[128:131], v[68:71], v[220:223]
    v_mfma_f32_16x16x32_bf16 v[220:223], v[132:135], v[72:75], v[220:223]
    v_mfma_f32_16x16x32_bf16 v[220:223], v[136:139], v[76:79], v[220:223]
    ds_read_b128 v[104:107], v16 offset:35328
    v_mfma_f32_16x16x32_bf16 v[220:223], v[140:143], v[80:83], v[220:223]
    v_mfma_f32_16x16x32_bf16 v[220:223], v[144:147], v[84:87], v[220:223]
    s_waitcnt lgkmcnt(3)
    v_mfma_f32_16x16x32_bf16 v[220:223], v[148:151], v[88:91], v[220:223]
    ds_read_b128 v[108:111], v18 offset:35328
    v_mfma_f32_16x16x32_bf16 v[224:227], v[120:123], v[64:67], v[224:227]
    v_mfma_f32_16x16x32_bf16 v[224:227], v[124:127], v[68:71], v[224:227]
    v_mfma_f32_16x16x32_bf16 v[224:227], v[128:131], v[72:75], v[224:227]
    ds_read_b128 v[112:115], v16 offset:35584
    v_mfma_f32_16x16x32_bf16 v[224:227], v[132:135], v[76:79], v[224:227]
    v_mfma_f32_16x16x32_bf16 v[224:227], v[136:139], v[80:83], v[224:227]
    v_mfma_f32_16x16x32_bf16 v[224:227], v[140:143], v[84:87], v[224:227]
    v_mfma_f32_16x16x32_bf16 v[224:227], v[144:147], v[88:91], v[224:227]
    v_mfma_f32_16x16x32_bf16 v[224:227], v[148:151], v[92:95], v[224:227]
    v_mfma_f32_16x16x32_bf16 v[228:231], v[120:123], v[68:71], v[228:231]
    v_mfma_f32_16x16x32_bf16 v[228:231], v[124:127], v[72:75], v[228:231]
    v_mfma_f32_16x16x32_bf16 v[228:231], v[128:131], v[76:79], v[228:231]
    v_mfma_f32_16x16x32_bf16 v[228:231], v[132:135], v[80:83], v[228:231]
    v_mfma_f32_16x16x32_bf16 v[228:231], v[136:139], v[84:87], v[228:231]
    v_mfma_f32_16x16x32_bf16 v[228:231], v[140:143], v[88:91], v[228:231]
    v_mfma_f32_16x16x32_bf16 v[228:231], v[144:147], v[92:95], v[228:231]
    s_waitcnt lgkmcnt(0)
    v_mfma_f32_16x16x32_bf16 v[228:231], v[148:151], v[96:99], v[228:231]
    s_barrier
    v_mfma_f32_16x16x32_bf16 v[232:235], v[120:123], v[72:75], v[232:235]
    ds_read_b128 v[56:59], v184 offset:0
    v_mfma_f32_16x16x32_bf16 v[232:235], v[124:127], v[76:79], v[232:235]
    v_mfma_f32_16x16x32_bf16 v[232:235], v[128:131], v[80:83], v[232:235]
    ds_read_b128 v[60:63], v186 offset:0
    v_mfma_f32_16x16x32_bf16 v[232:235], v[132:135], v[84:87], v[232:235]
    v_mfma_f32_16x16x32_bf16 v[232:235], v[136:139], v[88:91], v[232:235]
    ds_read_b128 v[64:67], v184 offset:256
    v_mfma_f32_16x16x32_bf16 v[232:235], v[140:143], v[92:95], v[232:235]
    v_mfma_f32_16x16x32_bf16 v[232:235], v[144:147], v[96:99], v[232:235]
    v_mfma_f32_16x16x32_bf16 v[232:235], v[148:151], v[100:103], v[232:235]
    v_mfma_f32_16x16x32_bf16 v[236:239], v[120:123], v[76:79], v[236:239]
    ds_read_b128 v[68:71], v186 offset:256
    v_mfma_f32_16x16x32_bf16 v[236:239], v[124:127], v[80:83], v[236:239]
    v_mfma_f32_16x16x32_bf16 v[236:239], v[128:131], v[84:87], v[236:239]
    ds_read_b128 v[72:75], v184 offset:512
    v_mfma_f32_16x16x32_bf16 v[236:239], v[132:135], v[88:91], v[236:239]
    v_mfma_f32_16x16x32_bf16 v[236:239], v[136:139], v[92:95], v[236:239]
    ds_read_b128 v[76:79], v186 offset:512
    v_mfma_f32_16x16x32_bf16 v[236:239], v[140:143], v[96:99], v[236:239]
    v_mfma_f32_16x16x32_bf16 v[236:239], v[144:147], v[100:103], v[236:239]
    v_mfma_f32_16x16x32_bf16 v[236:239], v[148:151], v[104:107], v[236:239]
    v_mfma_f32_16x16x32_bf16 v[240:243], v[120:123], v[80:83], v[240:243]
    v_mfma_f32_16x16x32_bf16 v[240:243], v[124:127], v[84:87], v[240:243]
    v_mfma_f32_16x16x32_bf16 v[240:243], v[128:131], v[88:91], v[240:243]
    ds_read_b128 v[80:83], v184 offset:768
    v_mfma_f32_16x16x32_bf16 v[240:243], v[132:135], v[92:95], v[240:243]
    v_mfma_f32_16x16x32_bf16 v[240:243], v[136:139], v[96:99], v[240:243]
    v_mfma_f32_16x16x32_bf16 v[240:243], v[140:143], v[100:103], v[240:243]
    v_mfma_f32_16x16x32_bf16 v[240:243], v[144:147], v[104:107], v[240:243]
    v_mfma_f32_16x16x32_bf16 v[240:243], v[148:151], v[108:111], v[240:243]
    v_mfma_f32_16x16x32_bf16 v[244:247], v[120:123], v[84:87], v[244:247]
    v_mfma_f32_16x16x32_bf16 v[244:247], v[124:127], v[88:91], v[244:247]
    ds_read_b128 v[84:87], v186 offset:768
    v_mfma_f32_16x16x32_bf16 v[244:247], v[128:131], v[92:95], v[244:247]
    v_mfma_f32_16x16x32_bf16 v[244:247], v[132:135], v[96:99], v[244:247]
    v_mfma_f32_16x16x32_bf16 v[244:247], v[136:139], v[100:103], v[244:247]
    v_mfma_f32_16x16x32_bf16 v[244:247], v[140:143], v[104:107], v[244:247]
    v_mfma_f32_16x16x32_bf16 v[244:247], v[144:147], v[108:111], v[244:247]
    v_mfma_f32_16x16x32_bf16 v[244:247], v[148:151], v[112:115], v[244:247]
    s_waitcnt lgkmcnt(1)
    v_mfma_f32_16x16x32_bf16 v[24:27], v[120:123], v[56:59], v[24:27]
    ds_read_b128 v[88:91], v188 offset:0
    v_mfma_f32_16x16x32_bf16 v[24:27], v[124:127], v[60:63], v[24:27]
    v_mfma_f32_16x16x32_bf16 v[24:27], v[128:131], v[64:67], v[24:27]
    v_mfma_f32_16x16x32_bf16 v[24:27], v[132:135], v[68:71], v[24:27]
    ds_read_b128 v[92:95], v190 offset:0
    v_mfma_f32_16x16x32_bf16 v[24:27], v[136:139], v[72:75], v[24:27]
    v_mfma_f32_16x16x32_bf16 v[24:27], v[140:143], v[76:79], v[24:27]
    v_mfma_f32_16x16x32_bf16 v[24:27], v[144:147], v[80:83], v[24:27]
    ds_read_b128 v[96:99], v188 offset:256
    s_waitcnt lgkmcnt(3)
    v_mfma_f32_16x16x32_bf16 v[24:27], v[148:151], v[84:87], v[24:27]
    v_mfma_f32_16x16x32_bf16 v[28:31], v[120:123], v[60:63], v[28:31]
    v_mfma_f32_16x16x32_bf16 v[28:31], v[124:127], v[64:67], v[28:31]
    ds_read_b128 v[100:103], v190 offset:256
    v_mfma_f32_16x16x32_bf16 v[28:31], v[128:131], v[68:71], v[28:31]
    v_mfma_f32_16x16x32_bf16 v[28:31], v[132:135], v[72:75], v[28:31]
    v_mfma_f32_16x16x32_bf16 v[28:31], v[136:139], v[76:79], v[28:31]
    ds_read_b128 v[104:107], v188 offset:512
    v_mfma_f32_16x16x32_bf16 v[28:31], v[140:143], v[80:83], v[28:31]
    v_mfma_f32_16x16x32_bf16 v[28:31], v[144:147], v[84:87], v[28:31]
    s_waitcnt lgkmcnt(3)
    v_mfma_f32_16x16x32_bf16 v[28:31], v[148:151], v[88:91], v[28:31]
    ds_read_b128 v[108:111], v190 offset:512
    v_mfma_f32_16x16x32_bf16 v[32:35], v[120:123], v[64:67], v[32:35]
    v_mfma_f32_16x16x32_bf16 v[32:35], v[124:127], v[68:71], v[32:35]
    v_mfma_f32_16x16x32_bf16 v[32:35], v[128:131], v[72:75], v[32:35]
    ds_read_b128 v[112:115], v188 offset:768
    v_mfma_f32_16x16x32_bf16 v[32:35], v[132:135], v[76:79], v[32:35]
    v_mfma_f32_16x16x32_bf16 v[32:35], v[136:139], v[80:83], v[32:35]
    v_mfma_f32_16x16x32_bf16 v[32:35], v[140:143], v[84:87], v[32:35]
    v_mfma_f32_16x16x32_bf16 v[32:35], v[144:147], v[88:91], v[32:35]
    v_mfma_f32_16x16x32_bf16 v[32:35], v[148:151], v[92:95], v[32:35]
    v_mfma_f32_16x16x32_bf16 v[36:39], v[120:123], v[68:71], v[36:39]
    v_mfma_f32_16x16x32_bf16 v[36:39], v[124:127], v[72:75], v[36:39]
    v_mfma_f32_16x16x32_bf16 v[36:39], v[128:131], v[76:79], v[36:39]
    v_mfma_f32_16x16x32_bf16 v[36:39], v[132:135], v[80:83], v[36:39]
    v_mfma_f32_16x16x32_bf16 v[36:39], v[136:139], v[84:87], v[36:39]
    v_mfma_f32_16x16x32_bf16 v[36:39], v[140:143], v[88:91], v[36:39]
    v_mfma_f32_16x16x32_bf16 v[36:39], v[144:147], v[92:95], v[36:39]
    s_waitcnt lgkmcnt(0)
    v_mfma_f32_16x16x32_bf16 v[36:39], v[148:151], v[96:99], v[36:39]
    s_barrier
    v_mfma_f32_16x16x32_bf16 v[40:43], v[120:123], v[72:75], v[40:43]
    ds_read_b64_tr_b16 v[152:153], v20 offset:0
    v_mfma_f32_16x16x32_bf16 v[40:43], v[124:127], v[76:79], v[40:43]
    ds_read_b64_tr_b16 v[154:155], v20 offset:512
    v_mfma_f32_16x16x32_bf16 v[40:43], v[128:131], v[80:83], v[40:43]
    ds_read_b128 v[56:59], v13 offset:34816
    v_mfma_f32_16x16x32_bf16 v[40:43], v[132:135], v[84:87], v[40:43]
    ds_read_b64_tr_b16 v[156:157], v20 offset:4096
    v_mfma_f32_16x16x32_bf16 v[40:43], v[136:139], v[88:91], v[40:43]
    ds_read_b64_tr_b16 v[158:159], v20 offset:4608
    v_mfma_f32_16x16x32_bf16 v[40:43], v[140:143], v[92:95], v[40:43]
    ds_read_b128 v[60:63], v15 offset:34816
    v_mfma_f32_16x16x32_bf16 v[40:43], v[144:147], v[96:99], v[40:43]
    ds_read_b64_tr_b16 v[160:161], v20 offset:8192
    v_mfma_f32_16x16x32_bf16 v[40:43], v[148:151], v[100:103], v[40:43]
    ds_read_b64_tr_b16 v[162:163], v20 offset:8704
    v_mfma_f32_16x16x32_bf16 v[44:47], v[120:123], v[76:79], v[44:47]
    ds_read_b128 v[64:67], v13 offset:35072
    v_mfma_f32_16x16x32_bf16 v[44:47], v[124:127], v[80:83], v[44:47]
    ds_read_b64_tr_b16 v[164:165], v20 offset:12288
    v_mfma_f32_16x16x32_bf16 v[44:47], v[128:131], v[84:87], v[44:47]
    ds_read_b64_tr_b16 v[166:167], v20 offset:12800
    v_mfma_f32_16x16x32_bf16 v[44:47], v[132:135], v[88:91], v[44:47]
    ds_read_b128 v[68:71], v15 offset:35072
    v_mfma_f32_16x16x32_bf16 v[44:47], v[136:139], v[92:95], v[44:47]
    ds_read_b64_tr_b16 v[168:169], v20 offset:16384
    v_mfma_f32_16x16x32_bf16 v[44:47], v[140:143], v[96:99], v[44:47]
    ds_read_b64_tr_b16 v[170:171], v20 offset:16896
    v_mfma_f32_16x16x32_bf16 v[44:47], v[144:147], v[100:103], v[44:47]
    ds_read_b128 v[72:75], v13 offset:35328
    v_mfma_f32_16x16x32_bf16 v[44:47], v[148:151], v[104:107], v[44:47]
    ds_read_b64_tr_b16 v[172:173], v20 offset:20480
    v_mfma_f32_16x16x32_bf16 v[48:51], v[120:123], v[80:83], v[48:51]
    ds_read_b64_tr_b16 v[174:175], v20 offset:20992
    v_mfma_f32_16x16x32_bf16 v[48:51], v[124:127], v[84:87], v[48:51]
    ds_read_b128 v[76:79], v15 offset:35328
    v_mfma_f32_16x16x32_bf16 v[48:51], v[128:131], v[88:91], v[48:51]
    ds_read_b64_tr_b16 v[176:177], v20 offset:24576
    v_mfma_f32_16x16x32_bf16 v[48:51], v[132:135], v[92:95], v[48:51]
    ds_read_b64_tr_b16 v[178:179], v20 offset:25088
    v_mfma_f32_16x16x32_bf16 v[48:51], v[136:139], v[96:99], v[48:51]
    ds_read_b128 v[80:83], v13 offset:35584
    v_mfma_f32_16x16x32_bf16 v[48:51], v[140:143], v[100:103], v[48:51]
    ds_read_b64_tr_b16 v[180:181], v20 offset:28672
    v_mfma_f32_16x16x32_bf16 v[48:51], v[144:147], v[104:107], v[48:51]
    ds_read_b64_tr_b16 v[182:183], v20 offset:29184
    v_mfma_f32_16x16x32_bf16 v[48:51], v[148:151], v[108:111], v[48:51]
    v_mfma_f32_16x16x32_bf16 v[52:55], v[120:123], v[84:87], v[52:55]
    v_mfma_f32_16x16x32_bf16 v[52:55], v[124:127], v[88:91], v[52:55]
    ds_read_b128 v[84:87], v15 offset:35584
    v_mfma_f32_16x16x32_bf16 v[52:55], v[128:131], v[92:95], v[52:55]
    v_mfma_f32_16x16x32_bf16 v[52:55], v[132:135], v[96:99], v[52:55]
    v_mfma_f32_16x16x32_bf16 v[52:55], v[136:139], v[100:103], v[52:55]
    v_mfma_f32_16x16x32_bf16 v[52:55], v[140:143], v[104:107], v[52:55]
    v_mfma_f32_16x16x32_bf16 v[52:55], v[144:147], v[108:111], v[52:55]
    v_mfma_f32_16x16x32_bf16 v[52:55], v[148:151], v[112:115], v[52:55]
    s_waitcnt lgkmcnt(2)
    v_mfma_f32_16x16x32_bf16 v[216:219], v[152:155], v[56:59], v[216:219]
    ds_read_b128 v[88:91], v17 offset:34816
    v_mfma_f32_16x16x32_bf16 v[216:219], v[156:159], v[60:63], v[216:219]
    v_mfma_f32_16x16x32_bf16 v[216:219], v[160:163], v[64:67], v[216:219]
    v_mfma_f32_16x16x32_bf16 v[216:219], v[164:167], v[68:71], v[216:219]
    ds_read_b128 v[92:95], v19 offset:34816
    v_mfma_f32_16x16x32_bf16 v[216:219], v[168:171], v[72:75], v[216:219]
    v_mfma_f32_16x16x32_bf16 v[216:219], v[172:175], v[76:79], v[216:219]
    v_mfma_f32_16x16x32_bf16 v[216:219], v[176:179], v[80:83], v[216:219]
    ds_read_b128 v[96:99], v17 offset:35072
    s_waitcnt lgkmcnt(3)
    v_mfma_f32_16x16x32_bf16 v[216:219], v[180:183], v[84:87], v[216:219]
    v_mfma_f32_16x16x32_bf16 v[220:223], v[152:155], v[60:63], v[220:223]
    v_mfma_f32_16x16x32_bf16 v[220:223], v[156:159], v[64:67], v[220:223]
    ds_read_b128 v[100:103], v19 offset:35072
    v_mfma_f32_16x16x32_bf16 v[220:223], v[160:163], v[68:71], v[220:223]
    v_mfma_f32_16x16x32_bf16 v[220:223], v[164:167], v[72:75], v[220:223]
    v_mfma_f32_16x16x32_bf16 v[220:223], v[168:171], v[76:79], v[220:223]
    ds_read_b128 v[104:107], v17 offset:35328
    v_mfma_f32_16x16x32_bf16 v[220:223], v[172:175], v[80:83], v[220:223]
    v_mfma_f32_16x16x32_bf16 v[220:223], v[176:179], v[84:87], v[220:223]
    s_waitcnt lgkmcnt(3)
    v_mfma_f32_16x16x32_bf16 v[220:223], v[180:183], v[88:91], v[220:223]
    ds_read_b128 v[108:111], v19 offset:35328
    v_mfma_f32_16x16x32_bf16 v[224:227], v[152:155], v[64:67], v[224:227]
    v_mfma_f32_16x16x32_bf16 v[224:227], v[156:159], v[68:71], v[224:227]
L_pg2:
    s_cbranch_execz L_pb2
    v_mfma_f32_16x16x32_bf16 v[224:227], v[160:163], v[72:75], v[224:227]
    ds_read_b128 v[112:115], v17 offset:35584
    v_mfma_f32_16x16x32_bf16 v[224:227], v[164:167], v[76:79], v[224:227]
    v_mfma_f32_16x16x32_bf16 v[224:227], v[168:171], v[80:83], v[224:227]
    v_mfma_f32_16x16x32_bf16 v[224:227], v[172:175], v[84:87], v[224:227]
    v_mfma_f32_16x16x32_bf16 v[224:227], v[176:179], v[88:91], v[224:227]
    v_mfma_f32_16x16x32_bf16 v[224:227], v[180:183], v[92:95], v[224:227]
    v_mfma_f32_16x16x32_bf16 v[228:231], v[152:155], v[68:71], v[228:231]
    v_mfma_f32_16x16x32_bf16 v[228:231], v[156:159], v[72:75], v[228:231]
    v_mfma_f32_16x16x32_bf16 v[228:231], v[160:163], v[76:79], v[228:231]
    v_mfma_f32_16x16x32_bf16 v[228:231], v[164:167], v[80:83], v[228:231]
    v_mfma_f32_16x16x32_bf16 v[228:231], v[168:171], v[84:87], v[228:231]
    v_mfma_f32_16x16x32_bf16 v[228:231], v[172:175], v[88:91], v[228:231]
    v_mfma_f32_16x16x32_bf16 v[228:231], v[176:179], v[92:95], v[228:231]
    s_waitcnt lgkmcnt(0)
    v_mfma_f32_16x16x32_bf16 v[228:231], v[180:183], v[96:99], v[228:231]
    s_barrier
    v_mfma_f32_16x16x32_bf16 v[232:235], v[152:155], v[72:75], v[232:235]
    ds_read_b128 v[56:59], v185 offset:0
    v_mfma_f32_16x16x32_bf16 v[232:235], v[156:159], v[76:79], v[232:235]
    v_mfma_f32_16x16x32_bf16 v[232:235], v[160:163], v[80:83], v[232:235]
    ds_read_b128 v[60:63], v187 offset:0
    v_mfma_f32_16x16x32_bf16 v[232:235], v[164:167], v[84:87], v[232:235]
    v_mfma_f32_16x16x32_bf16 v[232:235], v[168:171], v[88:91], v[232:235]
    ds_read_b128 v[64:67], v185 offset:256
    v_mfma_f32_16x16x32_bf16 v[232:235], v[172:175], v[92:95], v[232:235]
    v_mfma_f32_16x16x32_bf16 v[232:235], v[176:179], v[96:99], v[232:235]
    v_mfma_f32_16x16x32_bf16 v[232:235], v[180:183], v[100:103], v[232:235]
    v_mfma_f32_16x16x32_bf16 v[236:239], v[152:155], v[76:79], v[236:239]
    ds_read_b128 v[68:71], v187 offset:256
    v_mfma_f32_16x16x32_bf16 v[236:239], v[156:159], v[80:83], v[236:239]
    v_mfma_f32_16x16x32_bf16 v[236:239], v[160:163], v[84:87], v[236:239]
    ds_read_b128 v[72:75], v185 offset:512
    v_mfma_f32_16x16x32_bf16 v[236:239], v[164:167], v[88:91], v[236:239]
    v_mfma_f32_16x16x32_bf16 v[236:239], v[168:171], v[92:95], v[236:239]
    ds_read_b128 v[76:79], v187 offset:512
    v_mfma_f32_16x16x32_bf16 v[236:239], v[172:175], v[96:99], v[236:239]
    v_mfma_f32_16x16x32_bf16 v[236:239], v[176:179], v[100:103], v[236:239]
    v_mfma_f32_16x16x32_bf16 v[236:239], v[180:183], v[104:107], v[236:239]
    v_mfma_f32_16x16x32_bf16 v[240:243], v[152:155], v[80:83], v[240:243]
    v_mfma_f32_16x16x32_bf16 v[240:243], v[156:159], v[84:87], v[240:243]
    v_mfma_f32_16x16x32_bf16 v[240:243], v[160:163], v[88:91], v[240:243]
    ds_read_b128 v[80:83], v185 offset:768
    v_mfma_f32_16x16x32_bf16 v[240:243], v[164:167], v[92:95], v[240:243]
    v_mfma_f32_16x16x32_bf16 v[240:243], v[168:171], v[96:99], v[240:243]
    v_mfma_f32_16x16x32_bf16 v[240:243], v[172:175], v[100:103], v[240:243]
    v_mfma_f32_16x16x32_bf16 v[240:243], v[176:179], v[104:107], v[240:243]
    v_mfma_f32_16x16x32_bf16 v[240:243], v[180:183], v[108:111], v[240:243]
    v_mfma_f32_16x16x32_bf16 v[244:247], v[152:155], v[84:87], v[244:247]
    v_mfma_f32_16x16x32_bf16 v[244:247], v[156:159], v[88:91], v[244:247]
    ds_read_b128 v[84:87], v187 offset:768
    v_mfma_f32_16x16x32_bf16 v[244:247], v[160:163], v[92:95], v[244:247]
    v_mfma_f32_16x16x32_bf16 v[244:247], v[164:167], v[96:99], v[244:247]
    v_mfma_f32_16x16x32_bf16 v[244:247], v[168:171], v[100:103], v[244:247]
    v_mfma_f32_16x16x32_bf16 v[244:247], v[172:175], v[104:107], v[244:247]
    v_mfma_f32_16x16x32_bf16 v[244:247], v[176:179], v[108:111], v[244:247]
    v_mfma_f32_16x16x32_bf16 v[244:247], v[180:183], v[112:115], v[244:247]
    s_waitcnt lgkmcnt(1)
    v_mfma_f32_16x16x32_bf16 v[24:27], v[152:155], v[56:59], v[24:27]
    ds_read_b128 v[88:91], v189 offset:0
    v_mfma_f32_16x16x32_bf16 v[24:27], v[156:159], v[60:63], v[24:27]
    v_mfma_f32_16x16x32_bf16 v[24:27], v[160:163], v[64:67], v[24:27]
    v_mfma_f32_16x16x32_bf16 v[24:27], v[164:167], v[68:71], v[24:27]
    ds_read_b128 v[92:95], v191 offset:0
    v_mfma_f32_16x16x32_bf16 v[24:27], v[168:171], v[72:75], v[24:27]
    v_mfma_f32_16x16x32_bf16 v[24:27], v[172:175], v[76:79], v[24:27]
    v_mfma_f32_16x16x32_bf16 v[24:27], v[176:179], v[80:83], v[24:27]
    ds_read_b128 v[96:99], v189 offset:256
    s_waitcnt lgkmcnt(3)
    v_mfma_f32_16x16x32_bf16 v[24:27], v[180:183], v[84:87], v[24:27]
    v_mfma_f32_16x16x32_bf16 v[28:31], v[152:155], v[60:63], v[28:31]
    v_mfma_f32_16x16x32_bf16 v[28:31], v[156:159], v[64:67], v[28:31]
    ds_read_b128 v[100:103], v191 offset:256
    v_mfma_f32_16x16x32_bf16 v[28:31], v[160:163], v[68:71], v[28:31]
    v_mfma_f32_16x16x32_bf16 v[28:31], v[164:167], v[72:75], v[28:31]
    v_mfma_f32_16x16x32_bf16 v[28:31], v[168:171], v[76:79], v[28:31]
    ds_read_b128 v[104:107], v189 offset:512
    v_mfma_f32_16x16x32_bf16 v[28:31], v[172:175], v[80:83], v[28:31]
    v_mfma_f32_16x16x32_bf16 v[28:31], v[176:179], v[84:87], v[28:31]
    s_waitcnt lgkmcnt(3)
    v_mfma_f32_16x16x32_bf16 v[28:31], v[180:183], v[88:91], v[28:31]
    ds_read_b128 v[108:111], v191 offset:512
    v_mfma_f32_16x16x32_bf16 v[32:35], v[152:155], v[64:67], v[32:35]
    v_mfma_f32_16x16x32_bf16 v[32:35], v[156:159], v[68:71], v[32:35]
    v_mfma_f32_16x16x32_bf16 v[32:35], v[160:163], v[72:75], v[32:35]
    ds_read_b128 v[112:115], v189 offset:768
    v_mfma_f32_16x16x32_bf16 v[32:35], v[164:167], v[76:79], v[32:35]
    v_mfma_f32_16x16x32_bf16 v[32:35], v[168:171], v[80:83], v[32:35]
    v_mfma_f32_16x16x32_bf16 v[32:35], v[172:175], v[84:87], v[32:35]
    v_mfma_f32_16x16x32_bf16 v[32:35], v[176:179], v[88:91], v[32:35]
    v_mfma_f32_16x16x32_bf16 v[32:35], v[180:183], v[92:95], v[32:35]
    v_mfma_f32_16x16x32_bf16 v[36:39], v[152:155], v[68:71], v[36:39]
    v_mfma_f32_16x16x32_bf16 v[36:39], v[156:159], v[72:75], v[36:39]
    v_mfma_f32_16x16x32_bf16 v[36:39], v[160:163], v[76:79], v[36:39]
    v_mfma_f32_16x16x32_bf16 v[36:39], v[164:167], v[80:83], v[36:39]
    v_mfma_f32_16x16x32_bf16 v[36:39], v[168:171], v[84:87], v[36:39]
    v_mfma_f32_16x16x32_bf16 v[36:39], v[172:175], v[88:91], v[36:39]
    v_mfma_f32_16x16x32_bf16 v[36:39], v[176:179], v[92:95], v[36:39]
    s_waitcnt lgkmcnt(0)
    v_mfma_f32_16x16x32_bf16 v[36:39], v[180:183], v[96:99], v[36:39]
    s_barrier
    v_mfma_f32_16x16x32_bf16 v[40:43], v[152:155], v[72:75], v[40:43]
    ds_read_b64_tr_b16 v[120:121], v21 offset:0
    v_mfma_f32_16x16x32_bf16 v[40:43], v[156:159], v[76:79], v[40:43]
    ds_read_b64_tr_b16 v[122:123], v21 offset:512
    v_mfma_f32_16x16x32_bf16 v[40:43], v[160:163], v[80:83], v[40:43]
    ds_read_b128 v[56:59], v12 offset:52224
    v_mfma_f32_16x16x32_bf16 v[40:43], v[164:167], v[84:87], v[40:43]
    ds_read_b64_tr_b16 v[124:125], v21 offset:4096
    v_mfma_f32_16x16x32_bf16 v[40:43], v[168:171], v[88:91], v[40:43]
    ds_read_b64_tr_b16 v[126:127], v21 offset:4608
    v_mfma_f32_16x16x32_bf16 v[40:43], v[172:175], v[92:95], v[40:43]
    ds_read_b128 v[60:63], v14 offset:52224
    v_mfma_f32_16x16x32_bf16 v[40:43], v[176:179], v[96:99], v[40:43]
    ds_read_b64_tr_b16 v[128:129], v21 offset:8192
    v_mfma_f32_16x16x32_bf16 v[40:43], v[180:183], v[100:103], v[40:43]
    ds_read_b64_tr_b16 v[130:131], v21 offset:8704
    v_mfma_f32_16x16x32_bf16 v[44:47], v[152:155], v[76:79], v[44:47]
    ds_read_b128 v[64:67], v12 offset:52480
    v_mfma_f32_16x16x32_bf16 v[44:47], v[156:159], v[80:83], v[44:47]
    ds_read_b64_tr_b16 v[132:133], v21 offset:12288
    v_mfma_f32_16x16x32_bf16 v[44:47], v[160:163], v[84:87], v[44:47]
    ds_read_b64_tr_b16 v[134:135], v21 offset:12800
    v_mfma_f32_16x16x32_bf16 v[44:47], v[164:167], v[88:91], v[44:47]
    ds_read_b128 v[68:71], v14 offset:52480
    v_mfma_f32_16x16x32_bf16 v[44:47], v[168:171], v[92:95], v[44:47]
    ds_read_b64_tr_b16 v[136:137], v21 offset:16384
    v_mfma_f32_16x16x32_bf16 v[44:47], v[172:175], v[96:99], v[44:47]
    ds_read_b64_tr_b16 v[138:139], v21 offset:16896
    v_mfma_f32_16x16x32_bf16 v[44:47], v[176:179], v[100:103], v[44:47]
    ds_read_b128 v[72:75], v12 offset:52736
    v_mfma_f32_16x16x32_bf16 v[44:47], v[180:183], v[104:107], v[44:47]
    ds_read_b64_tr_b16 v[140:141], v21 offset:20480
    v_mfma_f32_16x16x32_bf16 v[48:51], v[152:155], v[80:83], v[48:51]
    ds_read_b64_tr_b16 v[142:143], v21 offset:20992
    v_mfma_f32_16x16x32_bf16 v[48:51], v[156:159], v[84:87], v[48:51]
    ds_read_b128 v[76:79], v14 offset:52736
    v_mfma_f32_16x16x32_bf16 v[48:51], v[160:163], v[88:91], v[48:51]
    ds_read_b64_tr_b16 v[144:145], v21 offset:24576
    v_mfma_f32_16x16x32_bf16 v[48:51], v[164:167], v[92:95], v[48:51]
    ds_read_b64_tr_b16 v[146:147], v21 offset:25088
    v_mfma_f32_16x16x32_bf16 v[48:51], v[168:171], v[96:99], v[48:51]
    ds_read_b128 v[80:83], v12 offset:52992
    v_mfma_f32_16x16x32_bf16 v[48:51], v[172:175], v[100:103], v[48:51]
    v_mfma_f32_16x16x32_bf16 v[48:51], v[176:179], v[104:107], v[48:51]
    v_mfma_f32_16x16x32_bf16 v[48:51], v[180:183], v[108:111], v[48:51]
    v_mfma_f32_16x16x32_bf16 v[52:55], v[152:155], v[84:87], v[52:55]
    v_mfma_f32_16x16x32_bf16 v[52:55], v[156:159], v[88:91], v[52:55]
    ds_read_b128 v[84:87], v14 offset:52992
    v_mfma_f32_16x16x32_bf16 v[52:55], v[160:163], v[92:95], v[52:55]
    v_mfma_f32_16x16x32_bf16 v[52:55], v[164:167], v[96:99], v[52:55]
    v_mfma_f32_16x16x32_bf16 v[52:55], v[168:171], v[100:103], v[52:55]
    v_mfma_f32_16x16x32_bf16 v[52:55], v[172:175], v[104:107], v[52:55]
    v_mfma_f32_16x16x32_bf16 v[52:55], v[176:179], v[108:111], v[52:55]
    v_mfma_f32_16x16x32_bf16 v[52:55], v[180:183], v[112:115], v[52:55]
    s_waitcnt lgkmcnt(1)
    v_mfma_f32_16x16x32_bf16 v[216:219], v[120:123], v[56:59], v[216:219]
    ds_read_b128 v[88:91], v16 offset:52224
    v_mfma_f32_16x16x32_bf16 v[216:219], v[124:127], v[60:63], v[216:219]
    v_mfma_f32_16x16x32_bf16 v[216:219], v[128:131], v[64:67], v[216:219]
    v_mfma_f32_16x16x32_bf16 v[216:219], v[132:135], v[68:71], v[216:219]
    ds_read_b128 v[92:95], v18 offset:52224
    v_mfma_f32_16x16x32_bf16 v[216:219], v[136:139], v[72:75], v[216:219]
    v_mfma_f32_16x16x32_bf16 v[216:219], v[140:143], v[76:79], v[216:219]
    v_mfma_f32_16x16x32_bf16 v[216:219], v[144:147], v[80:83], v[216:219]
    ds_read_b128 v[96:99], v16 offset:52480
    v_mfma_f32_16x16x32_bf16 v[220:223], v[120:123], v[60:63], v[220:223]
    v_mfma_f32_16x16x32_bf16 v[220:223], v[124:127], v[64:67], v[220:223]
    v_mfma_f32_16x16x32_bf16 v[220:223], v[128:131], v[68:71], v[220:223]
    ds_read_b128 v[100:103], v18 offset:52480
    v_mfma_f32_16x16x32_bf16 v[220:223], v[132:135], v[72:75], v[220:223]
    v_mfma_f32_16x16x32_bf16 v[220:223], v[136:139], v[76:79], v[220:223]
    v_mfma_f32_16x16x32_bf16 v[220:223], v[140:143], v[80:83], v[220:223]
    ds_read_b128 v[104:107], v16 offset:52736
    s_waitcnt lgkmcnt(4)
    v_mfma_f32_16x16x32_bf16 v[220:223], v[144:147], v[84:87], v[220:223]
    v_mfma_f32_16x16x32_bf16 v[224:227], v[120:123], v[64:67], v[224:227]
    v_mfma_f32_16x16x32_bf16 v[224:227], v[124:127], v[68:71], v[224:227]
    ds_read_b128 v[108:111], v18 offset:52736
    v_mfma_f32_16x16x32_bf16 v[224:227], v[128:131], v[72:75], v[224:227]
    v_mfma_f32_16x16x32_bf16 v[224:227], v[132:135], v[76:79], v[224:227]
    v_mfma_f32_16x16x32_bf16 v[224:227], v[136:139], v[80:83], v[224:227]
    v_mfma_f32_16x16x32_bf16 v[224:227], v[140:143], v[84:87], v[224:227]
    v_mfma_f32_16x16x32_bf16 v[224:227], v[144:147], v[88:91], v[224:227]
    v_mfma_f32_16x16x32_bf16 v[228:231], v[120:123], v[68:71], v[228:231]
    v_mfma_f32_16x16x32_bf16 v[228:231], v[124:127], v[72:75], v[228:231]
    v_mfma_f32_16x16x32_bf16 v[228:231], v[128:131], v[76:79], v[228:231]
    v_mfma_f32_16x16x32_bf16 v[228:231], v[132:135], v[80:83], v[228:231]
    v_mfma_f32_16x16x32_bf16 v[228:231], v[136:139], v[84:87], v[228:231]
    v_mfma_f32_16x16x32_bf16 v[228:231], v[140:143], v[88:91], v[228:231]
    s_waitcnt lgkmcnt(0)
    v_mfma_f32_16x16x32_bf16 v[228:231], v[144:147], v[92:95], v[228:231]
    s_barrier
    v_mfma_f32_16x16x32_bf16 v[232:235], v[120:123], v[72:75], v[232:235]
    ds_read_b128 v[56:59], v12 offset:34816
    v_mfma_f32_16x16x32_bf16 v[232:235], v[124:127], v[76:79], v[232:235]
    v_mfma_f32_16x16x32_bf16 v[232:235], v[128:131], v[80:83], v[232:235]
    ds_read_b128 v[60:63], v14 offset:34816
    v_mfma_f32_16x16x32_bf16 v[232:235], v[132:135], v[84:87], v[232:235]
    v_mfma_f32_16x16x32_bf16 v[232:235], v[136:139], v[88:91], v[232:235]
    ds_read_b128 v[64:67], v12 offset:35072
    v_mfma_f32_16x16x32_bf16 v[232:235], v[140:143], v[92:95], v[232:235]
    v_mfma_f32_16x16x32_bf16 v[232:235], v[144:147], v[96:99], v[232:235]
    v_mfma_f32_16x16x32_bf16 v[236:239], v[120:123], v[76:79], v[236:239]
    ds_read_b128 v[68:71], v14 offset:35072
    v_mfma_f32_16x16x32_bf16 v[236:239], v[124:127], v[80:83], v[236:239]
    v_mfma_f32_16x16x32_bf16 v[236:239], v[128:131], v[84:87], v[236:239]
    ds_read_b128 v[72:75], v12 offset:35328
    v_mfma_f32_16x16x32_bf16 v[236:239], v[132:135], v[88:91], v[236:239]
    v_mfma_f32_16x16x32_bf16 v[236:239], v[136:139], v[92:95], v[236:239]
    ds_read_b128 v[76:79], v14 offset:35328
    v_mfma_f32_16x16x32_bf16 v[236:239], v[140:143], v[96:99], v[236:239]
    v_mfma_f32_16x16x32_bf16 v[236:239], v[144:147], v[100:103], v[236:239]
    v_mfma_f32_16x16x32_bf16 v[240:243], v[120:123], v[80:83], v[240:243]
    v_mfma_f32_16x16x32_bf16 v[240:243], v[124:127], v[84:87], v[240:243]
    v_mfma_f32_16x16x32_bf16 v[240:243], v[128:131], v[88:91], v[240:243]
    ds_read_b128 v[80:83], v12 offset:35584
    v_mfma_f32_16x16x32_bf16 v[240:243], v[132:135], v[92:95], v[240:243]
    v_mfma_f32_16x16x32_bf16 v[240:243], v[136:139], v[96:99], v[240:243]
    v_mfma_f32_16x16x32_bf16 v[240:243], v[140:143], v[100:103], v[240:243]
    v_mfma_f32_16x16x32_bf16 v[240:243], v[144:147], v[104:107], v[240:243]
    v_mfma_f32_16x16x32_bf16 v[244:247], v[120:123], v[84:87], v[244:247]
    v_mfma_f32_16x16x32_bf16 v[244:247], v[124:127], v[88:91], v[244:247]
    ds_read_b128 v[84:87], v14 offset:35584
    v_mfma_f32_16x16x32_bf16 v[244:247], v[128:131], v[92:95], v[244:247]
    v_mfma_f32_16x16x32_bf16 v[244:247], v[132:135], v[96:99], v[244:247]
    v_mfma_f32_16x16x32_bf16 v[244:247], v[136:139], v[100:103], v[244:247]
    v_mfma_f32_16x16x32_bf16 v[244:247], v[140:143], v[104:107], v[244:247]
    v_mfma_f32_16x16x32_bf16 v[244:247], v[144:147], v[108:111], v[244:247]
    s_waitcnt lgkmcnt(1)
    v_mfma_f32_16x16x32_bf16 v[24:27], v[120:123], v[56:59], v[24:27]
    ds_read_b128 v[88:91], v16 offset:34816
    v_mfma_f32_16x16x32_bf16 v[24:27], v[124:127], v[60:63], v[24:27]
    v_mfma_f32_16x16x32_bf16 v[24:27], v[128:131], v[64:67], v[24:27]
    v_mfma_f32_16x16x32_bf16 v[24:27], v[132:135], v[68:71], v[24:27]
    ds_read_b128 v[92:95], v18 offset:34816
    v_mfma_f32_16x16x32_bf16 v[24:27], v[136:139], v[72:75], v[24:27]
    v_mfma_f32_16x16x32_bf16 v[24:27], v[140:143], v[76:79], v[24:27]
    v_mfma_f32_16x16x32_bf16 v[24:27], v[144:147], v[80:83], v[24:27]
    ds_read_b128 v[96:99], v16 offset:35072
    v_mfma_f32_16x16x32_bf16 v[28:31], v[120:123], v[60:63], v[28:31]
    v_mfma_f32_16x16x32_bf16 v[28:31], v[124:127], v[64:67], v[28:31]
    v_mfma_f32_16x16x32_bf16 v[28:31], v[128:131], v[68:71], v[28:31]
    ds_read_b128 v[100:103], v18 offset:35072
    v_mfma_f32_16x16x32_bf16 v[28:31], v[132:135], v[72:75], v[28:31]
    v_mfma_f32_16x16x32_bf16 v[28:31], v[136:139], v[76:79], v[28:31]
    v_mfma_f32_16x16x32_bf16 v[28:31], v[140:143], v[80:83], v[28:31]
    ds_read_b128 v[104:107], v16 offset:35328
    s_waitcnt lgkmcnt(4)
    v_mfma_f32_16x16x32_bf16 v[28:31], v[144:147], v[84:87], v[28:31]
    v_mfma_f32_16x16x32_bf16 v[32:35], v[120:123], v[64:67], v[32:35]
    v_mfma_f32_16x16x32_bf16 v[32:35], v[124:127], v[68:71], v[32:35]
    ds_read_b128 v[108:111], v18 offset:35328
    v_mfma_f32_16x16x32_bf16 v[32:35], v[128:131], v[72:75], v[32:35]
    v_mfma_f32_16x16x32_bf16 v[32:35], v[132:135], v[76:79], v[32:35]
    v_mfma_f32_16x16x32_bf16 v[32:35], v[136:139], v[80:83], v[32:35]
    v_mfma_f32_16x16x32_bf16 v[32:35], v[140:143], v[84:87], v[32:35]
    v_mfma_f32_16x16x32_bf16 v[32:35], v[144:147], v[88:91], v[32:35]
    v_mfma_f32_16x16x32_bf16 v[36:39], v[120:123], v[68:71], v[36:39]
    v_mfma_f32_16x16x32_bf16 v[36:39], v[124:127], v[72:75], v[36:39]
    v_mfma_f32_16x16x32_bf16 v[36:39], v[128:131], v[76:79], v[36:39]
    v_mfma_f32_16x16x32_bf16 v[36:39], v[132:135], v[80:83], v[36:39]
    v_mfma_f32_16x16x32_bf16 v[36:39], v[136:139], v[84:87], v[36:39]
    v_mfma_f32_16x16x32_bf16 v[36:39], v[140:143], v[88:91], v[36:39]
    s_waitcnt lgkmcnt(0)
    v_mfma_f32_16x16x32_bf16 v[36:39], v[144:147], v[92:95], v[36:39]
    s_barrier
    v_mfma_f32_16x16x32_bf16 v[40:43], v[120:123], v[72:75], v[40:43]
    ds_read_b64_tr_b16 v[152:153], v21 offset:32768
    v_mfma_f32_16x16x32_bf16 v[40:43], v[124:127], v[76:79], v[40:43]
    ds_read_b64_tr_b16 v[154:155], v21 offset:33280
    v_mfma_f32_16x16x32_bf16 v[40:43], v[128:131], v[80:83], v[40:43]
    ds_read_b128 v[56:59], v13 offset:52224
    v_mfma_f32_16x16x32_bf16 v[40:43], v[132:135], v[84:87], v[40:43]
    ds_read_b64_tr_b16 v[156:157], v21 offset:36864
    v_mfma_f32_16x16x32_bf16 v[40:43], v[136:139], v[88:91], v[40:43]
    ds_read_b64_tr_b16 v[158:159], v21 offset:37376
    v_mfma_f32_16x16x32_bf16 v[40:43], v[140:143], v[92:95], v[40:43]
    ds_read_b128 v[60:63], v15 offset:52224
    v_mfma_f32_16x16x32_bf16 v[40:43], v[144:147], v[96:99], v[40:43]
    ds_read_b64_tr_b16 v[160:161], v21 offset:40960
    v_mfma_f32_16x16x32_bf16 v[44:47], v[120:123], v[76:79], v[44:47]
    ds_read_b64_tr_b16 v[162:163], v21 offset:41472
    v_mfma_f32_16x16x32_bf16 v[44:47], v[124:127], v[80:83], v[44:47]
    ds_read_b128 v[64:67], v13 offset:52480
    v_mfma_f32_16x16x32_bf16 v[44:47], v[128:131], v[84:87], v[44:47]
    ds_read_b64_tr_b16 v[164:165], v21 offset:45056
    v_mfma_f32_16x16x32_bf16 v[44:47], v[132:135], v[88:91], v[44:47]
    ds_read_b64_tr_b16 v[166:167], v21 offset:45568
    v_mfma_f32_16x16x32_bf16 v[44:47], v[136:139], v[92:95], v[44:47]
    ds_read_b128 v[68:71], v15 offset:52480
    v_mfma_f32_16x16x32_bf16 v[44:47], v[140:143], v[96:99], v[44:47]
    ds_read_b64_tr_b16 v[168:169], v21 offset:49152
    v_mfma_f32_16x16x32_bf16 v[44:47], v[144:147], v[100:103], v[44:47]
    ds_read_b64_tr_b16 v[170:171], v21 offset:49664
    v_mfma_f32_16x16x32_bf16 v[48:51], v[120:123], v[80:83], v[48:51]
    ds_read_b128 v[72:75], v13 offset:52736
    v_mfma_f32_16x16x32_bf16 v[48:51], v[124:127], v[84:87], v[48:51]
    ds_read_b64_tr_b16 v[172:173], v21 offset:53248
    v_mfma_f32_16x16x32_bf16 v[48:51], v[128:131], v[88:91], v[48:51]
    ds_read_b64_tr_b16 v[174:175], v21 offset:53760
    v_mfma_f32_16x16x32_bf16 v[48:51], v[132:135], v[92:95], v[48:51]
    ds_read_b128 v[76:79], v15 offset:52736
    v_mfma_f32_16x16x32_bf16 v[48:51], v[136:139], v[96:99], v[48:51]
    ds_read_b64_tr_b16 v[176:177], v21 offset:57344
    v_mfma_f32_16x16x32_bf16 v[48:51], v[140:143], v[100:103], v[48:51]
    ds_read_b64_tr_b16 v[178:179], v21 offset:57856
    v_mfma_f32_16x16x32_bf16 v[48:51], v[144:147], v[104:107], v[48:51]
    ds_read_b128 v[80:83], v13 offset:52992
    v_mfma_f32_16x16x32_bf16 v[52:55], v[120:123], v[84:87], v[52:55]
    v_mfma_f32_16x16x32_bf16 v[52:55], v[124:127], v[88:91], v[52:55]
    ds_read_b128 v[84:87], v15 offset:52992
    v_mfma_f32_16x16x32_bf16 v[52:55], v[128:131], v[92:95], v[52:55]
    v_mfma_f32_16x16x32_bf16 v[52:55], v[132:135], v[96:99], v[52:55]
    v_mfma_f32_16x16x32_bf16 v[52:55], v[136:139], v[100:103], v[52:55]
    v_mfma_f32_16x16x32_bf16 v[52:55], v[140:143], v[104:107], v[52:55]
    v_mfma_f32_16x16x32_bf16 v[52:55], v[144:147], v[108:111], v[52:55]
    s_waitcnt lgkmcnt(4)
    v_mfma_f32_16x16x32_bf16 v[216:219], v[152:155], v[56:59], v[216:219]
    ds_read_b128 v[88:91], v17 offset:52224
    v_mfma_f32_16x16x32_bf16 v[216:219], v[156:159], v[60:63], v[216:219]
    v_mfma_f32_16x16x32_bf16 v[216:219], v[160:163], v[64:67], v[216:219]
    v_mfma_f32_16x16x32_bf16 v[216:219], v[164:167], v[68:71], v[216:219]
    ds_read_b128 v[92:95], v19 offset:52224
    v_mfma_f32_16x16x32_bf16 v[216:219], v[168:171], v[72:75], v[216:219]
    v_mfma_f32_16x16x32_bf16 v[216:219], v[172:175], v[76:79], v[216:219]
    s_waitcnt lgkmcnt(2)
    v_mfma_f32_16x16x32_bf16 v[216:219], v[176:179], v[80:83], v[216:219]
    ds_read_b128 v[96:99], v17 offset:52480
    v_mfma_f32_16x16x32_bf16 v[220:223], v[152:155], v[60:63], v[220:223]
    v_mfma_f32_16x16x32_bf16 v[220:223], v[156:159], v[64:67], v[220:223]
    v_mfma_f32_16x16x32_bf16 v[220:223], v[160:163], v[68:71], v[220:223]
    ds_read_b128 v[100:103], v19 offset:52480
    v_mfma_f32_16x16x32_bf16 v[220:223], v[164:167], v[72:75], v[220:223]
    v_mfma_f32_16x16x32_bf16 v[220:223], v[168:171], v[76:79], v[220:223]
    v_mfma_f32_16x16x32_bf16 v[220:223], v[172:175], v[80:83], v[220:223]
    ds_read_b128 v[104:107], v17 offset:52736
    v_mfma_f32_16x16x32_bf16 v[220:223], v[176:179], v[84:87], v[220:223]
    v_mfma_f32_16x16x32_bf16 v[224:227], v[152:155], v[64:67], v[224:227]
    v_mfma_f32_16x16x32_bf16 v[224:227], v[156:159], v[68:71], v[224:227]
    ds_read_b128 v[108:111], v19 offset:52736
    v_mfma_f32_16x16x32_bf16 v[224:227], v[160:163], v[72:75], v[224:227]
    v_mfma_f32_16x16x32_bf16 v[224:227], v[164:167], v[76:79], v[224:227]
    v_mfma_f32_16x16x32_bf16 v[224:227], v[168:171], v[80:83], v[224:227]
    v_mfma_f32_16x16x32_bf16 v[224:227], v[172:175], v[84:87], v[224:227]
    s_waitcnt lgkmcnt(2)
    v_mfma_f32_16x16x32_bf16 v[224:227], v[176:179], v[88:91], v[224:227]
    v_mfma_f32_16x16x32_bf16 v[228:231], v[152:155], v[68:71], v[228:231]
    v_mfma_f32_16x16x32_bf16 v[228:231], v[156:159], v[72:75], v[228:231]
    v_mfma_f32_16x16x32_bf16 v[228:231], v[160:163], v[76:79], v[228:231]
    v_mfma_f32_16x16x32_bf16 v[228:231], v[164:167], v[80:83], v[228:231]
    v_mfma_f32_16x16x32_bf16 v[228:231], v[168:171], v[84:87], v[228:231]
    v_mfma_f32_16x16x32_bf16 v[228:231], v[172:175], v[88:91], v[228:231]
    v_mfma_f32_16x16x32_bf16 v[228:231], v[176:179], v[92:95], v[228:231]
    s_waitcnt lgkmcnt(0)
    s_barrier
    v_mfma_f32_16x16x32_bf16 v[232:235], v[152:155], v[72:75], v[232:235]
    ds_read_b128 v[56:59], v13 offset:34816
    v_mfma_f32_16x16x32_bf16 v[232:235], v[156:159], v[76:79], v[232:235]
    v_mfma_f32_16x16x32_bf16 v[232:235], v[160:163], v[80:83], v[232:235]
    ds_read_b128 v[60:63], v15 offset:34816
    v_mfma_f32_16x16x32_bf16 v[232:235], v[164:167], v[84:87], v[232:235]
    v_mfma_f32_16x16x32_bf16 v[232:235], v[168:171], v[88:91], v[232:235]
    ds_read_b128 v[64:67], v13 offset:35072
    v_mfma_f32_16x16x32_bf16 v[232:235], v[172:175], v[92:95], v[232:235]
    v_mfma_f32_16x16x32_bf16 v[232:235], v[176:179], v[96:99], v[232:235]
    v_mfma_f32_16x16x32_bf16 v[236:239], v[152:155], v[76:79], v[236:239]
    ds_read_b128 v[68:71], v15 offset:35072
    v_mfma_f32_16x16x32_bf16 v[236:239], v[156:159], v[80:83], v[236:239]
    v_mfma_f32_16x16x32_bf16 v[236:239], v[160:163], v[84:87], v[236:239]
    ds_read_b128 v[72:75], v13 offset:35328
    v_mfma_f32_16x16x32_bf16 v[236:239], v[164:167], v[88:91], v[236:239]
    v_mfma_f32_16x16x32_bf16 v[236:239], v[168:171], v[92:95], v[236:239]
    ds_read_b128 v[76:79], v15 offset:35328
    v_mfma_f32_16x16x32_bf16 v[236:239], v[172:175], v[96:99], v[236:239]
    v_mfma_f32_16x16x32_bf16 v[236:239], v[176:179], v[100:103], v[236:239]
    v_mfma_f32_16x16x32_bf16 v[240:243], v[152:155], v[80:83], v[240:243]
    v_mfma_f32_16x16x32_bf16 v[240:243], v[156:159], v[84:87], v[240:243]
    v_mfma_f32_16x16x32_bf16 v[240:243], v[160:163], v[88:91], v[240:243]
    ds_read_b128 v[80:83], v13 offset:35584
    v_mfma_f32_16x16x32_bf16 v[240:243], v[164:167], v[92:95], v[240:243]
    v_mfma_f32_16x16x32_bf16 v[240:243], v[168:171], v[96:99], v[240:243]
    v_mfma_f32_16x16x32_bf16 v[240:243], v[172:175], v[100:103], v[240:243]
    v_mfma_f32_16x16x32_bf16 v[240:243], v[176:179], v[104:107], v[240:243]
    v_mfma_f32_16x16x32_bf16 v[244:247], v[152:155], v[84:87], v[244:247]
    v_mfma_f32_16x16x32_bf16 v[244:247], v[156:159], v[88:91], v[244:247]
    ds_read_b128 v[84:87], v15 offset:35584
    v_mfma_f32_16x16x32_bf16 v[244:247], v[160:163], v[92:95], v[244:247]
    v_mfma_f32_16x16x32_bf16 v[244:247], v[164:167], v[96:99], v[244:247]
    v_mfma_f32_16x16x32_bf16 v[244:247], v[168:171], v[100:103], v[244:247]
    v_mfma_f32_16x16x32_bf16 v[244:247], v[172:175], v[104:107], v[244:247]
    v_mfma_f32_16x16x32_bf16 v[244:247], v[176:179], v[108:111], v[244:247]
    s_waitcnt lgkmcnt(1)
    v_mfma_f32_16x16x32_bf16 v[24:27], v[152:155], v[56:59], v[24:27]
    ds_read_b128 v[88:91], v17 offset:34816
    v_mfma_f32_16x16x32_bf16 v[24:27], v[156:159], v[60:63], v[24:27]
    v_mfma_f32_16x16x32_bf16 v[24:27], v[160:163], v[64:67], v[24:27]
    v_mfma_f32_16x16x32_bf16 v[24:27], v[164:167], v[68:71], v[24:27]
    ds_read_b128 v[92:95], v19 offset:34816
    v_mfma_f32_16x16x32_bf16 v[24:27], v[168:171], v[72:75], v[24:27]
    v_mfma_f32_16x16x32_bf16 v[24:27], v[172:175], v[76:79], v[24:27]
    v_mfma_f32_16x16x32_bf16 v[24:27], v[176:179], v[80:83], v[24:27]
    ds_read_b128 v[96:99], v17 offset:35072
    v_mfma_f32_16x16x32_bf16 v[28:31], v[152:155], v[60:63], v[28:31]
    v_mfma_f32_16x16x32_bf16 v[28:31], v[156:159], v[64:67], v[28:31]
    v_mfma_f32_16x16x32_bf16 v[28:31], v[160:163], v[68:71], v[28:31]
    ds_read_b128 v[100:103], v19 offset:35072
    v_mfma_f32_16x16x32_bf16 v[28:31], v[164:167], v[72:75], v[28:31]
    v_mfma_f32_16x16x32_bf16 v[28:31], v[168:171], v[76:79], v[28:31]
    v_mfma_f32_16x16x32_bf16 v[28:31], v[172:175], v[80:83], v[28:31]
    ds_read_b128 v[104:107], v17 offset:35328
    s_waitcnt lgkmcnt(4)
    v_mfma_f32_16x16x32_bf16 v[28:31], v[176:179], v[84:87], v[28:31]
    v_mfma_f32_16x16x32_bf16 v[32:35], v[152:155], v[64:67], v[32:35]
    v_mfma_f32_16x16x32_bf16 v[32:35], v[156:159], v[68:71], v[32:35]
    ds_read_b128 v[108:111], v19 offset:35328
    v_mfma_f32_16x16x32_bf16 v[32:35], v[160:163], v[72:75], v[32:35]
    v_mfma_f32_16x16x32_bf16 v[32:35], v[164:167], v[76:79], v[32:35]
    v_mfma_f32_16x16x32_bf16 v[32:35], v[168:171], v[80:83], v[32:35]
    v_mfma_f32_16x16x32_bf16 v[32:35], v[172:175], v[84:87], v[32:35]
    v_mfma_f32_16x16x32_bf16 v[32:35], v[176:179], v[88:91], v[32:35]
    v_mfma_f32_16x16x32_bf16 v[36:39], v[152:155], v[68:71], v[36:39]
    v_mfma_f32_16x16x32_bf16 v[36:39], v[156:159], v[72:75], v[36:39]
    v_mfma_f32_16x16x32_bf16 v[36:39], v[160:163], v[76:79], v[36:39]
    v_mfma_f32_16x16x32_bf16 v[36:39], v[164:167], v[80:83], v[36:39]
    v_mfma_f32_16x16x32_bf16 v[36:39], v[168:171], v[84:87], v[36:39]
    v_mfma_f32_16x16x32_bf16 v[36:39], v[172:175], v[88:91], v[36:39]
    s_waitcnt lgkmcnt(0)
    v_mfma_f32_16x16x32_bf16 v[36:39], v[176:179], v[92:95], v[36:39]
    s_barrier
L_c_join:
    v_mfma_f32_16x16x32_bf16 v[40:43], v[152:155], v[72:75], v[40:43]
    ds_read_b64_tr_b16 v[120:121], v20 offset:0
    v_mfma_f32_16x16x32_bf16 v[40:43], v[156:159], v[76:79], v[40:43]
    ds_read_b64_tr_b16 v[122:123], v20 offset:512
    v_mfma_f32_16x16x32_bf16 v[40:43], v[160:163], v[80:83], v[40:43]
    ds_read_b128 v[56:59], v184 offset:0
    v_mfma_f32_16x16x32_bf16 v[40:43], v[164:167], v[84:87], v[40:43]
    ds_read_b64_tr_b16 v[124:125], v20 offset:4096
    v_mfma_f32_16x16x32_bf16 v[40:43], v[168:171], v[88:91], v[40:43]
    ds_read_b64_tr_b16 v[126:127], v20 offset:4608
    v_mfma_f32_16x16x32_bf16 v[40:43], v[172:175], v[92:95], v[40:43]
    ds_read_b128 v[60:63], v186 offset:0
    v_mfma_f32_16x16x32_bf16 v[40:43], v[176:179], v[96:99], v[40:43]
    ds_read_b64_tr_b16 v[128:129], v20 offset:8192
    v_mfma_f32_16x16x32_bf16 v[44:47], v[152:155], v[76:79], v[44:47]
    ds_read_b64_tr_b16 v[130:131], v20 offset:8704
    v_mfma_f32_16x16x32_bf16 v[44:47], v[156:159], v[80:83], v[44:47]
    ds_read_b128 v[64:67], v184 offset:256
    v_mfma_f32_16x16x32_bf16 v[44:47], v[160:163], v[84:87], v[44:47]
    ds_read_b64_tr_b16 v[132:133], v20 offset:12288
    v_mfma_f32_16x16x32_bf16 v[44:47], v[164:167], v[88:91], v[44:47]
    ds_read_b64_tr_b16 v[134:135], v20 offset:12800
    v_mfma_f32_16x16x32_bf16 v[44:47], v[168:171], v[92:95], v[44:47]
    ds_read_b128 v[68:71], v186 offset:256
    v_mfma_f32_16x16x32_bf16 v[44:47], v[172:175], v[96:99], v[44:47]
    ds_read_b64_tr_b16 v[136:137], v20 offset:16384
    v_mfma_f32_16x16x32_bf16 v[44:47], v[176:179], v[100:103], v[44:47]
    ds_read_b64_tr_b16 v[138:139], v20 offset:16896
    v_mfma_f32_16x16x32_bf16 v[48:51], v[152:155], v[80:83], v[48:51]
    ds_read_b128 v[72:75], v184 offset:512
    v_mfma_f32_16x16x32_bf16 v[48:51], v[156:159], v[84:87], v[48:51]
    ds_read_b64_tr_b16 v[140:141], v20 offset:20480
    v_mfma_f32_16x16x32_bf16 v[48:51], v[160:163], v[88:91], v[48:51]
    ds_read_b64_tr_b16 v[142:143], v20 offset:20992
    v_mfma_f32_16x16x32_bf16 v[48:51], v[164:167], v[92:95], v[48:51]
    ds_read_b128 v[76:79], v186 offset:512
    v_mfma_f32_16x16x32_bf16 v[48:51], v[168:171], v[96:99], v[48:51]
    ds_read_b64_tr_b16 v[144:145], v20 offset:24576
    v_mfma_f32_16x16x32_bf16 v[48:51], v[172:175], v[100:103], v[48:51]
    ds_read_b64_tr_b16 v[146:147], v20 offset:25088
    v_mfma_f32_16x16x32_bf16 v[48:51], v[176:179], v[104:107], v[48:51]
    ds_read_b128 v[80:83], v184 offset:768
    v_mfma_f32_16x16x32_bf16 v[52:55], v[152:155], v[84:87], v[52:55]
    ds_read_b64_tr_b16 v[148:149], v20 offset:28672
    v_mfma_f32_16x16x32_bf16 v[52:55], v[156:159], v[88:91], v[52:55]
    ds_read_b64_tr_b16 v[150:151], v20 offset:29184
    v_mfma_f32_16x16x32_bf16 v[52:55], v[160:163], v[92:95], v[52:55]
    ds_read_b128 v[84:87], v186 offset:768
    v_mfma_f32_16x16x32_bf16 v[52:55], v[164:167], v[96:99], v[52:55]
    v_mfma_f32_16x16x32_bf16 v[52:55], v[168:171], v[100:103], v[52:55]
    v_mfma_f32_16x16x32_bf16 v[52:55], v[172:175], v[104:107], v[52:55]
    v_mfma_f32_16x16x32_bf16 v[52:55], v[176:179], v[108:111], v[52:55]
    s_waitcnt lgkmcnt(6)
    v_mfma_f32_16x16x32_bf16 v[216:219], v[120:123], v[56:59], v[216:219]
    ds_read_b128 v[88:91], v188 offset:0
    v_mfma_f32_16x16x32_bf16 v[216:219], v[124:127], v[60:63], v[216:219]
    v_mfma_f32_16x16x32_bf16 v[216:219], v[128:131], v[64:67], v[216:219]
    v_mfma_f32_16x16x32_bf16 v[216:219], v[132:135], v[68:71], v[216:219]
    ds_read_b128 v[92:95], v190 offset:0
    v_mfma_f32_16x16x32_bf16 v[216:219], v[136:139], v[72:75], v[216:219]
    v_mfma_f32_16x16x32_bf16 v[216:219], v[140:143], v[76:79], v[216:219]
    s_waitcnt lgkmcnt(2)
    v_mfma_f32_16x16x32_bf16 v[216:219], v[144:147], v[80:83], v[216:219]
    ds_read_b128 v[96:99], v188 offset:256
    v_mfma_f32_16x16x32_bf16 v[216:219], v[148:151], v[84:87], v[216:219]
    v_mfma_f32_16x16x32_bf16 v[220:223], v[120:123], v[60:63], v[220:223]
    v_mfma_f32_16x16x32_bf16 v[220:223], v[124:127], v[64:67], v[220:223]
    ds_read_b128 v[100:103], v190 offset:256
    v_mfma_f32_16x16x32_bf16 v[220:223], v[128:131], v[68:71], v[220:223]
    v_mfma_f32_16x16x32_bf16 v[220:223], v[132:135], v[72:75], v[220:223]
    v_mfma_f32_16x16x32_bf16 v[220:223], v[136:139], v[76:79], v[220:223]
    ds_read_b128 v[104:107], v188 offset:512
    v_mfma_f32_16x16x32_bf16 v[220:223], v[140:143], v[80:83], v[220:223]
    v_mfma_f32_16x16x32_bf16 v[220:223], v[144:147], v[84:87], v[220:223]
    s_waitcnt lgkmcnt(3)
    v_mfma_f32_16x16x32_bf16 v[220:223], v[148:151], v[88:91], v[220:223]
    ds_read_b128 v[108:111], v190 offset:512
    v_mfma_f32_16x16x32_bf16 v[224:227], v[120:123], v[64:67], v[224:227]
    v_mfma_f32_16x16x32_bf16 v[224:227], v[124:127], v[68:71], v[224:227]
    v_mfma_f32_16x16x32_bf16 v[224:227], v[128:131], v[72:75], v[224:227]
    ds_read_b128 v[112:115], v188 offset:768
    v_mfma_f32_16x16x32_bf16 v[224:227], v[132:135], v[76:79], v[224:227]
    v_mfma_f32_16x16x32_bf16 v[224:227], v[136:139], v[80:83], v[224:227]
    v_mfma_f32_16x16x32_bf16 v[224:227], v[140:143], v[84:87], v[224:227]
    v_mfma_f32_16x16x32_bf16 v[224:227], v[144:147], v[88:91], v[224:227]
    v_mfma_f32_16x16x32_bf16 v[224:227], v[148:151], v[92:95], v[224:227]
    v_mfma_f32_16x16x32_bf16 v[228:231], v[120:123], v[68:71], v[228:231]
    v_mfma_f32_16x16x32_bf16 v[228:231], v[124:127], v[72:75], v[228:231]
    v_mfma_f32_16x16x32_bf16 v[228:231], v[128:131], v[76:79], v[228:231]
    v_mfma_f32_16x16x32_bf16 v[228:231], v[132:135], v[80:83], v[228:231]
    v_mfma_f32_16x16x32_bf16 v[228:231], v[136:139], v[84:87], v[228:231]
    v_mfma_f32_16x16x32_bf16 v[228:231], v[140:143], v[88:91], v[228:231]
    v_mfma_f32_16x16x32_bf16 v[228:231], v[144:147], v[92:95], v[228:231]
    s_waitcnt lgkmcnt(0)
    v_mfma_f32_16x16x32_bf16 v[228:231], v[148:151], v[96:99], v[228:231]
    s_barrier
L_pg3:
    s_cbranch_execz L_pb3
    v_mfma_f32_16x16x32_bf16 v[232:235], v[120:123], v[72:75], v[232:235]
    ds_read_b64_tr_b16 v[152:153], v21 offset:0
    v_mfma_f32_16x16x32_bf16 v[232:235], v[124:127], v[76:79], v[232:235]
    ds_read_b64_tr_b16 v[154:155], v21 offset:512
    v_mfma_f32_16x16x32_bf16 v[232:235], v[128:131], v[80:83], v[232:235]
    ds_read_b128 v[56:59], v185 offset:0
    v_mfma_f32_16x16x32_bf16 v[232:235], v[132:135], v[84:87], v[232:235]
    ds_read_b64_tr_b16 v[156:157], v21 offset:4096
    v_mfma_f32_16x16x32_bf16 v[232:235], v[136:139], v[88:91], v[232:235]
    ds_read_b64_tr_b16 v[158:159], v21 offset:4608
    v_mfma_f32_16x16x32_bf16 v[232:235], v[140:143], v[92:95], v[232:235]
    ds_read_b128 v[60:63], v187 offset:0
    v_mfma_f32_16x16x32_bf16 v[232:235], v[144:147], v[96:99], v[232:235]
    ds_read_b64_tr_b16 v[160:161], v21 offset:8192
    v_mfma_f32_16x16x32_bf16 v[232:235], v[148:151], v[100:103], v[232:235]
    ds_read_b64_tr_b16 v[162:163], v21 offset:8704
    v_mfma_f32_16x16x32_bf16 v[236:239], v[120:123], v[76:79], v[236:239]
    ds_read_b128 v[64:67], v185 offset:256
    v_mfma_f32_16x16x32_bf16 v[236:239], v[124:127], v[80:83], v[236:239]
    ds_read_b64_tr_b16 v[164:165], v21 offset:12288
    v_mfma_f32_16x16x32_bf16 v[236:239], v[128:131], v[84:87], v[236:239]
    ds_read_b64_tr_b16 v[166:167], v21 offset:12800
    v_mfma_f32_16x16x32_bf16 v[236:239], v[132:135], v[88:91], v[236:239]
    ds_read_b128 v[68:71], v187 offset:256
    v_mfma_f32_16x16x32_bf16 v[236:239], v[136:139], v[92:95], v[236:239]
    ds_read_b64_tr_b16 v[168:169], v21 offset:16384
    v_mfma_f32_16x16x32_bf16 v[236:239], v[140:143], v[96:99], v[236:239]
    ds_read_b64_tr_b16 v[170:171], v21 offset:16896
    v_mfma_f32_16x16x32_bf16 v[236:239], v[144:147], v[100:103], v[236:239]
    ds_read_b128 v[72:75], v185 offset:512
    v_mfma_f32_16x16x32_bf16 v[236:239], v[148:151], v[104:107], v[236:239]
    ds_read_b64_tr_b16 v[172:173], v21 offset:20480
    v_mfma_f32_16x16x32_bf16 v[240:243], v[120:123], v[80:83], v[240:243]
    ds_read_b64_tr_b16 v[174:175], v21 offset:20992
    v_mfma_f32_16x16x32_bf16 v[240:243], v[124:127], v[84:87], v[240:243]
    ds_read_b128 v[76:79], v187 offset:512
    v_mfma_f32_16x16x32_bf16 v[240:243], v[128:131], v[88:91], v[240:243]
    ds_read_b64_tr_b16 v[176:177], v21 offset:24576
    v_mfma_f32_16x16x32_bf16 v[240:243], v[132:135], v[92:95], v[240:243]
    ds_read_b64_tr_b16 v[178:179], v21 offset:25088
    v_mfma_f32_16x16x32_bf16 v[240:243], v[136:139], v[96:99], v[240:243]
    ds_read_b128 v[80:83], v185 offset:768
    v_mfma_f32_16x16x32_bf16 v[240:243], v[140:143], v[100:103], v[240:243]
    ds_read_b64_tr_b16 v[180:181], v21 offset:28672
    v_mfma_f32_16x16x32_bf16 v[240:243], v[144:147], v[104:107], v[240:243]
    ds_read_b64_tr_b16 v[182:183], v21 offset:29184
    v_mfma_f32_16x16x32_bf16 v[240:243], v[148:151], v[108:111], v[240:243]
    v_mfma_f32_16x16x32_bf16 v[244:247], v[120:123], v[84:87], v[244:247]
    v_mfma_f32_16x16x32_bf16 v[244:247], v[124:127], v[88:91], v[244:247]
    ds_read_b128 v[84:87], v187 offset:768
    v_mfma_f32_16x16x32_bf16 v[244:247], v[128:131], v[92:95], v[244:247]
    v_mfma_f32_16x16x32_bf16 v[244:247], v[132:135], v[96:99], v[244:247]
    v_mfma_f32_16x16x32_bf16 v[244:247], v[136:139], v[100:103], v[244:247]
    v_mfma_f32_16x16x32_bf16 v[244:247], v[140:143], v[104:107], v[244:247]
    v_mfma_f32_16x16x32_bf16 v[244:247], v[144:147], v[108:111], v[244:247]
    v_mfma_f32_16x16x32_bf16 v[244:247], v[148:151], v[112:115], v[244:247]
    s_waitcnt lgkmcnt(2)
    v_mfma_f32_16x16x32_bf16 v[216:219], v[152:155], v[56:59], v[216:219]
    ds_read_b128 v[88:91], v189 offset:0
    v_mfma_f32_16x16x32_bf16 v[216:219], v[156:159], v[60:63], v[216:219]
    v_mfma_f32_16x16x32_bf16 v[216:219], v[160:163], v[64:67], v[216:219]
    v_mfma_f32_16x16x32_bf16 v[216:219], v[164:167], v[68:71], v[216:219]
    ds_read_b128 v[92:95], v191 offset:0
    v_mfma_f32_16x16x32_bf16 v[216:219], v[168:171], v[72:75], v[216:219]
    v_mfma_f32_16x16x32_bf16 v[216:219], v[172:175], v[76:79], v[216:219]
    v_mfma_f32_16x16x32_bf16 v[216:219], v[176:179], v[80:83], v[216:219]
    ds_read_b128 v[96:99], v189 offset:256
    s_waitcnt lgkmcnt(3)
    v_mfma_f32_16x16x32_bf16 v[216:219], v[180:183], v[84:87], v[216:219]
    v_mfma_f32_16x16x32_bf16 v[220:223], v[152:155], v[60:63], v[220:223]
    v_mfma_f32_16x16x32_bf16 v[220:223], v[156:159], v[64:67], v[220:223]
    ds_read_b128 v[100:103], v191 offset:256
    v_mfma_f32_16x16x32_bf16 v[220:223], v[160:163], v[68:71], v[220:223]
    v_mfma_f32_16x16x32_bf16 v[220:223], v[164:167], v[72:75], v[220:223]
    v_mfma_f32_16x16x32_bf16 v[220:223], v[168:171], v[76:79], v[220:223]
    ds_read_b128 v[104:107], v189 offset:512
    v_mfma_f32_16x16x32_bf16 v[220:223], v[172:175], v[80:83], v[220:223]
    v_mfma_f32_16x16x32_bf16 v[220:223], v[176:179], v[84:87], v[220:223]
    s_waitcnt lgkmcnt(3)
    v_mfma_f32_16x16x32_bf16 v[220:223], v[180:183], v[88:91], v[220:223]
    ds_read_b128 v[108:111], v191 offset:512
    v_mfma_f32_16x16x32_bf16 v[224:227], v[152:155], v[64:67], v[224:227]
    v_mfma_f32_16x16x32_bf16 v[224:227], v[156:159], v[68:71], v[224:227]
    v_mfma_f32_16x16x32_bf16 v[224:227], v[160:163], v[72:75], v[224:227]
    ds_read_b128 v[112:115], v189 offset:768
    v_mfma_f32_16x16x32_bf16 v[224:227], v[164:167], v[76:79], v[224:227]
    v_mfma_f32_16x16x32_bf16 v[224:227], v[168:171], v[80:83], v[224:227]
    v_mfma_f32_16x16x32_bf16 v[224:227], v[172:175], v[84:87], v[224:227]
    v_mfma_f32_16x16x32_bf16 v[224:227], v[176:179], v[88:91], v[224:227]
    v_mfma_f32_16x16x32_bf16 v[224:227], v[180:183], v[92:95], v[224:227]
    v_mfma_f32_16x16x32_bf16 v[228:231], v[152:155], v[68:71], v[228:231]
    v_mfma_f32_16x16x32_bf16 v[228:231], v[156:159], v[72:75], v[228:231]
    v_mfma_f32_16x16x32_bf16 v[228:231], v[160:163], v[76:79], v[228:231]
    v_mfma_f32_16x16x32_bf16 v[228:231], v[164:167], v[80:83], v[228:231]
    v_mfma_f32_16x16x32_bf16 v[228:231], v[168:171], v[84:87], v[228:231]
    v_mfma_f32_16x16x32_bf16 v[228:231], v[172:175], v[88:91], v[228:231]
    v_mfma_f32_16x16x32_bf16 v[228:231], v[176:179], v[92:95], v[228:231]
    s_waitcnt lgkmcnt(0)
    v_mfma_f32_16x16x32_bf16 v[228:231], v[180:183], v[96:99], v[228:231]
    s_barrier
    v_mfma_f32_16x16x32_bf16 v[232:235], v[152:155], v[72:75], v[232:235]
    ds_read_b64_tr_b16 v[120:121], v21 offset:32768
    v_mfma_f32_16x16x32_bf16 v[232:235], v[156:159], v[76:79], v[232:235]
    ds_read_b64_tr_b16 v[122:123], v21 offset:33280
    v_mfma_f32_16x16x32_bf16 v[232:235], v[160:163], v[80:83], v[232:235]
    ds_read_b128 v[56:59], v12 offset:52224
    v_mfma_f32_16x16x32_bf16 v[232:235], v[164:167], v[84:87], v[232:235]
    ds_read_b64_tr_b16 v[124:125], v21 offset:36864
    v_mfma_f32_16x16x32_bf16 v[232:235], v[168:171], v[88:91], v[232:235]
    ds_read_b64_tr_b16 v[126:127], v21 offset:37376
    v_mfma_f32_16x16x32_bf16 v[232:235], v[172:175], v[92:95], v[232:235]
    ds_read_b128 v[60:63], v14 offset:52224
    v_mfma_f32_16x16x32_bf16 v[232:235], v[176:179], v[96:99], v[232:235]
    ds_read_b64_tr_b16 v[128:129], v21 offset:40960
    v_mfma_f32_16x16x32_bf16 v[232:235], v[180:183], v[100:103], v[232:235]
    ds_read_b64_tr_b16 v[130:131], v21 offset:41472
    v_mfma_f32_16x16x32_bf16 v[236:239], v[152:155], v[76:79], v[236:239]
    ds_read_b128 v[64:67], v12 offset:52480
    v_mfma_f32_16x16x32_bf16 v[236:239], v[156:159], v[80:83], v[236:239]
    ds_read_b64_tr_b16 v[132:133], v21 offset:45056
    v_mfma_f32_16x16x32_bf16 v[236:239], v[160:163], v[84:87], v[236:239]
    ds_read_b64_tr_b16 v[134:135], v21 offset:45568
    v_mfma_f32_16x16x32_bf16 v[236:239], v[164:167], v[88:91], v[236:239]
    ds_read_b128 v[68:71], v14 offset:52480
    v_mfma_f32_16x16x32_bf16 v[236:239], v[168:171], v[92:95], v[236:239]
    ds_read_b64_tr_b16 v[136:137], v21 offset:49152
    v_mfma_f32_16x16x32_bf16 v[236:239], v[172:175], v[96:99], v[236:239]
    ds_read_b64_tr_b16 v[138:139], v21 offset:49664
    v_mfma_f32_16x16x32_bf16 v[236:239], v[176:179], v[100:103], v[236:239]
    ds_read_b128 v[72:75], v12 offset:52736
    v_mfma_f32_16x16x32_bf16 v[236:239], v[180:183], v[104:107], v[236:239]
    ds_read_b64_tr_b16 v[140:141], v21 offset:53248
    v_mfma_f32_16x16x32_bf16 v[240:243], v[152:155], v[80:83], v[240:243]
    ds_read_b64_tr_b16 v[142:143], v21 offset:53760
    v_mfma_f32_16x16x32_bf16 v[240:243], v[156:159], v[84:87], v[240:243]
    ds_read_b128 v[76:79], v14 offset:52736
    v_mfma_f32_16x16x32_bf16 v[240:243], v[160:163], v[88:91], v[240:243]
    ds_read_b64_tr_b16 v[144:145], v21 offset:57344
    v_mfma_f32_16x16x32_bf16 v[240:243], v[164:167], v[92:95], v[240:243]
    ds_read_b64_tr_b16 v[146:147], v21 offset:57856
    v_mfma_f32_16x16x32_bf16 v[240:243], v[168:171], v[96:99], v[240:243]
    ds_read_b128 v[80:83], v12 offset:52992
    v_mfma_f32_16x16x32_bf16 v[240:243], v[172:175], v[100:103], v[240:243]
    v_mfma_f32_16x16x32_bf16 v[240:243], v[176:179], v[104:107], v[240:243]
    v_mfma_f32_16x16x32_bf16 v[240:243], v[180:183], v[108:111], v[240:243]
    v_mfma_f32_16x16x32_bf16 v[244:247], v[152:155], v[84:87], v[244:247]
    v_mfma_f32_16x16x32_bf16 v[244:247], v[156:159], v[88:91], v[244:247]
    ds_read_b128 v[84:87], v14 offset:52992
    v_mfma_f32_16x16x32_bf16 v[244:247], v[160:163], v[92:95], v[244:247]
    v_mfma_f32_16x16x32_bf16 v[244:247], v[164:167], v[96:99], v[244:247]
    v_mfma_f32_16x16x32_bf16 v[244:247], v[168:171], v[100:103], v[244:247]
    v_mfma_f32_16x16x32_bf16 v[244:247], v[172:175], v[104:107], v[244:247]
    v_mfma_f32_16x16x32_bf16 v[244:247], v[176:179], v[108:111], v[244:247]
    v_mfma_f32_16x16x32_bf16 v[244:247], v[180:183], v[112:115], v[244:247]
    s_waitcnt lgkmcnt(1)
    v_mfma_f32_16x16x32_bf16 v[216:219], v[120:123], v[56:59], v[216:219]
    ds_read_b128 v[88:91], v16 offset:52224
    v_mfma_f32_16x16x32_bf16 v[216:219], v[124:127], v[60:63], v[216:219]
    v_mfma_f32_16x16x32_bf16 v[216:219], v[128:131], v[64:67], v[216:219]
    v_mfma_f32_16x16x32_bf16 v[216:219], v[132:135], v[68:71], v[216:219]
    ds_read_b128 v[92:95], v18 offset:52224
    v_mfma_f32_16x16x32_bf16 v[216:219], v[136:139], v[72:75], v[216:219]
    v_mfma_f32_16x16x32_bf16 v[216:219], v[140:143], v[76:79], v[216:219]
    v_mfma_f32_16x16x32_bf16 v[216:219], v[144:147], v[80:83], v[216:219]
    ds_read_b128 v[96:99], v16 offset:52480
    v_mfma_f32_16x16x32_bf16 v[220:223], v[120:123], v[60:63], v[220:223]
    v_mfma_f32_16x16x32_bf16 v[220:223], v[124:127], v[64:67], v[220:223]
    v_mfma_f32_16x16x32_bf16 v[220:223], v[128:131], v[68:71], v[220:223]
    ds_read_b128 v[100:103], v18 offset:52480
    v_mfma_f32_16x16x32_bf16 v[220:223], v[132:135], v[72:75], v[220:223]
    v_mfma_f32_16x16x32_bf16 v[220:223], v[136:139], v[76:79], v[220:223]
    v_mfma_f32_16x16x32_bf16 v[220:223], v[140:143], v[80:83], v[220:223]
    ds_read_b128 v[104:107], v16 offset:52736
    s_waitcnt lgkmcnt(4)
    v_mfma_f32_16x16x32_bf16 v[220:223], v[144:147], v[84:87], v[220:223]
    v_mfma_f32_16x16x32_bf16 v[224:227], v[120:123], v[64:67], v[224:227]
    v_mfma_f32_16x16x32_bf16 v[224:227], v[124:127], v[68:71], v[224:227]
    ds_read_b128 v[108:111], v18 offset:52736
    v_mfma_f32_16x16x32_bf16 v[224:227], v[128:131], v[72:75], v[224:227]
    v_mfma_f32_16x16x32_bf16 v[224:227], v[132:135], v[76:79], v[224:227]
    v_mfma_f32_16x16x32_bf16 v[224:227], v[136:139], v[80:83], v[224:227]
    v_mfma_f32_16x16x32_bf16 v[224:227], v[140:143], v[84:87], v[224:227]
    v_mfma_f32_16x16x32_bf16 v[224:227], v[144:147], v[88:91], v[224:227]
    v_mfma_f32_16x16x32_bf16 v[228:231], v[120:123], v[68:71], v[228:231]
    v_mfma_f32_16x16x32_bf16 v[228:231], v[124:127], v[72:75], v[228:231]
    v_mfma_f32_16x16x32_bf16 v[228:231], v[128:131], v[76:79], v[228:231]
    v_mfma_f32_16x16x32_bf16 v[228:231], v[132:135], v[80:83], v[228:231]
    v_mfma_f32_16x16x32_bf16 v[228:231], v[136:139], v[84:87], v[228:231]
    v_mfma_f32_16x16x32_bf16 v[228:231], v[140:143], v[88:91], v[228:231]
    s_waitcnt lgkmcnt(0)
    v_mfma_f32_16x16x32_bf16 v[228:231], v[144:147], v[92:95], v[228:231]
    s_barrier
    v_mfma_f32_16x16x32_bf16 v[232:235], v[120:123], v[72:75], v[232:235]
    ds_read_b64_tr_b16 v[152:153], v20 offset:0
    v_mfma_f32_16x16x32_bf16 v[232:235], v[124:127], v[76:79], v[232:235]
    ds_read_b64_tr_b16 v[154:155], v20 offset:512
    v_mfma_f32_16x16x32_bf16 v[232:235], v[128:131], v[80:83], v[232:235]
    ds_read_b128 v[56:59], v13 offset:52224
    v_mfma_f32_16x16x32_bf16 v[232:235], v[132:135], v[84:87], v[232:235]
    ds_read_b64_tr_b16 v[156:157], v20 offset:4096
    v_mfma_f32_16x16x32_bf16 v[232:235], v[136:139], v[88:91], v[232:235]
    ds_read_b64_tr_b16 v[158:159], v20 offset:4608
    v_mfma_f32_16x16x32_bf16 v[232:235], v[140:143], v[92:95], v[232:235]
    ds_read_b128 v[60:63], v15 offset:52224
    v_mfma_f32_16x16x32_bf16 v[232:235], v[144:147], v[96:99], v[232:235]
    ds_read_b64_tr_b16 v[160:161], v20 offset:8192
    v_mfma_f32_16x16x32_bf16 v[236:239], v[120:123], v[76:79], v[236:239]
    ds_read_b64_tr_b16 v[162:163], v20 offset:8704
    v_mfma_f32_16x16x32_bf16 v[236:239], v[124:127], v[80:83], v[236:239]
    ds_read_b128 v[64:67], v13 offset:52480
    v_mfma_f32_16x16x32_bf16 v[236:239], v[128:131], v[84:87], v[236:239]
    ds_read_b64_tr_b16 v[164:165], v20 offset:12288
    v_mfma_f32_16x16x32_bf16 v[236:239], v[132:135], v[88:91], v[236:239]
    ds_read_b64_tr_b16 v[166:167], v20 offset:12800
    v_mfma_f32_16x16x32_bf16 v[236:239], v[136:139], v[92:95], v[236:239]
    ds_read_b128 v[68:71], v15 offset:52480
    v_mfma_f32_16x16x32_bf16 v[236:239], v[140:143], v[96:99], v[236:239]
    ds_read_b64_tr_b16 v[168:169], v20 offset:16384
    v_mfma_f32_16x16x32_bf16 v[236:239], v[144:147], v[100:103], v[236:239]
    ds_read_b64_tr_b16 v[170:171], v20 offset:16896
    v_mfma_f32_16x16x32_bf16 v[240:243], v[120:123], v[80:83], v[240:243]
    ds_read_b128 v[72:75], v13 offset:52736
    v_mfma_f32_16x16x32_bf16 v[240:243], v[124:127], v[84:87], v[240:243]
    ds_read_b64_tr_b16 v[172:173], v20 offset:20480
    v_mfma_f32_16x16x32_bf16 v[240:243], v[128:131], v[88:91], v[240:243]
    ds_read_b64_tr_b16 v[174:175], v20 offset:20992
    v_mfma_f32_16x16x32_bf16 v[240:243], v[132:135], v[92:95], v[240:243]
    ds_read_b128 v[76:79], v15 offset:52736
    v_mfma_f32_16x16x32_bf16 v[240:243], v[136:139], v[96:99], v[240:243]
    ds_read_b64_tr_b16 v[176:177], v20 offset:24576
    v_mfma_f32_16x16x32_bf16 v[240:243], v[140:143], v[100:103], v[240:243]
    ds_read_b64_tr_b16 v[178:179], v20 offset:25088
    v_mfma_f32_16x16x32_bf16 v[240:243], v[144:147], v[104:107], v[240:243]
    ds_read_b128 v[80:83], v13 offset:52992
    v_mfma_f32_16x16x32_bf16 v[244:247], v[120:123], v[84:87], v[244:247]
    v_mfma_f32_16x16x32_bf16 v[244:247], v[124:127], v[88:91], v[244:247]
    ds_read_b128 v[84:87], v15 offset:52992
    v_mfma_f32_16x16x32_bf16 v[244:247], v[128:131], v[92:95], v[244:247]
    v_mfma_f32_16x16x32_bf16 v[244:247], v[132:135], v[96:99], v[244:247]
    v_mfma_f32_16x16x32_bf16 v[244:247], v[136:139], v[100:103], v[244:247]
    v_mfma_f32_16x16x32_bf16 v[244:247], v[140:143], v[104:107], v[244:247]
    v_mfma_f32_16x16x32_bf16 v[244:247], v[144:147], v[108:111], v[244:247]
    s_waitcnt lgkmcnt(4)
    v_mfma_f32_16x16x32_bf16 v[216:219], v[152:155], v[56:59], v[216:219]
    ds_read_b128 v[88:91], v17 offset:52224
    v_mfma_f32_16x16x32_bf16 v[216:219], v[156:159], v[60:63], v[216:219]
    v_mfma_f32_16x16x32_bf16 v[216:219], v[160:163], v[64:67], v[216:219]
    v_mfma_f32_16x16x32_bf16 v[216:219], v[164:167], v[68:71], v[216:219]
    ds_read_b128 v[92:95], v19 offset:52224
    v_mfma_f32_16x16x32_bf16 v[216:219], v[168:171], v[72:75], v[216:219]
    v_mfma_f32_16x16x32_bf16 v[216:219], v[172:175], v[76:79], v[216:219]
    s_waitcnt lgkmcnt(2)
    v_mfma_f32_16x16x32_bf16 v[216:219], v[176:179], v[80:83], v[216:219]
    ds_read_b128 v[96:99], v17 offset:52480
    v_mfma_f32_16x16x32_bf16 v[220:223], v[152:155], v[60:63], v[220:223]
    v_mfma_f32_16x16x32_bf16 v[220:223], v[156:159], v[64:67], v[220:223]
    v_mfma_f32_16x16x32_bf16 v[220:223], v[160:163], v[68:71], v[220:223]
    ds_read_b128 v[100:103], v19 offset:52480
    v_mfma_f32_16x16x32_bf16 v[220:223], v[164:167], v[72:75], v[220:223]
    v_mfma_f32_16x16x32_bf16 v[220:223], v[168:171], v[76:79], v[220:223]
    v_mfma_f32_16x16x32_bf16 v[220:223], v[172:175], v[80:83], v[220:223]
    ds_read_b128 v[104:107], v17 offset:52736
    v_mfma_f32_16x16x32_bf16 v[220:223], v[176:179], v[84:87], v[220:223]
    v_mfma_f32_16x16x32_bf16 v[224:227], v[152:155], v[64:67], v[224:227]
    v_mfma_f32_16x16x32_bf16 v[224:227], v[156:159], v[68:71], v[224:227]
    ds_read_b128 v[108:111], v19 offset:52736
    v_mfma_f32_16x16x32_bf16 v[224:227], v[160:163], v[72:75], v[224:227]
    v_mfma_f32_16x16x32_bf16 v[224:227], v[164:167], v[76:79], v[224:227]
    v_mfma_f32_16x16x32_bf16 v[224:227], v[168:171], v[80:83], v[224:227]
    v_mfma_f32_16x16x32_bf16 v[224:227], v[172:175], v[84:87], v[224:227]
    s_waitcnt lgkmcnt(2)
    v_mfma_f32_16x16x32_bf16 v[224:227], v[176:179], v[88:91], v[224:227]
    v_mfma_f32_16x16x32_bf16 v[228:231], v[152:155], v[68:71], v[228:231]
    v_mfma_f32_16x16x32_bf16 v[228:231], v[156:159], v[72:75], v[228:231]
    v_mfma_f32_16x16x32_bf16 v[228:231], v[160:163], v[76:79], v[228:231]
    v_mfma_f32_16x16x32_bf16 v[228:231], v[164:167], v[80:83], v[228:231]
    v_mfma_f32_16x16x32_bf16 v[228:231], v[168:171], v[84:87], v[228:231]
    v_mfma_f32_16x16x32_bf16 v[228:231], v[172:175], v[88:91], v[228:231]
    v_mfma_f32_16x16x32_bf16 v[228:231], v[176:179], v[92:95], v[228:231]
    s_waitcnt lgkmcnt(0)
    s_barrier
    v_mfma_f32_16x16x32_bf16 v[232:235], v[152:155], v[72:75], v[232:235]
    ds_read_b64_tr_b16 v[120:121], v21 offset:0
    v_mfma_f32_16x16x32_bf16 v[232:235], v[156:159], v[76:79], v[232:235]
    ds_read_b64_tr_b16 v[122:123], v21 offset:512
    v_mfma_f32_16x16x32_bf16 v[232:235], v[160:163], v[80:83], v[232:235]
    ds_read_b128 v[56:59], v12 offset:34816
    v_mfma_f32_16x16x32_bf16 v[232:235], v[164:167], v[84:87], v[232:235]
    ds_read_b64_tr_b16 v[124:125], v21 offset:4096
    v_mfma_f32_16x16x32_bf16 v[232:235], v[168:171], v[88:91], v[232:235]
    ds_read_b64_tr_b16 v[126:127], v21 offset:4608
    v_mfma_f32_16x16x32_bf16 v[232:235], v[172:175], v[92:95], v[232:235]
    ds_read_b128 v[60:63], v14 offset:34816
    v_mfma_f32_16x16x32_bf16 v[232:235], v[176:179], v[96:99], v[232:235]
    ds_read_b64_tr_b16 v[128:129], v21 offset:8192
    v_mfma_f32_16x16x32_bf16 v[236:239], v[152:155], v[76:79], v[236:239]
    ds_read_b64_tr_b16 v[130:131], v21 offset:8704
    v_mfma_f32_16x16x32_bf16 v[236:239], v[156:159], v[80:83], v[236:239]
    ds_read_b128 v[64:67], v12 offset:35072
    v_mfma_f32_16x16x32_bf16 v[236:239], v[160:163], v[84:87], v[236:239]
    ds_read_b64_tr_b16 v[132:133], v21 offset:12288
    v_mfma_f32_16x16x32_bf16 v[236:239], v[164:167], v[88:91], v[236:239]
    ds_read_b64_tr_b16 v[134:135], v21 offset:12800
    v_mfma_f32_16x16x32_bf16 v[236:239], v[168:171], v[92:95], v[236:239]
    ds_read_b128 v[68:71], v14 offset:35072
    v_mfma_f32_16x16x32_bf16 v[236:239], v[172:175], v[96:99], v[236:239]
    ds_read_b64_tr_b16 v[136:137], v21 offset:16384
    v_mfma_f32_16x16x32_bf16 v[236:239], v[176:179], v[100:103], v[236:239]
    ds_read_b64_tr_b16 v[138:139], v21 offset:16896
    v_mfma_f32_16x16x32_bf16 v[240:243], v[152:155], v[80:83], v[240:243]
    ds_read_b128 v[72:75], v12 offset:35328
    v_mfma_f32_16x16x32_bf16 v[240:243], v[156:159], v[84:87], v[240:243]
    ds_read_b64_tr_b16 v[140:141], v21 offset:20480
    v_mfma_f32_16x16x32_bf16 v[240:243], v[160:163], v[88:91], v[240:243]
    ds_read_b64_tr_b16 v[142:143], v21 offset:20992
    v_mfma_f32_16x16x32_bf16 v[240:243], v[164:167], v[92:95], v[240:243]
    ds_read_b128 v[76:79], v14 offset:35328
    v_mfma_f32_16x16x32_bf16 v[240:243], v[168:171], v[96:99], v[240:243]
    ds_read_b64_tr_b16 v[144:145], v21 offset:24576
    v_mfma_f32_16x16x32_bf16 v[240:243], v[172:175], v[100:103], v[240:243]
    ds_read_b64_tr_b16 v[146:147], v21 offset:25088
    v_mfma_f32_16x16x32_bf16 v[240:243], v[176:179], v[104:107], v[240:243]
    ds_read_b128 v[80:83], v12 offset:35584
    v_mfma_f32_16x16x32_bf16 v[244:247], v[152:155], v[84:87], v[244:247]
    ds_read_b64_tr_b16 v[148:149], v21 offset:28672
    v_mfma_f32_16x16x32_bf16 v[244:247], v[156:159], v[88:91], v[244:247]
    ds_read_b64_tr_b16 v[150:151], v21 offset:29184
    v_mfma_f32_16x16x32_bf16 v[244:247], v[160:163], v[92:95], v[244:247]
    ds_read_b128 v[84:87], v14 offset:35584
    v_mfma_f32_16x16x32_bf16 v[244:247], v[164:167], v[96:99], v[244:247]
    v_mfma_f32_16x16x32_bf16 v[244:247], v[168:171], v[100:103], v[244:247]
    v_mfma_f32_16x16x32_bf16 v[244:247], v[172:175], v[104:107], v[244:247]
    v_mfma_f32_16x16x32_bf16 v[244:247], v[176:179], v[108:111], v[244:247]
    s_waitcnt lgkmcnt(6)
    v_mfma_f32_16x16x32_bf16 v[216:219], v[120:123], v[56:59], v[216:219]
    ds_read_b128 v[88:91], v16 offset:34816
    v_mfma_f32_16x16x32_bf16 v[216:219], v[124:127], v[60:63], v[216:219]
    v_mfma_f32_16x16x32_bf16 v[216:219], v[128:131], v[64:67], v[216:219]
    v_mfma_f32_16x16x32_bf16 v[216:219], v[132:135], v[68:71], v[216:219]
    ds_read_b128 v[92:95], v18 offset:34816
    v_mfma_f32_16x16x32_bf16 v[216:219], v[136:139], v[72:75], v[216:219]
    v_mfma_f32_16x16x32_bf16 v[216:219], v[140:143], v[76:79], v[216:219]
    s_waitcnt lgkmcnt(2)
    v_mfma_f32_16x16x32_bf16 v[216:219], v[144:147], v[80:83], v[216:219]
    ds_read_b128 v[96:99], v16 offset:35072
    v_mfma_f32_16x16x32_bf16 v[216:219], v[148:151], v[84:87], v[216:219]
    v_mfma_f32_16x16x32_bf16 v[220:223], v[120:123], v[60:63], v[220:223]
    v_mfma_f32_16x16x32_bf16 v[220:223], v[124:127], v[64:67], v[220:223]
    ds_read_b128 v[100:103], v18 offset:35072
    v_mfma_f32_16x16x32_bf16 v[220:223], v[128:131], v[68:71], v[220:223]
    v_mfma_f32_16x16x32_bf16 v[220:223], v[132:135], v[72:75], v[220:223]
    v_mfma_f32_16x16x32_bf16 v[220:223], v[136:139], v[76:79], v[220:223]
    ds_read_b128 v[104:107], v16 offset:35328
    v_mfma_f32_16x16x32_bf16 v[220:223], v[140:143], v[80:83], v[220:223]
    v_mfma_f32_16x16x32_bf16 v[220:223], v[144:147], v[84:87], v[220:223]
    s_waitcnt lgkmcnt(3)
    v_mfma_f32_16x16x32_bf16 v[220:223], v[148:151], v[88:91], v[220:223]
    ds_read_b128 v[108:111], v18 offset:35328
    v_mfma_f32_16x16x32_bf16 v[224:227], v[120:123], v[64:67], v[224:227]
    v_mfma_f32_16x16x32_bf16 v[224:227], v[124:127], v[68:71], v[224:227]
    v_mfma_f32_16x16x32_bf16 v[224:227], v[128:131], v[72:75], v[224:227]
    ds_read_b128 v[112:115], v16 offset:35584
    v_mfma_f32_16x16x32_bf16 v[224:227], v[132:135], v[76:79], v[224:227]
    v_mfma_f32_16x16x32_bf16 v[224:227], v[136:139], v[80:83], v[224:227]
    v_mfma_f32_16x16x32_bf16 v[224:227], v[140:143], v[84:87], v[224:227]
    v_mfma_f32_16x16x32_bf16 v[224:227], v[144:147], v[88:91], v[224:227]
    v_mfma_f32_16x16x32_bf16 v[224:227], v[148:151], v[92:95], v[224:227]
    v_mfma_f32_16x16x32_bf16 v[228:231], v[120:123], v[68:71], v[228:231]
    v_mfma_f32_16x16x32_bf16 v[228:231], v[124:127], v[72:75], v[228:231]
    v_mfma_f32_16x16x32_bf16 v[228:231], v[128:131], v[76:79], v[228:231]
    v_mfma_f32_16x16x32_bf16 v[228:231], v[132:135], v[80:83], v[228:231]
    v_mfma_f32_16x16x32_bf16 v[228:231], v[136:139], v[84:87], v[228:231]
    v_mfma_f32_16x16x32_bf16 v[228:231], v[140:143], v[88:91], v[228:231]
    v_mfma_f32_16x16x32_bf16 v[228:231], v[144:147], v[92:95], v[228:231]
    s_waitcnt lgkmcnt(0)
    v_mfma_f32_16x16x32_bf16 v[228:231], v[148:151], v[96:99], v[228:231]
    s_barrier
    v_mfma_f32_16x16x32_bf16 v[232:235], v[120:123], v[72:75], v[232:235]
    ds_read_b64_tr_b16 v[152:153], v21 offset:32768
    v_mfma_f32_16x16x32_bf16 v[232:235], v[124:127], v[76:79], v[232:235]
    ds_read_b64_tr_b16 v[154:155], v21 offset:33280
    v_mfma_f32_16x16x32_bf16 v[232:235], v[128:131], v[80:83], v[232:235]
    ds_read_b128 v[56:59], v13 offset:34816
    v_mfma_f32_16x16x32_bf16 v[232:235], v[132:135], v[84:87], v[232:235]
    ds_read_b64_tr_b16 v[156:157], v21 offset:36864
    v_mfma_f32_16x16x32_bf16 v[232:235], v[136:139], v[88:91], v[232:235]
    ds_read_b64_tr_b16 v[158:159], v21 offset:37376
    v_mfma_f32_16x16x32_bf16 v[232:235], v[140:143], v[92:95], v[232:235]
    ds_read_b128 v[60:63], v15 offset:34816
    v_mfma_f32_16x16x32_bf16 v[232:235], v[144:147], v[96:99], v[232:235]
    ds_read_b64_tr_b16 v[160:161], v21 offset:40960
    v_mfma_f32_16x16x32_bf16 v[232:235], v[148:151], v[100:103], v[232:235]
    ds_read_b64_tr_b16 v[162:163], v21 offset:41472
    v_mfma_f32_16x16x32_bf16 v[236:239], v[120:123], v[76:79], v[236:239]
    ds_read_b128 v[64:67], v13 offset:35072
    v_mfma_f32_16x16x32_bf16 v[236:239], v[124:127], v[80:83], v[236:239]
    ds_read_b64_tr_b16 v[164:165], v21 offset:45056
    v_mfma_f32_16x16x32_bf16 v[236:239], v[128:131], v[84:87], v[236:239]
    ds_read_b64_tr_b16 v[166:167], v21 offset:45568
    v_mfma_f32_16x16x32_bf16 v[236:239], v[132:135], v[88:91], v[236:239]
    ds_read_b128 v[68:71], v15 offset:35072
    v_mfma_f32_16x16x32_bf16 v[236:239], v[136:139], v[92:95], v[236:239]
    ds_read_b64_tr_b16 v[168:169], v21 offset:49152
    v_mfma_f32_16x16x32_bf16 v[236:239], v[140:143], v[96:99], v[236:239]
    ds_read_b64_tr_b16 v[170:171], v21 offset:49664
    v_mfma_f32_16x16x32_bf16 v[236:239], v[144:147], v[100:103], v[236:239]
    ds_read_b128 v[72:75], v13 offset:35328
    v_mfma_f32_16x16x32_bf16 v[236:239], v[148:151], v[104:107], v[236:239]
    ds_read_b64_tr_b16 v[172:173], v21 offset:53248
    v_mfma_f32_16x16x32_bf16 v[240:243], v[120:123], v[80:83], v[240:243]
    ds_read_b64_tr_b16 v[174:175], v21 offset:53760
    v_mfma_f32_16x16x32_bf16 v[240:243], v[124:127], v[84:87], v[240:243]
    ds_read_b128 v[76:79], v15 offset:35328
    v_mfma_f32_16x16x32_bf16 v[240:243], v[128:131], v[88:91], v[240:243]
    ds_read_b64_tr_b16 v[176:177], v21 offset:57344
    v_mfma_f32_16x16x32_bf16 v[240:243], v[132:135], v[92:95], v[240:243]
    ds_read_b64_tr_b16 v[178:179], v21 offset:57856
    v_mfma_f32_16x16x32_bf16 v[240:243], v[136:139], v[96:99], v[240:243]
    ds_read_b128 v[80:83], v13 offset:35584
    v_mfma_f32_16x16x32_bf16 v[240:243], v[140:143], v[100:103], v[240:243]
    ds_read_b64_tr_b16 v[180:181], v21 offset:61440
    v_mfma_f32_16x16x32_bf16 v[240:243], v[144:147], v[104:107], v[240:243]
    ds_read_b64_tr_b16 v[182:183], v21 offset:61952
    v_mfma_f32_16x16x32_bf16 v[240:243], v[148:151], v[108:111], v[240:243]
    v_mfma_f32_16x16x32_bf16 v[244:247], v[120:123], v[84:87], v[244:247]
    v_mfma_f32_16x16x32_bf16 v[244:247], v[124:127], v[88:91], v[244:247]
    ds_read_b128 v[84:87], v15 offset:35584
    v_mfma_f32_16x16x32_bf16 v[244:247], v[128:131], v[92:95], v[244:247]
    v_mfma_f32_16x16x32_bf16 v[244:247], v[132:135], v[96:99], v[244:247]
    v_mfma_f32_16x16x32_bf16 v[244:247], v[136:139], v[100:103], v[244:247]
    v_mfma_f32_16x16x32_bf16 v[244:247], v[140:143], v[104:107], v[244:247]
    v_mfma_f32_16x16x32_bf16 v[244:247], v[144:147], v[108:111], v[244:247]
    v_mfma_f32_16x16x32_bf16 v[244:247], v[148:151], v[112:115], v[244:247]
    s_waitcnt lgkmcnt(2)
    v_mfma_f32_16x16x32_bf16 v[216:219], v[152:155], v[56:59], v[216:219]
    ds_read_b128 v[88:91], v17 offset:34816
    v_mfma_f32_16x16x32_bf16 v[216:219], v[156:159], v[60:63], v[216:219]
    v_mfma_f32_16x16x32_bf16 v[216:219], v[160:163], v[64:67], v[216:219]
    v_mfma_f32_16x16x32_bf16 v[216:219], v[164:167], v[68:71], v[216:219]
    ds_read_b128 v[92:95], v19 offset:34816
    v_mfma_f32_16x16x32_bf16 v[216:219], v[168:171], v[72:75], v[216:219]
    v_mfma_f32_16x16x32_bf16 v[216:219], v[172:175], v[76:79], v[216:219]
    v_mfma_f32_16x16x32_bf16 v[216:219], v[176:179], v[80:83], v[216:219]
    ds_read_b128 v[96:99], v17 offset:35072
    s_waitcnt lgkmcnt(3)
    v_mfma_f32_16x16x32_bf16 v[216:219], v[180:183], v[84:87], v[216:219]
    v_mfma_f32_16x16x32_bf16 v[220:223], v[152:155], v[60:63], v[220:223]
    v_mfma_f32_16x16x32_bf16 v[220:223], v[156:159], v[64:67], v[220:223]
    ds_read_b128 v[100:103], v19 offset:35072
    v_mfma_f32_16x16x32_bf16 v[220:223], v[160:163], v[68:71], v[220:223]
    v_mfma_f32_16x16x32_bf16 v[220:223], v[164:167], v[72:75], v[220:223]
    v_mfma_f32_16x16x32_bf16 v[220:223], v[168:171], v[76:79], v[220:223]
    ds_read_b128 v[104:107], v17 offset:35328
    v_mfma_f32_16x16x32_bf16 v[220:223], v[172:175], v[80:83], v[220:223]
    v_mfma_f32_16x16x32_bf16 v[220:223], v[176:179], v[84:87], v[220:223]
    s_waitcnt lgkmcnt(3)
    v_mfma_f32_16x16x32_bf16 v[220:223], v[180:183], v[88:91], v[220:223]
    ds_read_b128 v[108:111], v19 offset:35328
    v_mfma_f32_16x16x32_bf16 v[224:227], v[152:155], v[64:67], v[224:227]
    v_mfma_f32_16x16x32_bf16 v[224:227], v[156:159], v[68:71], v[224:227]
    v_mfma_f32_16x16x32_bf16 v[224:227], v[160:163], v[72:75], v[224:227]
    ds_read_b128 v[112:115], v17 offset:35584
    v_mfma_f32_16x16x32_bf16 v[224:227], v[164:167], v[76:79], v[224:227]
    v_mfma_f32_16x16x32_bf16 v[224:227], v[168:171], v[80:83], v[224:227]
    v_mfma_f32_16x16x32_bf16 v[224:227], v[172:175], v[84:87], v[224:227]
    v_mfma_f32_16x16x32_bf16 v[224:227], v[176:179], v[88:91], v[224:227]
    v_mfma_f32_16x16x32_bf16 v[224:227], v[180:183], v[92:95], v[224:227]
    v_mfma_f32_16x16x32_bf16 v[228:231], v[152:155], v[68:71], v[228:231]
    v_mfma_f32_16x16x32_bf16 v[228:231], v[156:159], v[72:75], v[228:231]
    v_mfma_f32_16x16x32_bf16 v[228:231], v[160:163], v[76:79], v[228:231]
    v_mfma_f32_16x16x32_bf16 v[228:231], v[164:167], v[80:83], v[228:231]
    v_mfma_f32_16x16x32_bf16 v[228:231], v[168:171], v[84:87], v[228:231]
    v_mfma_f32_16x16x32_bf16 v[228:231], v[172:175], v[88:91], v[228:231]
    v_mfma_f32_16x16x32_bf16 v[228:231], v[176:179], v[92:95], v[228:231]
    s_waitcnt lgkmcnt(0)
    v_mfma_f32_16x16x32_bf16 v[228:231], v[180:183], v[96:99], v[228:231]
    s_barrier
    v_mfma_f32_16x16x32_bf16 v[232:235], v[152:155], v[72:75], v[232:235]
    ds_read_b64_tr_b16 v[120:121], v20 offset:0
    v_mfma_f32_16x16x32_bf16 v[232:235], v[156:159], v[76:79], v[232:235]
    ds_read_b64_tr_b16 v[122:123], v20 offset:512
    v_mfma_f32_16x16x32_bf16 v[232:235], v[160:163], v[80:83], v[232:235]
    ds_read_b128 v[56:59], v12 offset:52224
    v_mfma_f32_16x16x32_bf16 v[232:235], v[164:167], v[84:87], v[232:235]
    ds_read_b64_tr_b16 v[124:125], v20 offset:4096
    v_mfma_f32_16x16x32_bf16 v[232:235], v[168:171], v[88:91], v[232:235]
    ds_read_b64_tr_b16 v[126:127], v20 offset:4608
    v_mfma_f32_16x16x32_bf16 v[232:235], v[172:175], v[92:95], v[232:235]
    ds_read_b128 v[60:63], v14 offset:52224
    v_mfma_f32_16x16x32_bf16 v[232:235], v[176:179], v[96:99], v[232:235]
    ds_read_b64_tr_b16 v[128:129], v20 offset:8192
    v_mfma_f32_16x16x32_bf16 v[232:235], v[180:183], v[100:103], v[232:235]
    ds_read_b64_tr_b16 v[130:131], v20 offset:8704
    v_mfma_f32_16x16x32_bf16 v[236:239], v[152:155], v[76:79], v[236:239]
    ds_read_b128 v[64:67], v12 offset:52480
    v_mfma_f32_16x16x32_bf16 v[236:239], v[156:159], v[80:83], v[236:239]
    ds_read_b64_tr_b16 v[132:133], v20 offset:12288
    v_mfma_f32_16x16x32_bf16 v[236:239], v[160:163], v[84:87], v[236:239]
    ds_read_b64_tr_b16 v[134:135], v20 offset:12800
    v_mfma_f32_16x16x32_bf16 v[236:239], v[164:167], v[88:91], v[236:239]
    ds_read_b128 v[68:71], v14 offset:52480
    v_mfma_f32_16x16x32_bf16 v[236:239], v[168:171], v[92:95], v[236:239]
    ds_read_b64_tr_b16 v[136:137], v20 offset:16384
    v_mfma_f32_16x16x32_bf16 v[236:239], v[172:175], v[96:99], v[236:239]
    ds_read_b64_tr_b16 v[138:139], v20 offset:16896
    v_mfma_f32_16x16x32_bf16 v[236:239], v[176:179], v[100:103], v[236:239]
    ds_read_b128 v[72:75], v12 offset:52736
    v_mfma_f32_16x16x32_bf16 v[236:239], v[180:183], v[104:107], v[236:239]
    ds_read_b64_tr_b16 v[140:141], v20 offset:20480
    v_mfma_f32_16x16x32_bf16 v[240:243], v[152:155], v[80:83], v[240:243]
    ds_read_b64_tr_b16 v[142:143], v20 offset:20992
    v_mfma_f32_16x16x32_bf16 v[240:243], v[156:159], v[84:87], v[240:243]
    ds_read_b128 v[76:79], v14 offset:52736
    v_mfma_f32_16x16x32_bf16 v[240:243], v[160:163], v[88:91], v[240:243]
    ds_read_b64_tr_b16 v[144:145], v20 offset:24576
    v_mfma_f32_16x16x32_bf16 v[240:243], v[164:167], v[92:95], v[240:243]
    ds_read_b64_tr_b16 v[146:147], v20 offset:25088
    v_mfma_f32_16x16x32_bf16 v[240:243], v[168:171], v[96:99], v[240:243]
    ds_read_b128 v[80:83], v12 offset:52992
    v_mfma_f32_16x16x32_bf16 v[240:243], v[172:175], v[100:103], v[240:243]
    v_mfma_f32_16x16x32_bf16 v[240:243], v[176:179], v[104:107], v[240:243]
    v_mfma_f32_16x16x32_bf16 v[240:243], v[180:183], v[108:111], v[240:243]
    v_mfma_f32_16x16x32_bf16 v[244:247], v[152:155], v[84:87], v[244:247]
    v_mfma_f32_16x16x32_bf16 v[244:247], v[156:159], v[88:91], v[244:247]
L_pg4:
    s_cbranch_execz L_pb4
    ds_read_b128 v[84:87], v14 offset:52992
    v_mfma_f32_16x16x32_bf16 v[244:247], v[160:163], v[92:95], v[244:247]
    v_mfma_f32_16x16x32_bf16 v[244:247], v[164:167], v[96:99], v[244:247]
    v_mfma_f32_16x16x32_bf16 v[244:247], v[168:171], v[100:103], v[244:247]
    v_mfma_f32_16x16x32_bf16 v[244:247], v[172:175], v[104:107], v[244:247]
    v_mfma_f32_16x16x32_bf16 v[244:247], v[176:179], v[108:111], v[244:247]
    v_mfma_f32_16x16x32_bf16 v[244:247], v[180:183], v[112:115], v[244:247]
    s_waitcnt lgkmcnt(1)
    v_mfma_f32_16x16x32_bf16 v[216:219], v[120:123], v[56:59], v[216:219]
    ds_read_b128 v[88:91], v16 offset:52224
    v_mfma_f32_16x16x32_bf16 v[216:219], v[124:127], v[60:63], v[216:219]
    v_mfma_f32_16x16x32_bf16 v[216:219], v[128:131], v[64:67], v[216:219]
    v_mfma_f32_16x16x32_bf16 v[216:219], v[132:135], v[68:71], v[216:219]
    ds_read_b128 v[92:95], v18 offset:52224
    v_mfma_f32_16x16x32_bf16 v[216:219], v[136:139], v[72:75], v[216:219]
    v_mfma_f32_16x16x32_bf16 v[216:219], v[140:143], v[76:79], v[216:219]
    v_mfma_f32_16x16x32_bf16 v[216:219], v[144:147], v[80:83], v[216:219]
    ds_read_b128 v[96:99], v16 offset:52480
    v_mfma_f32_16x16x32_bf16 v[220:223], v[120:123], v[60:63], v[220:223]
    v_mfma_f32_16x16x32_bf16 v[220:223], v[124:127], v[64:67], v[220:223]
    v_mfma_f32_16x16x32_bf16 v[220:223], v[128:131], v[68:71], v[220:223]
    ds_read_b128 v[100:103], v18 offset:52480
    v_mfma_f32_16x16x32_bf16 v[220:223], v[132:135], v[72:75], v[220:223]
    v_mfma_f32_16x16x32_bf16 v[220:223], v[136:139], v[76:79], v[220:223]
    v_mfma_f32_16x16x32_bf16 v[220:223], v[140:143], v[80:83], v[220:223]
    ds_read_b128 v[104:107], v16 offset:52736
    s_waitcnt lgkmcnt(4)
    v_mfma_f32_16x16x32_bf16 v[220:223], v[144:147], v[84:87], v[220:223]
    v_mfma_f32_16x16x32_bf16 v[224:227], v[120:123], v[64:67], v[224:227]
    v_mfma_f32_16x16x32_bf16 v[224:227], v[124:127], v[68:71], v[224:227]
    ds_read_b128 v[108:111], v18 offset:52736
    v_mfma_f32_16x16x32_bf16 v[224:227], v[128:131], v[72:75], v[224:227]
    v_mfma_f32_16x16x32_bf16 v[224:227], v[132:135], v[76:79], v[224:227]
    v_mfma_f32_16x16x32_bf16 v[224:227], v[136:139], v[80:83], v[224:227]
    v_mfma_f32_16x16x32_bf16 v[224:227], v[140:143], v[84:87], v[224:227]
    v_mfma_f32_16x16x32_bf16 v[224:227], v[144:147], v[88:91], v[224:227]
    v_mfma_f32_16x16x32_bf16 v[228:231], v[120:123], v[68:71], v[228:231]
    v_mfma_f32_16x16x32_bf16 v[228:231], v[124:127], v[72:75], v[228:231]
    v_mfma_f32_16x16x32_bf16 v[228:231], v[128:131], v[76:79], v[228:231]
    v_mfma_f32_16x16x32_bf16 v[228:231], v[132:135], v[80:83], v[228:231]
    v_mfma_f32_16x16x32_bf16 v[228:231], v[136:139], v[84:87], v[228:231]
    v_mfma_f32_16x16x32_bf16 v[228:231], v[140:143], v[88:91], v[228:231]
    s_waitcnt lgkmcnt(0)
    v_mfma_f32_16x16x32_bf16 v[228:231], v[144:147], v[92:95], v[228:231]
    s_barrier
    v_mfma_f32_16x16x32_bf16 v[232:235], v[120:123], v[72:75], v[232:235]
    ds_read_b64_tr_b16 v[152:153], v21 offset:0
    v_mfma_f32_16x16x32_bf16 v[232:235], v[124:127], v[76:79], v[232:235]
    ds_read_b64_tr_b16 v[154:155], v21 offset:512
    v_mfma_f32_16x16x32_bf16 v[232:235], v[128:131], v[80:83], v[232:235]
    ds_read_b128 v[56:59], v13 offset:52224
    v_mfma_f32_16x16x32_bf16 v[232:235], v[132:135], v[84:87], v[232:235]
    ds_read_b64_tr_b16 v[156:157], v21 offset:4096
    v_mfma_f32_16x16x32_bf16 v[232:235], v[136:139], v[88:91], v[232:235]
    ds_read_b64_tr_b16 v[158:159], v21 offset:4608
    v_mfma_f32_16x16x32_bf16 v[232:235], v[140:143], v[92:95], v[232:235]
    ds_read_b128 v[60:63], v15 offset:52224
    v_mfma_f32_16x16x32_bf16 v[232:235], v[144:147], v[96:99], v[232:235]
    ds_read_b64_tr_b16 v[160:161], v21 offset:8192
    v_mfma_f32_16x16x32_bf16 v[236:239], v[120:123], v[76:79], v[236:239]
    ds_read_b64_tr_b16 v[162:163], v21 offset:8704
    v_mfma_f32_16x16x32_bf16 v[236:239], v[124:127], v[80:83], v[236:239]
    ds_read_b128 v[64:67], v13 offset:52480
    v_mfma_f32_16x16x32_bf16 v[236:239], v[128:131], v[84:87], v[236:239]
    ds_read_b64_tr_b16 v[164:165], v21 offset:12288
    v_mfma_f32_16x16x32_bf16 v[236:239], v[132:135], v[88:91], v[236:239]
    ds_read_b64_tr_b16 v[166:167], v21 offset:12800
    v_mfma_f32_16x16x32_bf16 v[236:239], v[136:139], v[92:95], v[236:239]
    ds_read_b128 v[68:71], v15 offset:52480
    v_mfma_f32_16x16x32_bf16 v[236:239], v[140:143], v[96:99], v[236:239]
    ds_read_b64_tr_b16 v[168:169], v21 offset:16384
    v_mfma_f32_16x16x32_bf16 v[236:239], v[144:147], v[100:103], v[236:239]
    ds_read_b64_tr_b16 v[170:171], v21 offset:16896
    v_mfma_f32_16x16x32_bf16 v[240:243], v[120:123], v[80:83], v[240:243]
    ds_read_b128 v[72:75], v13 offset:52736
    v_mfma_f32_16x16x32_bf16 v[240:243], v[124:127], v[84:87], v[240:243]
    ds_read_b64_tr_b16 v[172:173], v21 offset:20480
    v_mfma_f32_16x16x32_bf16 v[240:243], v[128:131], v[88:91], v[240:243]
    ds_read_b64_tr_b16 v[174:175], v21 offset:20992
    v_mfma_f32_16x16x32_bf16 v[240:243], v[132:135], v[92:95], v[240:243]
    ds_read_b128 v[76:79], v15 offset:52736
    v_mfma_f32_16x16x32_bf16 v[240:243], v[136:139], v[96:99], v[240:243]
    ds_read_b64_tr_b16 v[176:177], v21 offset:24576
    v_mfma_f32_16x16x32_bf16 v[240:243], v[140:143], v[100:103], v[240:243]
    ds_read_b64_tr_b16 v[178:179], v21 offset:25088
    v_mfma_f32_16x16x32_bf16 v[240:243], v[144:147], v[104:107], v[240:243]
    ds_read_b128 v[80:83], v13 offset:52992
    v_mfma_f32_16x16x32_bf16 v[244:247], v[120:123], v[84:87], v[244:247]
    v_mfma_f32_16x16x32_bf16 v[244:247], v[124:127], v[88:91], v[244:247]
    ds_read_b128 v[84:87], v15 offset:52992
    v_mfma_f32_16x16x32_bf16 v[244:247], v[128:131], v[92:95], v[244:247]
    v_mfma_f32_16x16x32_bf16 v[244:247], v[132:135], v[96:99], v[244:247]
    v_mfma_f32_16x16x32_bf16 v[244:247], v[136:139], v[100:103], v[244:247]
    v_mfma_f32_16x16x32_bf16 v[244:247], v[140:143], v[104:107], v[244:247]
    v_mfma_f32_16x16x32_bf16 v[244:247], v[144:147], v[108:111], v[244:247]
    s_waitcnt lgkmcnt(4)
    v_mfma_f32_16x16x32_bf16 v[216:219], v[152:155], v[56:59], v[216:219]
    ds_read_b128 v[88:91], v17 offset:52224
    v_mfma_f32_16x16x32_bf16 v[216:219], v[156:159], v[60:63], v[216:219]
    v_mfma_f32_16x16x32_bf16 v[216:219], v[160:163], v[64:67], v[216:219]
    v_mfma_f32_16x16x32_bf16 v[216:219], v[164:167], v[68:71], v[216:219]
    ds_read_b128 v[92:95], v19 offset:52224
    v_mfma_f32_16x16x32_bf16 v[216:219], v[168:171], v[72:75], v[216:219]
    v_mfma_f32_16x16x32_bf16 v[216:219], v[172:175], v[76:79], v[216:219]
    s_waitcnt lgkmcnt(2)
    v_mfma_f32_16x16x32_bf16 v[216:219], v[176:179], v[80:83], v[216:219]
    ds_read_b128 v[96:99], v17 offset:52480
    v_mfma_f32_16x16x32_bf16 v[220:223], v[152:155], v[60:63], v[220:223]
    v_mfma_f32_16x16x32_bf16 v[220:223], v[156:159], v[64:67], v[220:223]
    v_mfma_f32_16x16x32_bf16 v[220:223], v[160:163], v[68:71], v[220:223]
    ds_read_b128 v[100:103], v19 offset:52480
    v_mfma_f32_16x16x32_bf16 v[220:223], v[164:167], v[72:75], v[220:223]
    v_mfma_f32_16x16x32_bf16 v[220:223], v[168:171], v[76:79], v[220:223]
    v_mfma_f32_16x16x32_bf16 v[220:223], v[172:175], v[80:83], v[220:223]
    ds_read_b128 v[104:107], v17 offset:52736
    v_mfma_f32_16x16x32_bf16 v[220:223], v[176:179], v[84:87], v[220:223]
    v_mfma_f32_16x16x32_bf16 v[224:227], v[152:155], v[64:67], v[224:227]
    v_mfma_f32_16x16x32_bf16 v[224:227], v[156:159], v[68:71], v[224:227]
    ds_read_b128 v[108:111], v19 offset:52736
    v_mfma_f32_16x16x32_bf16 v[224:227], v[160:163], v[72:75], v[224:227]
    v_mfma_f32_16x16x32_bf16 v[224:227], v[164:167], v[76:79], v[224:227]
    v_mfma_f32_16x16x32_bf16 v[224:227], v[168:171], v[80:83], v[224:227]
    v_mfma_f32_16x16x32_bf16 v[224:227], v[172:175], v[84:87], v[224:227]
    s_waitcnt lgkmcnt(2)
    v_mfma_f32_16x16x32_bf16 v[224:227], v[176:179], v[88:91], v[224:227]
    v_mfma_f32_16x16x32_bf16 v[228:231], v[152:155], v[68:71], v[228:231]
    s_nop 0
    ds_write_b128 v22, v[216:219] offset:57344
    v_mfma_f32_16x16x32_bf16 v[228:231], v[156:159], v[72:75], v[228:231]
    v_mfma_f32_16x16x32_bf16 v[228:231], v[160:163], v[76:79], v[228:231]
    s_nop 0
    ds_write_b128 v22, v[220:223] offset:53248
    v_mfma_f32_16x16x32_bf16 v[228:231], v[164:167], v[80:83], v[228:231]
    v_mfma_f32_16x16x32_bf16 v[228:231], v[168:171], v[84:87], v[228:231]
    v_mfma_f32_16x16x32_bf16 v[228:231], v[172:175], v[88:91], v[228:231]
    v_mfma_f32_16x16x32_bf16 v[228:231], v[176:179], v[92:95], v[228:231]
    s_waitcnt lgkmcnt(0)
    s_barrier
    v_mfma_f32_16x16x32_bf16 v[232:235], v[152:155], v[72:75], v[232:235]
    ds_read_b128 v[56:59], v13 offset:34816
    s_add_u32 s32, s4, 8192000
    s_addc_u32 s33, s5, 0
    s_add_u32 m0, s31, 144384
    s_mov_b32 s52, 384
    v_mfma_f32_16x16x32_bf16 v[232:235], v[156:159], v[76:79], v[232:235]
    buffer_load_dwordx4 v248, s[32:35], s52 offen nt sc1 lds
    v_mfma_f32_16x16x32_bf16 v[232:235], v[160:163], v[80:83], v[232:235]
    ds_read_b128 v[60:63], v15 offset:34816
    v_mfma_f32_16x16x32_bf16 v[232:235], v[164:167], v[84:87], v[232:235]
    s_add_u32 m0, s31, 148480
    v_mfma_f32_16x16x32_bf16 v[232:235], v[168:171], v[88:91], v[232:235]
    ds_read_b128 v[64:67], v13 offset:35072
    v_mfma_f32_16x16x32_bf16 v[232:235], v[172:175], v[92:95], v[232:235]
    v_mfma_f32_16x16x32_bf16 v[232:235], v[176:179], v[96:99], v[232:235]
    buffer_load_dwordx4 v249, s[32:35], s52 offen nt sc1 lds
    v_mfma_f32_16x16x32_bf16 v[236:239], v[152:155], v[76:79], v[236:239]
    ds_read_b128 v[68:71], v15 offset:35072
    s_add_u32 m0, s31, 152576
    v_mfma_f32_16x16x32_bf16 v[236:239], v[156:159], v[80:83], v[236:239]
    buffer_load_dwordx4 v250, s[32:35], s52 offen nt sc1 lds
    v_mfma_f32_16x16x32_bf16 v[236:239], v[160:163], v[84:87], v[236:239]
    ds_read_b128 v[72:75], v13 offset:35328
    v_mfma_f32_16x16x32_bf16 v[236:239], v[164:167], v[88:91], v[236:239]
    v_mfma_f32_16x16x32_bf16 v[236:239], v[168:171], v[92:95], v[236:239]
    ds_read_b128 v[76:79], v15 offset:35328
    s_add_u32 m0, s31, 156672
    v_mfma_f32_16x16x32_bf16 v[236:239], v[172:175], v[96:99], v[236:239]
    v_mfma_f32_16x16x32_bf16 v[236:239], v[176:179], v[100:103], v[236:239]
    buffer_load_dwordx4 v251, s[32:35], s52 offen nt sc1 lds
    v_mfma_f32_16x16x32_bf16 v[240:243], v[152:155], v[80:83], v[240:243]
    v_mfma_f32_16x16x32_bf16 v[240:243], v[156:159], v[84:87], v[240:243]
    s_mov_b32 m0, 160768
    v_mfma_f32_16x16x32_bf16 v[240:243], v[160:163], v[88:91], v[240:243]
    ds_read_b128 v[80:83], v13 offset:35584
    v_mfma_f32_16x16x32_bf16 v[240:243], v[164:167], v[92:95], v[240:243]
    s_mov_b64 exec, s[62:63]
    buffer_load_dwordx4 v252, s[32:35], s52 offen nt sc1 lds
    s_mov_b64 exec, -1
    v_mfma_f32_16x16x32_bf16 v[240:243], v[168:171], v[96:99], v[240:243]
    v_mfma_f32_16x16x32_bf16 v[240:243], v[172:175], v[100:103], v[240:243]
    s_add_u32 m0, s31, 61440
    s_mov_b32 s51, 98304
    v_mfma_f32_16x16x32_bf16 v[240:243], v[176:179], v[104:107], v[240:243]
    buffer_load_dwordx4 v118, s[36:39], s51 offen sc1 lds
    v_mfma_f32_16x16x32_bf16 v[244:247], v[152:155], v[84:87], v[244:247]
    v_mfma_f32_16x16x32_bf16 v[244:247], v[156:159], v[88:91], v[244:247]
    ds_read_b128 v[84:87], v15 offset:35584
    v_mfma_f32_16x16x32_bf16 v[244:247], v[160:163], v[92:95], v[244:247]
    s_add_u32 m0, s31, 65536
    s_mov_b32 s51, 360448
    v_mfma_f32_16x16x32_bf16 v[244:247], v[164:167], v[96:99], v[244:247]
    buffer_load_dwordx4 v118, s[36:39], s51 offen sc1 lds
    v_mfma_f32_16x16x32_bf16 v[244:247], v[168:171], v[100:103], v[244:247]
    v_mfma_f32_16x16x32_bf16 v[244:247], v[172:175], v[104:107], v[244:247]
    s_add_u32 m0, s31, 69632
    s_mov_b32 s51, 622592
    v_mfma_f32_16x16x32_bf16 v[244:247], v[176:179], v[108:111], v[244:247]
    buffer_load_dwordx4 v118, s[36:39], s51 offen sc1 lds
    s_waitcnt lgkmcnt(1)
    v_mfma_f32_16x16x32_bf16 v[24:27], v[152:155], v[56:59], v[24:27]
    ds_read_b128 v[88:91], v17 offset:34816
    v_mfma_f32_16x16x32_bf16 v[24:27], v[156:159], v[60:63], v[24:27]
    v_mfma_f32_16x16x32_bf16 v[24:27], v[160:163], v[64:67], v[24:27]
    s_add_u32 m0, s31, 73728
    s_mov_b32 s51, 884736
    v_mfma_f32_16x16x32_bf16 v[24:27], v[164:167], v[68:71], v[24:27]
    ds_read_b128 v[92:95], v19 offset:34816
    v_mfma_f32_16x16x32_bf16 v[24:27], v[168:171], v[72:75], v[24:27]
    buffer_load_dwordx4 v118, s[36:39], s51 offen sc1 lds
    v_mfma_f32_16x16x32_bf16 v[24:27], v[172:175], v[76:79], v[24:27]
    v_mfma_f32_16x16x32_bf16 v[24:27], v[176:179], v[80:83], v[24:27]
    ds_read_b128 v[96:99], v17 offset:35072
    s_add_u32 m0, s31, 77824
    s_mov_b32 s51, 1146880
    v_mfma_f32_16x16x32_bf16 v[28:31], v[152:155], v[60:63], v[28:31]
    buffer_load_dwordx4 v118, s[36:39], s51 offen sc1 lds
    v_mfma_f32_16x16x32_bf16 v[28:31], v[156:159], v[64:67], v[28:31]
    v_mfma_f32_16x16x32_bf16 v[28:31], v[160:163], v[68:71], v[28:31]
    ds_read_b128 v[100:103], v19 offset:35072
    v_mfma_f32_16x16x32_bf16 v[28:31], v[164:167], v[72:75], v[28:31]
    s_add_u32 m0, s31, 81920
    s_mov_b32 s51, 1409024
    v_mfma_f32_16x16x32_bf16 v[28:31], v[168:171], v[76:79], v[28:31]
    buffer_load_dwordx4 v118, s[36:39], s51 offen sc1 lds
    v_mfma_f32_16x16x32_bf16 v[28:31], v[172:175], v[80:83], v[28:31]
    ds_read_b128 v[104:107], v17 offset:35328
    s_waitcnt lgkmcnt(4)
    v_mfma_f32_16x16x32_bf16 v[28:31], v[176:179], v[84:87], v[28:31]
    v_mfma_f32_16x16x32_bf16 v[32:35], v[152:155], v[64:67], v[32:35]
    s_add_u32 m0, s31, 86016
    s_mov_b32 s51, 1671168
    v_mfma_f32_16x16x32_bf16 v[32:35], v[156:159], v[68:71], v[32:35]
    ds_read_b128 v[108:111], v19 offset:35328
    v_mfma_f32_16x16x32_bf16 v[32:35], v[160:163], v[72:75], v[32:35]
    ds_write_b128 v22, v[224:227] offset:49152
    v_mfma_f32_16x16x32_bf16 v[32:35], v[164:167], v[76:79], v[32:35]
    buffer_load_dwordx4 v118, s[36:39], s51 offen sc1 lds
    v_mfma_f32_16x16x32_bf16 v[32:35], v[168:171], v[80:83], v[32:35]
    ds_write_b128 v22, v[228:231] offset:45056
    s_add_u32 m0, s31, 90112
    s_mov_b32 s51, 1933312
    v_mfma_f32_16x16x32_bf16 v[32:35], v[172:175], v[84:87], v[32:35]
    v_mfma_f32_16x16x32_bf16 v[32:35], v[176:179], v[88:91], v[32:35]
    ds_write_b128 v22, v[232:235] offset:40960
    v_mfma_f32_16x16x32_bf16 v[36:39], v[152:155], v[68:71], v[36:39]
    ds_write_b128 v22, v[236:239] offset:36864
    v_mfma_f32_16x16x32_bf16 v[36:39], v[156:159], v[72:75], v[36:39]
    buffer_load_dwordx4 v118, s[36:39], s51 offen sc1 lds
    v_mfma_f32_16x16x32_bf16 v[36:39], v[160:163], v[76:79], v[36:39]
    v_mfma_f32_16x16x32_bf16 v[36:39], v[164:167], v[80:83], v[36:39]
    v_mfma_f32_16x16x32_bf16 v[36:39], v[168:171], v[84:87], v[36:39]
    v_mfma_f32_16x16x32_bf16 v[36:39], v[172:175], v[88:91], v[36:39]
    s_waitcnt lgkmcnt(3)
    v_mfma_f32_16x16x32_bf16 v[36:39], v[176:179], v[92:95], v[36:39]
    s_waitcnt lgkmcnt(0)
    s_barrier
    v_mfma_f32_16x16x32_bf16 v[40:43], v[152:155], v[72:75], v[40:43]
    ds_read_b64_tr_b16 v[120:121], v20 offset:0
    v_mfma_f32_16x16x32_bf16 v[40:43], v[156:159], v[76:79], v[40:43]
    ds_read_b64_tr_b16 v[122:123], v20 offset:512
    v_mfma_f32_16x16x32_bf16 v[40:43], v[160:163], v[80:83], v[40:43]
    ds_read_b128 v[56:59], v12 offset:34816
    v_mfma_f32_16x16x32_bf16 v[40:43], v[164:167], v[84:87], v[40:43]
    ds_read_b64_tr_b16 v[124:125], v20 offset:4096
    v_mfma_f32_16x16x32_bf16 v[40:43], v[168:171], v[88:91], v[40:43]
    ds_read_b64_tr_b16 v[126:127], v20 offset:4608
    v_mfma_f32_16x16x32_bf16 v[40:43], v[172:175], v[92:95], v[40:43]
    ds_read_b128 v[60:63], v14 offset:34816
    v_mfma_f32_16x16x32_bf16 v[40:43], v[176:179], v[96:99], v[40:43]
    ds_read_b64_tr_b16 v[128:129], v20 offset:8192
    v_mfma_f32_16x16x32_bf16 v[44:47], v[152:155], v[76:79], v[44:47]
    ds_read_b64_tr_b16 v[130:131], v20 offset:8704
    v_mfma_f32_16x16x32_bf16 v[44:47], v[156:159], v[80:83], v[44:47]
    ds_read_b128 v[64:67], v12 offset:35072
    v_mfma_f32_16x16x32_bf16 v[44:47], v[160:163], v[84:87], v[44:47]
    ds_read_b64_tr_b16 v[132:133], v20 offset:12288
    v_mfma_f32_16x16x32_bf16 v[44:47], v[164:167], v[88:91], v[44:47]
    ds_read_b64_tr_b16 v[134:135], v20 offset:12800
    v_mfma_f32_16x16x32_bf16 v[44:47], v[168:171], v[92:95], v[44:47]
    ds_read_b128 v[68:71], v14 offset:35072
    v_mfma_f32_16x16x32_bf16 v[44:47], v[172:175], v[96:99], v[44:47]
    ds_read_b64_tr_b16 v[136:137], v20 offset:16384
    v_mfma_f32_16x16x32_bf16 v[44:47], v[176:179], v[100:103], v[44:47]
    ds_read_b64_tr_b16 v[138:139], v20 offset:16896
    v_mfma_f32_16x16x32_bf16 v[48:51], v[152:155], v[80:83], v[48:51]
    ds_read_b128 v[72:75], v12 offset:35328
    v_mfma_f32_16x16x32_bf16 v[48:51], v[156:159], v[84:87], v[48:51]
    ds_read_b64_tr_b16 v[140:141], v20 offset:20480
    v_mfma_f32_16x16x32_bf16 v[48:51], v[160:163], v[88:91], v[48:51]
    ds_read_b64_tr_b16 v[142:143], v20 offset:20992
    v_mfma_f32_16x16x32_bf16 v[48:51], v[164:167], v[92:95], v[48:51]
    ds_read_b128 v[76:79], v14 offset:35328
    v_mfma_f32_16x16x32_bf16 v[48:51], v[168:171], v[96:99], v[48:51]
    ds_read_b64_tr_b16 v[144:145], v20 offset:24576
    v_mfma_f32_16x16x32_bf16 v[48:51], v[172:175], v[100:103], v[48:51]
    ds_read_b64_tr_b16 v[146:147], v20 offset:25088
    v_mfma_f32_16x16x32_bf16 v[48:51], v[176:179], v[104:107], v[48:51]
    ds_read_b128 v[80:83], v12 offset:35584
    v_mfma_f32_16x16x32_bf16 v[52:55], v[152:155], v[84:87], v[52:55]
    v_mfma_f32_16x16x32_bf16 v[52:55], v[156:159], v[88:91], v[52:55]
    ds_read_b128 v[84:87], v14 offset:35584
    v_mfma_f32_16x16x32_bf16 v[52:55], v[160:163], v[92:95], v[52:55]
    v_mfma_f32_16x16x32_bf16 v[52:55], v[164:167], v[96:99], v[52:55]
    v_mfma_f32_16x16x32_bf16 v[52:55], v[168:171], v[100:103], v[52:55]
    v_mfma_f32_16x16x32_bf16 v[52:55], v[172:175], v[104:107], v[52:55]
    v_mfma_f32_16x16x32_bf16 v[52:55], v[176:179], v[108:111], v[52:55]
    s_waitcnt lgkmcnt(4)
    v_mfma_f32_16x16x32_bf16 v[24:27], v[120:123], v[56:59], v[24:27]
    ds_read_b128 v[88:91], v16 offset:34816
    v_mfma_f32_16x16x32_bf16 v[24:27], v[124:127], v[60:63], v[24:27]
    v_mfma_f32_16x16x32_bf16 v[24:27], v[128:131], v[64:67], v[24:27]
    v_mfma_f32_16x16x32_bf16 v[24:27], v[132:135], v[68:71], v[24:27]
    ds_read_b128 v[92:95], v18 offset:34816
    v_mfma_f32_16x16x32_bf16 v[24:27], v[136:139], v[72:75], v[24:27]
    v_mfma_f32_16x16x32_bf16 v[24:27], v[140:143], v[76:79], v[24:27]
    s_waitcnt lgkmcnt(2)
    v_mfma_f32_16x16x32_bf16 v[24:27], v[144:147], v[80:83], v[24:27]
    ds_read_b128 v[96:99], v16 offset:35072
    v_mfma_f32_16x16x32_bf16 v[28:31], v[120:123], v[60:63], v[28:31]
    v_mfma_f32_16x16x32_bf16 v[28:31], v[124:127], v[64:67], v[28:31]
    s_mov_b32 s49, 0
    v_mfma_f32_16x16x32_bf16 v[28:31], v[128:131], v[68:71], v[28:31]
    ds_read_b128 v[100:103], v18 offset:35072
    v_mfma_f32_16x16x32_bf16 v[28:31], v[132:135], v[72:75], v[28:31]
    buffer_load_dwordx4 v[216:219], v2, s[40:43], s49 offen offset:0 sc1
    v_mfma_f32_16x16x32_bf16 v[28:31], v[136:139], v[76:79], v[28:31]
    v_mfma_f32_16x16x32_bf16 v[28:31], v[140:143], v[80:83], v[28:31]
    ds_read_b128 v[104:107], v16 offset:35328
    v_mfma_f32_16x16x32_bf16 v[28:31], v[144:147], v[84:87], v[28:31]
    v_mfma_f32_16x16x32_bf16 v[32:35], v[120:123], v[64:67], v[32:35]
    v_mfma_f32_16x16x32_bf16 v[32:35], v[124:127], v[68:71], v[32:35]
    ds_read_b128 v[108:111], v18 offset:35328
    v_mfma_f32_16x16x32_bf16 v[32:35], v[128:131], v[72:75], v[32:35]
    buffer_load_dwordx4 v[220:223], v2, s[40:43], s49 offen offset:1024 sc1
    v_mfma_f32_16x16x32_bf16 v[32:35], v[132:135], v[76:79], v[32:35]
    ds_write_b128 v22, v[240:243] offset:32768
    v_mfma_f32_16x16x32_bf16 v[32:35], v[136:139], v[80:83], v[32:35]
    v_mfma_f32_16x16x32_bf16 v[32:35], v[140:143], v[84:87], v[32:35]
    s_waitcnt lgkmcnt(3)
    v_mfma_f32_16x16x32_bf16 v[32:35], v[144:147], v[88:91], v[32:35]
    ds_write_b128 v22, v[244:247] offset:28672
    v_mfma_f32_16x16x32_bf16 v[36:39], v[120:123], v[68:71], v[36:39]
    v_mfma_f32_16x16x32_bf16 v[36:39], v[124:127], v[72:75], v[36:39]
    buffer_load_dwordx4 v[224:227], v2, s[40:43], s49 offen offset:2048 sc1
    v_mfma_f32_16x16x32_bf16 v[36:39], v[128:131], v[76:79], v[36:39]
    v_mfma_f32_16x16x32_bf16 v[36:39], v[132:135], v[80:83], v[36:39]
    v_mfma_f32_16x16x32_bf16 v[36:39], v[136:139], v[84:87], v[36:39]
    v_mfma_f32_16x16x32_bf16 v[36:39], v[140:143], v[88:91], v[36:39]
    v_mfma_f32_16x16x32_bf16 v[36:39], v[144:147], v[92:95], v[36:39]
    s_waitcnt vmcnt(11) lgkmcnt(0)
    s_barrier
    v_mfma_f32_16x16x32_bf16 v[40:43], v[120:123], v[72:75], v[40:43]
    ds_read_b64_tr_b16 v[152:153], v21 offset:32768
    s_add_u32 s32, s4, 8192000
    s_addc_u32 s33, s5, 0
    s_add_u32 m0, s31, 126976
    s_mov_b32 s52, 256
    v_mfma_f32_16x16x32_bf16 v[40:43], v[124:127], v[76:79], v[40:43]
    ds_read_b64_tr_b16 v[154:155], v21 offset:33280
    buffer_load_dwordx4 v253, s[32:35], s52 offen nt sc1 lds
    v_mfma_f32_16x16x32_bf16 v[40:43], v[128:131], v[80:83], v[40:43]
    ds_read_b128 v[56:59], v13 offset:52224
    v_mfma_f32_16x16x32_bf16 v[40:43], v[132:135], v[84:87], v[40:43]
    ds_read_b64_tr_b16 v[156:157], v21 offset:36864
    v_mfma_f32_16x16x32_bf16 v[40:43], v[136:139], v[88:91], v[40:43]
    ds_read_b64_tr_b16 v[158:159], v21 offset:37376
    s_add_u32 m0, s31, 131072
    v_mfma_f32_16x16x32_bf16 v[40:43], v[140:143], v[92:95], v[40:43]
    ds_read_b128 v[60:63], v15 offset:52224
    buffer_load_dwordx4 v254, s[32:35], s52 offen nt sc1 lds
    v_mfma_f32_16x16x32_bf16 v[40:43], v[144:147], v[96:99], v[40:43]
    ds_read_b64_tr_b16 v[160:161], v21 offset:40960
    v_mfma_f32_16x16x32_bf16 v[44:47], v[120:123], v[76:79], v[44:47]
    ds_read_b64_tr_b16 v[162:163], v21 offset:41472
    v_mfma_f32_16x16x32_bf16 v[44:47], v[124:127], v[80:83], v[44:47]
    ds_read_b128 v[64:67], v13 offset:52480
    v_mfma_f32_16x16x32_bf16 v[44:47], v[128:131], v[84:87], v[44:47]
    ds_read_b64_tr_b16 v[164:165], v21 offset:45056
    s_add_u32 m0, s31, 135168
    v_mfma_f32_16x16x32_bf16 v[44:47], v[132:135], v[88:91], v[44:47]
    ds_read_b64_tr_b16 v[166:167], v21 offset:45568
    buffer_load_dwordx4 v255, s[32:35], s52 offen nt sc1 lds
    v_mfma_f32_16x16x32_bf16 v[44:47], v[136:139], v[92:95], v[44:47]
    ds_read_b128 v[68:71], v15 offset:52480
    v_mfma_f32_16x16x32_bf16 v[44:47], v[140:143], v[96:99], v[44:47]
    ds_read_b64_tr_b16 v[168:169], v21 offset:49152
    v_mfma_f32_16x16x32_bf16 v[44:47], v[144:147], v[100:103], v[44:47]
    ds_read_b64_tr_b16 v[170:171], v21 offset:49664
    s_add_u32 m0, s31, 139264
    v_mfma_f32_16x16x32_bf16 v[48:51], v[120:123], v[80:83], v[48:51]
    ds_read_b128 v[72:75], v13 offset:52736
    buffer_load_dwordx4 v116, s[32:35], s52 offen nt sc1 lds
    v_mfma_f32_16x16x32_bf16 v[48:51], v[124:127], v[84:87], v[48:51]
    ds_read_b64_tr_b16 v[172:173], v21 offset:53248
    v_mfma_f32_16x16x32_bf16 v[48:51], v[128:131], v[88:91], v[48:51]
    ds_read_b64_tr_b16 v[174:175], v21 offset:53760
    v_mfma_f32_16x16x32_bf16 v[48:51], v[132:135], v[92:95], v[48:51]
    ds_read_b128 v[76:79], v15 offset:52736
    v_mfma_f32_16x16x32_bf16 v[48:51], v[136:139], v[96:99], v[48:51]
    ds_read_b64_tr_b16 v[176:177], v21 offset:57344
    s_mov_b32 m0, 143360
    v_mfma_f32_16x16x32_bf16 v[48:51], v[140:143], v[100:103], v[48:51]
    ds_read_b64_tr_b16 v[178:179], v21 offset:57856
    v_mfma_f32_16x16x32_bf16 v[48:51], v[144:147], v[104:107], v[48:51]
    ds_read_b128 v[80:83], v13 offset:52992
    v_mfma_f32_16x16x32_bf16 v[52:55], v[120:123], v[84:87], v[52:55]
    ds_read_b64_tr_b16 v[180:181], v21 offset:61440
    v_mfma_f32_16x16x32_bf16 v[52:55], v[124:127], v[88:91], v[52:55]
    ds_read_b64_tr_b16 v[182:183], v21 offset:61952
    v_mfma_f32_16x16x32_bf16 v[52:55], v[128:131], v[92:95], v[52:55]
    ds_read_b128 v[84:87], v15 offset:52992
    v_mfma_f32_16x16x32_bf16 v[52:55], v[132:135], v[96:99], v[52:55]
    s_mov_b64 exec, s[62:63]
    buffer_load_dwordx4 v117, s[32:35], s52 offen nt sc1 lds
    s_mov_b64 exec, -1
    v_mfma_f32_16x16x32_bf16 v[52:55], v[136:139], v[100:103], v[52:55]
    s_add_u32 m0, s31, 0
    s_mov_b32 s51, 212992
    v_mfma_f32_16x16x32_bf16 v[52:55], v[140:143], v[104:107], v[52:55]
    buffer_load_dwordx4 v118, s[36:39], s51 offen sc1 lds
    v_mfma_f32_16x16x32_bf16 v[52:55], v[144:147], v[108:111], v[52:55]
    s_waitcnt lgkmcnt(6)
    v_mfma_f32_16x16x32_bf16 v[24:27], v[152:155], v[56:59], v[24:27]
    ds_read_b128 v[88:91], v17 offset:52224
    s_add_u32 m0, s31, 4096
    s_mov_b32 s51, 475136
    v_mfma_f32_16x16x32_bf16 v[24:27], v[156:159], v[60:63], v[24:27]
    buffer_load_dwordx4 v118, s[36:39], s51 offen sc1 lds
    v_mfma_f32_16x16x32_bf16 v[24:27], v[160:163], v[64:67], v[24:27]
    v_mfma_f32_16x16x32_bf16 v[24:27], v[164:167], v[68:71], v[24:27]
    ds_read_b128 v[92:95], v19 offset:52224
    s_add_u32 m0, s31, 8192
    s_mov_b32 s51, 737280
    v_mfma_f32_16x16x32_bf16 v[24:27], v[168:171], v[72:75], v[24:27]
    buffer_load_dwordx4 v118, s[36:39], s51 offen sc1 lds
    v_mfma_f32_16x16x32_bf16 v[24:27], v[172:175], v[76:79], v[24:27]
    s_waitcnt lgkmcnt(2)
    v_mfma_f32_16x16x32_bf16 v[24:27], v[176:179], v[80:83], v[24:27]
    ds_read_b128 v[96:99], v17 offset:52480
    v_mfma_f32_16x16x32_bf16 v[24:27], v[180:183], v[84:87], v[24:27]
    v_mfma_f32_16x16x32_bf16 v[28:31], v[152:155], v[60:63], v[28:31]
    s_add_u32 m0, s31, 12288
    s_mov_b32 s51, 999424
    v_mfma_f32_16x16x32_bf16 v[28:31], v[156:159], v[64:67], v[28:31]
    ds_read_b128 v[100:103], v19 offset:52480
    v_mfma_f32_16x16x32_bf16 v[28:31], v[160:163], v[68:71], v[28:31]
    buffer_load_dwordx4 v118, s[36:39], s51 offen sc1 lds
    v_mfma_f32_16x16x32_bf16 v[28:31], v[164:167], v[72:75], v[28:31]
    v_mfma_f32_16x16x32_bf16 v[28:31], v[168:171], v[76:79], v[28:31]
    ds_read_b128 v[104:107], v17 offset:52736
    s_add_u32 m0, s31, 16384
    s_mov_b32 s51, 1261568
    v_mfma_f32_16x16x32_bf16 v[28:31], v[172:175], v[80:83], v[28:31]
    buffer_load_dwordx4 v118, s[36:39], s51 offen sc1 lds
    v_mfma_f32_16x16x32_bf16 v[28:31], v[176:179], v[84:87], v[28:31]
    s_waitcnt lgkmcnt(3)
    v_mfma_f32_16x16x32_bf16 v[28:31], v[180:183], v[88:91], v[28:31]
    ds_read_b128 v[108:111], v19 offset:52736
    v_mfma_f32_16x16x32_bf16 v[32:35], v[152:155], v[64:67], v[32:35]
    v_mfma_f32_16x16x32_bf16 v[32:35], v[156:159], v[68:71], v[32:35]
    s_add_u32 m0, s31, 20480
    s_mov_b32 s51, 1523712
    v_mfma_f32_16x16x32_bf16 v[32:35], v[160:163], v[72:75], v[32:35]
    ds_read_b128 v[112:115], v17 offset:52992
    v_mfma_f32_16x16x32_bf16 v[32:35], v[164:167], v[76:79], v[32:35]
    buffer_load_dwordx4 v118, s[36:39], s51 offen sc1 lds
    v_mfma_f32_16x16x32_bf16 v[32:35], v[168:171], v[80:83], v[32:35]
    v_mfma_f32_16x16x32_bf16 v[32:35], v[172:175], v[84:87], v[32:35]
    s_add_u32 m0, s31, 24576
    s_mov_b32 s51, 1785856
    v_mfma_f32_16x16x32_bf16 v[32:35], v[176:179], v[88:91], v[32:35]
    v_mfma_f32_16x16x32_bf16 v[32:35], v[180:183], v[92:95], v[32:35]
    buffer_load_dwordx4 v118, s[36:39], s51 offen sc1 lds
    v_mfma_f32_16x16x32_bf16 v[36:39], v[152:155], v[68:71], v[36:39]
    v_mfma_f32_16x16x32_bf16 v[36:39], v[156:159], v[72:75], v[36:39]
    v_mfma_f32_16x16x32_bf16 v[36:39], v[160:163], v[76:79], v[36:39]
    v_mfma_f32_16x16x32_bf16 v[36:39], v[164:167], v[80:83], v[36:39]
    v_mfma_f32_16x16x32_bf16 v[36:39], v[168:171], v[84:87], v[36:39]
    v_mfma_f32_16x16x32_bf16 v[36:39], v[172:175], v[88:91], v[36:39]
    v_mfma_f32_16x16x32_bf16 v[36:39], v[176:179], v[92:95], v[36:39]
    s_waitcnt lgkmcnt(0)
    v_mfma_f32_16x16x32_bf16 v[36:39], v[180:183], v[96:99], v[36:39]
    s_waitcnt vmcnt(12)
    s_barrier
    v_mfma_f32_16x16x32_bf16 v[40:43], v[152:155], v[72:75], v[40:43]
    ds_read_b64_tr_b16 v[120:121], v21 offset:0
    s_add_u32 m0, s31, 94208
    s_mov_b32 s51, 196608
    v_mfma_f32_16x16x32_bf16 v[40:43], v[156:159], v[76:79], v[40:43]
    ds_read_b64_tr_b16 v[122:123], v21 offset:512
    buffer_load_dwordx4 v118, s[36:39], s51 offen sc1 lds
    v_mfma_f32_16x16x32_bf16 v[40:43], v[160:163], v[80:83], v[40:43]
    ds_read_b128 v[56:59], v12 offset:52224
    v_mfma_f32_16x16x32_bf16 v[40:43], v[164:167], v[84:87], v[40:43]
    ds_read_b64_tr_b16 v[124:125], v21 offset:4096
    v_mfma_f32_16x16x32_bf16 v[40:43], v[168:171], v[88:91], v[40:43]
    ds_read_b64_tr_b16 v[126:127], v21 offset:4608
    v_mfma_f32_16x16x32_bf16 v[40:43], v[172:175], v[92:95], v[40:43]
    ds_read_b128 v[60:63], v14 offset:52224
    v_mfma_f32_16x16x32_bf16 v[40:43], v[176:179], v[96:99], v[40:43]
    ds_read_b64_tr_b16 v[128:129], v21 offset:8192
    v_mfma_f32_16x16x32_bf16 v[40:43], v[180:183], v[100:103], v[40:43]
    ds_read_b64_tr_b16 v[130:131], v21 offset:8704
    v_mfma_f32_16x16x32_bf16 v[44:47], v[152:155], v[76:79], v[44:47]
    ds_read_b128 v[64:67], v12 offset:52480
    s_add_u32 m0, s31, 98304
    s_mov_b32 s51, 458752
    v_mfma_f32_16x16x32_bf16 v[44:47], v[156:159], v[80:83], v[44:47]
    ds_read_b64_tr_b16 v[132:133], v21 offset:12288
    buffer_load_dwordx4 v118, s[36:39], s51 offen sc1 lds
    v_mfma_f32_16x16x32_bf16 v[44:47], v[160:163], v[84:87], v[44:47]
    ds_read_b64_tr_b16 v[134:135], v21 offset:12800
    v_mfma_f32_16x16x32_bf16 v[44:47], v[164:167], v[88:91], v[44:47]
    ds_read_b128 v[68:71], v14 offset:52480
    v_mfma_f32_16x16x32_bf16 v[44:47], v[168:171], v[92:95], v[44:47]
    ds_read_b64_tr_b16 v[136:137], v21 offset:16384
    v_mfma_f32_16x16x32_bf16 v[44:47], v[172:175], v[96:99], v[44:47]
    ds_read_b64_tr_b16 v[138:139], v21 offset:16896
    v_mfma_f32_16x16x32_bf16 v[44:47], v[176:179], v[100:103], v[44:47]
    ds_read_b128 v[72:75], v12 offset:52736
    v_mfma_f32_16x16x32_bf16 v[44:47], v[180:183], v[104:107], v[44:47]
    ds_read_b64_tr_b16 v[140:141], v21 offset:20480
    v_mfma_f32_16x16x32_bf16 v[48:51], v[152:155], v[80:83], v[48:51]
    ds_read_b64_tr_b16 v[142:143], v21 offset:20992
    s_add_u32 m0, s31, 102400
    s_mov_b32 s51, 720896
    v_mfma_f32_16x16x32_bf16 v[48:51], v[156:159], v[84:87], v[48:51]
    ds_read_b128 v[76:79], v14 offset:52736
    v_mfma_f32_16x16x32_bf16 v[48:51], v[160:163], v[88:91], v[48:51]
L_pg5:
    s_cbranch_execz L_pb5
    ds_read_b64_tr_b16 v[144:145], v21 offset:24576
    v_mfma_f32_16x16x32_bf16 v[48:51], v[164:167], v[92:95], v[48:51]
    ds_read_b64_tr_b16 v[146:147], v21 offset:25088
    v_mfma_f32_16x16x32_bf16 v[48:51], v[168:171], v[96:99], v[48:51]
    ds_read_b128 v[80:83], v12 offset:52992
    v_mfma_f32_16x16x32_bf16 v[48:51], v[172:175], v[100:103], v[48:51]
    ds_read_b64_tr_b16 v[148:149], v21 offset:28672
    v_mfma_f32_16x16x32_bf16 v[48:51], v[176:179], v[104:107], v[48:51]
    ds_read_b64_tr_b16 v[150:151], v21 offset:29184
    v_mfma_f32_16x16x32_bf16 v[48:51], v[180:183], v[108:111], v[48:51]
    buffer_load_dwordx4 v118, s[36:39], s51 offen sc1 lds
    v_mfma_f32_16x16x32_bf16 v[52:55], v[152:155], v[84:87], v[52:55]
    s_add_u32 m0, s31, 106496
    s_mov_b32 s51, 983040
    v_mfma_f32_16x16x32_bf16 v[52:55], v[156:159], v[88:91], v[52:55]
    ds_read_b128 v[84:87], v14 offset:52992
    v_mfma_f32_16x16x32_bf16 v[52:55], v[160:163], v[92:95], v[52:55]
    buffer_load_dwordx4 v118, s[36:39], s51 offen sc1 lds
    v_mfma_f32_16x16x32_bf16 v[52:55], v[164:167], v[96:99], v[52:55]
    v_mfma_f32_16x16x32_bf16 v[52:55], v[168:171], v[100:103], v[52:55]
    v_mfma_f32_16x16x32_bf16 v[52:55], v[172:175], v[104:107], v[52:55]
    v_mfma_f32_16x16x32_bf16 v[52:55], v[176:179], v[108:111], v[52:55]
    v_mfma_f32_16x16x32_bf16 v[52:55], v[180:183], v[112:115], v[52:55]
    s_waitcnt lgkmcnt(2)
    v_mfma_f32_16x16x32_bf16 v[24:27], v[120:123], v[56:59], v[24:27]
    ds_read_b128 v[88:91], v16 offset:52224
    v_mfma_f32_16x16x32_bf16 v[24:27], v[124:127], v[60:63], v[24:27]
    s_add_u32 m0, s31, 110592
    s_mov_b32 s51, 1245184
    v_mfma_f32_16x16x32_bf16 v[24:27], v[128:131], v[64:67], v[24:27]
    buffer_load_dwordx4 v118, s[36:39], s51 offen sc1 lds
    v_mfma_f32_16x16x32_bf16 v[24:27], v[132:135], v[68:71], v[24:27]
    ds_read_b128 v[92:95], v18 offset:52224
    v_mfma_f32_16x16x32_bf16 v[24:27], v[136:139], v[72:75], v[24:27]
    v_mfma_f32_16x16x32_bf16 v[24:27], v[140:143], v[76:79], v[24:27]
    v_mfma_f32_16x16x32_bf16 v[24:27], v[144:147], v[80:83], v[24:27]
    ds_read_b128 v[96:99], v16 offset:52480
    s_waitcnt lgkmcnt(3)
    v_mfma_f32_16x16x32_bf16 v[24:27], v[148:151], v[84:87], v[24:27]
    v_mfma_f32_16x16x32_bf16 v[28:31], v[120:123], v[60:63], v[28:31]
    v_mfma_f32_16x16x32_bf16 v[28:31], v[124:127], v[64:67], v[28:31]
    ds_read_b128 v[100:103], v18 offset:52480
    v_mfma_f32_16x16x32_bf16 v[28:31], v[128:131], v[68:71], v[28:31]
    buffer_load_dwordx4 v[228:231], v2, s[40:43], s49 offen offset:3072 sc1
    v_mfma_f32_16x16x32_bf16 v[28:31], v[132:135], v[72:75], v[28:31]
    s_add_u32 m0, s31, 114688
    s_mov_b32 s51, 1507328
    v_mfma_f32_16x16x32_bf16 v[28:31], v[136:139], v[76:79], v[28:31]
    ds_read_b128 v[104:107], v16 offset:52736
    v_mfma_f32_16x16x32_bf16 v[28:31], v[140:143], v[80:83], v[28:31]
    buffer_load_dwordx4 v118, s[36:39], s51 offen sc1 lds
    v_mfma_f32_16x16x32_bf16 v[28:31], v[144:147], v[84:87], v[28:31]
    s_waitcnt lgkmcnt(3)
    v_mfma_f32_16x16x32_bf16 v[28:31], v[148:151], v[88:91], v[28:31]
    ds_read_b128 v[108:111], v18 offset:52736
    v_mfma_f32_16x16x32_bf16 v[32:35], v[120:123], v[64:67], v[32:35]
    v_mfma_f32_16x16x32_bf16 v[32:35], v[124:127], v[68:71], v[32:35]
    s_mov_b32 s49, 4096
    v_mfma_f32_16x16x32_bf16 v[32:35], v[128:131], v[72:75], v[32:35]
    ds_read_b128 v[112:115], v16 offset:52992
    v_mfma_f32_16x16x32_bf16 v[32:35], v[132:135], v[76:79], v[32:35]
    buffer_load_dwordx4 v[232:235], v2, s[40:43], s49 offen offset:0 sc1
    v_mfma_f32_16x16x32_bf16 v[32:35], v[136:139], v[80:83], v[32:35]
    s_add_u32 m0, s31, 118784
    s_mov_b32 s51, 1769472
    v_mfma_f32_16x16x32_bf16 v[32:35], v[140:143], v[84:87], v[32:35]
    buffer_load_dwordx4 v118, s[36:39], s51 offen sc1 lds
    v_mfma_f32_16x16x32_bf16 v[32:35], v[144:147], v[88:91], v[32:35]
    v_mfma_f32_16x16x32_bf16 v[32:35], v[148:151], v[92:95], v[32:35]
    v_mfma_f32_16x16x32_bf16 v[36:39], v[120:123], v[68:71], v[36:39]
    v_mfma_f32_16x16x32_bf16 v[36:39], v[124:127], v[72:75], v[36:39]
    buffer_load_dwordx4 v[236:239], v2, s[40:43], s49 offen offset:1024 sc1
    v_mfma_f32_16x16x32_bf16 v[36:39], v[128:131], v[76:79], v[36:39]
    v_mfma_f32_16x16x32_bf16 v[36:39], v[132:135], v[80:83], v[36:39]
    v_mfma_f32_16x16x32_bf16 v[36:39], v[136:139], v[84:87], v[36:39]
    v_mfma_f32_16x16x32_bf16 v[36:39], v[140:143], v[88:91], v[36:39]
    v_mfma_f32_16x16x32_bf16 v[36:39], v[144:147], v[92:95], v[36:39]
    s_waitcnt lgkmcnt(0)
    v_mfma_f32_16x16x32_bf16 v[36:39], v[148:151], v[96:99], v[36:39]
    s_waitcnt vmcnt(10)
    s_barrier
    v_mfma_f32_16x16x32_bf16 v[40:43], v[120:123], v[72:75], v[40:43]
    ds_read_b64_tr_b16 v[152:153], v20 offset:0
    v_mfma_f32_16x16x32_bf16 v[40:43], v[124:127], v[76:79], v[40:43]
    ds_read_b64_tr_b16 v[154:155], v20 offset:512
    v_mfma_f32_16x16x32_bf16 v[40:43], v[128:131], v[80:83], v[40:43]
    ds_read_b128 v[56:59], v13 offset:34816
    v_mfma_f32_16x16x32_bf16 v[40:43], v[132:135], v[84:87], v[40:43]
    ds_read_b64_tr_b16 v[156:157], v20 offset:4096
    v_mfma_f32_16x16x32_bf16 v[40:43], v[136:139], v[88:91], v[40:43]
    ds_read_b64_tr_b16 v[158:159], v20 offset:4608
    v_mfma_f32_16x16x32_bf16 v[40:43], v[140:143], v[92:95], v[40:43]
    ds_read_b128 v[60:63], v15 offset:34816
    v_mfma_f32_16x16x32_bf16 v[40:43], v[144:147], v[96:99], v[40:43]
    ds_read_b64_tr_b16 v[160:161], v20 offset:8192
    v_mfma_f32_16x16x32_bf16 v[40:43], v[148:151], v[100:103], v[40:43]
    ds_read_b64_tr_b16 v[162:163], v20 offset:8704
    v_mfma_f32_16x16x32_bf16 v[44:47], v[120:123], v[76:79], v[44:47]
    ds_read_b128 v[64:67], v13 offset:35072
    v_mfma_f32_16x16x32_bf16 v[44:47], v[124:127], v[80:83], v[44:47]
    ds_read_b64_tr_b16 v[164:165], v20 offset:12288
    v_mfma_f32_16x16x32_bf16 v[44:47], v[128:131], v[84:87], v[44:47]
    ds_read_b64_tr_b16 v[166:167], v20 offset:12800
    v_mfma_f32_16x16x32_bf16 v[44:47], v[132:135], v[88:91], v[44:47]
    ds_read_b128 v[68:71], v15 offset:35072
    v_mfma_f32_16x16x32_bf16 v[44:47], v[136:139], v[92:95], v[44:47]
    ds_read_b64_tr_b16 v[168:169], v20 offset:16384
    v_mfma_f32_16x16x32_bf16 v[44:47], v[140:143], v[96:99], v[44:47]
    ds_read_b64_tr_b16 v[170:171], v20 offset:16896
    v_mfma_f32_16x16x32_bf16 v[44:47], v[144:147], v[100:103], v[44:47]
    ds_read_b128 v[72:75], v13 offset:35328
    v_mfma_f32_16x16x32_bf16 v[44:47], v[148:151], v[104:107], v[44:47]
    ds_read_b64_tr_b16 v[172:173], v20 offset:20480
    v_mfma_f32_16x16x32_bf16 v[48:51], v[120:123], v[80:83], v[48:51]
    ds_read_b64_tr_b16 v[174:175], v20 offset:20992
    v_mfma_f32_16x16x32_bf16 v[48:51], v[124:127], v[84:87], v[48:51]
    ds_read_b128 v[76:79], v15 offset:35328
    v_mfma_f32_16x16x32_bf16 v[48:51], v[128:131], v[88:91], v[48:51]
    ds_read_b64_tr_b16 v[176:177], v20 offset:24576
    v_mfma_f32_16x16x32_bf16 v[48:51], v[132:135], v[92:95], v[48:51]
    ds_read_b64_tr_b16 v[178:179], v20 offset:25088
    v_mfma_f32_16x16x32_bf16 v[48:51], v[136:139], v[96:99], v[48:51]
    ds_read_b128 v[80:83], v13 offset:35584
    v_mfma_f32_16x16x32_bf16 v[48:51], v[140:143], v[100:103], v[48:51]
    v_mfma_f32_16x16x32_bf16 v[48:51], v[144:147], v[104:107], v[48:51]
    v_mfma_f32_16x16x32_bf16 v[48:51], v[148:151], v[108:111], v[48:51]
    v_mfma_f32_16x16x32_bf16 v[52:55], v[120:123], v[84:87], v[52:55]
    v_mfma_f32_16x16x32_bf16 v[52:55], v[124:127], v[88:91], v[52:55]
    ds_read_b128 v[84:87], v15 offset:35584
    v_mfma_f32_16x16x32_bf16 v[52:55], v[128:131], v[92:95], v[52:55]
    v_mfma_f32_16x16x32_bf16 v[52:55], v[132:135], v[96:99], v[52:55]
    v_mfma_f32_16x16x32_bf16 v[52:55], v[136:139], v[100:103], v[52:55]
    v_mfma_f32_16x16x32_bf16 v[52:55], v[140:143], v[104:107], v[52:55]
    v_mfma_f32_16x16x32_bf16 v[52:55], v[144:147], v[108:111], v[52:55]
    v_mfma_f32_16x16x32_bf16 v[52:55], v[148:151], v[112:115], v[52:55]
    s_waitcnt lgkmcnt(1)
    v_mfma_f32_16x16x32_bf16 v[24:27], v[152:155], v[56:59], v[24:27]
    ds_read_b128 v[88:91], v17 offset:34816
    v_mfma_f32_16x16x32_bf16 v[24:27], v[156:159], v[60:63], v[24:27]
    v_mfma_f32_16x16x32_bf16 v[24:27], v[160:163], v[64:67], v[24:27]
    v_mfma_f32_16x16x32_bf16 v[24:27], v[164:167], v[68:71], v[24:27]
    ds_read_b128 v[92:95], v19 offset:34816
    v_mfma_f32_16x16x32_bf16 v[24:27], v[168:171], v[72:75], v[24:27]
    v_mfma_f32_16x16x32_bf16 v[24:27], v[172:175], v[76:79], v[24:27]
    v_mfma_f32_16x16x32_bf16 v[24:27], v[176:179], v[80:83], v[24:27]
    ds_read_b128 v[96:99], v17 offset:35072
    v_mfma_f32_16x16x32_bf16 v[28:31], v[152:155], v[60:63], v[28:31]
    v_mfma_f32_16x16x32_bf16 v[28:31], v[156:159], v[64:67], v[28:31]
    v_mfma_f32_16x16x32_bf16 v[28:31], v[160:163], v[68:71], v[28:31]
    ds_read_b128 v[100:103], v19 offset:35072
    v_mfma_f32_16x16x32_bf16 v[28:31], v[164:167], v[72:75], v[28:31]
    v_mfma_f32_16x16x32_bf16 v[28:31], v[168:171], v[76:79], v[28:31]
    v_mfma_f32_16x16x32_bf16 v[28:31], v[172:175], v[80:83], v[28:31]
    ds_read_b128 v[104:107], v17 offset:35328
    s_waitcnt lgkmcnt(4)
    v_mfma_f32_16x16x32_bf16 v[28:31], v[176:179], v[84:87], v[28:31]
    v_mfma_f32_16x16x32_bf16 v[32:35], v[152:155], v[64:67], v[32:35]
    v_mfma_f32_16x16x32_bf16 v[32:35], v[156:159], v[68:71], v[32:35]
    ds_read_b128 v[108:111], v19 offset:35328
    v_mfma_f32_16x16x32_bf16 v[32:35], v[160:163], v[72:75], v[32:35]
    v_mfma_f32_16x16x32_bf16 v[32:35], v[164:167], v[76:79], v[32:35]
    v_mfma_f32_16x16x32_bf16 v[32:35], v[168:171], v[80:83], v[32:35]
    v_mfma_f32_16x16x32_bf16 v[32:35], v[172:175], v[84:87], v[32:35]
    v_mfma_f32_16x16x32_bf16 v[32:35], v[176:179], v[88:91], v[32:35]
    v_mfma_f32_16x16x32_bf16 v[36:39], v[152:155], v[68:71], v[36:39]
    v_mfma_f32_16x16x32_bf16 v[36:39], v[156:159], v[72:75], v[36:39]
    v_mfma_f32_16x16x32_bf16 v[36:39], v[160:163], v[76:79], v[36:39]
    v_mfma_f32_16x16x32_bf16 v[36:39], v[164:167], v[80:83], v[36:39]
    v_mfma_f32_16x16x32_bf16 v[36:39], v[168:171], v[84:87], v[36:39]
    v_mfma_f32_16x16x32_bf16 v[36:39], v[172:175], v[88:91], v[36:39]
    s_waitcnt lgkmcnt(0)
    v_mfma_f32_16x16x32_bf16 v[36:39], v[176:179], v[92:95], v[36:39]
    s_waitcnt vmcnt(0)
    s_barrier
    v_mfma_f32_16x16x32_bf16 v[40:43], v[152:155], v[72:75], v[40:43]
    ds_read_b64_tr_b16 v[120:121], v21 offset:32768
    v_mfma_f32_16x16x32_bf16 v[40:43], v[156:159], v[76:79], v[40:43]
    ds_read_b64_tr_b16 v[122:123], v21 offset:33280
    v_mfma_f32_16x16x32_bf16 v[40:43], v[160:163], v[80:83], v[40:43]
    ds_read_b128 v[56:59], v12 offset:34816
    v_mfma_f32_16x16x32_bf16 v[40:43], v[164:167], v[84:87], v[40:43]
    ds_read_b64_tr_b16 v[124:125], v21 offset:36864
    v_mfma_f32_16x16x32_bf16 v[40:43], v[168:171], v[88:91], v[40:43]
    ds_read_b64_tr_b16 v[126:127], v21 offset:37376
    v_mfma_f32_16x16x32_bf16 v[40:43], v[172:175], v[92:95], v[40:43]
    ds_read_b128 v[60:63], v14 offset:34816
    v_mfma_f32_16x16x32_bf16 v[40:43], v[176:179], v[96:99], v[40:43]
    ds_read_b64_tr_b16 v[128:129], v21 offset:40960
    v_mfma_f32_16x16x32_bf16 v[44:47], v[152:155], v[76:79], v[44:47]
    ds_read_b64_tr_b16 v[130:131], v21 offset:41472
    v_mfma_f32_16x16x32_bf16 v[44:47], v[156:159], v[80:83], v[44:47]
    ds_read_b128 v[64:67], v12 offset:35072
    v_mfma_f32_16x16x32_bf16 v[44:47], v[160:163], v[84:87], v[44:47]
    ds_read_b64_tr_b16 v[132:133], v21 offset:45056
    v_mfma_f32_16x16x32_bf16 v[44:47], v[164:167], v[88:91], v[44:47]
    ds_read_b64_tr_b16 v[134:135], v21 offset:45568
    v_mfma_f32_16x16x32_bf16 v[44:47], v[168:171], v[92:95], v[44:47]
    ds_read_b128 v[68:71], v14 offset:35072
    v_mfma_f32_16x16x32_bf16 v[44:47], v[172:175], v[96:99], v[44:47]
    ds_read_b64_tr_b16 v[136:137], v21 offset:49152
    v_mfma_f32_16x16x32_bf16 v[44:47], v[176:179], v[100:103], v[44:47]
    ds_read_b64_tr_b16 v[138:139], v21 offset:49664
    v_mfma_f32_16x16x32_bf16 v[48:51], v[152:155], v[80:83], v[48:51]
    ds_read_b128 v[72:75], v12 offset:35328
    v_mfma_f32_16x16x32_bf16 v[48:51], v[156:159], v[84:87], v[48:51]
    ds_read_b64_tr_b16 v[140:141], v21 offset:53248
    v_mfma_f32_16x16x32_bf16 v[48:51], v[160:163], v[88:91], v[48:51]
    ds_read_b64_tr_b16 v[142:143], v21 offset:53760
    v_mfma_f32_16x16x32_bf16 v[48:51], v[164:167], v[92:95], v[48:51]
    ds_read_b128 v[76:79], v14 offset:35328
    v_mfma_f32_16x16x32_bf16 v[48:51], v[168:171], v[96:99], v[48:51]
    ds_read_b64_tr_b16 v[144:145], v21 offset:57344
    v_mfma_f32_16x16x32_bf16 v[48:51], v[172:175], v[100:103], v[48:51]
    ds_read_b64_tr_b16 v[146:147], v21 offset:57856
    v_mfma_f32_16x16x32_bf16 v[48:51], v[176:179], v[104:107], v[48:51]
    ds_read_b128 v[80:83], v12 offset:35584
    v_mfma_f32_16x16x32_bf16 v[52:55], v[152:155], v[84:87], v[52:55]
    v_mfma_f32_16x16x32_bf16 v[52:55], v[156:159], v[88:91], v[52:55]
    ds_read_b128 v[84:87], v14 offset:35584
    v_mfma_f32_16x16x32_bf16 v[52:55], v[160:163], v[92:95], v[52:55]
    v_mfma_f32_16x16x32_bf16 v[52:55], v[164:167], v[96:99], v[52:55]
    v_mfma_f32_16x16x32_bf16 v[52:55], v[168:171], v[100:103], v[52:55]
    v_mfma_f32_16x16x32_bf16 v[52:55], v[172:175], v[104:107], v[52:55]
    v_mfma_f32_16x16x32_bf16 v[52:55], v[176:179], v[108:111], v[52:55]
    s_waitcnt lgkmcnt(4)
    v_mfma_f32_16x16x32_bf16 v[24:27], v[120:123], v[56:59], v[24:27]
    ds_read_b128 v[88:91], v16 offset:34816
    v_mfma_f32_16x16x32_bf16 v[24:27], v[124:127], v[60:63], v[24:27]
    v_mfma_f32_16x16x32_bf16 v[24:27], v[128:131], v[64:67], v[24:27]
    v_and_b32 v119, 0x1ff, v248
    v_mfma_f32_16x16x32_bf16 v[24:27], v[132:135], v[68:71], v[24:27]
    ds_read_b128 v[92:95], v18 offset:34816
    v_ashrrev_i32 v248, 9, v248
    v_mfma_f32_16x16x32_bf16 v[24:27], v[136:139], v[72:75], v[24:27]
    v_lshl_add_u32 v248, v248, 7, v119
    v_mfma_f32_16x16x32_bf16 v[24:27], v[140:143], v[76:79], v[24:27]
    v_add_u32 v248, s61, v248
    s_waitcnt lgkmcnt(2)
    v_mfma_f32_16x16x32_bf16 v[24:27], v[144:147], v[80:83], v[24:27]
    ds_read_b128 v[96:99], v16 offset:35072
    v_add_u32 v253, 128, v248
    v_mfma_f32_16x16x32_bf16 v[28:31], v[120:123], v[60:63], v[28:31]
    v_and_b32 v119, 0x1ff, v249
    v_mfma_f32_16x16x32_bf16 v[28:31], v[124:127], v[64:67], v[28:31]
    v_ashrrev_i32 v249, 9, v249
    buffer_load_dwordx4 v[240:243], v2, s[40:43], s49 offen offset:2048 sc1
    v_mfma_f32_16x16x32_bf16 v[28:31], v[128:131], v[68:71], v[28:31]
    ds_read_b128 v[100:103], v18 offset:35072
    v_lshl_add_u32 v249, v249, 7, v119
    v_mfma_f32_16x16x32_bf16 v[28:31], v[132:135], v[72:75], v[28:31]
    v_add_u32 v249, s61, v249
    v_mfma_f32_16x16x32_bf16 v[28:31], v[136:139], v[76:79], v[28:31]
    v_add_u32 v254, 128, v249
    v_mfma_f32_16x16x32_bf16 v[28:31], v[140:143], v[80:83], v[28:31]
    ds_read_b128 v[104:107], v16 offset:35328
    v_and_b32 v119, 0x1ff, v250
    v_mfma_f32_16x16x32_bf16 v[28:31], v[144:147], v[84:87], v[28:31]
    v_ashrrev_i32 v250, 9, v250
    v_mfma_f32_16x16x32_bf16 v[32:35], v[120:123], v[64:67], v[32:35]
    v_lshl_add_u32 v250, v250, 7, v119
    v_mfma_f32_16x16x32_bf16 v[32:35], v[124:127], v[68:71], v[32:35]
    ds_read_b128 v[108:111], v18 offset:35328
    v_add_u32 v250, s61, v250
    buffer_load_dwordx4 v[244:247], v2, s[40:43], s49 offen offset:3072 sc1
    v_mfma_f32_16x16x32_bf16 v[32:35], v[128:131], v[72:75], v[32:35]
    v_add_u32 v255, 128, v250
    v_mfma_f32_16x16x32_bf16 v[32:35], v[132:135], v[76:79], v[32:35]
    v_and_b32 v119, 0x1ff, v251
    v_mfma_f32_16x16x32_bf16 v[32:35], v[136:139], v[80:83], v[32:35]
    v_ashrrev_i32 v251, 9, v251
    v_mfma_f32_16x16x32_bf16 v[32:35], v[140:143], v[84:87], v[32:35]
    v_lshl_add_u32 v251, v251, 7, v119
    s_waitcnt lgkmcnt(2)
    v_mfma_f32_16x16x32_bf16 v[32:35], v[144:147], v[88:91], v[32:35]
    v_add_u32 v251, s61, v251
    v_mfma_f32_16x16x32_bf16 v[36:39], v[120:123], v[68:71], v[36:39]
    v_add_u32 v116, 128, v251
    v_mfma_f32_16x16x32_bf16 v[36:39], v[124:127], v[72:75], v[36:39]
    v_and_b32 v119, 0x1ff, v252
    v_mfma_f32_16x16x32_bf16 v[36:39], v[128:131], v[76:79], v[36:39]
    v_ashrrev_i32 v252, 9, v252
    v_mfma_f32_16x16x32_bf16 v[36:39], v[132:135], v[80:83], v[36:39]
    v_lshl_add_u32 v252, v252, 7, v119
    v_mfma_f32_16x16x32_bf16 v[36:39], v[136:139], v[84:87], v[36:39]
    v_add_u32 v252, s61, v252
    v_mfma_f32_16x16x32_bf16 v[36:39], v[140:143], v[88:91], v[36:39]
    v_add_u32 v117, 128, v252
    v_mfma_f32_16x16x32_bf16 v[36:39], v[144:147], v[92:95], v[36:39]
    s_waitcnt lgkmcnt(0)
    s_barrier
    v_mfma_f32_16x16x32_bf16 v[40:43], v[120:123], v[72:75], v[40:43]
    ds_read_b64_tr_b16 v[152:153], v21 offset:0
    v_mfma_f32_16x16x32_bf16 v[40:43], v[124:127], v[76:79], v[40:43]
    ds_read_b64_tr_b16 v[154:155], v21 offset:512
    v_mfma_f32_16x16x32_bf16 v[40:43], v[128:131], v[80:83], v[40:43]
    ds_read_b128 v[56:59], v13 offset:52224
    s_mov_b32 s48, 0
    v_mfma_f32_16x16x32_bf16 v[40:43], v[132:135], v[84:87], v[40:43]
    ds_read_b64_tr_b16 v[156:157], v21 offset:4096
    buffer_load_dwordx4 v[184:187], v23, s[40:43], s48 offen offset:0 sc1
    v_mfma_f32_16x16x32_bf16 v[40:43], v[136:139], v[88:91], v[40:43]
    ds_read_b64_tr_b16 v[158:159], v21 offset:4608
    v_mfma_f32_16x16x32_bf16 v[40:43], v[140:143], v[92:95], v[40:43]
    ds_read_b128 v[60:63], v15 offset:52224
    v_mfma_f32_16x16x32_bf16 v[40:43], v[144:147], v[96:99], v[40:43]
    ds_read_b64_tr_b16 v[160:161], v21 offset:8192
    v_mfma_f32_16x16x32_bf16 v[44:47], v[120:123], v[76:79], v[44:47]
    ds_read_b64_tr_b16 v[162:163], v21 offset:8704
    v_mfma_f32_16x16x32_bf16 v[44:47], v[124:127], v[80:83], v[44:47]
    ds_read_b128 v[64:67], v13 offset:52480
    buffer_load_dwordx4 v[188:191], v23, s[40:43], s48 offen offset:1024 sc1
    v_mfma_f32_16x16x32_bf16 v[44:47], v[128:131], v[84:87], v[44:47]
    ds_read_b64_tr_b16 v[164:165], v21 offset:12288
    v_mfma_f32_16x16x32_bf16 v[44:47], v[132:135], v[88:91], v[44:47]
    ds_read_b64_tr_b16 v[166:167], v21 offset:12800
    v_mfma_f32_16x16x32_bf16 v[44:47], v[136:139], v[92:95], v[44:47]
    ds_read_b128 v[68:71], v15 offset:52480
    v_mfma_f32_16x16x32_bf16 v[44:47], v[140:143], v[96:99], v[44:47]
    ds_read_b64_tr_b16 v[168:169], v21 offset:16384
    v_mfma_f32_16x16x32_bf16 v[44:47], v[144:147], v[100:103], v[44:47]
    ds_read_b64_tr_b16 v[170:171], v21 offset:16896
    v_mfma_f32_16x16x32_bf16 v[48:51], v[120:123], v[80:83], v[48:51]
    ds_read_b128 v[72:75], v13 offset:52736
    buffer_load_dwordx4 v[192:195], v23, s[40:43], s48 offen offset:2048 sc1
    v_mfma_f32_16x16x32_bf16 v[48:51], v[124:127], v[84:87], v[48:51]
    ds_read_b64_tr_b16 v[172:173], v21 offset:20480
    v_mfma_f32_16x16x32_bf16 v[48:51], v[128:131], v[88:91], v[48:51]
    ds_read_b64_tr_b16 v[174:175], v21 offset:20992
    v_mfma_f32_16x16x32_bf16 v[48:51], v[132:135], v[92:95], v[48:51]
    ds_read_b128 v[76:79], v15 offset:52736
    v_mfma_f32_16x16x32_bf16 v[48:51], v[136:139], v[96:99], v[48:51]
    ds_read_b64_tr_b16 v[176:177], v21 offset:24576
    v_mfma_f32_16x16x32_bf16 v[48:51], v[140:143], v[100:103], v[48:51]
    ds_read_b64_tr_b16 v[178:179], v21 offset:25088
    v_mfma_f32_16x16x32_bf16 v[48:51], v[144:147], v[104:107], v[48:51]
    ds_read_b128 v[80:83], v13 offset:52992
    v_mfma_f32_16x16x32_bf16 v[52:55], v[120:123], v[84:87], v[52:55]
    ds_read_b64_tr_b16 v[180:181], v21 offset:28672
    v_mfma_f32_16x16x32_bf16 v[52:55], v[124:127], v[88:91], v[52:55]
    ds_read_b64_tr_b16 v[182:183], v21 offset:29184
    v_mfma_f32_16x16x32_bf16 v[52:55], v[128:131], v[92:95], v[52:55]
    ds_read_b128 v[84:87], v15 offset:52992
    v_mfma_f32_16x16x32_bf16 v[52:55], v[132:135], v[96:99], v[52:55]
    buffer_load_dwordx4 v[196:199], v23, s[40:43], s48 offen offset:3072 sc1
    v_mfma_f32_16x16x32_bf16 v[52:55], v[136:139], v[100:103], v[52:55]
    v_mfma_f32_16x16x32_bf16 v[52:55], v[140:143], v[104:107], v[52:55]
    v_mfma_f32_16x16x32_bf16 v[52:55], v[144:147], v[108:111], v[52:55]
    s_waitcnt lgkmcnt(6)
    v_mfma_f32_16x16x32_bf16 v[24:27], v[152:155], v[56:59], v[24:27]
    ds_read_b128 v[88:91], v17 offset:52224
    v_mfma_f32_16x16x32_bf16 v[24:27], v[156:159], v[60:63], v[24:27]
    v_mfma_f32_16x16x32_bf16 v[24:27], v[160:163], v[64:67], v[24:27]
    s_mov_b32 s48, 4096
    v_mfma_f32_16x16x32_bf16 v[24:27], v[164:167], v[68:71], v[24:27]
    ds_read_b128 v[92:95], v19 offset:52224
    v_mfma_f32_16x16x32_bf16 v[24:27], v[168:171], v[72:75], v[24:27]
    buffer_load_dwordx4 v[200:203], v23, s[40:43], s48 offen offset:0 sc1
    v_mfma_f32_16x16x32_bf16 v[24:27], v[172:175], v[76:79], v[24:27]
    s_waitcnt lgkmcnt(2)
    v_mfma_f32_16x16x32_bf16 v[24:27], v[176:179], v[80:83], v[24:27]
    ds_read_b128 v[96:99], v17 offset:52480
    v_mfma_f32_16x16x32_bf16 v[24:27], v[180:183], v[84:87], v[24:27]
    v_mfma_f32_16x16x32_bf16 v[28:31], v[152:155], v[60:63], v[28:31]
    buffer_load_dwordx4 v[204:207], v23, s[40:43], s48 offen offset:1024 sc1
    v_mfma_f32_16x16x32_bf16 v[28:31], v[156:159], v[64:67], v[28:31]
    ds_read_b128 v[100:103], v19 offset:52480
    v_mfma_f32_16x16x32_bf16 v[28:31], v[160:163], v[68:71], v[28:31]
    v_mfma_f32_16x16x32_bf16 v[28:31], v[164:167], v[72:75], v[28:31]
    v_mfma_f32_16x16x32_bf16 v[28:31], v[168:171], v[76:79], v[28:31]
    ds_read_b128 v[104:107], v17 offset:52736
    v_mfma_f32_16x16x32_bf16 v[28:31], v[172:175], v[80:83], v[28:31]
    v_mfma_f32_16x16x32_bf16 v[28:31], v[176:179], v[84:87], v[28:31]
    s_waitcnt lgkmcnt(3)
    v_mfma_f32_16x16x32_bf16 v[28:31], v[180:183], v[88:91], v[28:31]
    ds_read_b128 v[108:111], v19 offset:52736
    v_mfma_f32_16x16x32_bf16 v[32:35], v[152:155], v[64:67], v[32:35]
    buffer_load_dwordx4 v[208:211], v23, s[40:43], s48 offen offset:2048 sc1
    v_mfma_f32_16x16x32_bf16 v[32:35], v[156:159], v[68:71], v[32:35]
    v_mfma_f32_16x16x32_bf16 v[32:35], v[160:163], v[72:75], v[32:35]
    ds_read_b128 v[112:115], v17 offset:52992
    v_mfma_f32_16x16x32_bf16 v[32:35], v[164:167], v[76:79], v[32:35]
    v_mfma_f32_16x16x32_bf16 v[32:35], v[168:171], v[80:83], v[32:35]
    buffer_load_dwordx4 v[212:215], v23, s[40:43], s48 offen offset:3072 sc1
    v_mfma_f32_16x16x32_bf16 v[32:35], v[172:175], v[84:87], v[32:35]
    v_mfma_f32_16x16x32_bf16 v[32:35], v[176:179], v[88:91], v[32:35]
    v_mfma_f32_16x16x32_bf16 v[32:35], v[180:183], v[92:95], v[32:35]
    v_mfma_f32_16x16x32_bf16 v[36:39], v[152:155], v[68:71], v[36:39]
    v_mfma_f32_16x16x32_bf16 v[36:39], v[156:159], v[72:75], v[36:39]
    v_mfma_f32_16x16x32_bf16 v[36:39], v[160:163], v[76:79], v[36:39]
    v_mfma_f32_16x16x32_bf16 v[36:39], v[164:167], v[80:83], v[36:39]
    v_mfma_f32_16x16x32_bf16 v[36:39], v[168:171], v[84:87], v[36:39]
    v_mfma_f32_16x16x32_bf16 v[36:39], v[172:175], v[88:91], v[36:39]
    v_mfma_f32_16x16x32_bf16 v[36:39], v[176:179], v[92:95], v[36:39]
    s_waitcnt lgkmcnt(0)
    v_mfma_f32_16x16x32_bf16 v[36:39], v[180:183], v[96:99], v[36:39]
    s_barrier
    v_mfma_f32_16x16x32_bf16 v[40:43], v[152:155], v[72:75], v[40:43]
    ds_read_b64_tr_b16 v[120:121], v20 offset:0
    s_add_u32 s32, s22, 0
    s_addc_u32 s33, s23, 0
    s_mov_b32 s34, 1024000
    s_mov_b32 s35, 0x20000
    s_add_u32 m0, s31, 126976
    v_mfma_f32_16x16x32_bf16 v[40:43], v[156:159], v[76:79], v[40:43]
    ds_read_b64_tr_b16 v[122:123], v20 offset:512
    buffer_load_dwordx4 v248, s[32:35], 0 offen sc1 lds
    v_mfma_f32_16x16x32_bf16 v[40:43], v[160:163], v[80:83], v[40:43]
    ds_read_b128 v[56:59], v12 offset:52224
    v_mfma_f32_16x16x32_bf16 v[40:43], v[164:167], v[84:87], v[40:43]
    ds_read_b64_tr_b16 v[124:125], v20 offset:4096
    v_mfma_f32_16x16x32_bf16 v[40:43], v[168:171], v[88:91], v[40:43]
    ds_read_b64_tr_b16 v[126:127], v20 offset:4608
    v_mfma_f32_16x16x32_bf16 v[40:43], v[172:175], v[92:95], v[40:43]
    ds_read_b128 v[60:63], v14 offset:52224
    s_add_u32 m0, s31, 131072
    v_mfma_f32_16x16x32_bf16 v[40:43], v[176:179], v[96:99], v[40:43]
    ds_read_b64_tr_b16 v[128:129], v20 offset:8192
    buffer_load_dwordx4 v249, s[32:35], 0 offen sc1 lds
    v_mfma_f32_16x16x32_bf16 v[40:43], v[180:183], v[100:103], v[40:43]
    ds_read_b64_tr_b16 v[130:131], v20 offset:8704
    v_mfma_f32_16x16x32_bf16 v[44:47], v[152:155], v[76:79], v[44:47]
    ds_read_b128 v[64:67], v12 offset:52480
    v_mfma_f32_16x16x32_bf16 v[44:47], v[156:159], v[80:83], v[44:47]
    ds_read_b64_tr_b16 v[132:133], v20 offset:12288
    v_mfma_f32_16x16x32_bf16 v[44:47], v[160:163], v[84:87], v[44:47]
    ds_read_b64_tr_b16 v[134:135], v20 offset:12800
    s_add_u32 m0, s31, 135168
    v_mfma_f32_16x16x32_bf16 v[44:47], v[164:167], v[88:91], v[44:47]
    ds_read_b128 v[68:71], v14 offset:52480
    buffer_load_dwordx4 v250, s[32:35], 0 offen sc1 lds
    v_mfma_f32_16x16x32_bf16 v[44:47], v[168:171], v[92:95], v[44:47]
    ds_read_b64_tr_b16 v[136:137], v20 offset:16384
    v_mfma_f32_16x16x32_bf16 v[44:47], v[172:175], v[96:99], v[44:47]
    ds_read_b64_tr_b16 v[138:139], v20 offset:16896
    v_mfma_f32_16x16x32_bf16 v[44:47], v[176:179], v[100:103], v[44:47]
    ds_read_b128 v[72:75], v12 offset:52736
    v_mfma_f32_16x16x32_bf16 v[44:47], v[180:183], v[104:107], v[44:47]
    ds_read_b64_tr_b16 v[140:141], v20 offset:20480
    v_mfma_f32_16x16x32_bf16 v[48:51], v[152:155], v[80:83], v[48:51]
    ds_read_b64_tr_b16 v[142:143], v20 offset:20992
    s_add_u32 m0, s31, 139264
    v_mfma_f32_16x16x32_bf16 v[48:51], v[156:159], v[84:87], v[48:51]
    ds_read_b128 v[76:79], v14 offset:52736
    v_mfma_f32_16x16x32_bf16 v[48:51], v[160:163], v[88:91], v[48:51]
    ds_read_b64_tr_b16 v[144:145], v20 offset:24576
    v_mfma_f32_16x16x32_bf16 v[48:51], v[164:167], v[92:95], v[48:51]
    ds_read_b64_tr_b16 v[146:147], v20 offset:25088
    v_mfma_f32_16x16x32_bf16 v[48:51], v[168:171], v[96:99], v[48:51]
    ds_read_b128 v[80:83], v12 offset:52992
    v_mfma_f32_16x16x32_bf16 v[48:51], v[172:175], v[100:103], v[48:51]
    ds_read_b64_tr_b16 v[148:149], v20 offset:28672
    v_mfma_f32_16x16x32_bf16 v[48:51], v[176:179], v[104:107], v[48:51]
    ds_read_b64_tr_b16 v[150:151], v20 offset:29184
    v_mfma_f32_16x16x32_bf16 v[48:51], v[180:183], v[108:111], v[48:51]
    buffer_load_dwordx4 v251, s[32:35], 0 offen sc1 lds
    v_mfma_f32_16x16x32_bf16 v[52:55], v[152:155], v[84:87], v[52:55]
    s_mov_b32 m0, 143360
    v_mfma_f32_16x16x32_bf16 v[52:55], v[156:159], v[88:91], v[52:55]
    ds_read_b128 v[84:87], v14 offset:52992
    v_mfma_f32_16x16x32_bf16 v[52:55], v[160:163], v[92:95], v[52:55]
    s_mov_b64 exec, s[62:63]
    buffer_load_dwordx4 v252, s[32:35], 0 offen sc1 lds
    s_mov_b64 exec, -1
    v_mfma_f32_16x16x32_bf16 v[52:55], v[164:167], v[96:99], v[52:55]
    s_mov_b32 s48, 8192
    v_mfma_f32_16x16x32_bf16 v[52:55], v[168:171], v[100:103], v[52:55]
    buffer_load_dwordx4 v[152:155], v23, s[40:43], s48 offen offset:0 sc1
    v_mfma_f32_16x16x32_bf16 v[52:55], v[172:175], v[104:107], v[52:55]
    s_add_u32 m0, s31, 109568
    v_mfma_f32_16x16x32_bf16 v[52:55], v[176:179], v[108:111], v[52:55]
    buffer_load_dwordx4 v253, s[32:35], 0 offen sc1 lds
    v_mfma_f32_16x16x32_bf16 v[52:55], v[180:183], v[112:115], v[52:55]
    buffer_load_dwordx4 v[156:159], v23, s[40:43], s48 offen offset:1024 sc1
    s_waitcnt lgkmcnt(2)
    v_mfma_f32_16x16x32_bf16 v[24:27], v[120:123], v[56:59], v[24:27]
    ds_read_b128 v[88:91], v16 offset:52224
    s_add_u32 m0, s31, 113664
    v_mfma_f32_16x16x32_bf16 v[24:27], v[124:127], v[60:63], v[24:27]
    buffer_load_dwordx4 v254, s[32:35], 0 offen sc1 lds
    v_mfma_f32_16x16x32_bf16 v[24:27], v[128:131], v[64:67], v[24:27]
    buffer_load_dwordx4 v[160:163], v23, s[40:43], s48 offen offset:2048 sc1
    v_mfma_f32_16x16x32_bf16 v[24:27], v[132:135], v[68:71], v[24:27]
    ds_read_b128 v[92:95], v18 offset:52224
    v_mfma_f32_16x16x32_bf16 v[24:27], v[136:139], v[72:75], v[24:27]
    v_mfma_f32_16x16x32_bf16 v[24:27], v[140:143], v[76:79], v[24:27]
    s_add_u32 m0, s31, 117760
    v_mfma_f32_16x16x32_bf16 v[24:27], v[144:147], v[80:83], v[24:27]
    ds_read_b128 v[96:99], v16 offset:52480
    s_waitcnt lgkmcnt(3)
    v_mfma_f32_16x16x32_bf16 v[24:27], v[148:151], v[84:87], v[24:27]
    buffer_load_dwordx4 v255, s[32:35], 0 offen sc1 lds
    v_mfma_f32_16x16x32_bf16 v[28:31], v[120:123], v[60:63], v[28:31]
    buffer_load_dwordx4 v[164:167], v23, s[40:43], s48 offen offset:3072 sc1
    v_mfma_f32_16x16x32_bf16 v[28:31], v[124:127], v[64:67], v[28:31]
    ds_read_b128 v[100:103], v18 offset:52480
    v_mfma_f32_16x16x32_bf16 v[28:31], v[128:131], v[68:71], v[28:31]
    v_mfma_f32_16x16x32_bf16 v[28:31], v[132:135], v[72:75], v[28:31]
    s_mov_b32 s48, 12288
    v_mfma_f32_16x16x32_bf16 v[28:31], v[136:139], v[76:79], v[28:31]
    ds_read_b128 v[104:107], v16 offset:52736
    v_mfma_f32_16x16x32_bf16 v[28:31], v[140:143], v[80:83], v[28:31]
    buffer_load_dwordx4 v[168:171], v23, s[40:43], s48 offen offset:0 sc1
    v_mfma_f32_16x16x32_bf16 v[28:31], v[144:147], v[84:87], v[28:31]
    s_add_u32 m0, s31, 121856
    s_waitcnt lgkmcnt(3)
    v_mfma_f32_16x16x32_bf16 v[28:31], v[148:151], v[88:91], v[28:31]
    ds_read_b128 v[108:111], v18 offset:52736
    v_mfma_f32_16x16x32_bf16 v[32:35], v[120:123], v[64:67], v[32:35]
    buffer_load_dwordx4 v116, s[32:35], 0 offen sc1 lds
    v_mfma_f32_16x16x32_bf16 v[32:35], v[124:127], v[68:71], v[32:35]
    buffer_load_dwordx4 v[172:175], v23, s[40:43], s48 offen offset:1024 sc1
    v_mfma_f32_16x16x32_bf16 v[32:35], v[128:131], v[72:75], v[32:35]
    ds_read_b128 v[112:115], v16 offset:52992
    s_nop 0
    ds_write_b128 v22, v[24:27] offset:57344
    v_mfma_f32_16x16x32_bf16 v[32:35], v[132:135], v[76:79], v[32:35]
    s_mov_b32 m0, 125952
    v_mfma_f32_16x16x32_bf16 v[32:35], v[136:139], v[80:83], v[32:35]
    s_mov_b64 exec, s[62:63]
    buffer_load_dwordx4 v117, s[32:35], 0 offen sc1 lds
    s_mov_b64 exec, -1
    v_mfma_f32_16x16x32_bf16 v[32:35], v[140:143], v[84:87], v[32:35]
    buffer_load_dwordx4 v[176:179], v23, s[40:43], s48 offen offset:2048 sc1
    v_mfma_f32_16x16x32_bf16 v[32:35], v[144:147], v[88:91], v[32:35]
    v_mfma_f32_16x16x32_bf16 v[32:35], v[148:151], v[92:95], v[32:35]
    s_nop 0
    ds_write_b128 v22, v[28:31] offset:53248
    v_mfma_f32_16x16x32_bf16 v[36:39], v[120:123], v[68:71], v[36:39]
    v_mfma_f32_16x16x32_bf16 v[36:39], v[124:127], v[72:75], v[36:39]
    v_mfma_f32_16x16x32_bf16 v[36:39], v[128:131], v[76:79], v[36:39]
    v_mfma_f32_16x16x32_bf16 v[36:39], v[132:135], v[80:83], v[36:39]
    v_mfma_f32_16x16x32_bf16 v[36:39], v[136:139], v[84:87], v[36:39]
    v_mfma_f32_16x16x32_bf16 v[36:39], v[140:143], v[88:91], v[36:39]
L_pg6:
    s_cbranch_execz L_pb6
    v_mfma_f32_16x16x32_bf16 v[36:39], v[144:147], v[92:95], v[36:39]
    s_waitcnt lgkmcnt(1)
    v_mfma_f32_16x16x32_bf16 v[36:39], v[148:151], v[96:99], v[36:39]
    s_nop 0
    ds_write_b128 v22, v[32:35] offset:49152
    s_waitcnt vmcnt(12) lgkmcnt(1)
    s_barrier
    v_mfma_f32_16x16x32_bf16 v[40:43], v[120:123], v[72:75], v[40:43]
    ds_read_b128 v[56:59], v8 offset:34816
    s_add_u32 s32, s22, 1048576
    s_addc_u32 s33, s23, 0
    s_mov_b32 s34, 1024000
    s_mov_b32 s35, 0x20000
    s_add_u32 m0, s31, 92160
    v_mfma_f32_16x16x32_bf16 v[40:43], v[124:127], v[76:79], v[40:43]
    buffer_load_dwordx4 v248, s[32:35], 0 offen sc1 lds
    v_mfma_f32_16x16x32_bf16 v[40:43], v[128:131], v[80:83], v[40:43]
    ds_read_b128 v[60:63], v9 offset:34816
    v_mfma_f32_16x16x32_bf16 v[40:43], v[132:135], v[84:87], v[40:43]
    v_mfma_f32_16x16x32_bf16 v[40:43], v[136:139], v[88:91], v[40:43]
    ds_read_b128 v[64:67], v8 offset:35072
    s_add_u32 m0, s31, 96256
    v_mfma_f32_16x16x32_bf16 v[40:43], v[140:143], v[92:95], v[40:43]
    buffer_load_dwordx4 v249, s[32:35], 0 offen sc1 lds
    v_mfma_f32_16x16x32_bf16 v[40:43], v[144:147], v[96:99], v[40:43]
    v_mfma_f32_16x16x32_bf16 v[40:43], v[148:151], v[100:103], v[40:43]
    s_nop 0
    ds_write_b128 v22, v[36:39] offset:45056
    v_mfma_f32_16x16x32_bf16 v[44:47], v[120:123], v[76:79], v[44:47]
    ds_read_b128 v[68:71], v9 offset:35072
    s_add_u32 m0, s31, 100352
    v_mfma_f32_16x16x32_bf16 v[44:47], v[124:127], v[80:83], v[44:47]
    buffer_load_dwordx4 v250, s[32:35], 0 offen sc1 lds
    v_mfma_f32_16x16x32_bf16 v[44:47], v[128:131], v[84:87], v[44:47]
    ds_read_b128 v[72:75], v8 offset:35328
    v_mfma_f32_16x16x32_bf16 v[44:47], v[132:135], v[88:91], v[44:47]
    v_mfma_f32_16x16x32_bf16 v[44:47], v[136:139], v[92:95], v[44:47]
    ds_read_b128 v[76:79], v9 offset:35328
    v_mfma_f32_16x16x32_bf16 v[44:47], v[140:143], v[96:99], v[44:47]
    s_add_u32 m0, s31, 104448
    v_mfma_f32_16x16x32_bf16 v[44:47], v[144:147], v[100:103], v[44:47]
    v_mfma_f32_16x16x32_bf16 v[44:47], v[148:151], v[104:107], v[44:47]
    s_nop 0
    ds_write_b128 v22, v[40:43] offset:40960
    v_mfma_f32_16x16x32_bf16 v[48:51], v[120:123], v[80:83], v[48:51]
    buffer_load_dwordx4 v251, s[32:35], 0 offen sc1 lds
    v_mfma_f32_16x16x32_bf16 v[48:51], v[124:127], v[84:87], v[48:51]
    s_mov_b32 m0, 108544
    v_mfma_f32_16x16x32_bf16 v[48:51], v[128:131], v[88:91], v[48:51]
    ds_read_b128 v[80:83], v8 offset:35584
    v_mfma_f32_16x16x32_bf16 v[48:51], v[132:135], v[92:95], v[48:51]
    s_mov_b64 exec, s[62:63]
    buffer_load_dwordx4 v252, s[32:35], 0 offen sc1 lds
    s_mov_b64 exec, -1
    v_mfma_f32_16x16x32_bf16 v[48:51], v[136:139], v[96:99], v[48:51]
    v_mfma_f32_16x16x32_bf16 v[48:51], v[140:143], v[100:103], v[48:51]
    v_mfma_f32_16x16x32_bf16 v[48:51], v[144:147], v[104:107], v[48:51]
    v_mfma_f32_16x16x32_bf16 v[48:51], v[148:151], v[108:111], v[48:51]
    s_nop 0
    ds_write_b128 v22, v[44:47] offset:36864
    v_mfma_f32_16x16x32_bf16 v[52:55], v[120:123], v[84:87], v[52:55]
    v_mfma_f32_16x16x32_bf16 v[52:55], v[124:127], v[88:91], v[52:55]
    ds_read_b128 v[84:87], v9 offset:35584
    s_mov_b32 s48, 32768
    v_mfma_f32_16x16x32_bf16 v[52:55], v[128:131], v[92:95], v[52:55]
    buffer_load_dwordx4 v[120:123], v23, s[40:43], s48 offen offset:0 sc1
    v_mfma_f32_16x16x32_bf16 v[52:55], v[132:135], v[96:99], v[52:55]
    v_mfma_f32_16x16x32_bf16 v[52:55], v[136:139], v[100:103], v[52:55]
    buffer_load_dwordx4 v[124:127], v23, s[40:43], s48 offen offset:1024 sc1
    v_mfma_f32_16x16x32_bf16 v[52:55], v[140:143], v[104:107], v[52:55]
    v_mfma_f32_16x16x32_bf16 v[52:55], v[144:147], v[108:111], v[52:55]
    v_mfma_f32_16x16x32_bf16 v[52:55], v[148:151], v[112:115], v[52:55]
    s_nop 0
    ds_write_b128 v22, v[48:51] offset:32768
    s_waitcnt lgkmcnt(3)
    v_mfma_f32_16x16x32_bf16 v[24:27], v[184:187], v[56:59], 0
    ds_read_b128 v[88:91], v10 offset:34816
    v_mfma_f32_16x16x32_bf16 v[24:27], v[188:191], v[60:63], v[24:27]
    buffer_load_dwordx4 v[128:131], v23, s[40:43], s48 offen offset:2048 sc1
    v_mfma_f32_16x16x32_bf16 v[24:27], v[192:195], v[64:67], v[24:27]
    v_mfma_f32_16x16x32_bf16 v[24:27], v[196:199], v[68:71], v[24:27]
    ds_read_b128 v[92:95], v11 offset:34816
    v_mfma_f32_16x16x32_bf16 v[24:27], v[200:203], v[72:75], v[24:27]
    v_mfma_f32_16x16x32_bf16 v[24:27], v[204:207], v[76:79], v[24:27]
    v_mfma_f32_16x16x32_bf16 v[24:27], v[208:211], v[80:83], v[24:27]
    ds_read_b128 v[96:99], v10 offset:35072
    s_waitcnt lgkmcnt(4)
    v_mfma_f32_16x16x32_bf16 v[24:27], v[212:215], v[84:87], v[24:27]
    ds_write_b128 v22, v[52:55] offset:28672
    v_mfma_f32_16x16x32_bf16 v[28:31], v[184:187], v[60:63], 0
    buffer_load_dwordx4 v[132:135], v23, s[40:43], s48 offen offset:3072 sc1
    v_mfma_f32_16x16x32_bf16 v[28:31], v[188:191], v[64:67], v[28:31]
    ds_read_b128 v[100:103], v11 offset:35072
    v_mfma_f32_16x16x32_bf16 v[28:31], v[192:195], v[68:71], v[28:31]
    v_mfma_f32_16x16x32_bf16 v[28:31], v[196:199], v[72:75], v[28:31]
    s_mov_b32 s48, 36864
    v_mfma_f32_16x16x32_bf16 v[28:31], v[200:203], v[76:79], v[28:31]
    ds_read_b128 v[104:107], v10 offset:35328
    v_mfma_f32_16x16x32_bf16 v[28:31], v[204:207], v[80:83], v[28:31]
    buffer_load_dwordx4 v[136:139], v23, s[40:43], s48 offen offset:0 sc1
    v_mfma_f32_16x16x32_bf16 v[28:31], v[208:211], v[84:87], v[28:31]
    s_waitcnt lgkmcnt(4)
    v_mfma_f32_16x16x32_bf16 v[28:31], v[212:215], v[88:91], v[28:31]
    ds_read_b128 v[108:111], v11 offset:35328
    v_mfma_f32_16x16x32_bf16 v[32:35], v[184:187], v[64:67], 0
    buffer_load_dwordx4 v[140:143], v23, s[40:43], s48 offen offset:1024 sc1
    v_mfma_f32_16x16x32_bf16 v[32:35], v[188:191], v[68:71], v[32:35]
    v_mfma_f32_16x16x32_bf16 v[32:35], v[192:195], v[72:75], v[32:35]
    ds_read_b128 v[112:115], v10 offset:35584
    v_mfma_f32_16x16x32_bf16 v[32:35], v[196:199], v[76:79], v[32:35]
    v_mfma_f32_16x16x32_bf16 v[32:35], v[200:203], v[80:83], v[32:35]
    v_mfma_f32_16x16x32_bf16 v[32:35], v[204:207], v[84:87], v[32:35]
    buffer_load_dwordx4 v[144:147], v23, s[40:43], s48 offen offset:2048 sc1
    v_mfma_f32_16x16x32_bf16 v[32:35], v[208:211], v[88:91], v[32:35]
    v_mfma_f32_16x16x32_bf16 v[32:35], v[212:215], v[92:95], v[32:35]
    v_mfma_f32_16x16x32_bf16 v[36:39], v[184:187], v[68:71], 0
    v_mfma_f32_16x16x32_bf16 v[36:39], v[188:191], v[72:75], v[36:39]
    v_mfma_f32_16x16x32_bf16 v[36:39], v[192:195], v[76:79], v[36:39]
    buffer_load_dwordx4 v[148:151], v23, s[40:43], s48 offen offset:3072 sc1
    v_mfma_f32_16x16x32_bf16 v[36:39], v[196:199], v[80:83], v[36:39]
    v_mfma_f32_16x16x32_bf16 v[36:39], v[200:203], v[84:87], v[36:39]
    v_mfma_f32_16x16x32_bf16 v[36:39], v[204:207], v[88:91], v[36:39]
    v_mfma_f32_16x16x32_bf16 v[36:39], v[208:211], v[92:95], v[36:39]
    s_waitcnt lgkmcnt(0)
    v_mfma_f32_16x16x32_bf16 v[36:39], v[212:215], v[96:99], v[36:39]
    s_waitcnt vmcnt(13)
    s_barrier
    v_mfma_f32_16x16x32_bf16 v[40:43], v[184:187], v[72:75], 0
    ds_read_b128 v[56:59], v8 offset:17408
    s_add_u32 m0, s31, 144384
    v_mfma_f32_16x16x32_bf16 v[40:43], v[188:191], v[76:79], v[40:43]
    buffer_load_dwordx4 v253, s[32:35], 0 offen sc1 lds
    v_mfma_f32_16x16x32_bf16 v[40:43], v[192:195], v[80:83], v[40:43]
    ds_read_b128 v[60:63], v9 offset:17408
    v_mfma_f32_16x16x32_bf16 v[40:43], v[196:199], v[84:87], v[40:43]
    v_mfma_f32_16x16x32_bf16 v[40:43], v[200:203], v[88:91], v[40:43]
    ds_read_b128 v[64:67], v8 offset:17664
    s_add_u32 m0, s31, 148480
    v_mfma_f32_16x16x32_bf16 v[40:43], v[204:207], v[92:95], v[40:43]
    buffer_load_dwordx4 v254, s[32:35], 0 offen sc1 lds
    v_mfma_f32_16x16x32_bf16 v[40:43], v[208:211], v[96:99], v[40:43]
    v_mfma_f32_16x16x32_bf16 v[40:43], v[212:215], v[100:103], v[40:43]
    v_mfma_f32_16x16x32_bf16 v[44:47], v[184:187], v[76:79], 0
    ds_read_b128 v[68:71], v9 offset:17664
    s_add_u32 m0, s31, 152576
    v_mfma_f32_16x16x32_bf16 v[44:47], v[188:191], v[80:83], v[44:47]
    buffer_load_dwordx4 v255, s[32:35], 0 offen sc1 lds
    v_mfma_f32_16x16x32_bf16 v[44:47], v[192:195], v[84:87], v[44:47]
    ds_read_b128 v[72:75], v8 offset:17920
    v_mfma_f32_16x16x32_bf16 v[44:47], v[196:199], v[88:91], v[44:47]
    v_mfma_f32_16x16x32_bf16 v[44:47], v[200:203], v[92:95], v[44:47]
    ds_read_b128 v[76:79], v9 offset:17920
    v_mfma_f32_16x16x32_bf16 v[44:47], v[204:207], v[96:99], v[44:47]
    s_add_u32 m0, s31, 156672
    v_mfma_f32_16x16x32_bf16 v[44:47], v[208:211], v[100:103], v[44:47]
    v_mfma_f32_16x16x32_bf16 v[44:47], v[212:215], v[104:107], v[44:47]
    buffer_load_dwordx4 v116, s[32:35], 0 offen sc1 lds
    v_mfma_f32_16x16x32_bf16 v[48:51], v[184:187], v[80:83], 0
    v_mfma_f32_16x16x32_bf16 v[48:51], v[188:191], v[84:87], v[48:51]
    s_mov_b32 m0, 160768
    v_mfma_f32_16x16x32_bf16 v[48:51], v[192:195], v[88:91], v[48:51]
    ds_read_b128 v[80:83], v8 offset:18176
    v_mfma_f32_16x16x32_bf16 v[48:51], v[196:199], v[92:95], v[48:51]
    s_mov_b64 exec, s[62:63]
    buffer_load_dwordx4 v117, s[32:35], 0 offen sc1 lds
    s_mov_b64 exec, -1
    v_mfma_f32_16x16x32_bf16 v[48:51], v[200:203], v[96:99], v[48:51]
    v_mfma_f32_16x16x32_bf16 v[48:51], v[204:207], v[100:103], v[48:51]
    v_mfma_f32_16x16x32_bf16 v[48:51], v[208:211], v[104:107], v[48:51]
    v_mfma_f32_16x16x32_bf16 v[48:51], v[212:215], v[108:111], v[48:51]
    v_mfma_f32_16x16x32_bf16 v[52:55], v[184:187], v[84:87], 0
    v_mfma_f32_16x16x32_bf16 v[52:55], v[188:191], v[88:91], v[52:55]
    ds_read_b128 v[84:87], v9 offset:18176
    s_mov_b32 s48, 40960
    v_mfma_f32_16x16x32_bf16 v[52:55], v[192:195], v[92:95], v[52:55]
    buffer_load_dwordx4 v[184:187], v23, s[40:43], s48 offen offset:0 sc1
    v_mfma_f32_16x16x32_bf16 v[52:55], v[196:199], v[96:99], v[52:55]
    v_mfma_f32_16x16x32_bf16 v[52:55], v[200:203], v[100:103], v[52:55]
    buffer_load_dwordx4 v[188:191], v23, s[40:43], s48 offen offset:1024 sc1
    v_mfma_f32_16x16x32_bf16 v[52:55], v[204:207], v[104:107], v[52:55]
    v_mfma_f32_16x16x32_bf16 v[52:55], v[208:211], v[108:111], v[52:55]
    v_mfma_f32_16x16x32_bf16 v[52:55], v[212:215], v[112:115], v[52:55]
    s_waitcnt lgkmcnt(1)
    v_mfma_f32_16x16x32_bf16 v[24:27], v[152:155], v[56:59], v[24:27]
    ds_read_b128 v[88:91], v10 offset:17408
    v_mfma_f32_16x16x32_bf16 v[24:27], v[156:159], v[60:63], v[24:27]
    buffer_load_dwordx4 v[192:195], v23, s[40:43], s48 offen offset:2048 sc1
    v_mfma_f32_16x16x32_bf16 v[24:27], v[160:163], v[64:67], v[24:27]
    v_mfma_f32_16x16x32_bf16 v[24:27], v[164:167], v[68:71], v[24:27]
    ds_read_b128 v[92:95], v11 offset:17408
    v_mfma_f32_16x16x32_bf16 v[24:27], v[168:171], v[72:75], v[24:27]
    v_mfma_f32_16x16x32_bf16 v[24:27], v[172:175], v[76:79], v[24:27]
    buffer_load_dwordx4 v[196:199], v23, s[40:43], s48 offen offset:3072 sc1
    v_mfma_f32_16x16x32_bf16 v[24:27], v[176:179], v[80:83], v[24:27]
    ds_read_b128 v[96:99], v10 offset:17664
    v_mfma_f32_16x16x32_bf16 v[28:31], v[152:155], v[60:63], v[28:31]
    v_mfma_f32_16x16x32_bf16 v[28:31], v[156:159], v[64:67], v[28:31]
    v_mfma_f32_16x16x32_bf16 v[28:31], v[160:163], v[68:71], v[28:31]
    ds_read_b128 v[100:103], v11 offset:17664
    s_mov_b32 s48, 45056
    v_mfma_f32_16x16x32_bf16 v[28:31], v[164:167], v[72:75], v[28:31]
    buffer_load_dwordx4 v[200:203], v23, s[40:43], s48 offen offset:0 sc1
    v_mfma_f32_16x16x32_bf16 v[28:31], v[168:171], v[76:79], v[28:31]
    v_mfma_f32_16x16x32_bf16 v[28:31], v[172:175], v[80:83], v[28:31]
    ds_read_b128 v[104:107], v10 offset:17920
    s_waitcnt lgkmcnt(4)
    v_mfma_f32_16x16x32_bf16 v[28:31], v[176:179], v[84:87], v[28:31]
    buffer_load_dwordx4 v[204:207], v23, s[40:43], s48 offen offset:1024 sc1
    v_mfma_f32_16x16x32_bf16 v[32:35], v[152:155], v[64:67], v[32:35]
    v_mfma_f32_16x16x32_bf16 v[32:35], v[156:159], v[68:71], v[32:35]
    ds_read_b128 v[108:111], v11 offset:17920
    v_mfma_f32_16x16x32_bf16 v[32:35], v[160:163], v[72:75], v[32:35]
    v_mfma_f32_16x16x32_bf16 v[32:35], v[164:167], v[76:79], v[32:35]
    buffer_load_dwordx4 v[208:211], v23, s[40:43], s48 offen offset:2048 sc1
    v_mfma_f32_16x16x32_bf16 v[32:35], v[168:171], v[80:83], v[32:35]
    v_mfma_f32_16x16x32_bf16 v[32:35], v[172:175], v[84:87], v[32:35]
    v_mfma_f32_16x16x32_bf16 v[32:35], v[176:179], v[88:91], v[32:35]
    v_mfma_f32_16x16x32_bf16 v[36:39], v[152:155], v[68:71], v[36:39]
    v_mfma_f32_16x16x32_bf16 v[36:39], v[156:159], v[72:75], v[36:39]
    v_mfma_f32_16x16x32_bf16 v[36:39], v[160:163], v[76:79], v[36:39]
    v_mfma_f32_16x16x32_bf16 v[36:39], v[164:167], v[80:83], v[36:39]
    v_mfma_f32_16x16x32_bf16 v[36:39], v[168:171], v[84:87], v[36:39]
    v_mfma_f32_16x16x32_bf16 v[36:39], v[172:175], v[88:91], v[36:39]
    s_waitcnt lgkmcnt(0)
    v_mfma_f32_16x16x32_bf16 v[36:39], v[176:179], v[92:95], v[36:39]
    s_waitcnt vmcnt(12)
    s_barrier
    v_mfma_f32_16x16x32_bf16 v[40:43], v[152:155], v[72:75], v[40:43]
    ds_read_b128 v[56:59], v8 offset:0
    s_add_u32 s32, s22, 2097152
    s_addc_u32 s33, s23, 0
    s_mov_b32 s34, 1024000
    s_mov_b32 s35, 0x20000
    s_add_u32 m0, s31, 126976
    v_mfma_f32_16x16x32_bf16 v[40:43], v[156:159], v[76:79], v[40:43]
    buffer_load_dwordx4 v248, s[32:35], 0 offen sc1 lds
    v_mfma_f32_16x16x32_bf16 v[40:43], v[160:163], v[80:83], v[40:43]
    ds_read_b128 v[60:63], v9 offset:0
    v_mfma_f32_16x16x32_bf16 v[40:43], v[164:167], v[84:87], v[40:43]
    s_add_u32 m0, s31, 131072
    v_mfma_f32_16x16x32_bf16 v[40:43], v[168:171], v[88:91], v[40:43]
    ds_read_b128 v[64:67], v8 offset:256
    v_mfma_f32_16x16x32_bf16 v[40:43], v[172:175], v[92:95], v[40:43]
    v_mfma_f32_16x16x32_bf16 v[40:43], v[176:179], v[96:99], v[40:43]
    buffer_load_dwordx4 v249, s[32:35], 0 offen sc1 lds
    v_mfma_f32_16x16x32_bf16 v[44:47], v[152:155], v[76:79], v[44:47]
    ds_read_b128 v[68:71], v9 offset:256
    s_add_u32 m0, s31, 135168
    v_mfma_f32_16x16x32_bf16 v[44:47], v[156:159], v[80:83], v[44:47]
    buffer_load_dwordx4 v250, s[32:35], 0 offen sc1 lds
    v_mfma_f32_16x16x32_bf16 v[44:47], v[160:163], v[84:87], v[44:47]
    ds_read_b128 v[72:75], v8 offset:512
    v_mfma_f32_16x16x32_bf16 v[44:47], v[164:167], v[88:91], v[44:47]
    v_mfma_f32_16x16x32_bf16 v[44:47], v[168:171], v[92:95], v[44:47]
    ds_read_b128 v[76:79], v9 offset:512
    s_add_u32 m0, s31, 139264
    v_mfma_f32_16x16x32_bf16 v[44:47], v[172:175], v[96:99], v[44:47]
    v_mfma_f32_16x16x32_bf16 v[44:47], v[176:179], v[100:103], v[44:47]
    buffer_load_dwordx4 v251, s[32:35], 0 offen sc1 lds
    v_mfma_f32_16x16x32_bf16 v[48:51], v[152:155], v[80:83], v[48:51]
    v_mfma_f32_16x16x32_bf16 v[48:51], v[156:159], v[84:87], v[48:51]
    s_mov_b32 m0, 143360
    v_mfma_f32_16x16x32_bf16 v[48:51], v[160:163], v[88:91], v[48:51]
    ds_read_b128 v[80:83], v8 offset:768
    v_mfma_f32_16x16x32_bf16 v[48:51], v[164:167], v[92:95], v[48:51]
    s_mov_b64 exec, s[62:63]
    buffer_load_dwordx4 v252, s[32:35], 0 offen sc1 lds
    s_mov_b64 exec, -1
    v_mfma_f32_16x16x32_bf16 v[48:51], v[168:171], v[96:99], v[48:51]
    v_mfma_f32_16x16x32_bf16 v[48:51], v[172:175], v[100:103], v[48:51]
    v_mfma_f32_16x16x32_bf16 v[48:51], v[176:179], v[104:107], v[48:51]
    v_mfma_f32_16x16x32_bf16 v[52:55], v[152:155], v[84:87], v[52:55]
    v_mfma_f32_16x16x32_bf16 v[52:55], v[156:159], v[88:91], v[52:55]
    ds_read_b128 v[84:87], v9 offset:768
    s_mov_b32 s48, 65536
    v_mfma_f32_16x16x32_bf16 v[52:55], v[160:163], v[92:95], v[52:55]
    buffer_load_dwordx4 v[152:155], v23, s[40:43], s48 offen offset:0 sc1
    v_mfma_f32_16x16x32_bf16 v[52:55], v[164:167], v[96:99], v[52:55]
    v_mfma_f32_16x16x32_bf16 v[52:55], v[168:171], v[100:103], v[52:55]
    buffer_load_dwordx4 v[156:159], v23, s[40:43], s48 offen offset:1024 sc1
    v_mfma_f32_16x16x32_bf16 v[52:55], v[172:175], v[104:107], v[52:55]
    v_mfma_f32_16x16x32_bf16 v[52:55], v[176:179], v[108:111], v[52:55]
    s_waitcnt lgkmcnt(1)
    v_mfma_f32_16x16x32_bf16 v[24:27], v[120:123], v[56:59], v[24:27]
    ds_read_b128 v[88:91], v10 offset:0
    v_mfma_f32_16x16x32_bf16 v[24:27], v[124:127], v[60:63], v[24:27]
    buffer_load_dwordx4 v[160:163], v23, s[40:43], s48 offen offset:2048 sc1
    v_mfma_f32_16x16x32_bf16 v[24:27], v[128:131], v[64:67], v[24:27]
    v_mfma_f32_16x16x32_bf16 v[24:27], v[132:135], v[68:71], v[24:27]
    ds_read_b128 v[92:95], v11 offset:0
    v_mfma_f32_16x16x32_bf16 v[24:27], v[136:139], v[72:75], v[24:27]
    v_mfma_f32_16x16x32_bf16 v[24:27], v[140:143], v[76:79], v[24:27]
    v_mfma_f32_16x16x32_bf16 v[24:27], v[144:147], v[80:83], v[24:27]
    ds_read_b128 v[96:99], v10 offset:256
    s_waitcnt lgkmcnt(3)
    v_mfma_f32_16x16x32_bf16 v[24:27], v[148:151], v[84:87], v[24:27]
    buffer_load_dwordx4 v[164:167], v23, s[40:43], s48 offen offset:3072 sc1
    v_mfma_f32_16x16x32_bf16 v[28:31], v[120:123], v[60:63], v[28:31]
    v_mfma_f32_16x16x32_bf16 v[28:31], v[124:127], v[64:67], v[28:31]
    ds_read_b128 v[100:103], v11 offset:256
    v_mfma_f32_16x16x32_bf16 v[28:31], v[128:131], v[68:71], v[28:31]
    v_mfma_f32_16x16x32_bf16 v[28:31], v[132:135], v[72:75], v[28:31]
    s_mov_b32 s48, 69632
    v_mfma_f32_16x16x32_bf16 v[28:31], v[136:139], v[76:79], v[28:31]
    ds_read_b128 v[104:107], v10 offset:512
    v_mfma_f32_16x16x32_bf16 v[28:31], v[140:143], v[80:83], v[28:31]
    buffer_load_dwordx4 v[168:171], v23, s[40:43], s48 offen offset:0 sc1
    v_mfma_f32_16x16x32_bf16 v[28:31], v[144:147], v[84:87], v[28:31]
    s_waitcnt lgkmcnt(3)
    v_mfma_f32_16x16x32_bf16 v[28:31], v[148:151], v[88:91], v[28:31]
    ds_read_b128 v[108:111], v11 offset:512
    v_mfma_f32_16x16x32_bf16 v[32:35], v[120:123], v[64:67], v[32:35]
    buffer_load_dwordx4 v[172:175], v23, s[40:43], s48 offen offset:1024 sc1
    v_mfma_f32_16x16x32_bf16 v[32:35], v[124:127], v[68:71], v[32:35]
    v_mfma_f32_16x16x32_bf16 v[32:35], v[128:131], v[72:75], v[32:35]
    ds_read_b128 v[112:115], v10 offset:768
    v_mfma_f32_16x16x32_bf16 v[32:35], v[132:135], v[76:79], v[32:35]
    v_mfma_f32_16x16x32_bf16 v[32:35], v[136:139], v[80:83], v[32:35]
    v_mfma_f32_16x16x32_bf16 v[32:35], v[140:143], v[84:87], v[32:35]
    buffer_load_dwordx4 v[176:179], v23, s[40:43], s48 offen offset:2048 sc1
    v_mfma_f32_16x16x32_bf16 v[32:35], v[144:147], v[88:91], v[32:35]
    v_mfma_f32_16x16x32_bf16 v[32:35], v[148:151], v[92:95], v[32:35]
    v_mfma_f32_16x16x32_bf16 v[36:39], v[120:123], v[68:71], v[36:39]
    v_mfma_f32_16x16x32_bf16 v[36:39], v[124:127], v[72:75], v[36:39]
    v_mfma_f32_16x16x32_bf16 v[36:39], v[128:131], v[76:79], v[36:39]
    buffer_load_dwordx4 v[180:183], v23, s[40:43], s48 offen offset:3072 sc1
    v_mfma_f32_16x16x32_bf16 v[36:39], v[132:135], v[80:83], v[36:39]
    v_mfma_f32_16x16x32_bf16 v[36:39], v[136:139], v[84:87], v[36:39]
    v_mfma_f32_16x16x32_bf16 v[36:39], v[140:143], v[88:91], v[36:39]
    v_mfma_f32_16x16x32_bf16 v[36:39], v[144:147], v[92:95], v[36:39]
    s_waitcnt lgkmcnt(0)
    v_mfma_f32_16x16x32_bf16 v[36:39], v[148:151], v[96:99], v[36:39]
    s_waitcnt vmcnt(13)
    s_barrier
    v_mfma_f32_16x16x32_bf16 v[40:43], v[120:123], v[72:75], v[40:43]
    ds_read_b128 v[56:59], v8 offset:52224
    s_add_u32 m0, s31, 109568
    v_mfma_f32_16x16x32_bf16 v[40:43], v[124:127], v[76:79], v[40:43]
    buffer_load_dwordx4 v253, s[32:35], 0 offen sc1 lds
    v_mfma_f32_16x16x32_bf16 v[40:43], v[128:131], v[80:83], v[40:43]
    ds_read_b128 v[60:63], v9 offset:52224
    v_mfma_f32_16x16x32_bf16 v[40:43], v[132:135], v[84:87], v[40:43]
    v_mfma_f32_16x16x32_bf16 v[40:43], v[136:139], v[88:91], v[40:43]
    ds_read_b128 v[64:67], v8 offset:52480
    s_add_u32 m0, s31, 113664
    v_mfma_f32_16x16x32_bf16 v[40:43], v[140:143], v[92:95], v[40:43]
    buffer_load_dwordx4 v254, s[32:35], 0 offen sc1 lds
    v_mfma_f32_16x16x32_bf16 v[40:43], v[144:147], v[96:99], v[40:43]
    v_mfma_f32_16x16x32_bf16 v[40:43], v[148:151], v[100:103], v[40:43]
    v_mfma_f32_16x16x32_bf16 v[44:47], v[120:123], v[76:79], v[44:47]
    ds_read_b128 v[68:71], v9 offset:52480
    s_add_u32 m0, s31, 117760
    v_mfma_f32_16x16x32_bf16 v[44:47], v[124:127], v[80:83], v[44:47]
    buffer_load_dwordx4 v255, s[32:35], 0 offen sc1 lds
    v_mfma_f32_16x16x32_bf16 v[44:47], v[128:131], v[84:87], v[44:47]
    ds_read_b128 v[72:75], v8 offset:52736
    v_mfma_f32_16x16x32_bf16 v[44:47], v[132:135], v[88:91], v[44:47]
    v_mfma_f32_16x16x32_bf16 v[44:47], v[136:139], v[92:95], v[44:47]
    ds_read_b128 v[76:79], v9 offset:52736
    v_mfma_f32_16x16x32_bf16 v[44:47], v[140:143], v[96:99], v[44:47]
    s_add_u32 m0, s31, 121856
    v_mfma_f32_16x16x32_bf16 v[44:47], v[144:147], v[100:103], v[44:47]
    v_mfma_f32_16x16x32_bf16 v[44:47], v[148:151], v[104:107], v[44:47]
    buffer_load_dwordx4 v116, s[32:35], 0 offen sc1 lds
    v_mfma_f32_16x16x32_bf16 v[48:51], v[120:123], v[80:83], v[48:51]
    v_mfma_f32_16x16x32_bf16 v[48:51], v[124:127], v[84:87], v[48:51]
    s_mov_b32 m0, 125952
    v_mfma_f32_16x16x32_bf16 v[48:51], v[128:131], v[88:91], v[48:51]
    ds_read_b128 v[80:83], v8 offset:52992
    v_mfma_f32_16x16x32_bf16 v[48:51], v[132:135], v[92:95], v[48:51]
    s_mov_b64 exec, s[62:63]
    buffer_load_dwordx4 v117, s[32:35], 0 offen sc1 lds
    s_mov_b64 exec, -1
    v_mfma_f32_16x16x32_bf16 v[48:51], v[136:139], v[96:99], v[48:51]
    v_mfma_f32_16x16x32_bf16 v[48:51], v[140:143], v[100:103], v[48:51]
    v_mfma_f32_16x16x32_bf16 v[48:51], v[144:147], v[104:107], v[48:51]
    v_mfma_f32_16x16x32_bf16 v[48:51], v[148:151], v[108:111], v[48:51]
    v_mfma_f32_16x16x32_bf16 v[52:55], v[120:123], v[84:87], v[52:55]
    v_mfma_f32_16x16x32_bf16 v[52:55], v[124:127], v[88:91], v[52:55]
    ds_read_b128 v[84:87], v9 offset:52992
    s_mov_b32 s48, 73728
    v_mfma_f32_16x16x32_bf16 v[52:55], v[128:131], v[92:95], v[52:55]
    buffer_load_dwordx4 v[120:123], v23, s[40:43], s48 offen offset:0 sc1
    v_mfma_f32_16x16x32_bf16 v[52:55], v[132:135], v[96:99], v[52:55]
    v_mfma_f32_16x16x32_bf16 v[52:55], v[136:139], v[100:103], v[52:55]
    buffer_load_dwordx4 v[124:127], v23, s[40:43], s48 offen offset:1024 sc1
    v_mfma_f32_16x16x32_bf16 v[52:55], v[140:143], v[104:107], v[52:55]
    v_mfma_f32_16x16x32_bf16 v[52:55], v[144:147], v[108:111], v[52:55]
    v_mfma_f32_16x16x32_bf16 v[52:55], v[148:151], v[112:115], v[52:55]
    s_waitcnt lgkmcnt(1)
    v_mfma_f32_16x16x32_bf16 v[24:27], v[184:187], v[56:59], v[24:27]
    ds_read_b128 v[88:91], v10 offset:52224
    v_mfma_f32_16x16x32_bf16 v[24:27], v[188:191], v[60:63], v[24:27]
    buffer_load_dwordx4 v[128:131], v23, s[40:43], s48 offen offset:2048 sc1
    v_mfma_f32_16x16x32_bf16 v[24:27], v[192:195], v[64:67], v[24:27]
    v_mfma_f32_16x16x32_bf16 v[24:27], v[196:199], v[68:71], v[24:27]
    ds_read_b128 v[92:95], v11 offset:52224
    v_mfma_f32_16x16x32_bf16 v[24:27], v[200:203], v[72:75], v[24:27]
    v_mfma_f32_16x16x32_bf16 v[24:27], v[204:207], v[76:79], v[24:27]
    buffer_load_dwordx4 v[132:135], v23, s[40:43], s48 offen offset:3072 sc1
    v_mfma_f32_16x16x32_bf16 v[24:27], v[208:211], v[80:83], v[24:27]
    ds_read_b128 v[96:99], v10 offset:52480
    v_mfma_f32_16x16x32_bf16 v[28:31], v[184:187], v[60:63], v[28:31]
    v_mfma_f32_16x16x32_bf16 v[28:31], v[188:191], v[64:67], v[28:31]
    v_mfma_f32_16x16x32_bf16 v[28:31], v[192:195], v[68:71], v[28:31]
    ds_read_b128 v[100:103], v11 offset:52480
    s_mov_b32 s48, 77824
    v_mfma_f32_16x16x32_bf16 v[28:31], v[196:199], v[72:75], v[28:31]
    buffer_load_dwordx4 v[136:139], v23, s[40:43], s48 offen offset:0 sc1
    v_mfma_f32_16x16x32_bf16 v[28:31], v[200:203], v[76:79], v[28:31]
    v_mfma_f32_16x16x32_bf16 v[28:31], v[204:207], v[80:83], v[28:31]
    ds_read_b128 v[104:107], v10 offset:52736
    s_waitcnt lgkmcnt(4)
    v_mfma_f32_16x16x32_bf16 v[28:31], v[208:211], v[84:87], v[28:31]
    buffer_load_dwordx4 v[140:143], v23, s[40:43], s48 offen offset:1024 sc1
    v_mfma_f32_16x16x32_bf16 v[32:35], v[184:187], v[64:67], v[32:35]
    v_mfma_f32_16x16x32_bf16 v[32:35], v[188:191], v[68:71], v[32:35]
    ds_read_b128 v[108:111], v11 offset:52736
    v_mfma_f32_16x16x32_bf16 v[32:35], v[192:195], v[72:75], v[32:35]
    v_mfma_f32_16x16x32_bf16 v[32:35], v[196:199], v[76:79], v[32:35]
    buffer_load_dwordx4 v[144:147], v23, s[40:43], s48 offen offset:2048 sc1
    v_mfma_f32_16x16x32_bf16 v[32:35], v[200:203], v[80:83], v[32:35]
    v_mfma_f32_16x16x32_bf16 v[32:35], v[204:207], v[84:87], v[32:35]
    v_mfma_f32_16x16x32_bf16 v[32:35], v[208:211], v[88:91], v[32:35]
    v_mfma_f32_16x16x32_bf16 v[36:39], v[184:187], v[68:71], v[36:39]
    v_mfma_f32_16x16x32_bf16 v[36:39], v[188:191], v[72:75], v[36:39]
    v_mfma_f32_16x16x32_bf16 v[36:39], v[192:195], v[76:79], v[36:39]
    v_mfma_f32_16x16x32_bf16 v[36:39], v[196:199], v[80:83], v[36:39]
    v_mfma_f32_16x16x32_bf16 v[36:39], v[200:203], v[84:87], v[36:39]
    v_mfma_f32_16x16x32_bf16 v[36:39], v[204:207], v[88:91], v[36:39]
    s_waitcnt lgkmcnt(0)
    v_mfma_f32_16x16x32_bf16 v[36:39], v[208:211], v[92:95], v[36:39]
    s_waitcnt vmcnt(12)
    s_barrier
    v_mfma_f32_16x16x32_bf16 v[40:43], v[184:187], v[72:75], v[40:43]
    ds_read_b128 v[56:59], v8 offset:34816
    s_add_u32 s32, s22, 3145728
    s_addc_u32 s33, s23, 0
    s_mov_b32 s34, 1024000
    s_mov_b32 s35, 0x20000
    s_add_u32 m0, s31, 92160
    v_mfma_f32_16x16x32_bf16 v[40:43], v[188:191], v[76:79], v[40:43]
    buffer_load_dwordx4 v248, s[32:35], 0 offen sc1 lds
    v_mfma_f32_16x16x32_bf16 v[40:43], v[192:195], v[80:83], v[40:43]
    ds_read_b128 v[60:63], v9 offset:34816
    v_mfma_f32_16x16x32_bf16 v[40:43], v[196:199], v[84:87], v[40:43]
    s_add_u32 m0, s31, 96256
    v_mfma_f32_16x16x32_bf16 v[40:43], v[200:203], v[88:91], v[40:43]
    ds_read_b128 v[64:67], v8 offset:35072
    v_mfma_f32_16x16x32_bf16 v[40:43], v[204:207], v[92:95], v[40:43]
    v_mfma_f32_16x16x32_bf16 v[40:43], v[208:211], v[96:99], v[40:43]
    buffer_load_dwordx4 v249, s[32:35], 0 offen sc1 lds
    v_mfma_f32_16x16x32_bf16 v[44:47], v[184:187], v[76:79], v[44:47]
    ds_read_b128 v[68:71], v9 offset:35072
    s_add_u32 m0, s31, 100352
    v_mfma_f32_16x16x32_bf16 v[44:47], v[188:191], v[80:83], v[44:47]
    buffer_load_dwordx4 v250, s[32:35], 0 offen sc1 lds
    v_mfma_f32_16x16x32_bf16 v[44:47], v[192:195], v[84:87], v[44:47]
    ds_read_b128 v[72:75], v8 offset:35328
    v_mfma_f32_16x16x32_bf16 v[44:47], v[196:199], v[88:91], v[44:47]
    v_mfma_f32_16x16x32_bf16 v[44:47], v[200:203], v[92:95], v[44:47]
    ds_read_b128 v[76:79], v9 offset:35328
    s_add_u32 m0, s31, 104448
    v_mfma_f32_16x16x32_bf16 v[44:47], v[204:207], v[96:99], v[44:47]
    v_mfma_f32_16x16x32_bf16 v[44:47], v[208:211], v[100:103], v[44:47]
    buffer_load_dwordx4 v251, s[32:35], 0 offen sc1 lds
    v_mfma_f32_16x16x32_bf16 v[48:51], v[184:187], v[80:83], v[48:51]
    v_mfma_f32_16x16x32_bf16 v[48:51], v[188:191], v[84:87], v[48:51]
    s_mov_b32 m0, 108544
    v_mfma_f32_16x16x32_bf16 v[48:51], v[192:195], v[88:91], v[48:51]
    ds_read_b128 v[80:83], v8 offset:35584
    v_mfma_f32_16x16x32_bf16 v[48:51], v[196:199], v[92:95], v[48:51]
    s_mov_b64 exec, s[62:63]
    buffer_load_dwordx4 v252, s[32:35], 0 offen sc1 lds
    s_mov_b64 exec, -1
    v_mfma_f32_16x16x32_bf16 v[48:51], v[200:203], v[96:99], v[48:51]
    v_mfma_f32_16x16x32_bf16 v[48:51], v[204:207], v[100:103], v[48:51]
    v_mfma_f32_16x16x32_bf16 v[48:51], v[208:211], v[104:107], v[48:51]
    v_mfma_f32_16x16x32_bf16 v[52:55], v[184:187], v[84:87], v[52:55]
    v_mfma_f32_16x16x32_bf16 v[52:55], v[188:191], v[88:91], v[52:55]
    ds_read_b128 v[84:87], v9 offset:35584
    s_mov_b32 s48, 98304
    v_mfma_f32_16x16x32_bf16 v[52:55], v[192:195], v[92:95], v[52:55]
    buffer_load_dwordx4 v[184:187], v23, s[40:43], s48 offen offset:0 sc1
    v_mfma_f32_16x16x32_bf16 v[52:55], v[196:199], v[96:99], v[52:55]
    v_mfma_f32_16x16x32_bf16 v[52:55], v[200:203], v[100:103], v[52:55]
    buffer_load_dwordx4 v[188:191], v23, s[40:43], s48 offen offset:1024 sc1
    v_mfma_f32_16x16x32_bf16 v[52:55], v[204:207], v[104:107], v[52:55]
    v_mfma_f32_16x16x32_bf16 v[52:55], v[208:211], v[108:111], v[52:55]
    s_waitcnt lgkmcnt(1)
    v_mfma_f32_16x16x32_bf16 v[24:27], v[152:155], v[56:59], v[24:27]
    ds_read_b128 v[88:91], v10 offset:34816
    v_mfma_f32_16x16x32_bf16 v[24:27], v[156:159], v[60:63], v[24:27]
    buffer_load_dwordx4 v[192:195], v23, s[40:43], s48 offen offset:2048 sc1
    v_mfma_f32_16x16x32_bf16 v[24:27], v[160:163], v[64:67], v[24:27]
    v_mfma_f32_16x16x32_bf16 v[24:27], v[164:167], v[68:71], v[24:27]
    ds_read_b128 v[92:95], v11 offset:34816
    v_mfma_f32_16x16x32_bf16 v[24:27], v[168:171], v[72:75], v[24:27]
    v_mfma_f32_16x16x32_bf16 v[24:27], v[172:175], v[76:79], v[24:27]
    v_mfma_f32_16x16x32_bf16 v[24:27], v[176:179], v[80:83], v[24:27]
    ds_read_b128 v[96:99], v10 offset:35072
    s_waitcnt lgkmcnt(3)
    v_mfma_f32_16x16x32_bf16 v[24:27], v[180:183], v[84:87], v[24:27]
    buffer_load_dwordx4 v[196:199], v23, s[40:43], s48 offen offset:3072 sc1
    v_mfma_f32_16x16x32_bf16 v[28:31], v[152:155], v[60:63], v[28:31]
    v_mfma_f32_16x16x32_bf16 v[28:31], v[156:159], v[64:67], v[28:31]
    ds_read_b128 v[100:103], v11 offset:35072
    v_mfma_f32_16x16x32_bf16 v[28:31], v[160:163], v[68:71], v[28:31]
    v_mfma_f32_16x16x32_bf16 v[28:31], v[164:167], v[72:75], v[28:31]
    s_mov_b32 s48, 102400
    v_mfma_f32_16x16x32_bf16 v[28:31], v[168:171], v[76:79], v[28:31]
    ds_read_b128 v[104:107], v10 offset:35328
    v_mfma_f32_16x16x32_bf16 v[28:31], v[172:175], v[80:83], v[28:31]
    buffer_load_dwordx4 v[200:203], v23, s[40:43], s48 offen offset:0 sc1
    v_mfma_f32_16x16x32_bf16 v[28:31], v[176:179], v[84:87], v[28:31]
    s_waitcnt lgkmcnt(3)
    v_mfma_f32_16x16x32_bf16 v[28:31], v[180:183], v[88:91], v[28:31]
    ds_read_b128 v[108:111], v11 offset:35328
    v_mfma_f32_16x16x32_bf16 v[32:35], v[152:155], v[64:67], v[32:35]
    buffer_load_dwordx4 v[204:207], v23, s[40:43], s48 offen offset:1024 sc1
    v_mfma_f32_16x16x32_bf16 v[32:35], v[156:159], v[68:71], v[32:35]
    v_mfma_f32_16x16x32_bf16 v[32:35], v[160:163], v[72:75], v[32:35]
    ds_read_b128 v[112:115], v10 offset:35584
    v_mfma_f32_16x16x32_bf16 v[32:35], v[164:167], v[76:79], v[32:35]
    v_mfma_f32_16x16x32_bf16 v[32:35], v[168:171], v[80:83], v[32:35]
    v_mfma_f32_16x16x32_bf16 v[32:35], v[172:175], v[84:87], v[32:35]
    buffer_load_dwordx4 v[208:211], v23, s[40:43], s48 offen offset:2048 sc1
    v_mfma_f32_16x16x32_bf16 v[32:35], v[176:179], v[88:91], v[32:35]
    v_mfma_f32_16x16x32_bf16 v[32:35], v[180:183], v[92:95], v[32:35]
    v_mfma_f32_16x16x32_bf16 v[36:39], v[152:155], v[68:71], v[36:39]
    v_mfma_f32_16x16x32_bf16 v[36:39], v[156:159], v[72:75], v[36:39]
    v_mfma_f32_16x16x32_bf16 v[36:39], v[160:163], v[76:79], v[36:39]
    buffer_load_dwordx4 v[212:215], v23, s[40:43], s48 offen offset:3072 sc1
    v_mfma_f32_16x16x32_bf16 v[36:39], v[164:167], v[80:83], v[36:39]
L_pg7:
    s_cbranch_execz L_pb7
    v_mfma_f32_16x16x32_bf16 v[36:39], v[168:171], v[84:87], v[36:39]
    v_mfma_f32_16x16x32_bf16 v[36:39], v[172:175], v[88:91], v[36:39]
    v_mfma_f32_16x16x32_bf16 v[36:39], v[176:179], v[92:95], v[36:39]
    s_waitcnt lgkmcnt(0)
    v_mfma_f32_16x16x32_bf16 v[36:39], v[180:183], v[96:99], v[36:39]
    s_waitcnt vmcnt(13)
    s_barrier
    v_mfma_f32_16x16x32_bf16 v[40:43], v[152:155], v[72:75], v[40:43]
    ds_read_b128 v[56:59], v8 offset:17408
    s_add_u32 m0, s31, 144384
    v_mfma_f32_16x16x32_bf16 v[40:43], v[156:159], v[76:79], v[40:43]
    buffer_load_dwordx4 v253, s[32:35], 0 offen sc1 lds
    v_mfma_f32_16x16x32_bf16 v[40:43], v[160:163], v[80:83], v[40:43]
    ds_read_b128 v[60:63], v9 offset:17408
    v_mfma_f32_16x16x32_bf16 v[40:43], v[164:167], v[84:87], v[40:43]
    v_mfma_f32_16x16x32_bf16 v[40:43], v[168:171], v[88:91], v[40:43]
    ds_read_b128 v[64:67], v8 offset:17664
    s_add_u32 m0, s31, 148480
    v_mfma_f32_16x16x32_bf16 v[40:43], v[172:175], v[92:95], v[40:43]
    buffer_load_dwordx4 v254, s[32:35], 0 offen sc1 lds
    v_mfma_f32_16x16x32_bf16 v[40:43], v[176:179], v[96:99], v[40:43]
    v_mfma_f32_16x16x32_bf16 v[40:43], v[180:183], v[100:103], v[40:43]
    v_mfma_f32_16x16x32_bf16 v[44:47], v[152:155], v[76:79], v[44:47]
    ds_read_b128 v[68:71], v9 offset:17664
    s_add_u32 m0, s31, 152576
    v_mfma_f32_16x16x32_bf16 v[44:47], v[156:159], v[80:83], v[44:47]
    buffer_load_dwordx4 v255, s[32:35], 0 offen sc1 lds
    v_mfma_f32_16x16x32_bf16 v[44:47], v[160:163], v[84:87], v[44:47]
    ds_read_b128 v[72:75], v8 offset:17920
    v_mfma_f32_16x16x32_bf16 v[44:47], v[164:167], v[88:91], v[44:47]
    v_mfma_f32_16x16x32_bf16 v[44:47], v[168:171], v[92:95], v[44:47]
    ds_read_b128 v[76:79], v9 offset:17920
    v_mfma_f32_16x16x32_bf16 v[44:47], v[172:175], v[96:99], v[44:47]
    s_add_u32 m0, s31, 156672
    v_mfma_f32_16x16x32_bf16 v[44:47], v[176:179], v[100:103], v[44:47]
    v_mfma_f32_16x16x32_bf16 v[44:47], v[180:183], v[104:107], v[44:47]
    buffer_load_dwordx4 v116, s[32:35], 0 offen sc1 lds
    v_mfma_f32_16x16x32_bf16 v[48:51], v[152:155], v[80:83], v[48:51]
    v_mfma_f32_16x16x32_bf16 v[48:51], v[156:159], v[84:87], v[48:51]
    s_mov_b32 m0, 160768
    v_mfma_f32_16x16x32_bf16 v[48:51], v[160:163], v[88:91], v[48:51]
    ds_read_b128 v[80:83], v8 offset:18176
    v_mfma_f32_16x16x32_bf16 v[48:51], v[164:167], v[92:95], v[48:51]
    s_mov_b64 exec, s[62:63]
    buffer_load_dwordx4 v117, s[32:35], 0 offen sc1 lds
    s_mov_b64 exec, -1
    v_mfma_f32_16x16x32_bf16 v[48:51], v[168:171], v[96:99], v[48:51]
    v_mfma_f32_16x16x32_bf16 v[48:51], v[172:175], v[100:103], v[48:51]
    v_mfma_f32_16x16x32_bf16 v[48:51], v[176:179], v[104:107], v[48:51]
    v_mfma_f32_16x16x32_bf16 v[48:51], v[180:183], v[108:111], v[48:51]
    v_mfma_f32_16x16x32_bf16 v[52:55], v[152:155], v[84:87], v[52:55]
    v_mfma_f32_16x16x32_bf16 v[52:55], v[156:159], v[88:91], v[52:55]
    ds_read_b128 v[84:87], v9 offset:18176
    s_mov_b32 s48, 106496
    v_mfma_f32_16x16x32_bf16 v[52:55], v[160:163], v[92:95], v[52:55]
    buffer_load_dwordx4 v[152:155], v23, s[40:43], s48 offen offset:0 sc1
    v_mfma_f32_16x16x32_bf16 v[52:55], v[164:167], v[96:99], v[52:55]
    v_mfma_f32_16x16x32_bf16 v[52:55], v[168:171], v[100:103], v[52:55]
    buffer_load_dwordx4 v[156:159], v23, s[40:43], s48 offen offset:1024 sc1
    v_mfma_f32_16x16x32_bf16 v[52:55], v[172:175], v[104:107], v[52:55]
    v_mfma_f32_16x16x32_bf16 v[52:55], v[176:179], v[108:111], v[52:55]
    v_mfma_f32_16x16x32_bf16 v[52:55], v[180:183], v[112:115], v[52:55]
    s_waitcnt lgkmcnt(1)
    v_mfma_f32_16x16x32_bf16 v[24:27], v[120:123], v[56:59], v[24:27]
    ds_read_b128 v[88:91], v10 offset:17408
    v_mfma_f32_16x16x32_bf16 v[24:27], v[124:127], v[60:63], v[24:27]
    buffer_load_dwordx4 v[160:163], v23, s[40:43], s48 offen offset:2048 sc1
    v_mfma_f32_16x16x32_bf16 v[24:27], v[128:131], v[64:67], v[24:27]
    v_mfma_f32_16x16x32_bf16 v[24:27], v[132:135], v[68:71], v[24:27]
    ds_read_b128 v[92:95], v11 offset:17408
    v_mfma_f32_16x16x32_bf16 v[24:27], v[136:139], v[72:75], v[24:27]
    v_mfma_f32_16x16x32_bf16 v[24:27], v[140:143], v[76:79], v[24:27]
    buffer_load_dwordx4 v[164:167], v23, s[40:43], s48 offen offset:3072 sc1
    v_mfma_f32_16x16x32_bf16 v[24:27], v[144:147], v[80:83], v[24:27]
    ds_read_b128 v[96:99], v10 offset:17664
    v_mfma_f32_16x16x32_bf16 v[28:31], v[120:123], v[60:63], v[28:31]
    v_mfma_f32_16x16x32_bf16 v[28:31], v[124:127], v[64:67], v[28:31]
    v_mfma_f32_16x16x32_bf16 v[28:31], v[128:131], v[68:71], v[28:31]
    ds_read_b128 v[100:103], v11 offset:17664
    s_mov_b32 s48, 110592
    v_mfma_f32_16x16x32_bf16 v[28:31], v[132:135], v[72:75], v[28:31]
    buffer_load_dwordx4 v[168:171], v23, s[40:43], s48 offen offset:0 sc1
    v_mfma_f32_16x16x32_bf16 v[28:31], v[136:139], v[76:79], v[28:31]
    v_mfma_f32_16x16x32_bf16 v[28:31], v[140:143], v[80:83], v[28:31]
    ds_read_b128 v[104:107], v10 offset:17920
    s_waitcnt lgkmcnt(4)
    v_mfma_f32_16x16x32_bf16 v[28:31], v[144:147], v[84:87], v[28:31]
    buffer_load_dwordx4 v[172:175], v23, s[40:43], s48 offen offset:1024 sc1
    v_mfma_f32_16x16x32_bf16 v[32:35], v[120:123], v[64:67], v[32:35]
    v_mfma_f32_16x16x32_bf16 v[32:35], v[124:127], v[68:71], v[32:35]
    ds_read_b128 v[108:111], v11 offset:17920
    v_mfma_f32_16x16x32_bf16 v[32:35], v[128:131], v[72:75], v[32:35]
    v_mfma_f32_16x16x32_bf16 v[32:35], v[132:135], v[76:79], v[32:35]
    buffer_load_dwordx4 v[176:179], v23, s[40:43], s48 offen offset:2048 sc1
    v_mfma_f32_16x16x32_bf16 v[32:35], v[136:139], v[80:83], v[32:35]
    v_mfma_f32_16x16x32_bf16 v[32:35], v[140:143], v[84:87], v[32:35]
    v_mfma_f32_16x16x32_bf16 v[32:35], v[144:147], v[88:91], v[32:35]
    v_mfma_f32_16x16x32_bf16 v[36:39], v[120:123], v[68:71], v[36:39]
    v_mfma_f32_16x16x32_bf16 v[36:39], v[124:127], v[72:75], v[36:39]
    v_mfma_f32_16x16x32_bf16 v[36:39], v[128:131], v[76:79], v[36:39]
    v_mfma_f32_16x16x32_bf16 v[36:39], v[132:135], v[80:83], v[36:39]
    v_mfma_f32_16x16x32_bf16 v[36:39], v[136:139], v[84:87], v[36:39]
    v_mfma_f32_16x16x32_bf16 v[36:39], v[140:143], v[88:91], v[36:39]
    s_waitcnt lgkmcnt(0)
    v_mfma_f32_16x16x32_bf16 v[36:39], v[144:147], v[92:95], v[36:39]
    s_waitcnt vmcnt(12)
    s_barrier
    v_mfma_f32_16x16x32_bf16 v[40:43], v[120:123], v[72:75], v[40:43]
    ds_read_b128 v[56:59], v8 offset:0
    v_mfma_f32_16x16x32_bf16 v[40:43], v[124:127], v[76:79], v[40:43]
    v_mfma_f32_16x16x32_bf16 v[40:43], v[128:131], v[80:83], v[40:43]
    ds_read_b128 v[60:63], v9 offset:0
    v_mfma_f32_16x16x32_bf16 v[40:43], v[132:135], v[84:87], v[40:43]
    v_mfma_f32_16x16x32_bf16 v[40:43], v[136:139], v[88:91], v[40:43]
    ds_read_b128 v[64:67], v8 offset:256
    v_mfma_f32_16x16x32_bf16 v[40:43], v[140:143], v[92:95], v[40:43]
    v_mfma_f32_16x16x32_bf16 v[40:43], v[144:147], v[96:99], v[40:43]
    v_mfma_f32_16x16x32_bf16 v[44:47], v[120:123], v[76:79], v[44:47]
    ds_read_b128 v[68:71], v9 offset:256
    v_mfma_f32_16x16x32_bf16 v[44:47], v[124:127], v[80:83], v[44:47]
    v_mfma_f32_16x16x32_bf16 v[44:47], v[128:131], v[84:87], v[44:47]
    ds_read_b128 v[72:75], v8 offset:512
    v_mfma_f32_16x16x32_bf16 v[44:47], v[132:135], v[88:91], v[44:47]
    v_mfma_f32_16x16x32_bf16 v[44:47], v[136:139], v[92:95], v[44:47]
    ds_read_b128 v[76:79], v9 offset:512
    v_mfma_f32_16x16x32_bf16 v[44:47], v[140:143], v[96:99], v[44:47]
    v_mfma_f32_16x16x32_bf16 v[44:47], v[144:147], v[100:103], v[44:47]
    v_mfma_f32_16x16x32_bf16 v[48:51], v[120:123], v[80:83], v[48:51]
    v_mfma_f32_16x16x32_bf16 v[48:51], v[124:127], v[84:87], v[48:51]
    v_mfma_f32_16x16x32_bf16 v[48:51], v[128:131], v[88:91], v[48:51]
    ds_read_b128 v[80:83], v8 offset:768
    v_mfma_f32_16x16x32_bf16 v[48:51], v[132:135], v[92:95], v[48:51]
    v_mfma_f32_16x16x32_bf16 v[48:51], v[136:139], v[96:99], v[48:51]
    v_mfma_f32_16x16x32_bf16 v[48:51], v[140:143], v[100:103], v[48:51]
    v_mfma_f32_16x16x32_bf16 v[48:51], v[144:147], v[104:107], v[48:51]
    v_mfma_f32_16x16x32_bf16 v[52:55], v[120:123], v[84:87], v[52:55]
    v_mfma_f32_16x16x32_bf16 v[52:55], v[124:127], v[88:91], v[52:55]
    ds_read_b128 v[84:87], v9 offset:768
    v_mfma_f32_16x16x32_bf16 v[52:55], v[128:131], v[92:95], v[52:55]
    v_mfma_f32_16x16x32_bf16 v[52:55], v[132:135], v[96:99], v[52:55]
    v_mfma_f32_16x16x32_bf16 v[52:55], v[136:139], v[100:103], v[52:55]
    v_mfma_f32_16x16x32_bf16 v[52:55], v[140:143], v[104:107], v[52:55]
    v_mfma_f32_16x16x32_bf16 v[52:55], v[144:147], v[108:111], v[52:55]
    s_waitcnt lgkmcnt(1)
    v_mfma_f32_16x16x32_bf16 v[24:27], v[184:187], v[56:59], v[24:27]
    ds_read_b128 v[88:91], v10 offset:0
    v_mfma_f32_16x16x32_bf16 v[24:27], v[188:191], v[60:63], v[24:27]
    v_mfma_f32_16x16x32_bf16 v[24:27], v[192:195], v[64:67], v[24:27]
    v_mfma_f32_16x16x32_bf16 v[24:27], v[196:199], v[68:71], v[24:27]
    ds_read_b128 v[92:95], v11 offset:0
    v_mfma_f32_16x16x32_bf16 v[24:27], v[200:203], v[72:75], v[24:27]
    v_mfma_f32_16x16x32_bf16 v[24:27], v[204:207], v[76:79], v[24:27]
    v_mfma_f32_16x16x32_bf16 v[24:27], v[208:211], v[80:83], v[24:27]
    ds_read_b128 v[96:99], v10 offset:256
    s_waitcnt lgkmcnt(3)
    v_mfma_f32_16x16x32_bf16 v[24:27], v[212:215], v[84:87], v[24:27]
    v_mfma_f32_16x16x32_bf16 v[28:31], v[184:187], v[60:63], v[28:31]
    v_mfma_f32_16x16x32_bf16 v[28:31], v[188:191], v[64:67], v[28:31]
    ds_read_b128 v[100:103], v11 offset:256
    v_mfma_f32_16x16x32_bf16 v[28:31], v[192:195], v[68:71], v[28:31]
    v_mfma_f32_16x16x32_bf16 v[28:31], v[196:199], v[72:75], v[28:31]
    v_mfma_f32_16x16x32_bf16 v[28:31], v[200:203], v[76:79], v[28:31]
    ds_read_b128 v[104:107], v10 offset:512
    v_mfma_f32_16x16x32_bf16 v[28:31], v[204:207], v[80:83], v[28:31]
    v_mfma_f32_16x16x32_bf16 v[28:31], v[208:211], v[84:87], v[28:31]
    s_waitcnt lgkmcnt(3)
    v_mfma_f32_16x16x32_bf16 v[28:31], v[212:215], v[88:91], v[28:31]
    ds_read_b128 v[108:111], v11 offset:512
    v_mfma_f32_16x16x32_bf16 v[32:35], v[184:187], v[64:67], v[32:35]
    v_mfma_f32_16x16x32_bf16 v[32:35], v[188:191], v[68:71], v[32:35]
    v_mfma_f32_16x16x32_bf16 v[32:35], v[192:195], v[72:75], v[32:35]
    ds_read_b128 v[112:115], v10 offset:768
    v_mfma_f32_16x16x32_bf16 v[32:35], v[196:199], v[76:79], v[32:35]
    v_mfma_f32_16x16x32_bf16 v[32:35], v[200:203], v[80:83], v[32:35]
    v_mfma_f32_16x16x32_bf16 v[32:35], v[204:207], v[84:87], v[32:35]
    v_mfma_f32_16x16x32_bf16 v[32:35], v[208:211], v[88:91], v[32:35]
    v_mfma_f32_16x16x32_bf16 v[32:35], v[212:215], v[92:95], v[32:35]
    v_mfma_f32_16x16x32_bf16 v[36:39], v[184:187], v[68:71], v[36:39]
    v_mfma_f32_16x16x32_bf16 v[36:39], v[188:191], v[72:75], v[36:39]
    v_mfma_f32_16x16x32_bf16 v[36:39], v[192:195], v[76:79], v[36:39]
    v_mfma_f32_16x16x32_bf16 v[36:39], v[196:199], v[80:83], v[36:39]
    v_mfma_f32_16x16x32_bf16 v[36:39], v[200:203], v[84:87], v[36:39]
    v_mfma_f32_16x16x32_bf16 v[36:39], v[204:207], v[88:91], v[36:39]
    v_mfma_f32_16x16x32_bf16 v[36:39], v[208:211], v[92:95], v[36:39]
    s_waitcnt lgkmcnt(0)
    v_mfma_f32_16x16x32_bf16 v[36:39], v[212:215], v[96:99], v[36:39]
    s_waitcnt vmcnt(0)
    s_barrier
    v_mfma_f32_16x16x32_bf16 v[40:43], v[184:187], v[72:75], v[40:43]
    ds_read_b128 v[56:59], v8 offset:52224
    s_add_u32 s32, s22, 7340032
    s_addc_u32 s33, s23, 0
    s_mov_b32 s34, 1024000
    s_mov_b32 s35, 0x20000
    s_add_u32 m0, s31, 126976
    v_mfma_f32_16x16x32_bf16 v[40:43], v[188:191], v[76:79], v[40:43]
    buffer_load_dwordx4 v253, s[32:35], 0 offen sc1 lds
    v_mfma_f32_16x16x32_bf16 v[40:43], v[192:195], v[80:83], v[40:43]
    ds_read_b128 v[60:63], v9 offset:52224
    v_mfma_f32_16x16x32_bf16 v[40:43], v[196:199], v[84:87], v[40:43]
    v_mfma_f32_16x16x32_bf16 v[40:43], v[200:203], v[88:91], v[40:43]
    ds_read_b128 v[64:67], v8 offset:52480
    v_mfma_f32_16x16x32_bf16 v[40:43], v[204:207], v[92:95], v[40:43]
    s_add_u32 m0, s31, 131072
    v_mfma_f32_16x16x32_bf16 v[40:43], v[208:211], v[96:99], v[40:43]
    v_mfma_f32_16x16x32_bf16 v[40:43], v[212:215], v[100:103], v[40:43]
    buffer_load_dwordx4 v254, s[32:35], 0 offen sc1 lds
    v_mfma_f32_16x16x32_bf16 v[44:47], v[184:187], v[76:79], v[44:47]
    ds_read_b128 v[68:71], v9 offset:52480
    v_mfma_f32_16x16x32_bf16 v[44:47], v[188:191], v[80:83], v[44:47]
    v_mfma_f32_16x16x32_bf16 v[44:47], v[192:195], v[84:87], v[44:47]
    ds_read_b128 v[72:75], v8 offset:52736
    v_mfma_f32_16x16x32_bf16 v[44:47], v[196:199], v[88:91], v[44:47]
    s_add_u32 m0, s31, 135168
    v_mfma_f32_16x16x32_bf16 v[44:47], v[200:203], v[92:95], v[44:47]
    ds_read_b128 v[76:79], v9 offset:52736
    v_mfma_f32_16x16x32_bf16 v[44:47], v[204:207], v[96:99], v[44:47]
    buffer_load_dwordx4 v255, s[32:35], 0 offen sc1 lds
    v_mfma_f32_16x16x32_bf16 v[44:47], v[208:211], v[100:103], v[44:47]
    v_mfma_f32_16x16x32_bf16 v[44:47], v[212:215], v[104:107], v[44:47]
    v_mfma_f32_16x16x32_bf16 v[48:51], v[184:187], v[80:83], v[48:51]
    v_mfma_f32_16x16x32_bf16 v[48:51], v[188:191], v[84:87], v[48:51]
    s_add_u32 m0, s31, 139264
    v_mfma_f32_16x16x32_bf16 v[48:51], v[192:195], v[88:91], v[48:51]
    ds_read_b128 v[80:83], v8 offset:52992
    v_mfma_f32_16x16x32_bf16 v[48:51], v[196:199], v[92:95], v[48:51]
    buffer_load_dwordx4 v116, s[32:35], 0 offen sc1 lds
    v_mfma_f32_16x16x32_bf16 v[48:51], v[200:203], v[96:99], v[48:51]
    v_mfma_f32_16x16x32_bf16 v[48:51], v[204:207], v[100:103], v[48:51]
    v_mfma_f32_16x16x32_bf16 v[48:51], v[208:211], v[104:107], v[48:51]
    v_mfma_f32_16x16x32_bf16 v[48:51], v[212:215], v[108:111], v[48:51]
    s_mov_b32 m0, 143360
    v_mfma_f32_16x16x32_bf16 v[52:55], v[184:187], v[84:87], v[52:55]
    s_mov_b64 exec, s[62:63]
    buffer_load_dwordx4 v117, s[32:35], 0 offen sc1 lds
    s_mov_b64 exec, -1
    v_mfma_f32_16x16x32_bf16 v[52:55], v[188:191], v[88:91], v[52:55]
    ds_read_b128 v[84:87], v9 offset:52992
    v_mfma_f32_16x16x32_bf16 v[52:55], v[192:195], v[92:95], v[52:55]
    v_mfma_f32_16x16x32_bf16 v[52:55], v[196:199], v[96:99], v[52:55]
    v_mfma_f32_16x16x32_bf16 v[52:55], v[200:203], v[100:103], v[52:55]
    v_mfma_f32_16x16x32_bf16 v[52:55], v[204:207], v[104:107], v[52:55]
    s_add_u32 m0, s31, 109568
    v_mfma_f32_16x16x32_bf16 v[52:55], v[208:211], v[108:111], v[52:55]
    buffer_load_dwordx4 v248, s[32:35], 0 offen sc1 lds
    v_mfma_f32_16x16x32_bf16 v[52:55], v[212:215], v[112:115], v[52:55]
    s_waitcnt lgkmcnt(1)
    v_mfma_f32_16x16x32_bf16 v[24:27], v[152:155], v[56:59], v[24:27]
    ds_read_b128 v[88:91], v10 offset:52224
    v_mfma_f32_16x16x32_bf16 v[24:27], v[156:159], v[60:63], v[24:27]
    v_mfma_f32_16x16x32_bf16 v[24:27], v[160:163], v[64:67], v[24:27]
    v_mfma_f32_16x16x32_bf16 v[24:27], v[164:167], v[68:71], v[24:27]
    ds_read_b128 v[92:95], v11 offset:52224
    s_add_u32 m0, s31, 113664
    v_mfma_f32_16x16x32_bf16 v[24:27], v[168:171], v[72:75], v[24:27]
    buffer_load_dwordx4 v249, s[32:35], 0 offen sc1 lds
    v_mfma_f32_16x16x32_bf16 v[24:27], v[172:175], v[76:79], v[24:27]
    v_mfma_f32_16x16x32_bf16 v[24:27], v[176:179], v[80:83], v[24:27]
    ds_read_b128 v[96:99], v10 offset:52480
    v_mfma_f32_16x16x32_bf16 v[28:31], v[152:155], v[60:63], v[28:31]
    v_mfma_f32_16x16x32_bf16 v[28:31], v[156:159], v[64:67], v[28:31]
    v_mfma_f32_16x16x32_bf16 v[28:31], v[160:163], v[68:71], v[28:31]
    ds_read_b128 v[100:103], v11 offset:52480
    s_add_u32 m0, s31, 117760
    v_mfma_f32_16x16x32_bf16 v[28:31], v[164:167], v[72:75], v[28:31]
    buffer_load_dwordx4 v250, s[32:35], 0 offen sc1 lds
    v_mfma_f32_16x16x32_bf16 v[28:31], v[168:171], v[76:79], v[28:31]
    v_mfma_f32_16x16x32_bf16 v[28:31], v[172:175], v[80:83], v[28:31]
    ds_read_b128 v[104:107], v10 offset:52736
    s_waitcnt lgkmcnt(4)
    v_mfma_f32_16x16x32_bf16 v[28:31], v[176:179], v[84:87], v[28:31]
    v_mfma_f32_16x16x32_bf16 v[32:35], v[152:155], v[64:67], v[32:35]
    v_mfma_f32_16x16x32_bf16 v[32:35], v[156:159], v[68:71], v[32:35]
    ds_read_b128 v[108:111], v11 offset:52736
    ds_write_b128 v1, v[24:27] offset:28672
    v_mfma_f32_16x16x32_bf16 v[32:35], v[160:163], v[72:75], v[32:35]
    s_add_u32 m0, s31, 121856
    v_mfma_f32_16x16x32_bf16 v[32:35], v[164:167], v[76:79], v[32:35]
    buffer_load_dwordx4 v251, s[32:35], 0 offen sc1 lds
    v_mfma_f32_16x16x32_bf16 v[32:35], v[168:171], v[80:83], v[32:35]
    v_mfma_f32_16x16x32_bf16 v[32:35], v[172:175], v[84:87], v[32:35]
    v_mfma_f32_16x16x32_bf16 v[32:35], v[176:179], v[88:91], v[32:35]
    v_mfma_f32_16x16x32_bf16 v[36:39], v[152:155], v[68:71], v[36:39]
    s_mov_b32 m0, 125952
    v_mfma_f32_16x16x32_bf16 v[36:39], v[156:159], v[72:75], v[36:39]
    ds_write_b128 v1, v[28:31] offset:30752
    v_mfma_f32_16x16x32_bf16 v[36:39], v[160:163], v[76:79], v[36:39]
    s_mov_b64 exec, s[62:63]
    buffer_load_dwordx4 v252, s[32:35], 0 offen sc1 lds
    s_mov_b64 exec, -1
    v_mfma_f32_16x16x32_bf16 v[36:39], v[164:167], v[80:83], v[36:39]
    v_mfma_f32_16x16x32_bf16 v[36:39], v[168:171], v[84:87], v[36:39]
    v_mfma_f32_16x16x32_bf16 v[36:39], v[172:175], v[88:91], v[36:39]
    s_waitcnt lgkmcnt(1)
    v_mfma_f32_16x16x32_bf16 v[36:39], v[176:179], v[92:95], v[36:39]
    s_nop 0
    ds_write_b128 v1, v[32:35] offset:32832
    v_mfma_f32_16x16x32_bf16 v[40:43], v[152:155], v[72:75], v[40:43]
    v_mfma_f32_16x16x32_bf16 v[40:43], v[156:159], v[76:79], v[40:43]
    v_mfma_f32_16x16x32_bf16 v[40:43], v[160:163], v[80:83], v[40:43]
    v_mfma_f32_16x16x32_bf16 v[40:43], v[164:167], v[84:87], v[40:43]
    v_mfma_f32_16x16x32_bf16 v[40:43], v[168:171], v[88:91], v[40:43]
    v_mfma_f32_16x16x32_bf16 v[40:43], v[172:175], v[92:95], v[40:43]
    v_mfma_f32_16x16x32_bf16 v[40:43], v[176:179], v[96:99], v[40:43]
    s_nop 0
    ds_write_b128 v1, v[36:39] offset:34912
    v_mfma_f32_16x16x32_bf16 v[44:47], v[152:155], v[76:79], v[44:47]
    v_mfma_f32_16x16x32_bf16 v[44:47], v[156:159], v[80:83], v[44:47]
    s_waitcnt vmcnt(5) lgkmcnt(0)
    s_barrier
    v_mfma_f32_16x16x32_bf16 v[44:47], v[160:163], v[84:87], v[44:47]
    s_add_u32 s32, s22, 6291456
    s_addc_u32 s33, s23, 0
    s_mov_b32 s34, 1024000
    s_mov_b32 s35, 0x20000
    s_add_u32 m0, s31, 92160
    v_mfma_f32_16x16x32_bf16 v[44:47], v[164:167], v[88:91], v[44:47]
    buffer_load_dwordx4 v253, s[32:35], 0 offen sc1 lds
    v_mfma_f32_16x16x32_bf16 v[44:47], v[168:171], v[92:95], v[44:47]
    ds_read_b128 v[56:59], v8 offset:34816
    v_mfma_f32_16x16x32_bf16 v[44:47], v[172:175], v[96:99], v[44:47]
    ds_read_b128 v[60:63], v9 offset:34816
    v_mfma_f32_16x16x32_bf16 v[44:47], v[176:179], v[100:103], v[44:47]
    ds_read_b128 v[64:67], v8 offset:35072
    s_nop 0
    ds_write_b128 v1, v[40:43] offset:36992
    v_mfma_f32_16x16x32_bf16 v[48:51], v[152:155], v[80:83], v[48:51]
    ds_read_b128 v[68:71], v9 offset:35072
    s_add_u32 m0, s31, 96256
    v_mfma_f32_16x16x32_bf16 v[48:51], v[156:159], v[84:87], v[48:51]
    ds_read_b128 v[72:75], v8 offset:35328
    v_mfma_f32_16x16x32_bf16 v[48:51], v[160:163], v[88:91], v[48:51]
    ds_read_b128 v[76:79], v9 offset:35328
    v_mfma_f32_16x16x32_bf16 v[48:51], v[164:167], v[92:95], v[48:51]
    buffer_load_dwordx4 v254, s[32:35], 0 offen sc1 lds
    v_mfma_f32_16x16x32_bf16 v[48:51], v[168:171], v[96:99], v[48:51]
    ds_read_b128 v[80:83], v8 offset:35584
    s_add_u32 m0, s31, 100352
    v_mfma_f32_16x16x32_bf16 v[48:51], v[172:175], v[100:103], v[48:51]
    v_mfma_f32_16x16x32_bf16 v[48:51], v[176:179], v[104:107], v[48:51]
    s_nop 0
    ds_write_b128 v1, v[44:47] offset:39072
    v_mfma_f32_16x16x32_bf16 v[52:55], v[152:155], v[84:87], v[52:55]
    buffer_load_dwordx4 v255, s[32:35], 0 offen sc1 lds
    v_mfma_f32_16x16x32_bf16 v[52:55], v[156:159], v[88:91], v[52:55]
    ds_read_b128 v[84:87], v9 offset:35584
    s_add_u32 m0, s31, 104448
    v_mfma_f32_16x16x32_bf16 v[52:55], v[160:163], v[92:95], v[52:55]
    buffer_load_dwordx4 v116, s[32:35], 0 offen sc1 lds
    v_mfma_f32_16x16x32_bf16 v[52:55], v[164:167], v[96:99], v[52:55]
    s_mov_b32 m0, 108544
    v_mfma_f32_16x16x32_bf16 v[52:55], v[168:171], v[100:103], v[52:55]
    s_mov_b64 exec, s[62:63]
    buffer_load_dwordx4 v117, s[32:35], 0 offen sc1 lds
    s_mov_b64 exec, -1
    v_mfma_f32_16x16x32_bf16 v[52:55], v[172:175], v[104:107], v[52:55]
    v_mfma_f32_16x16x32_bf16 v[52:55], v[176:179], v[108:111], v[52:55]
    s_nop 0
    ds_write_b128 v1, v[48:51] offset:41152
    s_waitcnt lgkmcnt(4)
    v_mfma_f32_16x16x32_bf16 v[24:27], v[152:155], v[56:59], 0
    ds_read_b128 v[88:91], v10 offset:34816
    v_mfma_f32_16x16x32_bf16 v[24:27], v[156:159], v[60:63], v[24:27]
    v_mfma_f32_16x16x32_bf16 v[24:27], v[160:163], v[64:67], v[24:27]
    v_mfma_f32_16x16x32_bf16 v[24:27], v[164:167], v[68:71], v[24:27]
    ds_read_b128 v[92:95], v11 offset:34816
    v_mfma_f32_16x16x32_bf16 v[24:27], v[168:171], v[72:75], v[24:27]
    v_mfma_f32_16x16x32_bf16 v[24:27], v[172:175], v[76:79], v[24:27]
    s_waitcnt lgkmcnt(3)
    v_mfma_f32_16x16x32_bf16 v[24:27], v[176:179], v[80:83], v[24:27]
    ds_read_b128 v[96:99], v10 offset:35072
    ds_write_b128 v1, v[52:55] offset:43232
    v_mfma_f32_16x16x32_bf16 v[28:31], v[152:155], v[60:63], 0
    v_mfma_f32_16x16x32_bf16 v[28:31], v[156:159], v[64:67], v[28:31]
    v_mfma_f32_16x16x32_bf16 v[28:31], v[160:163], v[68:71], v[28:31]
    ds_read_b128 v[100:103], v11 offset:35072
    v_mfma_f32_16x16x32_bf16 v[28:31], v[164:167], v[72:75], v[28:31]
    v_mfma_f32_16x16x32_bf16 v[28:31], v[168:171], v[76:79], v[28:31]
    v_mfma_f32_16x16x32_bf16 v[28:31], v[172:175], v[80:83], v[28:31]
    ds_read_b128 v[104:107], v10 offset:35328
    v_mfma_f32_16x16x32_bf16 v[28:31], v[176:179], v[84:87], v[28:31]
    v_mfma_f32_16x16x32_bf16 v[32:35], v[152:155], v[64:67], 0
    v_mfma_f32_16x16x32_bf16 v[32:35], v[156:159], v[68:71], v[32:35]
    ds_read_b128 v[108:111], v11 offset:35328
    v_mfma_f32_16x16x32_bf16 v[32:35], v[160:163], v[72:75], v[32:35]
    v_mfma_f32_16x16x32_bf16 v[32:35], v[164:167], v[76:79], v[32:35]
    v_mfma_f32_16x16x32_bf16 v[32:35], v[168:171], v[80:83], v[32:35]
    v_mfma_f32_16x16x32_bf16 v[32:35], v[172:175], v[84:87], v[32:35]
    s_waitcnt lgkmcnt(2)
    v_mfma_f32_16x16x32_bf16 v[32:35], v[176:179], v[88:91], v[32:35]
    v_mfma_f32_16x16x32_bf16 v[36:39], v[152:155], v[68:71], 0
    v_mfma_f32_16x16x32_bf16 v[36:39], v[156:159], v[72:75], v[36:39]
    v_mfma_f32_16x16x32_bf16 v[36:39], v[160:163], v[76:79], v[36:39]
    v_mfma_f32_16x16x32_bf16 v[36:39], v[164:167], v[80:83], v[36:39]
    v_mfma_f32_16x16x32_bf16 v[36:39], v[168:171], v[84:87], v[36:39]
    v_mfma_f32_16x16x32_bf16 v[36:39], v[172:175], v[88:91], v[36:39]
    v_mfma_f32_16x16x32_bf16 v[36:39], v[176:179], v[92:95], v[36:39]
    s_waitcnt vmcnt(5) lgkmcnt(0)
    s_barrier
    v_mfma_f32_16x16x32_bf16 v[40:43], v[152:155], v[72:75], 0
    ds_read_b128 v[56:59], v8 offset:17408
    s_add_u32 m0, s31, 144384
    v_mfma_f32_16x16x32_bf16 v[40:43], v[156:159], v[76:79], v[40:43]
    buffer_load_dwordx4 v248, s[32:35], 0 offen sc1 lds
    v_mfma_f32_16x16x32_bf16 v[40:43], v[160:163], v[80:83], v[40:43]
    ds_read_b128 v[60:63], v9 offset:17408
    v_mfma_f32_16x16x32_bf16 v[40:43], v[164:167], v[84:87], v[40:43]
    s_add_u32 m0, s31, 148480
    v_mfma_f32_16x16x32_bf16 v[40:43], v[168:171], v[88:91], v[40:43]
    ds_read_b128 v[64:67], v8 offset:17664
    v_mfma_f32_16x16x32_bf16 v[40:43], v[172:175], v[92:95], v[40:43]
    v_mfma_f32_16x16x32_bf16 v[40:43], v[176:179], v[96:99], v[40:43]
    buffer_load_dwordx4 v249, s[32:35], 0 offen sc1 lds
    v_mfma_f32_16x16x32_bf16 v[44:47], v[152:155], v[76:79], 0
    ds_read_b128 v[68:71], v9 offset:17664
    s_add_u32 m0, s31, 152576
    v_mfma_f32_16x16x32_bf16 v[44:47], v[156:159], v[80:83], v[44:47]
    buffer_load_dwordx4 v250, s[32:35], 0 offen sc1 lds
    v_mfma_f32_16x16x32_bf16 v[44:47], v[160:163], v[84:87], v[44:47]
    ds_read_b128 v[72:75], v8 offset:17920
    v_mfma_f32_16x16x32_bf16 v[44:47], v[164:167], v[88:91], v[44:47]
    v_mfma_f32_16x16x32_bf16 v[44:47], v[168:171], v[92:95], v[44:47]
    ds_read_b128 v[76:79], v9 offset:17920
    s_add_u32 m0, s31, 156672
    v_mfma_f32_16x16x32_bf16 v[44:47], v[172:175], v[96:99], v[44:47]
    v_mfma_f32_16x16x32_bf16 v[44:47], v[176:179], v[100:103], v[44:47]
    buffer_load_dwordx4 v251, s[32:35], 0 offen sc1 lds
    v_mfma_f32_16x16x32_bf16 v[48:51], v[152:155], v[80:83], 0
    v_mfma_f32_16x16x32_bf16 v[48:51], v[156:159], v[84:87], v[48:51]
    s_mov_b32 m0, 160768
    v_mfma_f32_16x16x32_bf16 v[48:51], v[160:163], v[88:91], v[48:51]
    ds_read_b128 v[80:83], v8 offset:18176
    v_mfma_f32_16x16x32_bf16 v[48:51], v[164:167], v[92:95], v[48:51]
    s_mov_b64 exec, s[62:63]
    buffer_load_dwordx4 v252, s[32:35], 0 offen sc1 lds
    s_mov_b64 exec, -1
    v_mfma_f32_16x16x32_bf16 v[48:51], v[168:171], v[96:99], v[48:51]
    v_mfma_f32_16x16x32_bf16 v[48:51], v[172:175], v[100:103], v[48:51]
    v_mfma_f32_16x16x32_bf16 v[48:51], v[176:179], v[104:107], v[48:51]
    v_mfma_f32_16x16x32_bf16 v[52:55], v[152:155], v[84:87], 0
    v_mfma_f32_16x16x32_bf16 v[52:55], v[156:159], v[88:91], v[52:55]
    ds_read_b128 v[84:87], v9 offset:18176
    s_mov_b32 s48, 65536
    v_mfma_f32_16x16x32_bf16 v[52:55], v[160:163], v[92:95], v[52:55]
    buffer_load_dwordx4 v[152:155], v23, s[40:43], s48 offen offset:0 sc1
    v_mfma_f32_16x16x32_bf16 v[52:55], v[164:167], v[96:99], v[52:55]
    v_mfma_f32_16x16x32_bf16 v[52:55], v[168:171], v[100:103], v[52:55]
    buffer_load_dwordx4 v[156:159], v23, s[40:43], s48 offen offset:1024 sc1
    v_mfma_f32_16x16x32_bf16 v[52:55], v[172:175], v[104:107], v[52:55]
    v_mfma_f32_16x16x32_bf16 v[52:55], v[176:179], v[108:111], v[52:55]
    s_waitcnt lgkmcnt(1)
    v_mfma_f32_16x16x32_bf16 v[24:27], v[184:187], v[56:59], v[24:27]
    ds_read_b128 v[88:91], v10 offset:17408
    v_mfma_f32_16x16x32_bf16 v[24:27], v[188:191], v[60:63], v[24:27]
    buffer_load_dwordx4 v[160:163], v23, s[40:43], s48 offen offset:2048 sc1
    v_mfma_f32_16x16x32_bf16 v[24:27], v[192:195], v[64:67], v[24:27]
    v_mfma_f32_16x16x32_bf16 v[24:27], v[196:199], v[68:71], v[24:27]
    ds_read_b128 v[92:95], v11 offset:17408
    v_mfma_f32_16x16x32_bf16 v[24:27], v[200:203], v[72:75], v[24:27]
    v_mfma_f32_16x16x32_bf16 v[24:27], v[204:207], v[76:79], v[24:27]
    v_mfma_f32_16x16x32_bf16 v[24:27], v[208:211], v[80:83], v[24:27]
    ds_read_b128 v[96:99], v10 offset:17664
    s_waitcnt lgkmcnt(3)
    v_mfma_f32_16x16x32_bf16 v[24:27], v[212:215], v[84:87], v[24:27]
    buffer_load_dwordx4 v[164:167], v23, s[40:43], s48 offen offset:3072 sc1
    v_mfma_f32_16x16x32_bf16 v[28:31], v[184:187], v[60:63], v[28:31]
    v_mfma_f32_16x16x32_bf16 v[28:31], v[188:191], v[64:67], v[28:31]
    ds_read_b128 v[100:103], v11 offset:17664
    v_mfma_f32_16x16x32_bf16 v[28:31], v[192:195], v[68:71], v[28:31]
    v_mfma_f32_16x16x32_bf16 v[28:31], v[196:199], v[72:75], v[28:31]
    s_mov_b32 s48, 69632
    v_mfma_f32_16x16x32_bf16 v[28:31], v[200:203], v[76:79], v[28:31]
    ds_read_b128 v[104:107], v10 offset:17920
    v_mfma_f32_16x16x32_bf16 v[28:31], v[204:207], v[80:83], v[28:31]
    buffer_load_dwordx4 v[168:171], v23, s[40:43], s48 offen offset:0 sc1
    v_mfma_f32_16x16x32_bf16 v[28:31], v[208:211], v[84:87], v[28:31]
    s_waitcnt lgkmcnt(3)
    v_mfma_f32_16x16x32_bf16 v[28:31], v[212:215], v[88:91], v[28:31]
    ds_read_b128 v[108:111], v11 offset:17920
    v_mfma_f32_16x16x32_bf16 v[32:35], v[184:187], v[64:67], v[32:35]
    buffer_load_dwordx4 v[172:175], v23, s[40:43], s48 offen offset:1024 sc1
    v_mfma_f32_16x16x32_bf16 v[32:35], v[188:191], v[68:71], v[32:35]
    v_mfma_f32_16x16x32_bf16 v[32:35], v[192:195], v[72:75], v[32:35]
    ds_read_b128 v[112:115], v10 offset:18176
    v_mfma_f32_16x16x32_bf16 v[32:35], v[196:199], v[76:79], v[32:35]
    v_mfma_f32_16x16x32_bf16 v[32:35], v[200:203], v[80:83], v[32:35]
    v_mfma_f32_16x16x32_bf16 v[32:35], v[204:207], v[84:87], v[32:35]
    buffer_load_dwordx4 v[176:179], v23, s[40:43], s48 offen offset:2048 sc1
    v_mfma_f32_16x16x32_bf16 v[32:35], v[208:211], v[88:91], v[32:35]
    v_mfma_f32_16x16x32_bf16 v[32:35], v[212:215], v[92:95], v[32:35]
    v_mfma_f32_16x16x32_bf16 v[36:39], v[184:187], v[68:71], v[36:39]
    v_mfma_f32_16x16x32_bf16 v[36:39], v[188:191], v[72:75], v[36:39]
    v_mfma_f32_16x16x32_bf16 v[36:39], v[192:195], v[76:79], v[36:39]
    buffer_load_dwordx4 v[180:183], v23, s[40:43], s48 offen offset:3072 sc1
    v_mfma_f32_16x16x32_bf16 v[36:39], v[196:199], v[80:83], v[36:39]
    v_mfma_f32_16x16x32_bf16 v[36:39], v[200:203], v[84:87], v[36:39]
    v_mfma_f32_16x16x32_bf16 v[36:39], v[204:207], v[88:91], v[36:39]
    v_mfma_f32_16x16x32_bf16 v[36:39], v[208:211], v[92:95], v[36:39]
    s_waitcnt lgkmcnt(0)
    v_mfma_f32_16x16x32_bf16 v[36:39], v[212:215], v[96:99], v[36:39]
    s_waitcnt vmcnt(13)
    s_barrier
    v_mfma_f32_16x16x32_bf16 v[40:43], v[184:187], v[72:75], v[40:43]
    ds_read_b128 v[56:59], v8 offset:0
    s_add_u32 s32, s22, 5242880
    s_addc_u32 s33, s23, 0
    s_mov_b32 s34, 1024000
    s_mov_b32 s35, 0x20000
    s_add_u32 m0, s31, 126976
    v_mfma_f32_16x16x32_bf16 v[40:43], v[188:191], v[76:79], v[40:43]
    buffer_load_dwordx4 v253, s[32:35], 0 offen sc1 lds
    v_mfma_f32_16x16x32_bf16 v[40:43], v[192:195], v[80:83], v[40:43]
    ds_read_b128 v[60:63], v9 offset:0
    v_mfma_f32_16x16x32_bf16 v[40:43], v[196:199], v[84:87], v[40:43]
    v_mfma_f32_16x16x32_bf16 v[40:43], v[200:203], v[88:91], v[40:43]
    ds_read_b128 v[64:67], v8 offset:256
    s_add_u32 m0, s31, 131072
    v_mfma_f32_16x16x32_bf16 v[40:43], v[204:207], v[92:95], v[40:43]
    buffer_load_dwordx4 v254, s[32:35], 0 offen sc1 lds
    v_mfma_f32_16x16x32_bf16 v[40:43], v[208:211], v[96:99], v[40:43]
    v_mfma_f32_16x16x32_bf16 v[40:43], v[212:215], v[100:103], v[40:43]
    v_mfma_f32_16x16x32_bf16 v[44:47], v[184:187], v[76:79], v[44:47]
    ds_read_b128 v[68:71], v9 offset:256
    s_add_u32 m0, s31, 135168
    v_mfma_f32_16x16x32_bf16 v[44:47], v[188:191], v[80:83], v[44:47]
    buffer_load_dwordx4 v255, s[32:35], 0 offen sc1 lds
    v_mfma_f32_16x16x32_bf16 v[44:47], v[192:195], v[84:87], v[44:47]
    ds_read_b128 v[72:75], v8 offset:512
    v_mfma_f32_16x16x32_bf16 v[44:47], v[196:199], v[88:91], v[44:47]
    v_mfma_f32_16x16x32_bf16 v[44:47], v[200:203], v[92:95], v[44:47]
    ds_read_b128 v[76:79], v9 offset:512
    v_mfma_f32_16x16x32_bf16 v[44:47], v[204:207], v[96:99], v[44:47]
    s_add_u32 m0, s31, 139264
    v_mfma_f32_16x16x32_bf16 v[44:47], v[208:211], v[100:103], v[44:47]
    v_mfma_f32_16x16x32_bf16 v[44:47], v[212:215], v[104:107], v[44:47]
    buffer_load_dwordx4 v116, s[32:35], 0 offen sc1 lds
L_pg8:
    s_cbranch_execz L_pb8
    v_mfma_f32_16x16x32_bf16 v[48:51], v[184:187], v[80:83], v[48:51]
    v_mfma_f32_16x16x32_bf16 v[48:51], v[188:191], v[84:87], v[48:51]
    s_mov_b32 m0, 143360
    v_mfma_f32_16x16x32_bf16 v[48:51], v[192:195], v[88:91], v[48:51]
    ds_read_b128 v[80:83], v8 offset:768
    v_mfma_f32_16x16x32_bf16 v[48:51], v[196:199], v[92:95], v[48:51]
    s_mov_b64 exec, s[62:63]
    buffer_load_dwordx4 v117, s[32:35], 0 offen sc1 lds
    s_mov_b64 exec, -1
    v_mfma_f32_16x16x32_bf16 v[48:51], v[200:203], v[96:99], v[48:51]
    v_mfma_f32_16x16x32_bf16 v[48:51], v[204:207], v[100:103], v[48:51]
    v_mfma_f32_16x16x32_bf16 v[48:51], v[208:211], v[104:107], v[48:51]
    v_mfma_f32_16x16x32_bf16 v[48:51], v[212:215], v[108:111], v[48:51]
    v_mfma_f32_16x16x32_bf16 v[52:55], v[184:187], v[84:87], v[52:55]
    v_mfma_f32_16x16x32_bf16 v[52:55], v[188:191], v[88:91], v[52:55]
    ds_read_b128 v[84:87], v9 offset:768
    s_mov_b32 s48, 40960
    v_mfma_f32_16x16x32_bf16 v[52:55], v[192:195], v[92:95], v[52:55]
    buffer_load_dwordx4 v[184:187], v23, s[40:43], s48 offen offset:0 sc1
    v_mfma_f32_16x16x32_bf16 v[52:55], v[196:199], v[96:99], v[52:55]
    v_mfma_f32_16x16x32_bf16 v[52:55], v[200:203], v[100:103], v[52:55]
    buffer_load_dwordx4 v[188:191], v23, s[40:43], s48 offen offset:1024 sc1
    v_mfma_f32_16x16x32_bf16 v[52:55], v[204:207], v[104:107], v[52:55]
    v_mfma_f32_16x16x32_bf16 v[52:55], v[208:211], v[108:111], v[52:55]
    v_mfma_f32_16x16x32_bf16 v[52:55], v[212:215], v[112:115], v[52:55]
    s_waitcnt lgkmcnt(1)
    v_mfma_f32_16x16x32_bf16 v[24:27], v[120:123], v[56:59], v[24:27]
    ds_read_b128 v[88:91], v10 offset:0
    v_mfma_f32_16x16x32_bf16 v[24:27], v[124:127], v[60:63], v[24:27]
    buffer_load_dwordx4 v[192:195], v23, s[40:43], s48 offen offset:2048 sc1
    v_mfma_f32_16x16x32_bf16 v[24:27], v[128:131], v[64:67], v[24:27]
    v_mfma_f32_16x16x32_bf16 v[24:27], v[132:135], v[68:71], v[24:27]
    ds_read_b128 v[92:95], v11 offset:0
    v_mfma_f32_16x16x32_bf16 v[24:27], v[136:139], v[72:75], v[24:27]
    v_mfma_f32_16x16x32_bf16 v[24:27], v[140:143], v[76:79], v[24:27]
    buffer_load_dwordx4 v[196:199], v23, s[40:43], s48 offen offset:3072 sc1
    v_mfma_f32_16x16x32_bf16 v[24:27], v[144:147], v[80:83], v[24:27]
    ds_read_b128 v[96:99], v10 offset:256
    v_mfma_f32_16x16x32_bf16 v[28:31], v[120:123], v[60:63], v[28:31]
    v_mfma_f32_16x16x32_bf16 v[28:31], v[124:127], v[64:67], v[28:31]
    v_mfma_f32_16x16x32_bf16 v[28:31], v[128:131], v[68:71], v[28:31]
    ds_read_b128 v[100:103], v11 offset:256
    s_mov_b32 s48, 45056
    v_mfma_f32_16x16x32_bf16 v[28:31], v[132:135], v[72:75], v[28:31]
    buffer_load_dwordx4 v[200:203], v23, s[40:43], s48 offen offset:0 sc1
    v_mfma_f32_16x16x32_bf16 v[28:31], v[136:139], v[76:79], v[28:31]
    v_mfma_f32_16x16x32_bf16 v[28:31], v[140:143], v[80:83], v[28:31]
    ds_read_b128 v[104:107], v10 offset:512
    s_waitcnt lgkmcnt(4)
    v_mfma_f32_16x16x32_bf16 v[28:31], v[144:147], v[84:87], v[28:31]
    buffer_load_dwordx4 v[204:207], v23, s[40:43], s48 offen offset:1024 sc1
    v_mfma_f32_16x16x32_bf16 v[32:35], v[120:123], v[64:67], v[32:35]
    v_mfma_f32_16x16x32_bf16 v[32:35], v[124:127], v[68:71], v[32:35]
    ds_read_b128 v[108:111], v11 offset:512
    v_mfma_f32_16x16x32_bf16 v[32:35], v[128:131], v[72:75], v[32:35]
    v_mfma_f32_16x16x32_bf16 v[32:35], v[132:135], v[76:79], v[32:35]
    buffer_load_dwordx4 v[208:211], v23, s[40:43], s48 offen offset:2048 sc1
    v_mfma_f32_16x16x32_bf16 v[32:35], v[136:139], v[80:83], v[32:35]
    v_mfma_f32_16x16x32_bf16 v[32:35], v[140:143], v[84:87], v[32:35]
    v_mfma_f32_16x16x32_bf16 v[32:35], v[144:147], v[88:91], v[32:35]
    v_mfma_f32_16x16x32_bf16 v[36:39], v[120:123], v[68:71], v[36:39]
    v_mfma_f32_16x16x32_bf16 v[36:39], v[124:127], v[72:75], v[36:39]
    v_mfma_f32_16x16x32_bf16 v[36:39], v[128:131], v[76:79], v[36:39]
    v_mfma_f32_16x16x32_bf16 v[36:39], v[132:135], v[80:83], v[36:39]
    v_mfma_f32_16x16x32_bf16 v[36:39], v[136:139], v[84:87], v[36:39]
    v_mfma_f32_16x16x32_bf16 v[36:39], v[140:143], v[88:91], v[36:39]
    s_waitcnt lgkmcnt(0)
    v_mfma_f32_16x16x32_bf16 v[36:39], v[144:147], v[92:95], v[36:39]
    s_waitcnt vmcnt(12)
    s_barrier
    v_mfma_f32_16x16x32_bf16 v[40:43], v[120:123], v[72:75], v[40:43]
    ds_read_b128 v[56:59], v8 offset:52224
    s_add_u32 m0, s31, 109568
    v_mfma_f32_16x16x32_bf16 v[40:43], v[124:127], v[76:79], v[40:43]
    buffer_load_dwordx4 v248, s[32:35], 0 offen sc1 lds
    v_mfma_f32_16x16x32_bf16 v[40:43], v[128:131], v[80:83], v[40:43]
    ds_read_b128 v[60:63], v9 offset:52224
    v_mfma_f32_16x16x32_bf16 v[40:43], v[132:135], v[84:87], v[40:43]
    s_add_u32 m0, s31, 113664
    v_mfma_f32_16x16x32_bf16 v[40:43], v[136:139], v[88:91], v[40:43]
    ds_read_b128 v[64:67], v8 offset:52480
    v_mfma_f32_16x16x32_bf16 v[40:43], v[140:143], v[92:95], v[40:43]
    v_mfma_f32_16x16x32_bf16 v[40:43], v[144:147], v[96:99], v[40:43]
    buffer_load_dwordx4 v249, s[32:35], 0 offen sc1 lds
    v_mfma_f32_16x16x32_bf16 v[44:47], v[120:123], v[76:79], v[44:47]
    ds_read_b128 v[68:71], v9 offset:52480
    s_add_u32 m0, s31, 117760
    v_mfma_f32_16x16x32_bf16 v[44:47], v[124:127], v[80:83], v[44:47]
    buffer_load_dwordx4 v250, s[32:35], 0 offen sc1 lds
    v_mfma_f32_16x16x32_bf16 v[44:47], v[128:131], v[84:87], v[44:47]
    ds_read_b128 v[72:75], v8 offset:52736
    v_mfma_f32_16x16x32_bf16 v[44:47], v[132:135], v[88:91], v[44:47]
    v_mfma_f32_16x16x32_bf16 v[44:47], v[136:139], v[92:95], v[44:47]
    ds_read_b128 v[76:79], v9 offset:52736
    s_add_u32 m0, s31, 121856
    v_mfma_f32_16x16x32_bf16 v[44:47], v[140:143], v[96:99], v[44:47]
    v_mfma_f32_16x16x32_bf16 v[44:47], v[144:147], v[100:103], v[44:47]
    buffer_load_dwordx4 v251, s[32:35], 0 offen sc1 lds
    v_mfma_f32_16x16x32_bf16 v[48:51], v[120:123], v[80:83], v[48:51]
    v_mfma_f32_16x16x32_bf16 v[48:51], v[124:127], v[84:87], v[48:51]
    s_mov_b32 m0, 125952
    v_mfma_f32_16x16x32_bf16 v[48:51], v[128:131], v[88:91], v[48:51]
    ds_read_b128 v[80:83], v8 offset:52992
    v_mfma_f32_16x16x32_bf16 v[48:51], v[132:135], v[92:95], v[48:51]
    s_mov_b64 exec, s[62:63]
    buffer_load_dwordx4 v252, s[32:35], 0 offen sc1 lds
    s_mov_b64 exec, -1
    v_mfma_f32_16x16x32_bf16 v[48:51], v[136:139], v[96:99], v[48:51]
    v_mfma_f32_16x16x32_bf16 v[48:51], v[140:143], v[100:103], v[48:51]
    v_mfma_f32_16x16x32_bf16 v[48:51], v[144:147], v[104:107], v[48:51]
    v_mfma_f32_16x16x32_bf16 v[52:55], v[120:123], v[84:87], v[52:55]
    v_mfma_f32_16x16x32_bf16 v[52:55], v[124:127], v[88:91], v[52:55]
    ds_read_b128 v[84:87], v9 offset:52992
    s_mov_b32 s48, 32768
    v_mfma_f32_16x16x32_bf16 v[52:55], v[128:131], v[92:95], v[52:55]
    buffer_load_dwordx4 v[120:123], v23, s[40:43], s48 offen offset:0 sc1
    v_mfma_f32_16x16x32_bf16 v[52:55], v[132:135], v[96:99], v[52:55]
    v_mfma_f32_16x16x32_bf16 v[52:55], v[136:139], v[100:103], v[52:55]
    buffer_load_dwordx4 v[124:127], v23, s[40:43], s48 offen offset:1024 sc1
    v_mfma_f32_16x16x32_bf16 v[52:55], v[140:143], v[104:107], v[52:55]
    v_mfma_f32_16x16x32_bf16 v[52:55], v[144:147], v[108:111], v[52:55]
    s_waitcnt lgkmcnt(1)
    v_mfma_f32_16x16x32_bf16 v[24:27], v[152:155], v[56:59], v[24:27]
    ds_read_b128 v[88:91], v10 offset:52224
    v_mfma_f32_16x16x32_bf16 v[24:27], v[156:159], v[60:63], v[24:27]
    buffer_load_dwordx4 v[128:131], v23, s[40:43], s48 offen offset:2048 sc1
    v_mfma_f32_16x16x32_bf16 v[24:27], v[160:163], v[64:67], v[24:27]
    v_mfma_f32_16x16x32_bf16 v[24:27], v[164:167], v[68:71], v[24:27]
    ds_read_b128 v[92:95], v11 offset:52224
    v_mfma_f32_16x16x32_bf16 v[24:27], v[168:171], v[72:75], v[24:27]
    v_mfma_f32_16x16x32_bf16 v[24:27], v[172:175], v[76:79], v[24:27]
    v_mfma_f32_16x16x32_bf16 v[24:27], v[176:179], v[80:83], v[24:27]
    ds_read_b128 v[96:99], v10 offset:52480
    s_waitcnt lgkmcnt(3)
    v_mfma_f32_16x16x32_bf16 v[24:27], v[180:183], v[84:87], v[24:27]
    buffer_load_dwordx4 v[132:135], v23, s[40:43], s48 offen offset:3072 sc1
    v_mfma_f32_16x16x32_bf16 v[28:31], v[152:155], v[60:63], v[28:31]
    v_mfma_f32_16x16x32_bf16 v[28:31], v[156:159], v[64:67], v[28:31]
    ds_read_b128 v[100:103], v11 offset:52480
    v_mfma_f32_16x16x32_bf16 v[28:31], v[160:163], v[68:71], v[28:31]
    v_mfma_f32_16x16x32_bf16 v[28:31], v[164:167], v[72:75], v[28:31]
    s_mov_b32 s48, 36864
    v_mfma_f32_16x16x32_bf16 v[28:31], v[168:171], v[76:79], v[28:31]
    ds_read_b128 v[104:107], v10 offset:52736
    v_mfma_f32_16x16x32_bf16 v[28:31], v[172:175], v[80:83], v[28:31]
    buffer_load_dwordx4 v[136:139], v23, s[40:43], s48 offen offset:0 sc1
    v_mfma_f32_16x16x32_bf16 v[28:31], v[176:179], v[84:87], v[28:31]
    s_waitcnt lgkmcnt(3)
    v_mfma_f32_16x16x32_bf16 v[28:31], v[180:183], v[88:91], v[28:31]
    ds_read_b128 v[108:111], v11 offset:52736
    v_mfma_f32_16x16x32_bf16 v[32:35], v[152:155], v[64:67], v[32:35]
    buffer_load_dwordx4 v[140:143], v23, s[40:43], s48 offen offset:1024 sc1
    v_mfma_f32_16x16x32_bf16 v[32:35], v[156:159], v[68:71], v[32:35]
    v_mfma_f32_16x16x32_bf16 v[32:35], v[160:163], v[72:75], v[32:35]
    ds_read_b128 v[112:115], v10 offset:52992
    v_mfma_f32_16x16x32_bf16 v[32:35], v[164:167], v[76:79], v[32:35]
    v_mfma_f32_16x16x32_bf16 v[32:35], v[168:171], v[80:83], v[32:35]
    v_mfma_f32_16x16x32_bf16 v[32:35], v[172:175], v[84:87], v[32:35]
    buffer_load_dwordx4 v[144:147], v23, s[40:43], s48 offen offset:2048 sc1
    v_mfma_f32_16x16x32_bf16 v[32:35], v[176:179], v[88:91], v[32:35]
    v_mfma_f32_16x16x32_bf16 v[32:35], v[180:183], v[92:95], v[32:35]
    v_mfma_f32_16x16x32_bf16 v[36:39], v[152:155], v[68:71], v[36:39]
    v_mfma_f32_16x16x32_bf16 v[36:39], v[156:159], v[72:75], v[36:39]
    v_mfma_f32_16x16x32_bf16 v[36:39], v[160:163], v[76:79], v[36:39]
    buffer_load_dwordx4 v[148:151], v23, s[40:43], s48 offen offset:3072 sc1
    v_mfma_f32_16x16x32_bf16 v[36:39], v[164:167], v[80:83], v[36:39]
    v_mfma_f32_16x16x32_bf16 v[36:39], v[168:171], v[84:87], v[36:39]
    v_mfma_f32_16x16x32_bf16 v[36:39], v[172:175], v[88:91], v[36:39]
    v_mfma_f32_16x16x32_bf16 v[36:39], v[176:179], v[92:95], v[36:39]
    s_waitcnt lgkmcnt(0)
    v_mfma_f32_16x16x32_bf16 v[36:39], v[180:183], v[96:99], v[36:39]
    s_waitcnt vmcnt(13)
    s_barrier
    v_mfma_f32_16x16x32_bf16 v[40:43], v[152:155], v[72:75], v[40:43]
    ds_read_b128 v[56:59], v8 offset:34816
    s_add_u32 s32, s22, 4194304
    s_addc_u32 s33, s23, 0
    s_mov_b32 s34, 1024000
    s_mov_b32 s35, 0x20000
    s_add_u32 m0, s31, 92160
    v_mfma_f32_16x16x32_bf16 v[40:43], v[156:159], v[76:79], v[40:43]
    buffer_load_dwordx4 v253, s[32:35], 0 offen sc1 lds
    v_mfma_f32_16x16x32_bf16 v[40:43], v[160:163], v[80:83], v[40:43]
    ds_read_b128 v[60:63], v9 offset:34816
    v_mfma_f32_16x16x32_bf16 v[40:43], v[164:167], v[84:87], v[40:43]
    v_mfma_f32_16x16x32_bf16 v[40:43], v[168:171], v[88:91], v[40:43]
    ds_read_b128 v[64:67], v8 offset:35072
    s_add_u32 m0, s31, 96256
    v_mfma_f32_16x16x32_bf16 v[40:43], v[172:175], v[92:95], v[40:43]
    buffer_load_dwordx4 v254, s[32:35], 0 offen sc1 lds
    v_mfma_f32_16x16x32_bf16 v[40:43], v[176:179], v[96:99], v[40:43]
    v_mfma_f32_16x16x32_bf16 v[40:43], v[180:183], v[100:103], v[40:43]
    v_mfma_f32_16x16x32_bf16 v[44:47], v[152:155], v[76:79], v[44:47]
    ds_read_b128 v[68:71], v9 offset:35072
    s_add_u32 m0, s31, 100352
    v_mfma_f32_16x16x32_bf16 v[44:47], v[156:159], v[80:83], v[44:47]
    buffer_load_dwordx4 v255, s[32:35], 0 offen sc1 lds
    v_mfma_f32_16x16x32_bf16 v[44:47], v[160:163], v[84:87], v[44:47]
    ds_read_b128 v[72:75], v8 offset:35328
    v_mfma_f32_16x16x32_bf16 v[44:47], v[164:167], v[88:91], v[44:47]
    v_mfma_f32_16x16x32_bf16 v[44:47], v[168:171], v[92:95], v[44:47]
    ds_read_b128 v[76:79], v9 offset:35328
    v_mfma_f32_16x16x32_bf16 v[44:47], v[172:175], v[96:99], v[44:47]
    s_add_u32 m0, s31, 104448
    v_mfma_f32_16x16x32_bf16 v[44:47], v[176:179], v[100:103], v[44:47]
    v_mfma_f32_16x16x32_bf16 v[44:47], v[180:183], v[104:107], v[44:47]
    buffer_load_dwordx4 v116, s[32:35], 0 offen sc1 lds
    v_mfma_f32_16x16x32_bf16 v[48:51], v[152:155], v[80:83], v[48:51]
    v_mfma_f32_16x16x32_bf16 v[48:51], v[156:159], v[84:87], v[48:51]
    s_mov_b32 m0, 108544
    v_mfma_f32_16x16x32_bf16 v[48:51], v[160:163], v[88:91], v[48:51]
    ds_read_b128 v[80:83], v8 offset:35584
    v_mfma_f32_16x16x32_bf16 v[48:51], v[164:167], v[92:95], v[48:51]
    s_mov_b64 exec, s[62:63]
    buffer_load_dwordx4 v117, s[32:35], 0 offen sc1 lds
    s_mov_b64 exec, -1
    v_mfma_f32_16x16x32_bf16 v[48:51], v[168:171], v[96:99], v[48:51]
    v_mfma_f32_16x16x32_bf16 v[48:51], v[172:175], v[100:103], v[48:51]
    v_mfma_f32_16x16x32_bf16 v[48:51], v[176:179], v[104:107], v[48:51]
    v_mfma_f32_16x16x32_bf16 v[48:51], v[180:183], v[108:111], v[48:51]
    v_mfma_f32_16x16x32_bf16 v[52:55], v[152:155], v[84:87], v[52:55]
    v_mfma_f32_16x16x32_bf16 v[52:55], v[156:159], v[88:91], v[52:55]
    ds_read_b128 v[84:87], v9 offset:35584
    s_mov_b32 s48, 8192
    v_mfma_f32_16x16x32_bf16 v[52:55], v[160:163], v[92:95], v[52:55]
    buffer_load_dwordx4 v[152:155], v23, s[40:43], s48 offen offset:0 sc1
    v_mfma_f32_16x16x32_bf16 v[52:55], v[164:167], v[96:99], v[52:55]
    v_mfma_f32_16x16x32_bf16 v[52:55], v[168:171], v[100:103], v[52:55]
    buffer_load_dwordx4 v[156:159], v23, s[40:43], s48 offen offset:1024 sc1
    v_mfma_f32_16x16x32_bf16 v[52:55], v[172:175], v[104:107], v[52:55]
    v_mfma_f32_16x16x32_bf16 v[52:55], v[176:179], v[108:111], v[52:55]
    v_mfma_f32_16x16x32_bf16 v[52:55], v[180:183], v[112:115], v[52:55]
    s_waitcnt lgkmcnt(1)
    v_mfma_f32_16x16x32_bf16 v[24:27], v[184:187], v[56:59], v[24:27]
    ds_read_b128 v[88:91], v10 offset:34816
    v_mfma_f32_16x16x32_bf16 v[24:27], v[188:191], v[60:63], v[24:27]
    buffer_load_dwordx4 v[160:163], v23, s[40:43], s48 offen offset:2048 sc1
    v_mfma_f32_16x16x32_bf16 v[24:27], v[192:195], v[64:67], v[24:27]
    v_mfma_f32_16x16x32_bf16 v[24:27], v[196:199], v[68:71], v[24:27]
    ds_read_b128 v[92:95], v11 offset:34816
    v_mfma_f32_16x16x32_bf16 v[24:27], v[200:203], v[72:75], v[24:27]
    v_mfma_f32_16x16x32_bf16 v[24:27], v[204:207], v[76:79], v[24:27]
    buffer_load_dwordx4 v[164:167], v23, s[40:43], s48 offen offset:3072 sc1
    v_mfma_f32_16x16x32_bf16 v[24:27], v[208:211], v[80:83], v[24:27]
    ds_read_b128 v[96:99], v10 offset:35072
    v_mfma_f32_16x16x32_bf16 v[28:31], v[184:187], v[60:63], v[28:31]
    v_mfma_f32_16x16x32_bf16 v[28:31], v[188:191], v[64:67], v[28:31]
    v_mfma_f32_16x16x32_bf16 v[28:31], v[192:195], v[68:71], v[28:31]
    ds_read_b128 v[100:103], v11 offset:35072
    s_mov_b32 s48, 12288
    v_mfma_f32_16x16x32_bf16 v[28:31], v[196:199], v[72:75], v[28:31]
    buffer_load_dwordx4 v[168:171], v23, s[40:43], s48 offen offset:0 sc1
    v_mfma_f32_16x16x32_bf16 v[28:31], v[200:203], v[76:79], v[28:31]
    v_mfma_f32_16x16x32_bf16 v[28:31], v[204:207], v[80:83], v[28:31]
    ds_read_b128 v[104:107], v10 offset:35328
    s_waitcnt lgkmcnt(4)
    v_mfma_f32_16x16x32_bf16 v[28:31], v[208:211], v[84:87], v[28:31]
    buffer_load_dwordx4 v[172:175], v23, s[40:43], s48 offen offset:1024 sc1
    v_mfma_f32_16x16x32_bf16 v[32:35], v[184:187], v[64:67], v[32:35]
    v_mfma_f32_16x16x32_bf16 v[32:35], v[188:191], v[68:71], v[32:35]
    ds_read_b128 v[108:111], v11 offset:35328
    v_mfma_f32_16x16x32_bf16 v[32:35], v[192:195], v[72:75], v[32:35]
    v_mfma_f32_16x16x32_bf16 v[32:35], v[196:199], v[76:79], v[32:35]
    buffer_load_dwordx4 v[176:179], v23, s[40:43], s48 offen offset:2048 sc1
    v_mfma_f32_16x16x32_bf16 v[32:35], v[200:203], v[80:83], v[32:35]
    v_mfma_f32_16x16x32_bf16 v[32:35], v[204:207], v[84:87], v[32:35]
    v_mfma_f32_16x16x32_bf16 v[32:35], v[208:211], v[88:91], v[32:35]
    v_mfma_f32_16x16x32_bf16 v[36:39], v[184:187], v[68:71], v[36:39]
    v_mfma_f32_16x16x32_bf16 v[36:39], v[188:191], v[72:75], v[36:39]
    v_mfma_f32_16x16x32_bf16 v[36:39], v[192:195], v[76:79], v[36:39]
    v_mfma_f32_16x16x32_bf16 v[36:39], v[196:199], v[80:83], v[36:39]
    v_mfma_f32_16x16x32_bf16 v[36:39], v[200:203], v[84:87], v[36:39]
    v_mfma_f32_16x16x32_bf16 v[36:39], v[204:207], v[88:91], v[36:39]
    s_waitcnt lgkmcnt(0)
    v_mfma_f32_16x16x32_bf16 v[36:39], v[208:211], v[92:95], v[36:39]
    s_waitcnt vmcnt(12)
    s_barrier
    v_mfma_f32_16x16x32_bf16 v[40:43], v[184:187], v[72:75], v[40:43]
    ds_read_b128 v[56:59], v8 offset:17408
    s_add_u32 m0, s31, 144384
    v_mfma_f32_16x16x32_bf16 v[40:43], v[188:191], v[76:79], v[40:43]
    buffer_load_dwordx4 v248, s[32:35], 0 offen sc1 lds
    v_mfma_f32_16x16x32_bf16 v[40:43], v[192:195], v[80:83], v[40:43]
    ds_read_b128 v[60:63], v9 offset:17408
    v_mfma_f32_16x16x32_bf16 v[40:43], v[196:199], v[84:87], v[40:43]
    s_add_u32 m0, s31, 148480
    v_mfma_f32_16x16x32_bf16 v[40:43], v[200:203], v[88:91], v[40:43]
    ds_read_b128 v[64:67], v8 offset:17664
    v_mfma_f32_16x16x32_bf16 v[40:43], v[204:207], v[92:95], v[40:43]
    v_mfma_f32_16x16x32_bf16 v[40:43], v[208:211], v[96:99], v[40:43]
    buffer_load_dwordx4 v249, s[32:35], 0 offen sc1 lds
    v_mfma_f32_16x16x32_bf16 v[44:47], v[184:187], v[76:79], v[44:47]
    ds_read_b128 v[68:71], v9 offset:17664
    s_add_u32 m0, s31, 152576
    v_mfma_f32_16x16x32_bf16 v[44:47], v[188:191], v[80:83], v[44:47]
    buffer_load_dwordx4 v250, s[32:35], 0 offen sc1 lds
    v_mfma_f32_16x16x32_bf16 v[44:47], v[192:195], v[84:87], v[44:47]
    ds_read_b128 v[72:75], v8 offset:17920
    v_mfma_f32_16x16x32_bf16 v[44:47], v[196:199], v[88:91], v[44:47]
    v_mfma_f32_16x16x32_bf16 v[44:47], v[200:203], v[92:95], v[44:47]
    ds_read_b128 v[76:79], v9 offset:17920
    s_add_u32 m0, s31, 156672
    v_mfma_f32_16x16x32_bf16 v[44:47], v[204:207], v[96:99], v[44:47]
    v_mfma_f32_16x16x32_bf16 v[44:47], v[208:211], v[100:103], v[44:47]
    buffer_load_dwordx4 v251, s[32:35], 0 offen sc1 lds
    v_mfma_f32_16x16x32_bf16 v[48:51], v[184:187], v[80:83], v[48:51]
    v_mfma_f32_16x16x32_bf16 v[48:51], v[188:191], v[84:87], v[48:51]
    s_mov_b32 m0, 160768
    v_mfma_f32_16x16x32_bf16 v[48:51], v[192:195], v[88:91], v[48:51]
    ds_read_b128 v[80:83], v8 offset:18176
    v_mfma_f32_16x16x32_bf16 v[48:51], v[196:199], v[92:95], v[48:51]
    s_mov_b64 exec, s[62:63]
    buffer_load_dwordx4 v252, s[32:35], 0 offen sc1 lds
    s_mov_b64 exec, -1
    v_mfma_f32_16x16x32_bf16 v[48:51], v[200:203], v[96:99], v[48:51]
    v_mfma_f32_16x16x32_bf16 v[48:51], v[204:207], v[100:103], v[48:51]
    v_mfma_f32_16x16x32_bf16 v[48:51], v[208:211], v[104:107], v[48:51]
    v_mfma_f32_16x16x32_bf16 v[52:55], v[184:187], v[84:87], v[52:55]
    v_mfma_f32_16x16x32_bf16 v[52:55], v[188:191], v[88:91], v[52:55]
    ds_read_b128 v[84:87], v9 offset:18176
    s_mov_b32 s48, 0
    v_mfma_f32_16x16x32_bf16 v[52:55], v[192:195], v[92:95], v[52:55]
    buffer_load_dwordx4 v[184:187], v23, s[40:43], s48 offen offset:0 sc1
    v_mfma_f32_16x16x32_bf16 v[52:55], v[196:199], v[96:99], v[52:55]
    v_mfma_f32_16x16x32_bf16 v[52:55], v[200:203], v[100:103], v[52:55]
    buffer_load_dwordx4 v[188:191], v23, s[40:43], s48 offen offset:1024 sc1
    v_mfma_f32_16x16x32_bf16 v[52:55], v[204:207], v[104:107], v[52:55]
    v_mfma_f32_16x16x32_bf16 v[52:55], v[208:211], v[108:111], v[52:55]
    s_waitcnt lgkmcnt(1)
    v_mfma_f32_16x16x32_bf16 v[24:27], v[120:123], v[56:59], v[24:27]
    ds_read_b128 v[88:91], v10 offset:17408
    v_mfma_f32_16x16x32_bf16 v[24:27], v[124:127], v[60:63], v[24:27]
    buffer_load_dwordx4 v[192:195], v23, s[40:43], s48 offen offset:2048 sc1
    v_mfma_f32_16x16x32_bf16 v[24:27], v[128:131], v[64:67], v[24:27]
    v_mfma_f32_16x16x32_bf16 v[24:27], v[132:135], v[68:71], v[24:27]
    ds_read_b128 v[92:95], v11 offset:17408
    v_mfma_f32_16x16x32_bf16 v[24:27], v[136:139], v[72:75], v[24:27]
    v_mfma_f32_16x16x32_bf16 v[24:27], v[140:143], v[76:79], v[24:27]
    v_mfma_f32_16x16x32_bf16 v[24:27], v[144:147], v[80:83], v[24:27]
    ds_read_b128 v[96:99], v10 offset:17664
    s_waitcnt lgkmcnt(3)
    v_mfma_f32_16x16x32_bf16 v[24:27], v[148:151], v[84:87], v[24:27]
    buffer_load_dwordx4 v[196:199], v23, s[40:43], s48 offen offset:3072 sc1
    v_mfma_f32_16x16x32_bf16 v[28:31], v[120:123], v[60:63], v[28:31]
    v_mfma_f32_16x16x32_bf16 v[28:31], v[124:127], v[64:67], v[28:31]
    ds_read_b128 v[100:103], v11 offset:17664
    v_mfma_f32_16x16x32_bf16 v[28:31], v[128:131], v[68:71], v[28:31]
    v_mfma_f32_16x16x32_bf16 v[28:31], v[132:135], v[72:75], v[28:31]
    s_mov_b32 s48, 4096
    v_mfma_f32_16x16x32_bf16 v[28:31], v[136:139], v[76:79], v[28:31]
    ds_read_b128 v[104:107], v10 offset:17920
    v_mfma_f32_16x16x32_bf16 v[28:31], v[140:143], v[80:83], v[28:31]
    buffer_load_dwordx4 v[200:203], v23, s[40:43], s48 offen offset:0 sc1
    v_mfma_f32_16x16x32_bf16 v[28:31], v[144:147], v[84:87], v[28:31]
    s_waitcnt lgkmcnt(3)
    v_mfma_f32_16x16x32_bf16 v[28:31], v[148:151], v[88:91], v[28:31]
    ds_read_b128 v[108:111], v11 offset:17920
    v_mfma_f32_16x16x32_bf16 v[32:35], v[120:123], v[64:67], v[32:35]
    buffer_load_dwordx4 v[204:207], v23, s[40:43], s48 offen offset:1024 sc1
    v_mfma_f32_16x16x32_bf16 v[32:35], v[124:127], v[68:71], v[32:35]
    v_mfma_f32_16x16x32_bf16 v[32:35], v[128:131], v[72:75], v[32:35]
    ds_read_b128 v[112:115], v10 offset:18176
    v_mfma_f32_16x16x32_bf16 v[32:35], v[132:135], v[76:79], v[32:35]
    v_mfma_f32_16x16x32_bf16 v[32:35], v[136:139], v[80:83], v[32:35]
    v_mfma_f32_16x16x32_bf16 v[32:35], v[140:143], v[84:87], v[32:35]
    buffer_load_dwordx4 v[208:211], v23, s[40:43], s48 offen offset:2048 sc1
    v_mfma_f32_16x16x32_bf16 v[32:35], v[144:147], v[88:91], v[32:35]
    v_mfma_f32_16x16x32_bf16 v[32:35], v[148:151], v[92:95], v[32:35]
    v_mfma_f32_16x16x32_bf16 v[36:39], v[120:123], v[68:71], v[36:39]
    v_mfma_f32_16x16x32_bf16 v[36:39], v[124:127], v[72:75], v[36:39]
    v_mfma_f32_16x16x32_bf16 v[36:39], v[128:131], v[76:79], v[36:39]
    buffer_load_dwordx4 v[212:215], v23, s[40:43], s48 offen offset:3072 sc1
    v_mfma_f32_16x16x32_bf16 v[36:39], v[132:135], v[80:83], v[36:39]
    v_mfma_f32_16x16x32_bf16 v[36:39], v[136:139], v[84:87], v[36:39]
    v_mfma_f32_16x16x32_bf16 v[36:39], v[140:143], v[88:91], v[36:39]
    v_mfma_f32_16x16x32_bf16 v[36:39], v[144:147], v[92:95], v[36:39]
    s_waitcnt lgkmcnt(0)
    v_mfma_f32_16x16x32_bf16 v[36:39], v[148:151], v[96:99], v[36:39]
    s_waitcnt vmcnt(13)
    s_barrier
    v_mfma_f32_16x16x32_bf16 v[40:43], v[120:123], v[72:75], v[40:43]
    ds_read_b128 v[56:59], v8 offset:0
    v_mfma_f32_16x16x32_bf16 v[40:43], v[124:127], v[76:79], v[40:43]
    v_mfma_f32_16x16x32_bf16 v[40:43], v[128:131], v[80:83], v[40:43]
    ds_read_b128 v[60:63], v9 offset:0
    v_mfma_f32_16x16x32_bf16 v[40:43], v[132:135], v[84:87], v[40:43]
    v_mfma_f32_16x16x32_bf16 v[40:43], v[136:139], v[88:91], v[40:43]
    ds_read_b128 v[64:67], v8 offset:256
    v_mfma_f32_16x16x32_bf16 v[40:43], v[140:143], v[92:95], v[40:43]
    v_mfma_f32_16x16x32_bf16 v[40:43], v[144:147], v[96:99], v[40:43]
    v_mfma_f32_16x16x32_bf16 v[40:43], v[148:151], v[100:103], v[40:43]
    v_mfma_f32_16x16x32_bf16 v[44:47], v[120:123], v[76:79], v[44:47]
    ds_read_b128 v[68:71], v9 offset:256
    v_mfma_f32_16x16x32_bf16 v[44:47], v[124:127], v[80:83], v[44:47]
    v_mfma_f32_16x16x32_bf16 v[44:47], v[128:131], v[84:87], v[44:47]
    ds_read_b128 v[72:75], v8 offset:512
    v_mfma_f32_16x16x32_bf16 v[44:47], v[132:135], v[88:91], v[44:47]
    v_mfma_f32_16x16x32_bf16 v[44:47], v[136:139], v[92:95], v[44:47]
    ds_read_b128 v[76:79], v9 offset:512
    v_mfma_f32_16x16x32_bf16 v[44:47], v[140:143], v[96:99], v[44:47]
    v_mfma_f32_16x16x32_bf16 v[44:47], v[144:147], v[100:103], v[44:47]
    v_mfma_f32_16x16x32_bf16 v[44:47], v[148:151], v[104:107], v[44:47]
    v_mfma_f32_16x16x32_bf16 v[48:51], v[120:123], v[80:83], v[48:51]
    v_mfma_f32_16x16x32_bf16 v[48:51], v[124:127], v[84:87], v[48:51]
    v_mfma_f32_16x16x32_bf16 v[48:51], v[128:131], v[88:91], v[48:51]
    ds_read_b128 v[80:83], v8 offset:768
    v_mfma_f32_16x16x32_bf16 v[48:51], v[132:135], v[92:95], v[48:51]
    v_mfma_f32_16x16x32_bf16 v[48:51], v[136:139], v[96:99], v[48:51]
    v_mfma_f32_16x16x32_bf16 v[48:51], v[140:143], v[100:103], v[48:51]
    v_mfma_f32_16x16x32_bf16 v[48:51], v[144:147], v[104:107], v[48:51]
    v_mfma_f32_16x16x32_bf16 v[48:51], v[148:151], v[108:111], v[48:51]
    v_mfma_f32_16x16x32_bf16 v[52:55], v[120:123], v[84:87], v[52:55]
    v_mfma_f32_16x16x32_bf16 v[52:55], v[124:127], v[88:91], v[52:55]
    ds_read_b128 v[84:87], v9 offset:768
    s_mov_b32 s49, 8192
    v_mfma_f32_16x16x32_bf16 v[52:55], v[128:131], v[92:95], v[52:55]
    buffer_load_dwordx4 v[120:123], v2, s[40:43], s49 offen offset:0 sc1
    v_mfma_f32_16x16x32_bf16 v[52:55], v[132:135], v[96:99], v[52:55]
    v_mfma_f32_16x16x32_bf16 v[52:55], v[136:139], v[100:103], v[52:55]
    buffer_load_dwordx4 v[124:127], v2, s[40:43], s49 offen offset:1024 sc1
    v_mfma_f32_16x16x32_bf16 v[52:55], v[140:143], v[104:107], v[52:55]
    v_mfma_f32_16x16x32_bf16 v[52:55], v[144:147], v[108:111], v[52:55]
    v_mfma_f32_16x16x32_bf16 v[52:55], v[148:151], v[112:115], v[52:55]
    s_waitcnt lgkmcnt(1)
    v_mfma_f32_16x16x32_bf16 v[24:27], v[152:155], v[56:59], v[24:27]
    ds_read_b128 v[88:91], v10 offset:0
    v_mfma_f32_16x16x32_bf16 v[24:27], v[156:159], v[60:63], v[24:27]
    buffer_load_dwordx4 v[128:131], v2, s[40:43], s49 offen offset:2048 sc1
    v_mfma_f32_16x16x32_bf16 v[24:27], v[160:163], v[64:67], v[24:27]
    v_mfma_f32_16x16x32_bf16 v[24:27], v[164:167], v[68:71], v[24:27]
    ds_read_b128 v[92:95], v11 offset:0
    v_mfma_f32_16x16x32_bf16 v[24:27], v[168:171], v[72:75], v[24:27]
    v_mfma_f32_16x16x32_bf16 v[24:27], v[172:175], v[76:79], v[24:27]
    buffer_load_dwordx4 v[132:135], v2, s[40:43], s49 offen offset:3072 sc1
    v_mfma_f32_16x16x32_bf16 v[24:27], v[176:179], v[80:83], v[24:27]
    ds_read_b128 v[96:99], v10 offset:256
    v_mfma_f32_16x16x32_bf16 v[28:31], v[152:155], v[60:63], v[28:31]
    s_mov_b32 s32, s18
    s_mov_b32 s33, s19
    s_mov_b32 s34, 16384000
    s_mov_b32 s35, 0x20000
    v_mfma_f32_16x16x32_bf16 v[28:31], v[156:159], v[64:67], v[28:31]
    v_mfma_f32_16x16x32_bf16 v[28:31], v[160:163], v[68:71], v[28:31]
    ds_read_b128 v[100:103], v11 offset:256
    s_mov_b32 s49, 12288
    v_mfma_f32_16x16x32_bf16 v[28:31], v[164:167], v[72:75], v[28:31]
    buffer_load_dwordx4 v[136:139], v2, s[40:43], s49 offen offset:0 sc1
    v_mfma_f32_16x16x32_bf16 v[28:31], v[168:171], v[76:79], v[28:31]
    v_mfma_f32_16x16x32_bf16 v[28:31], v[172:175], v[80:83], v[28:31]
    ds_read_b128 v[104:107], v10 offset:512
    s_waitcnt lgkmcnt(4)
    v_mfma_f32_16x16x32_bf16 v[28:31], v[176:179], v[84:87], v[28:31]
    buffer_load_dwordx4 v[140:143], v2, s[40:43], s49 offen offset:1024 sc1
    v_mfma_f32_16x16x32_bf16 v[32:35], v[152:155], v[64:67], v[32:35]
    s_add_u32 s36, s18, 16384000
    s_addc_u32 s37, s19, 0
    s_mov_b32 s38, 16384000
    s_mov_b32 s39, 0x20000
    v_mfma_f32_16x16x32_bf16 v[32:35], v[156:159], v[68:71], v[32:35]
    ds_read_b128 v[108:111], v11 offset:512
    v_mfma_f32_16x16x32_bf16 v[32:35], v[160:163], v[72:75], v[32:35]
    v_mfma_f32_16x16x32_bf16 v[32:35], v[164:167], v[76:79], v[32:35]
    buffer_load_dwordx4 v[144:147], v2, s[40:43], s49 offen offset:2048 sc1
    v_mfma_f32_16x16x32_bf16 v[32:35], v[168:171], v[80:83], v[32:35]
    v_mfma_f32_16x16x32_bf16 v[32:35], v[172:175], v[84:87], v[32:35]
    v_mfma_f32_16x16x32_bf16 v[32:35], v[176:179], v[88:91], v[32:35]
    v_mfma_f32_16x16x32_bf16 v[36:39], v[152:155], v[68:71], v[36:39]
    buffer_load_dwordx4 v[148:151], v2, s[40:43], s49 offen offset:3072 sc1
    v_mfma_f32_16x16x32_bf16 v[36:39], v[156:159], v[72:75], v[36:39]
    v_mfma_f32_16x16x32_bf16 v[36:39], v[160:163], v[76:79], v[36:39]
    v_mfma_f32_16x16x32_bf16 v[36:39], v[164:167], v[80:83], v[36:39]
    v_mfma_f32_16x16x32_bf16 v[36:39], v[168:171], v[84:87], v[36:39]
    v_mfma_f32_16x16x32_bf16 v[36:39], v[172:175], v[88:91], v[36:39]
    s_waitcnt lgkmcnt(0)
    v_mfma_f32_16x16x32_bf16 v[36:39], v[176:179], v[92:95], v[36:39]
    s_waitcnt vmcnt(8)
    s_barrier
    v_mfma_f32_16x16x32_bf16 v[40:43], v[152:155], v[72:75], v[40:43]
    ds_read_b128 v[56:59], v8 offset:52224
    v_mfma_f32_16x16x32_bf16 v[40:43], v[156:159], v[76:79], v[40:43]
    s_mov_b32 s50, 24576
    v_mfma_f32_16x16x32_bf16 v[40:43], v[160:163], v[80:83], v[40:43]
    ds_read_b128 v[60:63], v9 offset:52224
    v_mfma_f32_16x16x32_bf16 v[40:43], v[164:167], v[84:87], v[40:43]
    buffer_load_dwordx4 v[12:15], v2, s[40:43], s50 offen offset:0 sc1
    v_mfma_f32_16x16x32_bf16 v[40:43], v[168:171], v[88:91], v[40:43]
    ds_read_b128 v[64:67], v8 offset:52480
    v_mfma_f32_16x16x32_bf16 v[40:43], v[172:175], v[92:95], v[40:43]
    s_mov_b32 s50, 24576
    v_mfma_f32_16x16x32_bf16 v[40:43], v[176:179], v[96:99], v[40:43]
    buffer_load_dwordx4 v[16:19], v2, s[40:43], s50 offen offset:1024 sc1
    v_mfma_f32_16x16x32_bf16 v[44:47], v[152:155], v[76:79], v[44:47]
    ds_read_b128 v[68:71], v9 offset:52480
    v_mfma_f32_16x16x32_bf16 v[44:47], v[156:159], v[80:83], v[44:47]
    v_mfma_f32_16x16x32_bf16 v[44:47], v[160:163], v[84:87], v[44:47]
    ds_read_b128 v[72:75], v8 offset:52736
    s_mov_b32 s50, 24576
    v_mfma_f32_16x16x32_bf16 v[44:47], v[164:167], v[88:91], v[44:47]
    buffer_load_dwordx4 v[20:23], v2, s[40:43], s50 offen offset:2048 sc1
    v_mfma_f32_16x16x32_bf16 v[44:47], v[168:171], v[92:95], v[44:47]
    ds_read_b128 v[76:79], v9 offset:52736
    v_mfma_f32_16x16x32_bf16 v[44:47], v[172:175], v[96:99], v[44:47]
    v_mfma_f32_16x16x32_bf16 v[44:47], v[176:179], v[100:103], v[44:47]
    s_mov_b32 s50, 24576
    v_mfma_f32_16x16x32_bf16 v[48:51], v[152:155], v[80:83], v[48:51]
    buffer_load_dwordx4 v[248:251], v2, s[40:43], s50 offen offset:3072 sc1
    v_mfma_f32_16x16x32_bf16 v[48:51], v[156:159], v[84:87], v[48:51]
    v_mfma_f32_16x16x32_bf16 v[48:51], v[160:163], v[88:91], v[48:51]
    ds_read_b128 v[80:83], v8 offset:52992
    v_mfma_f32_16x16x32_bf16 v[48:51], v[164:167], v[92:95], v[48:51]
    s_mov_b32 s50, 28672
    v_mfma_f32_16x16x32_bf16 v[48:51], v[168:171], v[96:99], v[48:51]
    buffer_load_dwordx4 v[252:255], v2, s[40:43], s50 offen offset:0 sc1
    v_mfma_f32_16x16x32_bf16 v[48:51], v[172:175], v[100:103], v[48:51]
    v_mfma_f32_16x16x32_bf16 v[48:51], v[176:179], v[104:107], v[48:51]
    v_mfma_f32_16x16x32_bf16 v[52:55], v[152:155], v[84:87], v[52:55]
    v_mfma_f32_16x16x32_bf16 v[52:55], v[156:159], v[88:91], v[52:55]
    ds_read_b128 v[84:87], v9 offset:52992
    s_mov_b32 s49, 16384
    v_mfma_f32_16x16x32_bf16 v[52:55], v[160:163], v[92:95], v[52:55]
    buffer_load_dwordx4 v[152:155], v2, s[40:43], s49 offen offset:0 sc1
    v_mfma_f32_16x16x32_bf16 v[52:55], v[164:167], v[96:99], v[52:55]
    v_mfma_f32_16x16x32_bf16 v[52:55], v[168:171], v[100:103], v[52:55]
    buffer_load_dwordx4 v[156:159], v2, s[40:43], s49 offen offset:1024 sc1
    v_mfma_f32_16x16x32_bf16 v[52:55], v[172:175], v[104:107], v[52:55]
    v_mfma_f32_16x16x32_bf16 v[52:55], v[176:179], v[108:111], v[52:55]
    s_waitcnt lgkmcnt(1)
    v_mfma_f32_16x16x32_bf16 v[24:27], v[184:187], v[56:59], v[24:27]
    ds_read_b128 v[88:91], v10 offset:52224
    v_mfma_f32_16x16x32_bf16 v[24:27], v[188:191], v[60:63], v[24:27]
    buffer_load_dwordx4 v[160:163], v2, s[40:43], s49 offen offset:2048 sc1
    v_mfma_f32_16x16x32_bf16 v[24:27], v[192:195], v[64:67], v[24:27]
L_pg9:
    s_cbranch_execz L_pb9
    v_mfma_f32_16x16x32_bf16 v[24:27], v[196:199], v[68:71], v[24:27]
    ds_read_b128 v[92:95], v11 offset:52224
    v_mfma_f32_16x16x32_bf16 v[24:27], v[200:203], v[72:75], v[24:27]
    v_mfma_f32_16x16x32_bf16 v[24:27], v[204:207], v[76:79], v[24:27]
    v_mfma_f32_16x16x32_bf16 v[24:27], v[208:211], v[80:83], v[24:27]
    ds_read_b128 v[96:99], v10 offset:52480
    s_waitcnt lgkmcnt(3)
    v_mfma_f32_16x16x32_bf16 v[24:27], v[212:215], v[84:87], v[24:27]
    buffer_load_dwordx4 v[164:167], v2, s[40:43], s49 offen offset:3072 sc1
    v_mfma_f32_16x16x32_bf16 v[28:31], v[184:187], v[60:63], v[28:31]
    v_mfma_f32_16x16x32_bf16 v[28:31], v[188:191], v[64:67], v[28:31]
    ds_read_b128 v[100:103], v11 offset:52480
    v_mfma_f32_16x16x32_bf16 v[28:31], v[192:195], v[68:71], v[28:31]
    v_mfma_f32_16x16x32_bf16 v[28:31], v[196:199], v[72:75], v[28:31]
    s_mov_b32 s49, 20480
    v_mfma_f32_16x16x32_bf16 v[28:31], v[200:203], v[76:79], v[28:31]
    ds_read_b128 v[104:107], v10 offset:52736
    v_mfma_f32_16x16x32_bf16 v[28:31], v[204:207], v[80:83], v[28:31]
    buffer_load_dwordx4 v[168:171], v2, s[40:43], s49 offen offset:0 sc1
    v_mfma_f32_16x16x32_bf16 v[28:31], v[208:211], v[84:87], v[28:31]
    s_waitcnt lgkmcnt(3)
    v_mfma_f32_16x16x32_bf16 v[28:31], v[212:215], v[88:91], v[28:31]
    ds_read_b128 v[108:111], v11 offset:52736
    v_mfma_f32_16x16x32_bf16 v[32:35], v[184:187], v[64:67], v[32:35]
    buffer_load_dwordx4 v[172:175], v2, s[40:43], s49 offen offset:1024 sc1
    v_mfma_f32_16x16x32_bf16 v[32:35], v[188:191], v[68:71], v[32:35]
    ds_write_b128 v1, v[24:27] offset:28672
    v_mfma_f32_16x16x32_bf16 v[32:35], v[192:195], v[72:75], v[32:35]
    ds_read_b128 v[112:115], v10 offset:52992
    v_mfma_f32_16x16x32_bf16 v[32:35], v[196:199], v[76:79], v[32:35]
    v_mfma_f32_16x16x32_bf16 v[32:35], v[200:203], v[80:83], v[32:35]
    v_mfma_f32_16x16x32_bf16 v[32:35], v[204:207], v[84:87], v[32:35]
    buffer_load_dwordx4 v[176:179], v2, s[40:43], s49 offen offset:2048 sc1
    v_mfma_f32_16x16x32_bf16 v[32:35], v[208:211], v[88:91], v[32:35]
    v_mfma_f32_16x16x32_bf16 v[32:35], v[212:215], v[92:95], v[32:35]
    v_mfma_f32_16x16x32_bf16 v[36:39], v[184:187], v[68:71], v[36:39]
    v_mfma_f32_16x16x32_bf16 v[36:39], v[188:191], v[72:75], v[36:39]
    ds_write_b128 v1, v[28:31] offset:30752
    v_mfma_f32_16x16x32_bf16 v[36:39], v[192:195], v[76:79], v[36:39]
    buffer_load_dwordx4 v[180:183], v2, s[40:43], s49 offen offset:3072 sc1
    v_mfma_f32_16x16x32_bf16 v[36:39], v[196:199], v[80:83], v[36:39]
    v_mfma_f32_16x16x32_bf16 v[36:39], v[200:203], v[84:87], v[36:39]
    v_mfma_f32_16x16x32_bf16 v[36:39], v[204:207], v[88:91], v[36:39]
    v_mfma_f32_16x16x32_bf16 v[36:39], v[208:211], v[92:95], v[36:39]
    s_waitcnt lgkmcnt(1)
    v_mfma_f32_16x16x32_bf16 v[36:39], v[212:215], v[96:99], v[36:39]
    s_nop 0
    ds_write_b128 v1, v[32:35] offset:32832
    v_mfma_f32_16x16x32_bf16 v[40:43], v[184:187], v[72:75], v[40:43]
    v_mfma_f32_16x16x32_bf16 v[40:43], v[188:191], v[76:79], v[40:43]
    v_mfma_f32_16x16x32_bf16 v[40:43], v[192:195], v[80:83], v[40:43]
    v_mfma_f32_16x16x32_bf16 v[40:43], v[196:199], v[84:87], v[40:43]
    v_mfma_f32_16x16x32_bf16 v[40:43], v[200:203], v[88:91], v[40:43]
    v_mfma_f32_16x16x32_bf16 v[40:43], v[204:207], v[92:95], v[40:43]
    v_mfma_f32_16x16x32_bf16 v[40:43], v[208:211], v[96:99], v[40:43]
    v_mfma_f32_16x16x32_bf16 v[40:43], v[212:215], v[100:103], v[40:43]
    s_nop 0
    ds_write_b128 v1, v[36:39] offset:34912
    v_mfma_f32_16x16x32_bf16 v[44:47], v[184:187], v[76:79], v[44:47]
    v_mfma_f32_16x16x32_bf16 v[44:47], v[188:191], v[80:83], v[44:47]
    s_waitcnt lgkmcnt(0)
    s_barrier
    v_mfma_f32_16x16x32_bf16 v[44:47], v[192:195], v[84:87], v[44:47]
    v_mfma_f32_16x16x32_bf16 v[44:47], v[196:199], v[88:91], v[44:47]
    v_mfma_f32_16x16x32_bf16 v[44:47], v[200:203], v[92:95], v[44:47]
    ds_read_b128 v[56:59], v3 offset:0
    v_mfma_f32_16x16x32_bf16 v[44:47], v[204:207], v[96:99], v[44:47]
    ds_read_b128 v[60:63], v3 offset:1024
    v_mfma_f32_16x16x32_bf16 v[44:47], v[208:211], v[100:103], v[44:47]
    ds_read_b128 v[64:67], v3 offset:2048
    v_mfma_f32_16x16x32_bf16 v[44:47], v[212:215], v[104:107], v[44:47]
    s_nop 0
    ds_write_b128 v1, v[40:43] offset:36992
    v_mfma_f32_16x16x32_bf16 v[48:51], v[184:187], v[80:83], v[48:51]
    ds_read_b128 v[68:71], v3 offset:3072
    v_mfma_f32_16x16x32_bf16 v[48:51], v[188:191], v[84:87], v[48:51]
    ds_read_b128 v[72:75], v3 offset:4096
    v_mfma_f32_16x16x32_bf16 v[48:51], v[192:195], v[88:91], v[48:51]
    ds_read_b128 v[76:79], v3 offset:5120
    v_mfma_f32_16x16x32_bf16 v[48:51], v[196:199], v[92:95], v[48:51]
    v_mfma_f32_16x16x32_bf16 v[48:51], v[200:203], v[96:99], v[48:51]
    ds_read_b128 v[80:83], v3 offset:6144
    v_mfma_f32_16x16x32_bf16 v[48:51], v[204:207], v[100:103], v[48:51]
    v_mfma_f32_16x16x32_bf16 v[48:51], v[208:211], v[104:107], v[48:51]
    v_mfma_f32_16x16x32_bf16 v[48:51], v[212:215], v[108:111], v[48:51]
    s_nop 0
    ds_write_b128 v1, v[44:47] offset:39072
    v_mfma_f32_16x16x32_bf16 v[52:55], v[184:187], v[84:87], v[52:55]
    buffer_load_dwordx4 v[184:187], v2, s[40:43], s50 offen offset:1024 sc1
    v_mfma_f32_16x16x32_bf16 v[52:55], v[188:191], v[88:91], v[52:55]
    ds_read_b128 v[84:87], v3 offset:7168
    v_mfma_f32_16x16x32_bf16 v[52:55], v[192:195], v[92:95], v[52:55]
    buffer_load_dwordx4 v[188:191], v2, s[40:43], s50 offen offset:2048 sc1
    v_mfma_f32_16x16x32_bf16 v[52:55], v[196:199], v[96:99], v[52:55]
    v_mfma_f32_16x16x32_bf16 v[52:55], v[200:203], v[100:103], v[52:55]
    buffer_load_dwordx4 v[192:195], v2, s[40:43], s50 offen offset:3072 sc1
    v_mfma_f32_16x16x32_bf16 v[52:55], v[204:207], v[104:107], v[52:55]
    v_mfma_f32_16x16x32_bf16 v[52:55], v[208:211], v[108:111], v[52:55]
    v_mfma_f32_16x16x32_bf16 v[52:55], v[212:215], v[112:115], v[52:55]
    s_nop 0
    ds_write_b128 v1, v[48:51] offset:41152
    s_nop 7
    ds_write_b128 v1, v[52:55] offset:43232
    s_setprio 2
    s_waitcnt lgkmcnt(0)
    s_barrier
    v_mfma_f32_16x16x32_bf16 v[24:27], v[56:59], v[216:219], 0
    ds_read_b128 v[88:91], v3 offset:8192
    v_mfma_f32_16x16x32_bf16 v[24:27], v[60:63], v[220:223], v[24:27]
    v_mfma_f32_16x16x32_bf16 v[24:27], v[64:67], v[224:227], v[24:27]
    ds_read_b128 v[92:95], v3 offset:9216
    v_mfma_f32_16x16x32_bf16 v[24:27], v[68:71], v[228:231], v[24:27]
    v_mfma_f32_16x16x32_bf16 v[24:27], v[72:75], v[232:235], v[24:27]
    ds_read_b128 v[96:99], v3 offset:10240
    v_mfma_f32_16x16x32_bf16 v[24:27], v[76:79], v[236:239], v[24:27]
    v_mfma_f32_16x16x32_bf16 v[24:27], v[80:83], v[240:243], v[24:27]
    ds_read_b128 v[100:103], v3 offset:11264
    v_mfma_f32_16x16x32_bf16 v[24:27], v[84:87], v[244:247], v[24:27]
    s_waitcnt vmcnt(6)
    v_mfma_f32_16x16x32_bf16 v[28:31], v[56:59], v[120:123], 0
    ds_read_b128 v[104:107], v3 offset:12288
    v_mfma_f32_16x16x32_bf16 v[28:31], v[60:63], v[124:127], v[28:31]
    v_mfma_f32_16x16x32_bf16 v[28:31], v[64:67], v[128:131], v[28:31]
    ds_read_b128 v[108:111], v3 offset:13312
    v_mfma_f32_16x16x32_bf16 v[28:31], v[68:71], v[132:135], v[28:31]
    v_mfma_f32_16x16x32_bf16 v[28:31], v[72:75], v[136:139], v[28:31]
    ds_read_b128 v[112:115], v3 offset:14336
    v_mfma_f32_16x16x32_bf16 v[28:31], v[76:79], v[140:143], v[28:31]
    v_mfma_f32_16x16x32_bf16 v[28:31], v[80:83], v[144:147], v[28:31]
    ds_read_b128 v[116:119], v3 offset:15360
    v_mfma_f32_16x16x32_bf16 v[28:31], v[84:87], v[148:151], v[28:31]
    v_mfma_f32_16x16x32_bf16 v[32:35], v[56:59], v[152:155], 0
    v_mfma_f32_16x16x32_bf16 v[32:35], v[60:63], v[156:159], v[32:35]
    v_mfma_f32_16x16x32_bf16 v[32:35], v[64:67], v[160:163], v[32:35]
    v_mfma_f32_16x16x32_bf16 v[32:35], v[68:71], v[164:167], v[32:35]
    v_mfma_f32_16x16x32_bf16 v[32:35], v[72:75], v[168:171], v[32:35]
    s_waitcnt vmcnt(3)
    v_mfma_f32_16x16x32_bf16 v[32:35], v[76:79], v[172:175], v[32:35]
    v_mfma_f32_16x16x32_bf16 v[32:35], v[80:83], v[176:179], v[32:35]
    v_mfma_f32_16x16x32_bf16 v[32:35], v[84:87], v[180:183], v[32:35]
    v_mfma_f32_16x16x32_bf16 v[36:39], v[56:59], v[12:15], 0
    v_mfma_f32_16x16x32_bf16 v[36:39], v[60:63], v[16:19], v[36:39]
    v_mfma_f32_16x16x32_bf16 v[36:39], v[64:67], v[20:23], v[36:39]
    v_mfma_f32_16x16x32_bf16 v[36:39], v[68:71], v[248:251], v[36:39]
    v_mfma_f32_16x16x32_bf16 v[36:39], v[72:75], v[252:255], v[36:39]
    s_waitcnt vmcnt(2)
    v_mfma_f32_16x16x32_bf16 v[36:39], v[76:79], v[184:187], v[36:39]
    s_waitcnt vmcnt(1)
    v_mfma_f32_16x16x32_bf16 v[36:39], v[80:83], v[188:191], v[36:39]
    s_waitcnt vmcnt(0)
    v_mfma_f32_16x16x32_bf16 v[36:39], v[84:87], v[192:195], v[36:39]
    s_waitcnt lgkmcnt(0)
    v_mfma_f32_16x16x32_bf16 v[40:43], v[88:91], v[216:219], 0
    ds_read_b128 v[56:59], v3 offset:16384
    v_mfma_f32_16x16x32_bf16 v[40:43], v[92:95], v[220:223], v[40:43]
    v_mfma_f32_16x16x32_bf16 v[40:43], v[96:99], v[224:227], v[40:43]
    ds_read_b128 v[60:63], v3 offset:17408
    v_mfma_f32_16x16x32_bf16 v[40:43], v[100:103], v[228:231], v[40:43]
    v_mfma_f32_16x16x32_bf16 v[40:43], v[104:107], v[232:235], v[40:43]
    ds_read_b128 v[64:67], v3 offset:18432
    v_mfma_f32_16x16x32_bf16 v[40:43], v[108:111], v[236:239], v[40:43]
    v_mfma_f32_16x16x32_bf16 v[40:43], v[112:115], v[240:243], v[40:43]
    ds_read_b128 v[68:71], v3 offset:19456
    v_mfma_f32_16x16x32_bf16 v[40:43], v[116:119], v[244:247], v[40:43]
    v_mfma_f32_16x16x32_bf16 v[44:47], v[88:91], v[120:123], 0
    ds_read_b128 v[72:75], v3 offset:20480
    v_mfma_f32_16x16x32_bf16 v[44:47], v[92:95], v[124:127], v[44:47]
    v_cvt_pk_bf16_f32 v200, v24, v28
    v_mfma_f32_16x16x32_bf16 v[44:47], v[96:99], v[128:131], v[44:47]
    ds_read_b128 v[76:79], v3 offset:21504
    v_cvt_pk_bf16_f32 v201, v32, v36
    v_mfma_f32_16x16x32_bf16 v[44:47], v[100:103], v[132:135], v[44:47]
    v_mfma_f32_16x16x32_bf16 v[44:47], v[104:107], v[136:139], v[44:47]
    ds_read_b128 v[80:83], v3 offset:22528
    buffer_store_dwordx2 v[200:201], v5, s[32:35], s56 offen offset:0 nt sc1
    v_mfma_f32_16x16x32_bf16 v[44:47], v[108:111], v[140:143], v[44:47]
    v_cvt_pk_bf16_f32 v202, v25, v29
    v_mfma_f32_16x16x32_bf16 v[44:47], v[112:115], v[144:147], v[44:47]
    ds_read_b128 v[84:87], v3 offset:23552
    v_mfma_f32_16x16x32_bf16 v[44:47], v[116:119], v[148:151], v[44:47]
    v_cvt_pk_bf16_f32 v203, v33, v37
    v_mfma_f32_16x16x32_bf16 v[48:51], v[88:91], v[152:155], 0
    buffer_store_dwordx2 v[202:203], v5, s[32:35], s57 offen offset:0 nt sc1
    v_mfma_f32_16x16x32_bf16 v[48:51], v[92:95], v[156:159], v[48:51]
    v_mfma_f32_16x16x32_bf16 v[48:51], v[96:99], v[160:163], v[48:51]
    v_cvt_pk_bf16_f32 v204, v26, v30
    v_mfma_f32_16x16x32_bf16 v[48:51], v[100:103], v[164:167], v[48:51]
    v_cvt_pk_bf16_f32 v205, v34, v38
    v_mfma_f32_16x16x32_bf16 v[48:51], v[104:107], v[168:171], v[48:51]
    v_mfma_f32_16x16x32_bf16 v[48:51], v[108:111], v[172:175], v[48:51]
    buffer_store_dwordx2 v[204:205], v5, s[32:35], s58 offen offset:0 nt sc1
    v_mfma_f32_16x16x32_bf16 v[48:51], v[112:115], v[176:179], v[48:51]
    v_cvt_pk_bf16_f32 v206, v27, v31
    v_mfma_f32_16x16x32_bf16 v[48:51], v[116:119], v[180:183], v[48:51]
    v_mfma_f32_16x16x32_bf16 v[52:55], v[88:91], v[12:15], 0
    v_cvt_pk_bf16_f32 v207, v35, v39
    v_mfma_f32_16x16x32_bf16 v[52:55], v[92:95], v[16:19], v[52:55]
    buffer_store_dwordx2 v[206:207], v5, s[32:35], s59 offen offset:0 nt sc1
    v_mfma_f32_16x16x32_bf16 v[52:55], v[96:99], v[20:23], v[52:55]
    v_mfma_f32_16x16x32_bf16 v[52:55], v[100:103], v[248:251], v[52:55]
    v_mfma_f32_16x16x32_bf16 v[52:55], v[104:107], v[252:255], v[52:55]
    v_mfma_f32_16x16x32_bf16 v[52:55], v[108:111], v[184:187], v[52:55]
    v_mfma_f32_16x16x32_bf16 v[52:55], v[112:115], v[188:191], v[52:55]
    v_mfma_f32_16x16x32_bf16 v[52:55], v[116:119], v[192:195], v[52:55]
    s_waitcnt lgkmcnt(0)
    v_mfma_f32_16x16x32_bf16 v[24:27], v[56:59], v[216:219], 0
    ds_read_b128 v[88:91], v4 offset:0
    v_mfma_f32_16x16x32_bf16 v[24:27], v[60:63], v[220:223], v[24:27]
    v_mfma_f32_16x16x32_bf16 v[24:27], v[64:67], v[224:227], v[24:27]
    ds_read_b128 v[92:95], v4 offset:1024
    v_mfma_f32_16x16x32_bf16 v[24:27], v[68:71], v[228:231], v[24:27]
    v_mfma_f32_16x16x32_bf16 v[24:27], v[72:75], v[232:235], v[24:27]
    ds_read_b128 v[96:99], v4 offset:2048
    v_mfma_f32_16x16x32_bf16 v[24:27], v[76:79], v[236:239], v[24:27]
    v_mfma_f32_16x16x32_bf16 v[24:27], v[80:83], v[240:243], v[24:27]
    ds_read_b128 v[100:103], v4 offset:3072
    v_mfma_f32_16x16x32_bf16 v[24:27], v[84:87], v[244:247], v[24:27]
    v_mfma_f32_16x16x32_bf16 v[28:31], v[56:59], v[120:123], 0
    ds_read_b128 v[104:107], v4 offset:4096
    v_mfma_f32_16x16x32_bf16 v[28:31], v[60:63], v[124:127], v[28:31]
    v_cvt_pk_bf16_f32 v200, v40, v44
    v_mfma_f32_16x16x32_bf16 v[28:31], v[64:67], v[128:131], v[28:31]
    ds_read_b128 v[108:111], v4 offset:5120
    v_cvt_pk_bf16_f32 v201, v48, v52
    v_mfma_f32_16x16x32_bf16 v[28:31], v[68:71], v[132:135], v[28:31]
    v_mfma_f32_16x16x32_bf16 v[28:31], v[72:75], v[136:139], v[28:31]
    ds_read_b128 v[112:115], v4 offset:6144
    buffer_store_dwordx2 v[200:201], v5, s[32:35], s56 offen offset:512 nt sc1
    v_mfma_f32_16x16x32_bf16 v[28:31], v[76:79], v[140:143], v[28:31]
    v_cvt_pk_bf16_f32 v202, v41, v45
    v_mfma_f32_16x16x32_bf16 v[28:31], v[80:83], v[144:147], v[28:31]
    ds_read_b128 v[116:119], v4 offset:7168
    v_mfma_f32_16x16x32_bf16 v[28:31], v[84:87], v[148:151], v[28:31]
    v_cvt_pk_bf16_f32 v203, v49, v53
    v_mfma_f32_16x16x32_bf16 v[32:35], v[56:59], v[152:155], 0
    buffer_store_dwordx2 v[202:203], v5, s[32:35], s57 offen offset:512 nt sc1
    v_mfma_f32_16x16x32_bf16 v[32:35], v[60:63], v[156:159], v[32:35]
    v_mfma_f32_16x16x32_bf16 v[32:35], v[64:67], v[160:163], v[32:35]
    v_cvt_pk_bf16_f32 v204, v42, v46
    v_mfma_f32_16x16x32_bf16 v[32:35], v[68:71], v[164:167], v[32:35]
    v_cvt_pk_bf16_f32 v205, v50, v54
    v_mfma_f32_16x16x32_bf16 v[32:35], v[72:75], v[168:171], v[32:35]
    v_mfma_f32_16x16x32_bf16 v[32:35], v[76:79], v[172:175], v[32:35]
    buffer_store_dwordx2 v[204:205], v5, s[32:35], s58 offen offset:512 nt sc1
    v_mfma_f32_16x16x32_bf16 v[32:35], v[80:83], v[176:179], v[32:35]
    v_cvt_pk_bf16_f32 v206, v43, v47
    v_mfma_f32_16x16x32_bf16 v[32:35], v[84:87], v[180:183], v[32:35]
    v_mfma_f32_16x16x32_bf16 v[36:39], v[56:59], v[12:15], 0
    v_cvt_pk_bf16_f32 v207, v51, v55
    v_mfma_f32_16x16x32_bf16 v[36:39], v[60:63], v[16:19], v[36:39]
    buffer_store_dwordx2 v[206:207], v5, s[32:35], s59 offen offset:512 nt sc1
    v_mfma_f32_16x16x32_bf16 v[36:39], v[64:67], v[20:23], v[36:39]
    v_mfma_f32_16x16x32_bf16 v[36:39], v[68:71], v[248:251], v[36:39]
    v_mfma_f32_16x16x32_bf16 v[36:39], v[72:75], v[252:255], v[36:39]
    v_mfma_f32_16x16x32_bf16 v[36:39], v[76:79], v[184:187], v[36:39]
    v_mfma_f32_16x16x32_bf16 v[36:39], v[80:83], v[188:191], v[36:39]
    v_mfma_f32_16x16x32_bf16 v[36:39], v[84:87], v[192:195], v[36:39]
    s_waitcnt lgkmcnt(0)
    s_barrier
    v_mfma_f32_16x16x32_bf16 v[40:43], v[88:91], v[216:219], 0
    ds_read_b128 v[56:59], v4 offset:48128
    v_mfma_f32_16x16x32_bf16 v[40:43], v[92:95], v[220:223], v[40:43]
    v_mfma_f32_16x16x32_bf16 v[40:43], v[96:99], v[224:227], v[40:43]
    ds_read_b128 v[60:63], v4 offset:49152
    v_mfma_f32_16x16x32_bf16 v[40:43], v[100:103], v[228:231], v[40:43]
    v_mfma_f32_16x16x32_bf16 v[40:43], v[104:107], v[232:235], v[40:43]
    ds_read_b128 v[64:67], v4 offset:50176
    v_mfma_f32_16x16x32_bf16 v[40:43], v[108:111], v[236:239], v[40:43]
    v_mfma_f32_16x16x32_bf16 v[40:43], v[112:115], v[240:243], v[40:43]
    ds_read_b128 v[68:71], v4 offset:51200
    v_mfma_f32_16x16x32_bf16 v[40:43], v[116:119], v[244:247], v[40:43]
    v_mfma_f32_16x16x32_bf16 v[44:47], v[88:91], v[120:123], 0
    ds_read_b128 v[72:75], v4 offset:52224
    v_mfma_f32_16x16x32_bf16 v[44:47], v[92:95], v[124:127], v[44:47]
    v_cvt_pk_bf16_f32 v200, v24, v28
    v_mfma_f32_16x16x32_bf16 v[44:47], v[96:99], v[128:131], v[44:47]
    ds_read_b128 v[76:79], v4 offset:53248
    v_cvt_pk_bf16_f32 v201, v32, v36
    v_mfma_f32_16x16x32_bf16 v[44:47], v[100:103], v[132:135], v[44:47]
    v_mfma_f32_16x16x32_bf16 v[44:47], v[104:107], v[136:139], v[44:47]
    ds_read_b128 v[80:83], v4 offset:54272
    buffer_store_dwordx2 v[200:201], v5, s[32:35], s56 offen offset:1024 nt sc1
    v_mfma_f32_16x16x32_bf16 v[44:47], v[108:111], v[140:143], v[44:47]
    v_cvt_pk_bf16_f32 v202, v25, v29
    v_mfma_f32_16x16x32_bf16 v[44:47], v[112:115], v[144:147], v[44:47]
    ds_read_b128 v[84:87], v4 offset:55296
    v_mfma_f32_16x16x32_bf16 v[44:47], v[116:119], v[148:151], v[44:47]
    v_cvt_pk_bf16_f32 v203, v33, v37
    v_mfma_f32_16x16x32_bf16 v[48:51], v[88:91], v[152:155], 0
    buffer_store_dwordx2 v[202:203], v5, s[32:35], s57 offen offset:1024 nt sc1
    v_mfma_f32_16x16x32_bf16 v[48:51], v[92:95], v[156:159], v[48:51]
    v_mfma_f32_16x16x32_bf16 v[48:51], v[96:99], v[160:163], v[48:51]
    v_cvt_pk_bf16_f32 v204, v26, v30
    v_mfma_f32_16x16x32_bf16 v[48:51], v[100:103], v[164:167], v[48:51]
    v_cvt_pk_bf16_f32 v205, v34, v38
    v_mfma_f32_16x16x32_bf16 v[48:51], v[104:107], v[168:171], v[48:51]
    v_mfma_f32_16x16x32_bf16 v[48:51], v[108:111], v[172:175], v[48:51]
    buffer_store_dwordx2 v[204:205], v5, s[32:35], s58 offen offset:1024 nt sc1
    v_mfma_f32_16x16x32_bf16 v[48:51], v[112:115], v[176:179], v[48:51]
    v_cvt_pk_bf16_f32 v206, v27, v31
    v_mfma_f32_16x16x32_bf16 v[48:51], v[116:119], v[180:183], v[48:51]
    v_mfma_f32_16x16x32_bf16 v[52:55], v[88:91], v[12:15], 0
    v_cvt_pk_bf16_f32 v207, v35, v39
    v_mfma_f32_16x16x32_bf16 v[52:55], v[92:95], v[16:19], v[52:55]
    buffer_store_dwordx2 v[206:207], v5, s[32:35], s59 offen offset:1024 nt sc1
    v_mfma_f32_16x16x32_bf16 v[52:55], v[96:99], v[20:23], v[52:55]
    v_mfma_f32_16x16x32_bf16 v[52:55], v[100:103], v[248:251], v[52:55]
    v_mfma_f32_16x16x32_bf16 v[52:55], v[104:107], v[252:255], v[52:55]
    v_mfma_f32_16x16x32_bf16 v[52:55], v[108:111], v[184:187], v[52:55]
    v_mfma_f32_16x16x32_bf16 v[52:55], v[112:115], v[188:191], v[52:55]
    v_mfma_f32_16x16x32_bf16 v[52:55], v[116:119], v[192:195], v[52:55]
    s_waitcnt lgkmcnt(0)
    v_mfma_f32_16x16x32_bf16 v[24:27], v[56:59], v[216:219], 0
    ds_read_b128 v[88:91], v4 offset:56320
    v_mfma_f32_16x16x32_bf16 v[24:27], v[60:63], v[220:223], v[24:27]
    v_mfma_f32_16x16x32_bf16 v[24:27], v[64:67], v[224:227], v[24:27]
    ds_read_b128 v[92:95], v4 offset:57344
    v_mfma_f32_16x16x32_bf16 v[24:27], v[68:71], v[228:231], v[24:27]
    v_mfma_f32_16x16x32_bf16 v[24:27], v[72:75], v[232:235], v[24:27]
    ds_read_b128 v[96:99], v4 offset:58368
    v_mfma_f32_16x16x32_bf16 v[24:27], v[76:79], v[236:239], v[24:27]
    v_mfma_f32_16x16x32_bf16 v[24:27], v[80:83], v[240:243], v[24:27]
    ds_read_b128 v[100:103], v4 offset:59392
    v_mfma_f32_16x16x32_bf16 v[24:27], v[84:87], v[244:247], v[24:27]
    v_mfma_f32_16x16x32_bf16 v[28:31], v[56:59], v[120:123], 0
    ds_read_b128 v[104:107], v4 offset:60416
    v_mfma_f32_16x16x32_bf16 v[28:31], v[60:63], v[124:127], v[28:31]
    v_cvt_pk_bf16_f32 v200, v40, v44
    v_mfma_f32_16x16x32_bf16 v[28:31], v[64:67], v[128:131], v[28:31]
    ds_read_b128 v[108:111], v4 offset:61440
    v_cvt_pk_bf16_f32 v201, v48, v52
    v_mfma_f32_16x16x32_bf16 v[28:31], v[68:71], v[132:135], v[28:31]
    v_mfma_f32_16x16x32_bf16 v[28:31], v[72:75], v[136:139], v[28:31]
    ds_read_b128 v[112:115], v4 offset:62464
    buffer_store_dwordx2 v[200:201], v5, s[32:35], s56 offen offset:1536 nt sc1
    v_mfma_f32_16x16x32_bf16 v[28:31], v[76:79], v[140:143], v[28:31]
    v_cvt_pk_bf16_f32 v202, v41, v45
    v_mfma_f32_16x16x32_bf16 v[28:31], v[80:83], v[144:147], v[28:31]
    ds_read_b128 v[116:119], v4 offset:63488
    v_mfma_f32_16x16x32_bf16 v[28:31], v[84:87], v[148:151], v[28:31]
    v_cvt_pk_bf16_f32 v203, v49, v53
    v_mfma_f32_16x16x32_bf16 v[32:35], v[56:59], v[152:155], 0
    buffer_store_dwordx2 v[202:203], v5, s[32:35], s57 offen offset:1536 nt sc1
    v_mfma_f32_16x16x32_bf16 v[32:35], v[60:63], v[156:159], v[32:35]
    v_mfma_f32_16x16x32_bf16 v[32:35], v[64:67], v[160:163], v[32:35]
    v_cvt_pk_bf16_f32 v204, v42, v46
    v_mfma_f32_16x16x32_bf16 v[32:35], v[68:71], v[164:167], v[32:35]
    v_cvt_pk_bf16_f32 v205, v50, v54
    v_mfma_f32_16x16x32_bf16 v[32:35], v[72:75], v[168:171], v[32:35]
    v_mfma_f32_16x16x32_bf16 v[32:35], v[76:79], v[172:175], v[32:35]
    buffer_store_dwordx2 v[204:205], v5, s[32:35], s58 offen offset:1536 nt sc1
    v_mfma_f32_16x16x32_bf16 v[32:35], v[80:83], v[176:179], v[32:35]
    v_cvt_pk_bf16_f32 v206, v43, v47
    v_mfma_f32_16x16x32_bf16 v[32:35], v[84:87], v[180:183], v[32:35]
    v_mfma_f32_16x16x32_bf16 v[36:39], v[56:59], v[12:15], 0
    v_cvt_pk_bf16_f32 v207, v51, v55
    v_mfma_f32_16x16x32_bf16 v[36:39], v[60:63], v[16:19], v[36:39]
    buffer_store_dwordx2 v[206:207], v5, s[32:35], s59 offen offset:1536 nt sc1
    v_mfma_f32_16x16x32_bf16 v[36:39], v[64:67], v[20:23], v[36:39]
    v_mfma_f32_16x16x32_bf16 v[36:39], v[68:71], v[248:251], v[36:39]
    v_mfma_f32_16x16x32_bf16 v[36:39], v[72:75], v[252:255], v[36:39]
    v_mfma_f32_16x16x32_bf16 v[36:39], v[76:79], v[184:187], v[36:39]
    v_mfma_f32_16x16x32_bf16 v[36:39], v[80:83], v[188:191], v[36:39]
    v_mfma_f32_16x16x32_bf16 v[36:39], v[84:87], v[192:195], v[36:39]
    s_waitcnt lgkmcnt(0)
    s_barrier
    v_mfma_f32_16x16x32_bf16 v[40:43], v[88:91], v[216:219], 0
    ds_read_b128 v[56:59], v4 offset:30720
    v_mfma_f32_16x16x32_bf16 v[40:43], v[92:95], v[220:223], v[40:43]
    v_mfma_f32_16x16x32_bf16 v[40:43], v[96:99], v[224:227], v[40:43]
    ds_read_b128 v[60:63], v4 offset:31744
    v_mfma_f32_16x16x32_bf16 v[40:43], v[100:103], v[228:231], v[40:43]
    v_mfma_f32_16x16x32_bf16 v[40:43], v[104:107], v[232:235], v[40:43]
    ds_read_b128 v[64:67], v4 offset:32768
    v_mfma_f32_16x16x32_bf16 v[40:43], v[108:111], v[236:239], v[40:43]
    v_mfma_f32_16x16x32_bf16 v[40:43], v[112:115], v[240:243], v[40:43]
    ds_read_b128 v[68:71], v4 offset:33792
    v_mfma_f32_16x16x32_bf16 v[40:43], v[116:119], v[244:247], v[40:43]
    v_mfma_f32_16x16x32_bf16 v[44:47], v[88:91], v[120:123], 0
    ds_read_b128 v[72:75], v4 offset:34816
    v_mfma_f32_16x16x32_bf16 v[44:47], v[92:95], v[124:127], v[44:47]
    v_cvt_pk_bf16_f32 v200, v24, v28
    v_mfma_f32_16x16x32_bf16 v[44:47], v[96:99], v[128:131], v[44:47]
    ds_read_b128 v[76:79], v4 offset:35840
    v_cvt_pk_bf16_f32 v201, v32, v36
    v_mfma_f32_16x16x32_bf16 v[44:47], v[100:103], v[132:135], v[44:47]
    v_mfma_f32_16x16x32_bf16 v[44:47], v[104:107], v[136:139], v[44:47]
    ds_read_b128 v[80:83], v4 offset:36864
    buffer_store_dwordx2 v[200:201], v5, s[32:35], s56 offen offset:2048 nt sc1
    v_mfma_f32_16x16x32_bf16 v[44:47], v[108:111], v[140:143], v[44:47]
    v_cvt_pk_bf16_f32 v202, v25, v29
    v_mfma_f32_16x16x32_bf16 v[44:47], v[112:115], v[144:147], v[44:47]
    ds_read_b128 v[84:87], v4 offset:37888
    v_mfma_f32_16x16x32_bf16 v[44:47], v[116:119], v[148:151], v[44:47]
    v_cvt_pk_bf16_f32 v203, v33, v37
    v_mfma_f32_16x16x32_bf16 v[48:51], v[88:91], v[152:155], 0
    buffer_store_dwordx2 v[202:203], v5, s[32:35], s57 offen offset:2048 nt sc1
    v_mfma_f32_16x16x32_bf16 v[48:51], v[92:95], v[156:159], v[48:51]
    v_mfma_f32_16x16x32_bf16 v[48:51], v[96:99], v[160:163], v[48:51]
    v_cvt_pk_bf16_f32 v204, v26, v30
    v_mfma_f32_16x16x32_bf16 v[48:51], v[100:103], v[164:167], v[48:51]
    v_cvt_pk_bf16_f32 v205, v34, v38
    v_mfma_f32_16x16x32_bf16 v[48:51], v[104:107], v[168:171], v[48:51]
    v_mfma_f32_16x16x32_bf16 v[48:51], v[108:111], v[172:175], v[48:51]
    buffer_store_dwordx2 v[204:205], v5, s[32:35], s58 offen offset:2048 nt sc1
    v_mfma_f32_16x16x32_bf16 v[48:51], v[112:115], v[176:179], v[48:51]
    v_cvt_pk_bf16_f32 v206, v27, v31
    v_mfma_f32_16x16x32_bf16 v[48:51], v[116:119], v[180:183], v[48:51]
    v_mfma_f32_16x16x32_bf16 v[52:55], v[88:91], v[12:15], 0
    v_cvt_pk_bf16_f32 v207, v35, v39
    v_mfma_f32_16x16x32_bf16 v[52:55], v[92:95], v[16:19], v[52:55]
    buffer_store_dwordx2 v[206:207], v5, s[32:35], s59 offen offset:2048 nt sc1
    v_mfma_f32_16x16x32_bf16 v[52:55], v[96:99], v[20:23], v[52:55]
    v_mfma_f32_16x16x32_bf16 v[52:55], v[100:103], v[248:251], v[52:55]
    v_mfma_f32_16x16x32_bf16 v[52:55], v[104:107], v[252:255], v[52:55]
    v_mfma_f32_16x16x32_bf16 v[52:55], v[108:111], v[184:187], v[52:55]
    v_mfma_f32_16x16x32_bf16 v[52:55], v[112:115], v[188:191], v[52:55]
    v_mfma_f32_16x16x32_bf16 v[52:55], v[116:119], v[192:195], v[52:55]
    s_waitcnt lgkmcnt(0)
    v_mfma_f32_16x16x32_bf16 v[24:27], v[56:59], v[216:219], 0
    ds_read_b128 v[88:91], v4 offset:38912
    v_mfma_f32_16x16x32_bf16 v[24:27], v[60:63], v[220:223], v[24:27]
    v_mfma_f32_16x16x32_bf16 v[24:27], v[64:67], v[224:227], v[24:27]
    ds_read_b128 v[92:95], v4 offset:39936
    v_mfma_f32_16x16x32_bf16 v[24:27], v[68:71], v[228:231], v[24:27]
    v_mfma_f32_16x16x32_bf16 v[24:27], v[72:75], v[232:235], v[24:27]
    ds_read_b128 v[96:99], v4 offset:40960
    v_mfma_f32_16x16x32_bf16 v[24:27], v[76:79], v[236:239], v[24:27]
    v_mfma_f32_16x16x32_bf16 v[24:27], v[80:83], v[240:243], v[24:27]
    ds_read_b128 v[100:103], v4 offset:41984
    v_mfma_f32_16x16x32_bf16 v[24:27], v[84:87], v[244:247], v[24:27]
    v_mfma_f32_16x16x32_bf16 v[28:31], v[56:59], v[120:123], 0
    ds_read_b128 v[104:107], v4 offset:43008
    v_mfma_f32_16x16x32_bf16 v[28:31], v[60:63], v[124:127], v[28:31]
    v_cvt_pk_bf16_f32 v200, v40, v44
    v_mfma_f32_16x16x32_bf16 v[28:31], v[64:67], v[128:131], v[28:31]
    ds_read_b128 v[108:111], v4 offset:44032
    v_cvt_pk_bf16_f32 v201, v48, v52
    v_mfma_f32_16x16x32_bf16 v[28:31], v[68:71], v[132:135], v[28:31]
    v_mfma_f32_16x16x32_bf16 v[28:31], v[72:75], v[136:139], v[28:31]
    ds_read_b128 v[112:115], v4 offset:45056
    buffer_store_dwordx2 v[200:201], v5, s[32:35], s56 offen offset:2560 nt sc1
    v_mfma_f32_16x16x32_bf16 v[28:31], v[76:79], v[140:143], v[28:31]
    v_cvt_pk_bf16_f32 v202, v41, v45
    v_mfma_f32_16x16x32_bf16 v[28:31], v[80:83], v[144:147], v[28:31]
    ds_read_b128 v[116:119], v4 offset:46080
    v_mfma_f32_16x16x32_bf16 v[28:31], v[84:87], v[148:151], v[28:31]
    v_cvt_pk_bf16_f32 v203, v49, v53
    v_mfma_f32_16x16x32_bf16 v[32:35], v[56:59], v[152:155], 0
    buffer_store_dwordx2 v[202:203], v5, s[32:35], s57 offen offset:2560 nt sc1
    v_mfma_f32_16x16x32_bf16 v[32:35], v[60:63], v[156:159], v[32:35]
    v_mfma_f32_16x16x32_bf16 v[32:35], v[64:67], v[160:163], v[32:35]
    v_cvt_pk_bf16_f32 v204, v42, v46
    v_mfma_f32_16x16x32_bf16 v[32:35], v[68:71], v[164:167], v[32:35]
    v_cvt_pk_bf16_f32 v205, v50, v54
    v_mfma_f32_16x16x32_bf16 v[32:35], v[72:75], v[168:171], v[32:35]
    v_mfma_f32_16x16x32_bf16 v[32:35], v[76:79], v[172:175], v[32:35]
    buffer_store_dwordx2 v[204:205], v5, s[32:35], s58 offen offset:2560 nt sc1
    v_mfma_f32_16x16x32_bf16 v[32:35], v[80:83], v[176:179], v[32:35]
    v_cvt_pk_bf16_f32 v206, v43, v47
    v_mfma_f32_16x16x32_bf16 v[32:35], v[84:87], v[180:183], v[32:35]
    v_mfma_f32_16x16x32_bf16 v[36:39], v[56:59], v[12:15], 0
    v_cvt_pk_bf16_f32 v207, v51, v55
    v_mfma_f32_16x16x32_bf16 v[36:39], v[60:63], v[16:19], v[36:39]
    buffer_store_dwordx2 v[206:207], v5, s[32:35], s59 offen offset:2560 nt sc1
    v_mfma_f32_16x16x32_bf16 v[36:39], v[64:67], v[20:23], v[36:39]
    v_mfma_f32_16x16x32_bf16 v[36:39], v[68:71], v[248:251], v[36:39]
    v_mfma_f32_16x16x32_bf16 v[36:39], v[72:75], v[252:255], v[36:39]
    v_mfma_f32_16x16x32_bf16 v[36:39], v[76:79], v[184:187], v[36:39]
    v_mfma_f32_16x16x32_bf16 v[36:39], v[80:83], v[188:191], v[36:39]
    v_mfma_f32_16x16x32_bf16 v[36:39], v[84:87], v[192:195], v[36:39]
    s_waitcnt lgkmcnt(0)
    s_barrier
    v_mfma_f32_16x16x32_bf16 v[40:43], v[88:91], v[216:219], 0
    ds_read_b128 v[56:59], v3 offset:0
    v_mfma_f32_16x16x32_bf16 v[40:43], v[92:95], v[220:223], v[40:43]
    v_mfma_f32_16x16x32_bf16 v[40:43], v[96:99], v[224:227], v[40:43]
    ds_read_b128 v[60:63], v3 offset:1024
    v_mfma_f32_16x16x32_bf16 v[40:43], v[100:103], v[228:231], v[40:43]
    v_mfma_f32_16x16x32_bf16 v[40:43], v[104:107], v[232:235], v[40:43]
    ds_read_b128 v[64:67], v3 offset:2048
    v_mfma_f32_16x16x32_bf16 v[40:43], v[108:111], v[236:239], v[40:43]
    v_mfma_f32_16x16x32_bf16 v[40:43], v[112:115], v[240:243], v[40:43]
    ds_read_b128 v[68:71], v3 offset:3072
    v_mfma_f32_16x16x32_bf16 v[40:43], v[116:119], v[244:247], v[40:43]
    v_mfma_f32_16x16x32_bf16 v[44:47], v[88:91], v[120:123], 0
    ds_read_b128 v[72:75], v3 offset:4096
    v_mfma_f32_16x16x32_bf16 v[44:47], v[92:95], v[124:127], v[44:47]
    v_cvt_pk_bf16_f32 v200, v24, v28
    v_mfma_f32_16x16x32_bf16 v[44:47], v[96:99], v[128:131], v[44:47]
    ds_read_b128 v[76:79], v3 offset:5120
    v_cvt_pk_bf16_f32 v201, v32, v36
    v_mfma_f32_16x16x32_bf16 v[44:47], v[100:103], v[132:135], v[44:47]
    v_mfma_f32_16x16x32_bf16 v[44:47], v[104:107], v[136:139], v[44:47]
    ds_read_b128 v[80:83], v3 offset:6144
    buffer_store_dwordx2 v[200:201], v5, s[32:35], s56 offen offset:3072 nt sc1
    v_mfma_f32_16x16x32_bf16 v[44:47], v[108:111], v[140:143], v[44:47]
    v_cvt_pk_bf16_f32 v202, v25, v29
    v_mfma_f32_16x16x32_bf16 v[44:47], v[112:115], v[144:147], v[44:47]
    ds_read_b128 v[84:87], v3 offset:7168
    v_mfma_f32_16x16x32_bf16 v[44:47], v[116:119], v[148:151], v[44:47]
    v_cvt_pk_bf16_f32 v203, v33, v37
    v_mfma_f32_16x16x32_bf16 v[48:51], v[88:91], v[152:155], 0
    buffer_store_dwordx2 v[202:203], v5, s[32:35], s57 offen offset:3072 nt sc1
    v_mfma_f32_16x16x32_bf16 v[48:51], v[92:95], v[156:159], v[48:51]
    v_mfma_f32_16x16x32_bf16 v[48:51], v[96:99], v[160:163], v[48:51]
    v_cvt_pk_bf16_f32 v204, v26, v30
    v_mfma_f32_16x16x32_bf16 v[48:51], v[100:103], v[164:167], v[48:51]
    v_cvt_pk_bf16_f32 v205, v34, v38
    v_mfma_f32_16x16x32_bf16 v[48:51], v[104:107], v[168:171], v[48:51]
    v_mfma_f32_16x16x32_bf16 v[48:51], v[108:111], v[172:175], v[48:51]
    buffer_store_dwordx2 v[204:205], v5, s[32:35], s58 offen offset:3072 nt sc1
    v_mfma_f32_16x16x32_bf16 v[48:51], v[112:115], v[176:179], v[48:51]
    v_cvt_pk_bf16_f32 v206, v27, v31
    v_mfma_f32_16x16x32_bf16 v[48:51], v[116:119], v[180:183], v[48:51]
    v_mfma_f32_16x16x32_bf16 v[52:55], v[88:91], v[12:15], 0
    v_cvt_pk_bf16_f32 v207, v35, v39
    v_mfma_f32_16x16x32_bf16 v[52:55], v[92:95], v[16:19], v[52:55]
    buffer_store_dwordx2 v[206:207], v5, s[32:35], s59 offen offset:3072 nt sc1
    v_mfma_f32_16x16x32_bf16 v[52:55], v[96:99], v[20:23], v[52:55]
    v_mfma_f32_16x16x32_bf16 v[52:55], v[100:103], v[248:251], v[52:55]
    v_mfma_f32_16x16x32_bf16 v[52:55], v[104:107], v[252:255], v[52:55]
    v_mfma_f32_16x16x32_bf16 v[52:55], v[108:111], v[184:187], v[52:55]
    v_mfma_f32_16x16x32_bf16 v[52:55], v[112:115], v[188:191], v[52:55]
    v_mfma_f32_16x16x32_bf16 v[52:55], v[116:119], v[192:195], v[52:55]
    s_waitcnt lgkmcnt(0)
L_pg10:
    s_cbranch_execz L_pb10
    s_barrier
    v_mfma_f32_16x16x32_bf16 v[24:27], v[56:59], v[216:219], 0
    ds_read_b128 v[88:91], v3 offset:8192
    v_mfma_f32_16x16x32_bf16 v[24:27], v[60:63], v[220:223], v[24:27]
    v_mfma_f32_16x16x32_bf16 v[24:27], v[64:67], v[224:227], v[24:27]
    ds_read_b128 v[92:95], v3 offset:9216
    v_mfma_f32_16x16x32_bf16 v[24:27], v[68:71], v[228:231], v[24:27]
    v_mfma_f32_16x16x32_bf16 v[24:27], v[72:75], v[232:235], v[24:27]
    ds_read_b128 v[96:99], v3 offset:10240
    v_mfma_f32_16x16x32_bf16 v[24:27], v[76:79], v[236:239], v[24:27]
    v_mfma_f32_16x16x32_bf16 v[24:27], v[80:83], v[240:243], v[24:27]
    ds_read_b128 v[100:103], v3 offset:11264
    v_mfma_f32_16x16x32_bf16 v[24:27], v[84:87], v[244:247], v[24:27]
    v_mfma_f32_16x16x32_bf16 v[28:31], v[56:59], v[120:123], 0
    ds_read_b128 v[104:107], v3 offset:12288
    v_mfma_f32_16x16x32_bf16 v[28:31], v[60:63], v[124:127], v[28:31]
    v_cvt_pk_bf16_f32 v200, v40, v44
    v_mfma_f32_16x16x32_bf16 v[28:31], v[64:67], v[128:131], v[28:31]
    ds_read_b128 v[108:111], v3 offset:13312
    v_cvt_pk_bf16_f32 v201, v48, v52
    v_mfma_f32_16x16x32_bf16 v[28:31], v[68:71], v[132:135], v[28:31]
    v_mfma_f32_16x16x32_bf16 v[28:31], v[72:75], v[136:139], v[28:31]
    ds_read_b128 v[112:115], v3 offset:14336
    buffer_store_dwordx2 v[200:201], v5, s[32:35], s56 offen offset:3584 nt sc1
    v_mfma_f32_16x16x32_bf16 v[28:31], v[76:79], v[140:143], v[28:31]
    v_cvt_pk_bf16_f32 v202, v41, v45
    v_mfma_f32_16x16x32_bf16 v[28:31], v[80:83], v[144:147], v[28:31]
    ds_read_b128 v[116:119], v3 offset:15360
    v_mfma_f32_16x16x32_bf16 v[28:31], v[84:87], v[148:151], v[28:31]
    v_cvt_pk_bf16_f32 v203, v49, v53
    v_mfma_f32_16x16x32_bf16 v[32:35], v[56:59], v[152:155], 0
    buffer_store_dwordx2 v[202:203], v5, s[32:35], s57 offen offset:3584 nt sc1
    v_mfma_f32_16x16x32_bf16 v[32:35], v[60:63], v[156:159], v[32:35]
    v_mfma_f32_16x16x32_bf16 v[32:35], v[64:67], v[160:163], v[32:35]
    v_cvt_pk_bf16_f32 v204, v42, v46
    v_mfma_f32_16x16x32_bf16 v[32:35], v[68:71], v[164:167], v[32:35]
    v_cvt_pk_bf16_f32 v205, v50, v54
    v_mfma_f32_16x16x32_bf16 v[32:35], v[72:75], v[168:171], v[32:35]
    v_mfma_f32_16x16x32_bf16 v[32:35], v[76:79], v[172:175], v[32:35]
    buffer_store_dwordx2 v[204:205], v5, s[32:35], s58 offen offset:3584 nt sc1
    v_mfma_f32_16x16x32_bf16 v[32:35], v[80:83], v[176:179], v[32:35]
    v_cvt_pk_bf16_f32 v206, v43, v47
    v_mfma_f32_16x16x32_bf16 v[32:35], v[84:87], v[180:183], v[32:35]
    v_mfma_f32_16x16x32_bf16 v[36:39], v[56:59], v[12:15], 0
    v_cvt_pk_bf16_f32 v207, v51, v55
    v_mfma_f32_16x16x32_bf16 v[36:39], v[60:63], v[16:19], v[36:39]
    buffer_store_dwordx2 v[206:207], v5, s[32:35], s59 offen offset:3584 nt sc1
    v_mfma_f32_16x16x32_bf16 v[36:39], v[64:67], v[20:23], v[36:39]
    v_mfma_f32_16x16x32_bf16 v[36:39], v[68:71], v[248:251], v[36:39]
    v_mfma_f32_16x16x32_bf16 v[36:39], v[72:75], v[252:255], v[36:39]
    v_mfma_f32_16x16x32_bf16 v[36:39], v[76:79], v[184:187], v[36:39]
    v_mfma_f32_16x16x32_bf16 v[36:39], v[80:83], v[188:191], v[36:39]
    v_mfma_f32_16x16x32_bf16 v[36:39], v[84:87], v[192:195], v[36:39]
    s_waitcnt lgkmcnt(0)
    s_barrier
    v_mfma_f32_16x16x32_bf16 v[40:43], v[88:91], v[216:219], 0
    ds_read_b128 v[56:59], v3 offset:16384
    v_mfma_f32_16x16x32_bf16 v[40:43], v[92:95], v[220:223], v[40:43]
    v_mfma_f32_16x16x32_bf16 v[40:43], v[96:99], v[224:227], v[40:43]
    ds_read_b128 v[60:63], v3 offset:17408
    v_mfma_f32_16x16x32_bf16 v[40:43], v[100:103], v[228:231], v[40:43]
    v_mfma_f32_16x16x32_bf16 v[40:43], v[104:107], v[232:235], v[40:43]
    ds_read_b128 v[64:67], v3 offset:18432
    v_mfma_f32_16x16x32_bf16 v[40:43], v[108:111], v[236:239], v[40:43]
    v_mfma_f32_16x16x32_bf16 v[40:43], v[112:115], v[240:243], v[40:43]
    ds_read_b128 v[68:71], v3 offset:19456
    v_mfma_f32_16x16x32_bf16 v[40:43], v[116:119], v[244:247], v[40:43]
    v_mfma_f32_16x16x32_bf16 v[44:47], v[88:91], v[120:123], 0
    ds_read_b128 v[72:75], v3 offset:20480
    v_mfma_f32_16x16x32_bf16 v[44:47], v[92:95], v[124:127], v[44:47]
    v_cvt_pk_bf16_f32 v200, v24, v28
    v_mfma_f32_16x16x32_bf16 v[44:47], v[96:99], v[128:131], v[44:47]
    ds_read_b128 v[76:79], v3 offset:21504
    v_cvt_pk_bf16_f32 v201, v32, v36
    v_mfma_f32_16x16x32_bf16 v[44:47], v[100:103], v[132:135], v[44:47]
    v_mfma_f32_16x16x32_bf16 v[44:47], v[104:107], v[136:139], v[44:47]
    ds_read_b128 v[80:83], v3 offset:22528
    buffer_store_dwordx2 v[200:201], v5, s[36:39], s56 offen offset:0 nt sc1
    v_mfma_f32_16x16x32_bf16 v[44:47], v[108:111], v[140:143], v[44:47]
    v_cvt_pk_bf16_f32 v202, v25, v29
    v_mfma_f32_16x16x32_bf16 v[44:47], v[112:115], v[144:147], v[44:47]
    ds_read_b128 v[84:87], v3 offset:23552
    v_mfma_f32_16x16x32_bf16 v[44:47], v[116:119], v[148:151], v[44:47]
    v_cvt_pk_bf16_f32 v203, v33, v37
    v_mfma_f32_16x16x32_bf16 v[48:51], v[88:91], v[152:155], 0
    buffer_store_dwordx2 v[202:203], v5, s[36:39], s57 offen offset:0 nt sc1
    v_mfma_f32_16x16x32_bf16 v[48:51], v[92:95], v[156:159], v[48:51]
    v_mfma_f32_16x16x32_bf16 v[48:51], v[96:99], v[160:163], v[48:51]
    v_cvt_pk_bf16_f32 v204, v26, v30
    v_mfma_f32_16x16x32_bf16 v[48:51], v[100:103], v[164:167], v[48:51]
    v_cvt_pk_bf16_f32 v205, v34, v38
    v_mfma_f32_16x16x32_bf16 v[48:51], v[104:107], v[168:171], v[48:51]
    v_mfma_f32_16x16x32_bf16 v[48:51], v[108:111], v[172:175], v[48:51]
    buffer_store_dwordx2 v[204:205], v5, s[36:39], s58 offen offset:0 nt sc1
    v_mfma_f32_16x16x32_bf16 v[48:51], v[112:115], v[176:179], v[48:51]
    v_cvt_pk_bf16_f32 v206, v27, v31
    v_mfma_f32_16x16x32_bf16 v[48:51], v[116:119], v[180:183], v[48:51]
    v_mfma_f32_16x16x32_bf16 v[52:55], v[88:91], v[12:15], 0
    v_cvt_pk_bf16_f32 v207, v35, v39
    v_mfma_f32_16x16x32_bf16 v[52:55], v[92:95], v[16:19], v[52:55]
    buffer_store_dwordx2 v[206:207], v5, s[36:39], s59 offen offset:0 nt sc1
    v_mfma_f32_16x16x32_bf16 v[52:55], v[96:99], v[20:23], v[52:55]
    v_mfma_f32_16x16x32_bf16 v[52:55], v[100:103], v[248:251], v[52:55]
    v_mfma_f32_16x16x32_bf16 v[52:55], v[104:107], v[252:255], v[52:55]
    v_mfma_f32_16x16x32_bf16 v[52:55], v[108:111], v[184:187], v[52:55]
    v_mfma_f32_16x16x32_bf16 v[52:55], v[112:115], v[188:191], v[52:55]
    v_mfma_f32_16x16x32_bf16 v[52:55], v[116:119], v[192:195], v[52:55]
    s_waitcnt lgkmcnt(0)
    s_barrier
    v_mfma_f32_16x16x32_bf16 v[24:27], v[56:59], v[216:219], 0
    ds_read_b128 v[88:91], v4 offset:0
    v_mfma_f32_16x16x32_bf16 v[24:27], v[60:63], v[220:223], v[24:27]
    v_mfma_f32_16x16x32_bf16 v[24:27], v[64:67], v[224:227], v[24:27]
    ds_read_b128 v[92:95], v4 offset:1024
    v_mfma_f32_16x16x32_bf16 v[24:27], v[68:71], v[228:231], v[24:27]
    v_mfma_f32_16x16x32_bf16 v[24:27], v[72:75], v[232:235], v[24:27]
    ds_read_b128 v[96:99], v4 offset:2048
    v_mfma_f32_16x16x32_bf16 v[24:27], v[76:79], v[236:239], v[24:27]
    v_mfma_f32_16x16x32_bf16 v[24:27], v[80:83], v[240:243], v[24:27]
    ds_read_b128 v[100:103], v4 offset:3072
    v_mfma_f32_16x16x32_bf16 v[24:27], v[84:87], v[244:247], v[24:27]
    v_mfma_f32_16x16x32_bf16 v[28:31], v[56:59], v[120:123], 0
    ds_read_b128 v[104:107], v4 offset:4096
    v_mfma_f32_16x16x32_bf16 v[28:31], v[60:63], v[124:127], v[28:31]
    v_cvt_pk_bf16_f32 v200, v40, v44
    v_mfma_f32_16x16x32_bf16 v[28:31], v[64:67], v[128:131], v[28:31]
    ds_read_b128 v[108:111], v4 offset:5120
    v_cvt_pk_bf16_f32 v201, v48, v52
    v_mfma_f32_16x16x32_bf16 v[28:31], v[68:71], v[132:135], v[28:31]
    v_mfma_f32_16x16x32_bf16 v[28:31], v[72:75], v[136:139], v[28:31]
    ds_read_b128 v[112:115], v4 offset:6144
    buffer_store_dwordx2 v[200:201], v5, s[36:39], s56 offen offset:512 nt sc1
    v_mfma_f32_16x16x32_bf16 v[28:31], v[76:79], v[140:143], v[28:31]
    v_cvt_pk_bf16_f32 v202, v41, v45
    v_mfma_f32_16x16x32_bf16 v[28:31], v[80:83], v[144:147], v[28:31]
    ds_read_b128 v[116:119], v4 offset:7168
    v_mfma_f32_16x16x32_bf16 v[28:31], v[84:87], v[148:151], v[28:31]
    v_cvt_pk_bf16_f32 v203, v49, v53
    v_mfma_f32_16x16x32_bf16 v[32:35], v[56:59], v[152:155], 0
    buffer_store_dwordx2 v[202:203], v5, s[36:39], s57 offen offset:512 nt sc1
    v_mfma_f32_16x16x32_bf16 v[32:35], v[60:63], v[156:159], v[32:35]
    v_mfma_f32_16x16x32_bf16 v[32:35], v[64:67], v[160:163], v[32:35]
    v_cvt_pk_bf16_f32 v204, v42, v46
    v_mfma_f32_16x16x32_bf16 v[32:35], v[68:71], v[164:167], v[32:35]
    v_cvt_pk_bf16_f32 v205, v50, v54
    v_mfma_f32_16x16x32_bf16 v[32:35], v[72:75], v[168:171], v[32:35]
    v_mfma_f32_16x16x32_bf16 v[32:35], v[76:79], v[172:175], v[32:35]
    buffer_store_dwordx2 v[204:205], v5, s[36:39], s58 offen offset:512 nt sc1
    v_mfma_f32_16x16x32_bf16 v[32:35], v[80:83], v[176:179], v[32:35]
    v_cvt_pk_bf16_f32 v206, v43, v47
    v_mfma_f32_16x16x32_bf16 v[32:35], v[84:87], v[180:183], v[32:35]
    v_mfma_f32_16x16x32_bf16 v[36:39], v[56:59], v[12:15], 0
    v_cvt_pk_bf16_f32 v207, v51, v55
    v_mfma_f32_16x16x32_bf16 v[36:39], v[60:63], v[16:19], v[36:39]
    buffer_store_dwordx2 v[206:207], v5, s[36:39], s59 offen offset:512 nt sc1
    v_mfma_f32_16x16x32_bf16 v[36:39], v[64:67], v[20:23], v[36:39]
    v_mfma_f32_16x16x32_bf16 v[36:39], v[68:71], v[248:251], v[36:39]
    v_mfma_f32_16x16x32_bf16 v[36:39], v[72:75], v[252:255], v[36:39]
    v_mfma_f32_16x16x32_bf16 v[36:39], v[76:79], v[184:187], v[36:39]
    v_mfma_f32_16x16x32_bf16 v[36:39], v[80:83], v[188:191], v[36:39]
    v_mfma_f32_16x16x32_bf16 v[36:39], v[84:87], v[192:195], v[36:39]
    s_waitcnt lgkmcnt(0)
    s_barrier
    v_mfma_f32_16x16x32_bf16 v[40:43], v[88:91], v[216:219], 0
    ds_read_b128 v[56:59], v4 offset:48128
    v_mfma_f32_16x16x32_bf16 v[40:43], v[92:95], v[220:223], v[40:43]
    v_mfma_f32_16x16x32_bf16 v[40:43], v[96:99], v[224:227], v[40:43]
    ds_read_b128 v[60:63], v4 offset:49152
    v_mfma_f32_16x16x32_bf16 v[40:43], v[100:103], v[228:231], v[40:43]
    v_mfma_f32_16x16x32_bf16 v[40:43], v[104:107], v[232:235], v[40:43]
    ds_read_b128 v[64:67], v4 offset:50176
    v_mfma_f32_16x16x32_bf16 v[40:43], v[108:111], v[236:239], v[40:43]
    v_mfma_f32_16x16x32_bf16 v[40:43], v[112:115], v[240:243], v[40:43]
    ds_read_b128 v[68:71], v4 offset:51200
    v_mfma_f32_16x16x32_bf16 v[40:43], v[116:119], v[244:247], v[40:43]
    v_mfma_f32_16x16x32_bf16 v[44:47], v[88:91], v[120:123], 0
    ds_read_b128 v[72:75], v4 offset:52224
    v_mfma_f32_16x16x32_bf16 v[44:47], v[92:95], v[124:127], v[44:47]
    v_cvt_pk_bf16_f32 v200, v24, v28
    v_mfma_f32_16x16x32_bf16 v[44:47], v[96:99], v[128:131], v[44:47]
    ds_read_b128 v[76:79], v4 offset:53248
    v_cvt_pk_bf16_f32 v201, v32, v36
    v_mfma_f32_16x16x32_bf16 v[44:47], v[100:103], v[132:135], v[44:47]
    v_mfma_f32_16x16x32_bf16 v[44:47], v[104:107], v[136:139], v[44:47]
    ds_read_b128 v[80:83], v4 offset:54272
    buffer_store_dwordx2 v[200:201], v5, s[36:39], s56 offen offset:1024 nt sc1
    v_mfma_f32_16x16x32_bf16 v[44:47], v[108:111], v[140:143], v[44:47]
    v_cvt_pk_bf16_f32 v202, v25, v29
    v_mfma_f32_16x16x32_bf16 v[44:47], v[112:115], v[144:147], v[44:47]
    ds_read_b128 v[84:87], v4 offset:55296
    v_mfma_f32_16x16x32_bf16 v[44:47], v[116:119], v[148:151], v[44:47]
    v_cvt_pk_bf16_f32 v203, v33, v37
    v_mfma_f32_16x16x32_bf16 v[48:51], v[88:91], v[152:155], 0
    buffer_store_dwordx2 v[202:203], v5, s[36:39], s57 offen offset:1024 nt sc1
    v_mfma_f32_16x16x32_bf16 v[48:51], v[92:95], v[156:159], v[48:51]
    v_mfma_f32_16x16x32_bf16 v[48:51], v[96:99], v[160:163], v[48:51]
    v_cvt_pk_bf16_f32 v204, v26, v30
    v_mfma_f32_16x16x32_bf16 v[48:51], v[100:103], v[164:167], v[48:51]
    v_cvt_pk_bf16_f32 v205, v34, v38
    v_mfma_f32_16x16x32_bf16 v[48:51], v[104:107], v[168:171], v[48:51]
    v_mfma_f32_16x16x32_bf16 v[48:51], v[108:111], v[172:175], v[48:51]
    buffer_store_dwordx2 v[204:205], v5, s[36:39], s58 offen offset:1024 nt sc1
    v_mfma_f32_16x16x32_bf16 v[48:51], v[112:115], v[176:179], v[48:51]
    v_cvt_pk_bf16_f32 v206, v27, v31
    v_mfma_f32_16x16x32_bf16 v[48:51], v[116:119], v[180:183], v[48:51]
    v_mfma_f32_16x16x32_bf16 v[52:55], v[88:91], v[12:15], 0
    v_cvt_pk_bf16_f32 v207, v35, v39
    v_mfma_f32_16x16x32_bf16 v[52:55], v[92:95], v[16:19], v[52:55]
    buffer_store_dwordx2 v[206:207], v5, s[36:39], s59 offen offset:1024 nt sc1
    v_mfma_f32_16x16x32_bf16 v[52:55], v[96:99], v[20:23], v[52:55]
    v_mfma_f32_16x16x32_bf16 v[52:55], v[100:103], v[248:251], v[52:55]
    v_mfma_f32_16x16x32_bf16 v[52:55], v[104:107], v[252:255], v[52:55]
    v_mfma_f32_16x16x32_bf16 v[52:55], v[108:111], v[184:187], v[52:55]
    v_mfma_f32_16x16x32_bf16 v[52:55], v[112:115], v[188:191], v[52:55]
    v_mfma_f32_16x16x32_bf16 v[52:55], v[116:119], v[192:195], v[52:55]
    s_waitcnt lgkmcnt(0)
    s_barrier
    v_mfma_f32_16x16x32_bf16 v[24:27], v[56:59], v[216:219], 0
    ds_read_b128 v[88:91], v4 offset:56320
    v_mfma_f32_16x16x32_bf16 v[24:27], v[60:63], v[220:223], v[24:27]
    v_mfma_f32_16x16x32_bf16 v[24:27], v[64:67], v[224:227], v[24:27]
    ds_read_b128 v[92:95], v4 offset:57344
    v_mfma_f32_16x16x32_bf16 v[24:27], v[68:71], v[228:231], v[24:27]
    v_mfma_f32_16x16x32_bf16 v[24:27], v[72:75], v[232:235], v[24:27]
    ds_read_b128 v[96:99], v4 offset:58368
    v_mfma_f32_16x16x32_bf16 v[24:27], v[76:79], v[236:239], v[24:27]
    v_mfma_f32_16x16x32_bf16 v[24:27], v[80:83], v[240:243], v[24:27]
    ds_read_b128 v[100:103], v4 offset:59392
    v_mfma_f32_16x16x32_bf16 v[24:27], v[84:87], v[244:247], v[24:27]
    v_mfma_f32_16x16x32_bf16 v[28:31], v[56:59], v[120:123], 0
    ds_read_b128 v[104:107], v4 offset:60416
    v_mfma_f32_16x16x32_bf16 v[28:31], v[60:63], v[124:127], v[28:31]
    v_cvt_pk_bf16_f32 v200, v40, v44
    v_mfma_f32_16x16x32_bf16 v[28:31], v[64:67], v[128:131], v[28:31]
    ds_read_b128 v[108:111], v4 offset:61440
    v_cvt_pk_bf16_f32 v201, v48, v52
    v_mfma_f32_16x16x32_bf16 v[28:31], v[68:71], v[132:135], v[28:31]
    v_mfma_f32_16x16x32_bf16 v[28:31], v[72:75], v[136:139], v[28:31]
    ds_read_b128 v[112:115], v4 offset:62464
    buffer_store_dwordx2 v[200:201], v5, s[36:39], s56 offen offset:1536 nt sc1
    v_mfma_f32_16x16x32_bf16 v[28:31], v[76:79], v[140:143], v[28:31]
    v_cvt_pk_bf16_f32 v202, v41, v45
    v_mfma_f32_16x16x32_bf16 v[28:31], v[80:83], v[144:147], v[28:31]
    ds_read_b128 v[116:119], v4 offset:63488
    v_mfma_f32_16x16x32_bf16 v[28:31], v[84:87], v[148:151], v[28:31]
    v_cvt_pk_bf16_f32 v203, v49, v53
    v_mfma_f32_16x16x32_bf16 v[32:35], v[56:59], v[152:155], 0
    buffer_store_dwordx2 v[202:203], v5, s[36:39], s57 offen offset:1536 nt sc1
    v_mfma_f32_16x16x32_bf16 v[32:35], v[60:63], v[156:159], v[32:35]
    v_mfma_f32_16x16x32_bf16 v[32:35], v[64:67], v[160:163], v[32:35]
    v_cvt_pk_bf16_f32 v204, v42, v46
    v_mfma_f32_16x16x32_bf16 v[32:35], v[68:71], v[164:167], v[32:35]
    v_cvt_pk_bf16_f32 v205, v50, v54
    v_mfma_f32_16x16x32_bf16 v[32:35], v[72:75], v[168:171], v[32:35]
    v_mfma_f32_16x16x32_bf16 v[32:35], v[76:79], v[172:175], v[32:35]
    buffer_store_dwordx2 v[204:205], v5, s[36:39], s58 offen offset:1536 nt sc1
    v_mfma_f32_16x16x32_bf16 v[32:35], v[80:83], v[176:179], v[32:35]
    v_cvt_pk_bf16_f32 v206, v43, v47
    v_mfma_f32_16x16x32_bf16 v[32:35], v[84:87], v[180:183], v[32:35]
    v_mfma_f32_16x16x32_bf16 v[36:39], v[56:59], v[12:15], 0
    v_cvt_pk_bf16_f32 v207, v51, v55
    v_mfma_f32_16x16x32_bf16 v[36:39], v[60:63], v[16:19], v[36:39]
    buffer_store_dwordx2 v[206:207], v5, s[36:39], s59 offen offset:1536 nt sc1
    v_mfma_f32_16x16x32_bf16 v[36:39], v[64:67], v[20:23], v[36:39]
    v_mfma_f32_16x16x32_bf16 v[36:39], v[68:71], v[248:251], v[36:39]
    v_mfma_f32_16x16x32_bf16 v[36:39], v[72:75], v[252:255], v[36:39]
    v_mfma_f32_16x16x32_bf16 v[36:39], v[76:79], v[184:187], v[36:39]
    v_mfma_f32_16x16x32_bf16 v[36:39], v[80:83], v[188:191], v[36:39]
    v_mfma_f32_16x16x32_bf16 v[36:39], v[84:87], v[192:195], v[36:39]
    s_waitcnt lgkmcnt(0)
    s_barrier
    v_mfma_f32_16x16x32_bf16 v[40:43], v[88:91], v[216:219], 0
    ds_read_b128 v[56:59], v4 offset:30720
    v_mfma_f32_16x16x32_bf16 v[40:43], v[92:95], v[220:223], v[40:43]
    v_mfma_f32_16x16x32_bf16 v[40:43], v[96:99], v[224:227], v[40:43]
    ds_read_b128 v[60:63], v4 offset:31744
    v_mfma_f32_16x16x32_bf16 v[40:43], v[100:103], v[228:231], v[40:43]
    v_mfma_f32_16x16x32_bf16 v[40:43], v[104:107], v[232:235], v[40:43]
    ds_read_b128 v[64:67], v4 offset:32768
    v_mfma_f32_16x16x32_bf16 v[40:43], v[108:111], v[236:239], v[40:43]
    v_mfma_f32_16x16x32_bf16 v[40:43], v[112:115], v[240:243], v[40:43]
    ds_read_b128 v[68:71], v4 offset:33792
    v_mfma_f32_16x16x32_bf16 v[40:43], v[116:119], v[244:247], v[40:43]
    v_mfma_f32_16x16x32_bf16 v[44:47], v[88:91], v[120:123], 0
    ds_read_b128 v[72:75], v4 offset:34816
    v_mfma_f32_16x16x32_bf16 v[44:47], v[92:95], v[124:127], v[44:47]
    v_cvt_pk_bf16_f32 v200, v24, v28
    v_mfma_f32_16x16x32_bf16 v[44:47], v[96:99], v[128:131], v[44:47]
    ds_read_b128 v[76:79], v4 offset:35840
    v_cvt_pk_bf16_f32 v201, v32, v36
    v_mfma_f32_16x16x32_bf16 v[44:47], v[100:103], v[132:135], v[44:47]
    v_mfma_f32_16x16x32_bf16 v[44:47], v[104:107], v[136:139], v[44:47]
    ds_read_b128 v[80:83], v4 offset:36864
    buffer_store_dwordx2 v[200:201], v5, s[36:39], s56 offen offset:2048 nt sc1
    v_mfma_f32_16x16x32_bf16 v[44:47], v[108:111], v[140:143], v[44:47]
    v_cvt_pk_bf16_f32 v202, v25, v29
    v_mfma_f32_16x16x32_bf16 v[44:47], v[112:115], v[144:147], v[44:47]
    ds_read_b128 v[84:87], v4 offset:37888
    v_mfma_f32_16x16x32_bf16 v[44:47], v[116:119], v[148:151], v[44:47]
    v_cvt_pk_bf16_f32 v203, v33, v37
    v_mfma_f32_16x16x32_bf16 v[48:51], v[88:91], v[152:155], 0
    buffer_store_dwordx2 v[202:203], v5, s[36:39], s57 offen offset:2048 nt sc1
    v_mfma_f32_16x16x32_bf16 v[48:51], v[92:95], v[156:159], v[48:51]
    v_mfma_f32_16x16x32_bf16 v[48:51], v[96:99], v[160:163], v[48:51]
    v_cvt_pk_bf16_f32 v204, v26, v30
    v_mfma_f32_16x16x32_bf16 v[48:51], v[100:103], v[164:167], v[48:51]
    v_cvt_pk_bf16_f32 v205, v34, v38
    v_mfma_f32_16x16x32_bf16 v[48:51], v[104:107], v[168:171], v[48:51]
    v_mfma_f32_16x16x32_bf16 v[48:51], v[108:111], v[172:175], v[48:51]
    buffer_store_dwordx2 v[204:205], v5, s[36:39], s58 offen offset:2048 nt sc1
    v_mfma_f32_16x16x32_bf16 v[48:51], v[112:115], v[176:179], v[48:51]
    v_cvt_pk_bf16_f32 v206, v27, v31
    v_mfma_f32_16x16x32_bf16 v[48:51], v[116:119], v[180:183], v[48:51]
    v_mfma_f32_16x16x32_bf16 v[52:55], v[88:91], v[12:15], 0
    v_cvt_pk_bf16_f32 v207, v35, v39
    v_mfma_f32_16x16x32_bf16 v[52:55], v[92:95], v[16:19], v[52:55]
    buffer_store_dwordx2 v[206:207], v5, s[36:39], s59 offen offset:2048 nt sc1
    v_mfma_f32_16x16x32_bf16 v[52:55], v[96:99], v[20:23], v[52:55]
    v_mfma_f32_16x16x32_bf16 v[52:55], v[100:103], v[248:251], v[52:55]
    v_mfma_f32_16x16x32_bf16 v[52:55], v[104:107], v[252:255], v[52:55]
    v_mfma_f32_16x16x32_bf16 v[52:55], v[108:111], v[184:187], v[52:55]
    v_mfma_f32_16x16x32_bf16 v[52:55], v[112:115], v[188:191], v[52:55]
    v_mfma_f32_16x16x32_bf16 v[52:55], v[116:119], v[192:195], v[52:55]
    s_waitcnt lgkmcnt(0)
    s_barrier
    v_mfma_f32_16x16x32_bf16 v[24:27], v[56:59], v[216:219], 0
    ds_read_b128 v[88:91], v4 offset:38912
    v_mfma_f32_16x16x32_bf16 v[24:27], v[60:63], v[220:223], v[24:27]
    v_mfma_f32_16x16x32_bf16 v[24:27], v[64:67], v[224:227], v[24:27]
    ds_read_b128 v[92:95], v4 offset:39936
    v_mfma_f32_16x16x32_bf16 v[24:27], v[68:71], v[228:231], v[24:27]
    v_mfma_f32_16x16x32_bf16 v[24:27], v[72:75], v[232:235], v[24:27]
    ds_read_b128 v[96:99], v4 offset:40960
    v_mfma_f32_16x16x32_bf16 v[24:27], v[76:79], v[236:239], v[24:27]
    v_mfma_f32_16x16x32_bf16 v[24:27], v[80:83], v[240:243], v[24:27]
    ds_read_b128 v[100:103], v4 offset:41984
    v_mfma_f32_16x16x32_bf16 v[24:27], v[84:87], v[244:247], v[24:27]
    v_mfma_f32_16x16x32_bf16 v[28:31], v[56:59], v[120:123], 0
    ds_read_b128 v[104:107], v4 offset:43008
    v_mfma_f32_16x16x32_bf16 v[28:31], v[60:63], v[124:127], v[28:31]
    v_cvt_pk_bf16_f32 v200, v40, v44
    v_mfma_f32_16x16x32_bf16 v[28:31], v[64:67], v[128:131], v[28:31]
    ds_read_b128 v[108:111], v4 offset:44032
    v_cvt_pk_bf16_f32 v201, v48, v52
    v_mfma_f32_16x16x32_bf16 v[28:31], v[68:71], v[132:135], v[28:31]
    v_mfma_f32_16x16x32_bf16 v[28:31], v[72:75], v[136:139], v[28:31]
    ds_read_b128 v[112:115], v4 offset:45056
    buffer_store_dwordx2 v[200:201], v5, s[36:39], s56 offen offset:2560 nt sc1
    v_mfma_f32_16x16x32_bf16 v[28:31], v[76:79], v[140:143], v[28:31]
    v_cvt_pk_bf16_f32 v202, v41, v45
    v_mfma_f32_16x16x32_bf16 v[28:31], v[80:83], v[144:147], v[28:31]
    ds_read_b128 v[116:119], v4 offset:46080
    v_mfma_f32_16x16x32_bf16 v[28:31], v[84:87], v[148:151], v[28:31]
    v_cvt_pk_bf16_f32 v203, v49, v53
    v_mfma_f32_16x16x32_bf16 v[32:35], v[56:59], v[152:155], 0
    buffer_store_dwordx2 v[202:203], v5, s[36:39], s57 offen offset:2560 nt sc1
    v_mfma_f32_16x16x32_bf16 v[32:35], v[60:63], v[156:159], v[32:35]
    v_mfma_f32_16x16x32_bf16 v[32:35], v[64:67], v[160:163], v[32:35]
    v_cvt_pk_bf16_f32 v204, v42, v46
    v_mfma_f32_16x16x32_bf16 v[32:35], v[68:71], v[164:167], v[32:35]
    v_cvt_pk_bf16_f32 v205, v50, v54
    v_mfma_f32_16x16x32_bf16 v[32:35], v[72:75], v[168:171], v[32:35]
    v_mfma_f32_16x16x32_bf16 v[32:35], v[76:79], v[172:175], v[32:35]
    buffer_store_dwordx2 v[204:205], v5, s[36:39], s58 offen offset:2560 nt sc1
    v_mfma_f32_16x16x32_bf16 v[32:35], v[80:83], v[176:179], v[32:35]
    v_cvt_pk_bf16_f32 v206, v43, v47
    v_mfma_f32_16x16x32_bf16 v[32:35], v[84:87], v[180:183], v[32:35]
    v_mfma_f32_16x16x32_bf16 v[36:39], v[56:59], v[12:15], 0
    v_cvt_pk_bf16_f32 v207, v51, v55
    v_mfma_f32_16x16x32_bf16 v[36:39], v[60:63], v[16:19], v[36:39]
    buffer_store_dwordx2 v[206:207], v5, s[36:39], s59 offen offset:2560 nt sc1
    v_mfma_f32_16x16x32_bf16 v[36:39], v[64:67], v[20:23], v[36:39]
    v_mfma_f32_16x16x32_bf16 v[36:39], v[68:71], v[248:251], v[36:39]
    v_mfma_f32_16x16x32_bf16 v[36:39], v[72:75], v[252:255], v[36:39]
    v_mfma_f32_16x16x32_bf16 v[36:39], v[76:79], v[184:187], v[36:39]
    v_mfma_f32_16x16x32_bf16 v[36:39], v[80:83], v[188:191], v[36:39]
    v_mfma_f32_16x16x32_bf16 v[36:39], v[84:87], v[192:195], v[36:39]
    s_waitcnt lgkmcnt(0)
    v_mfma_f32_16x16x32_bf16 v[40:43], v[88:91], v[216:219], 0
    v_mfma_f32_16x16x32_bf16 v[40:43], v[92:95], v[220:223], v[40:43]
    v_mfma_f32_16x16x32_bf16 v[40:43], v[96:99], v[224:227], v[40:43]
    v_mfma_f32_16x16x32_bf16 v[40:43], v[100:103], v[228:231], v[40:43]
    v_mfma_f32_16x16x32_bf16 v[40:43], v[104:107], v[232:235], v[40:43]
    v_mfma_f32_16x16x32_bf16 v[40:43], v[108:111], v[236:239], v[40:43]
    v_mfma_f32_16x16x32_bf16 v[40:43], v[112:115], v[240:243], v[40:43]
    v_mfma_f32_16x16x32_bf16 v[40:43], v[116:119], v[244:247], v[40:43]
    v_mfma_f32_16x16x32_bf16 v[44:47], v[88:91], v[120:123], 0
    v_mfma_f32_16x16x32_bf16 v[44:47], v[92:95], v[124:127], v[44:47]
    v_cvt_pk_bf16_f32 v200, v24, v28
    v_mfma_f32_16x16x32_bf16 v[44:47], v[96:99], v[128:131], v[44:47]
    v_cvt_pk_bf16_f32 v201, v32, v36
    v_mfma_f32_16x16x32_bf16 v[44:47], v[100:103], v[132:135], v[44:47]
    v_mfma_f32_16x16x32_bf16 v[44:47], v[104:107], v[136:139], v[44:47]
    buffer_store_dwordx2 v[200:201], v5, s[36:39], s56 offen offset:3072 nt sc1
    v_mfma_f32_16x16x32_bf16 v[44:47], v[108:111], v[140:143], v[44:47]
    v_cvt_pk_bf16_f32 v202, v25, v29
    v_mfma_f32_16x16x32_bf16 v[44:47], v[112:115], v[144:147], v[44:47]
    v_mfma_f32_16x16x32_bf16 v[44:47], v[116:119], v[148:151], v[44:47]
    v_cvt_pk_bf16_f32 v203, v33, v37
    v_mfma_f32_16x16x32_bf16 v[48:51], v[88:91], v[152:155], 0
    buffer_store_dwordx2 v[202:203], v5, s[36:39], s57 offen offset:3072 nt sc1
    v_mfma_f32_16x16x32_bf16 v[48:51], v[92:95], v[156:159], v[48:51]
    v_mfma_f32_16x16x32_bf16 v[48:51], v[96:99], v[160:163], v[48:51]
    v_cvt_pk_bf16_f32 v204, v26, v30
    v_mfma_f32_16x16x32_bf16 v[48:51], v[100:103], v[164:167], v[48:51]
    v_cvt_pk_bf16_f32 v205, v34, v38
    v_mfma_f32_16x16x32_bf16 v[48:51], v[104:107], v[168:171], v[48:51]
    v_mfma_f32_16x16x32_bf16 v[48:51], v[108:111], v[172:175], v[48:51]
    buffer_store_dwordx2 v[204:205], v5, s[36:39], s58 offen offset:3072 nt sc1
    v_mfma_f32_16x16x32_bf16 v[48:51], v[112:115], v[176:179], v[48:51]
    v_cvt_pk_bf16_f32 v206, v27, v31
    v_mfma_f32_16x16x32_bf16 v[48:51], v[116:119], v[180:183], v[48:51]
    v_mfma_f32_16x16x32_bf16 v[52:55], v[88:91], v[12:15], 0
    v_cvt_pk_bf16_f32 v207, v35, v39
    v_mfma_f32_16x16x32_bf16 v[52:55], v[92:95], v[16:19], v[52:55]
    buffer_store_dwordx2 v[206:207], v5, s[36:39], s59 offen offset:3072 nt sc1
    v_mfma_f32_16x16x32_bf16 v[52:55], v[96:99], v[20:23], v[52:55]
    v_mfma_f32_16x16x32_bf16 v[52:55], v[100:103], v[248:251], v[52:55]
    v_mfma_f32_16x16x32_bf16 v[52:55], v[104:107], v[252:255], v[52:55]
    v_mfma_f32_16x16x32_bf16 v[52:55], v[108:111], v[184:187], v[52:55]
    v_mfma_f32_16x16x32_bf16 v[52:55], v[112:115], v[188:191], v[52:55]
    v_mfma_f32_16x16x32_bf16 v[52:55], v[116:119], v[192:195], v[52:55]
    s_nop 7
    v_cvt_pk_bf16_f32 v200, v40, v44
    v_cvt_pk_bf16_f32 v201, v48, v52
    buffer_store_dwordx2 v[200:201], v5, s[36:39], s56 offen offset:3584 nt sc1
    v_cvt_pk_bf16_f32 v202, v41, v45
    v_cvt_pk_bf16_f32 v203, v49, v53
    buffer_store_dwordx2 v[202:203], v5, s[36:39], s57 offen offset:3584 nt sc1
    v_cvt_pk_bf16_f32 v204, v42, v46
    v_cvt_pk_bf16_f32 v205, v50, v54
    buffer_store_dwordx2 v[204:205], v5, s[36:39], s58 offen offset:3584 nt sc1
    v_cvt_pk_bf16_f32 v206, v43, v47
    v_cvt_pk_bf16_f32 v207, v51, v55
    buffer_store_dwordx2 v[206:207], v5, s[36:39], s59 offen offset:3584 nt sc1
    s_endpgm
L_c_ge:
    s_waitcnt vmcnt(0) lgkmcnt(0)
    s_barrier
    s_branch L_c_join
L_hmain:
    s_waitcnt vmcnt(3)
    s_barrier
    s_add_u32 m0, s31, 94208
    s_mov_b32 s68, 16384
    buffer_load_dwordx4 v21, s[36:39], s68 offen sc1 lds
    s_add_u32 m0, s31, 98304
    s_mov_b32 s68, 278528
    buffer_load_dwordx4 v21, s[36:39], s68 offen sc1 lds
    s_add_u32 m0, s31, 102400
    s_mov_b32 s68, 540672
    buffer_load_dwordx4 v21, s[36:39], s68 offen sc1 lds
    s_add_u32 m0, s31, 106496
    s_mov_b32 s68, 802816
    buffer_load_dwordx4 v21, s[36:39], s68 offen sc1 lds
    s_add_u32 m0, s31, 110592
    s_mov_b32 s68, 1064960
    buffer_load_dwordx4 v21, s[36:39], s68 offen sc1 lds
    s_add_u32 m0, s31, 114688
    s_mov_b32 s68, 1327104
    buffer_load_dwordx4 v21, s[36:39], s68 offen sc1 lds
    s_add_u32 m0, s31, 118784
    s_mov_b32 s68, 1589248
    buffer_load_dwordx4 v21, s[36:39], s68 offen sc1 lds
    s_add_u32 m0, s31, 122880
    s_mov_b32 s68, 1851392
    buffer_load_dwordx4 v21, s[36:39], s68 offen sc1 lds
    s_mov_b32 s73, s55
    buffer_load_dwordx2 v[48:49], v16, s[44:47], s73 offen
    s_add_u32 s73, s73, s65
    buffer_load_dwordx2 v[50:51], v16, s[44:47], s73 offen
    s_add_u32 s73, s73, s65
    buffer_load_dwordx2 v[52:53], v16, s[44:47], s73 offen
    s_add_u32 s73, s73, s65
    buffer_load_dwordx2 v[54:55], v16, s[44:47], s73 offen
    s_add_u32 s55, s55, s66
    s_mov_b32 s73, s55
    buffer_load_dwordx2 v[56:57], v16, s[44:47], s73 offen
    s_add_u32 s73, s73, s65
    buffer_load_dwordx2 v[58:59], v16, s[44:47], s73 offen
    s_add_u32 s73, s73, s65
    buffer_load_dwordx2 v[60:61], v16, s[44:47], s73 offen
    s_add_u32 s73, s73, s65
    buffer_load_dwordx2 v[62:63], v16, s[44:47], s73 offen
    s_load_dword s82, s[80:81], 49152
    s_load_dword s82, s[80:81], 48896
    s_load_dword s82, s[80:81], 65536
    s_load_dword s82, s[80:81], 65280
    s_load_dword s82, s[60:61], 0
    s_load_dword s82, s[60:61], -1024
    s_load_dword s82, s[60:61], 64
    s_load_dword s82, s[60:61], -960
    s_load_dword s82, s[60:61], 128
    s_load_dword s82, s[60:61], -896
    s_load_dword s82, s[60:61], 192
    s_load_dword s82, s[60:61], -832
    s_waitcnt vmcnt(16)
    s_barrier
    s_mov_b64 exec, 3
    buffer_store_dword v40, v32, s[40:43], 0 offen sc1
    s_mov_b64 exec, -1
    s_mov_b32 s32, s4
    s_mov_b32 s33, s5
    s_add_u32 m0, s31, 44032
    s_nop 0
    buffer_load_dwordx4 v6, s[32:35], 0 offen nt sc1 lds
    s_add_u32 m0, s31, 48128
    s_nop 0
    buffer_load_dwordx4 v7, s[32:35], 0 offen nt sc1 lds
    s_add_u32 m0, s31, 52224
    s_nop 0
    buffer_load_dwordx4 v8, s[32:35], 0 offen nt sc1 lds
    s_add_u32 m0, s31, 56320
    s_nop 0
    buffer_load_dwordx4 v9, s[32:35], 0 offen nt sc1 lds
    s_mov_b32 m0, 60416
    s_mov_b64 exec, s[58:59]
    buffer_load_dwordx4 v10, s[32:35], 0 offen nt sc1 lds
    s_mov_b64 exec, -1
    s_add_u32 m0, s31, 0
    s_mov_b32 s68, 131072
    buffer_load_dwordx4 v21, s[36:39], s68 offen sc1 lds
    s_add_u32 m0, s31, 4096
    s_mov_b32 s68, 393216
    buffer_load_dwordx4 v21, s[36:39], s68 offen sc1 lds
    s_add_u32 m0, s31, 8192
    s_mov_b32 s68, 655360
    buffer_load_dwordx4 v21, s[36:39], s68 offen sc1 lds
    s_add_u32 m0, s31, 12288
    s_mov_b32 s68, 917504
    buffer_load_dwordx4 v21, s[36:39], s68 offen sc1 lds
    s_add_u32 m0, s31, 16384
    s_mov_b32 s68, 1179648
    buffer_load_dwordx4 v21, s[36:39], s68 offen sc1 lds
    s_add_u32 m0, s31, 20480
    s_mov_b32 s68, 1441792
    buffer_load_dwordx4 v21, s[36:39], s68 offen sc1 lds
    s_add_u32 m0, s31, 24576
    s_mov_b32 s68, 1703936
    buffer_load_dwordx4 v21, s[36:39], s68 offen sc1 lds
    s_load_dword s78, s[74:75], 128
    s_load_dword s78, s[74:75], 192
    s_load_dword s78, s[74:75], 1152
    s_load_dword s78, s[74:75], 1216
    s_load_dword s78, s[74:75], 2176
    s_load_dword s78, s[74:75], 2240
    s_load_dword s78, s[74:75], 3200
    s_load_dword s78, s[74:75], 3264
    s_load_dword s78, s[74:75], 4224
    s_load_dword s78, s[74:75], 4288
    s_waitcnt vmcnt(21)
    s_barrier
    s_waitcnt vmcnt(13)
    v_perm_b32 v80, v50, v48, s50
    v_perm_b32 v81, v54, v52, s50
    v_perm_b32 v82, v58, v56, s50
    v_perm_b32 v83, v62, v60, s50
    buffer_store_dwordx4 v[80:83], v31, s[40:43], s64 offen sc1
    s_add_u32 s64, s64, s48
    s_add_u32 m0, s31, 61440
    s_mov_b32 s68, 147456
    buffer_load_dwordx4 v21, s[36:39], s68 offen sc1 lds
    s_add_u32 m0, s31, 65536
    s_mov_b32 s68, 409600
    buffer_load_dwordx4 v21, s[36:39], s68 offen sc1 lds
    s_add_u32 m0, s31, 69632
    s_mov_b32 s68, 671744
    buffer_load_dwordx4 v21, s[36:39], s68 offen sc1 lds
    s_add_u32 m0, s31, 73728
    s_mov_b32 s68, 933888
    buffer_load_dwordx4 v21, s[36:39], s68 offen sc1 lds
    s_add_u32 m0, s31, 77824
    s_mov_b32 s68, 1196032
    buffer_load_dwordx4 v21, s[36:39], s68 offen sc1 lds
    s_add_u32 m0, s31, 81920
    s_mov_b32 s68, 1458176
    buffer_load_dwordx4 v21, s[36:39], s68 offen sc1 lds
    s_add_u32 m0, s31, 86016
    s_mov_b32 s68, 1720320
    buffer_load_dwordx4 v21, s[36:39], s68 offen sc1 lds
    s_mov_b64 exec, 0
    s_branch L_pg1
L_pb1:
    s_mov_b64 exec, -1
    s_load_dword s82, s[60:61], 32768
    s_load_dword s82, s[60:61], 31744
    s_load_dword s82, s[60:61], 32832
    s_load_dword s82, s[60:61], 31808
    s_load_dword s82, s[60:61], 32896
    s_load_dword s82, s[60:61], 31872
    s_load_dword s82, s[60:61], 32960
    s_load_dword s82, s[60:61], 31936
    s_barrier
    v_perm_b32 v84, v50, v48, s51
    v_perm_b32 v85, v54, v52, s51
    v_perm_b32 v86, v58, v56, s51
    v_perm_b32 v87, v62, v60, s51
    buffer_store_dwordx4 v[84:87], v31, s[40:43], s64 offen sc1
    s_add_u32 s64, s64, s48
    s_add_u32 s32, s4, 8192000
    s_addc_u32 s33, s5, 0
    s_add_u32 m0, s31, 144384
    s_nop 0
    buffer_load_dwordx4 v6, s[32:35], 0 offen nt sc1 lds
    s_add_u32 m0, s31, 148480
    s_nop 0
    buffer_load_dwordx4 v7, s[32:35], 0 offen nt sc1 lds
    s_add_u32 m0, s31, 152576
    s_nop 0
    buffer_load_dwordx4 v8, s[32:35], 0 offen nt sc1 lds
    s_add_u32 m0, s31, 156672
    s_nop 0
    buffer_load_dwordx4 v9, s[32:35], 0 offen nt sc1 lds
    s_mov_b32 m0, 160768
    s_mov_b64 exec, s[58:59]
    buffer_load_dwordx4 v10, s[32:35], 0 offen nt sc1 lds
    s_mov_b64 exec, -1
    s_add_u32 m0, s31, 94208
    s_mov_b32 s68, 32768
    buffer_load_dwordx4 v21, s[36:39], s68 offen sc1 lds
    s_add_u32 m0, s31, 98304
    s_mov_b32 s68, 294912
    buffer_load_dwordx4 v21, s[36:39], s68 offen sc1 lds
    s_add_u32 m0, s31, 102400
    s_mov_b32 s68, 557056
    buffer_load_dwordx4 v21, s[36:39], s68 offen sc1 lds
    s_add_u32 m0, s31, 106496
    s_mov_b32 s68, 819200
    buffer_load_dwordx4 v21, s[36:39], s68 offen sc1 lds
    s_add_u32 m0, s31, 110592
    s_mov_b32 s68, 1081344
    buffer_load_dwordx4 v21, s[36:39], s68 offen sc1 lds
    s_add_u32 m0, s31, 114688
    s_mov_b32 s68, 1343488
    buffer_load_dwordx4 v21, s[36:39], s68 offen sc1 lds
    s_add_u32 m0, s31, 118784
    s_mov_b32 s68, 1605632
    buffer_load_dwordx4 v21, s[36:39], s68 offen sc1 lds
    s_add_u32 m0, s31, 122880
    s_mov_b32 s68, 1867776
    buffer_load_dwordx4 v21, s[36:39], s68 offen sc1 lds
    s_load_dword s78, s[74:75], 5248
    s_load_dword s78, s[74:75], 5312
    s_load_dword s78, s[74:75], 6272
    s_load_dword s78, s[74:75], 6336
    s_load_dword s78, s[74:75], 7296
    s_load_dword s78, s[74:75], 7360
    s_load_dword s78, s[74:75], 8320
    s_load_dword s78, s[74:75], 8384
    s_load_dword s78, s[76:77], 128
    s_load_dword s78, s[76:77], 192
    s_waitcnt vmcnt(22)
    s_barrier
    v_perm_b32 v88, v51, v49, s50
    v_perm_b32 v89, v55, v53, s50
    v_perm_b32 v90, v59, v57, s50
    v_perm_b32 v91, v63, v61, s50
    buffer_store_dwordx4 v[88:91], v31, s[40:43], s64 offen sc1
    s_add_u32 s64, s64, s48
    s_mov_b32 s32, s4
    s_mov_b32 s33, s5
    s_add_u32 m0, s31, 126976
    s_mov_b32 s68, 128
    buffer_load_dwordx4 v1, s[32:35], s68 offen nt sc1 lds
    s_add_u32 m0, s31, 131072
    s_mov_b32 s68, 128
    buffer_load_dwordx4 v2, s[32:35], s68 offen nt sc1 lds
    s_add_u32 m0, s31, 135168
    s_mov_b32 s68, 128
    buffer_load_dwordx4 v3, s[32:35], s68 offen nt sc1 lds
    s_add_u32 m0, s31, 139264
    s_mov_b32 s68, 128
    buffer_load_dwordx4 v4, s[32:35], s68 offen nt sc1 lds
    s_mov_b32 m0, 143360
    s_mov_b64 exec, s[58:59]
    s_mov_b32 s68, 128
    buffer_load_dwordx4 v5, s[32:35], s68 offen nt sc1 lds
    s_mov_b64 exec, -1
    s_load_dword s78, s[76:77], 1152
    s_load_dword s78, s[76:77], 1216
    s_load_dword s78, s[76:77], 2176
    s_load_dword s78, s[76:77], 2240
    s_load_dword s78, s[76:77], 3200
    s_load_dword s78, s[76:77], 3264
    s_load_dword s78, s[76:77], 4224
    s_load_dword s78, s[76:77], 4288
    s_load_dword s78, s[76:77], 5248
    s_load_dword s78, s[76:77], 5312
    s_waitcnt vmcnt(14)
    s_barrier
    v_perm_b32 v92, v51, v49, s51
    v_perm_b32 v93, v55, v53, s51
    v_perm_b32 v94, v59, v57, s51
    v_perm_b32 v95, v63, v61, s51
    buffer_store_dwordx4 v[92:95], v31, s[40:43], s64 offen sc1
    s_add_u32 s64, s64, s48
    s_add_u32 m0, s31, 0
    s_mov_b32 s68, 49152
    buffer_load_dwordx4 v21, s[36:39], s68 offen sc1 lds
    s_add_u32 m0, s31, 4096
    s_mov_b32 s68, 311296
    buffer_load_dwordx4 v21, s[36:39], s68 offen sc1 lds
    s_add_u32 m0, s31, 8192
    s_mov_b32 s68, 573440
    buffer_load_dwordx4 v21, s[36:39], s68 offen sc1 lds
    s_add_u32 m0, s31, 12288
    s_mov_b32 s68, 835584
    buffer_load_dwordx4 v21, s[36:39], s68 offen sc1 lds
    s_add_u32 m0, s31, 16384
    s_mov_b32 s68, 1097728
    buffer_load_dwordx4 v21, s[36:39], s68 offen sc1 lds
    s_add_u32 m0, s31, 20480
    s_mov_b32 s68, 1359872
    buffer_load_dwordx4 v21, s[36:39], s68 offen sc1 lds
    s_add_u32 m0, s31, 24576
    s_mov_b32 s68, 1622016
    buffer_load_dwordx4 v21, s[36:39], s68 offen sc1 lds
    s_add_u32 m0, s31, 28672
    s_mov_b32 s68, 1884160
    buffer_load_dwordx4 v21, s[36:39], s68 offen sc1 lds
    s_load_dword s82, s[60:61], 65536
    s_load_dword s82, s[60:61], 64512
    s_load_dword s82, s[60:61], 65600
    s_load_dword s82, s[60:61], 64576
    s_load_dword s82, s[60:61], 65664
    s_load_dword s82, s[60:61], 64640
    s_load_dword s82, s[60:61], 65728
    s_load_dword s82, s[60:61], 64704
    s_barrier
    s_mov_b64 exec, 0
    s_branch L_pg2
L_pb2:
    s_mov_b64 exec, -1
    s_mov_b64 exec, 0
    s_branch L_pg13
L_pb13:
    s_mov_b64 exec, -1
    s_load_dword s78, s[76:77], 6272
    s_load_dword s78, s[76:77], 6336
    s_load_dword s78, s[76:77], 7296
    s_load_dword s78, s[76:77], 7360
    s_load_dword s78, s[76:77], 8320
    s_load_dword s78, s[76:77], 8384
    s_load_dword s78, s[74:75], 640
    s_load_dword s78, s[74:75], 704
    s_load_dword s78, s[74:75], 1664
    s_load_dword s78, s[74:75], 1728
    s_waitcnt vmcnt(8)
    s_barrier
    s_add_u32 s32, s4, 8192000
    s_addc_u32 s33, s5, 0
    s_add_u32 m0, s31, 44032
    s_mov_b32 s68, 128
    buffer_load_dwordx4 v1, s[32:35], s68 offen nt sc1 lds
    s_add_u32 m0, s31, 48128
    s_mov_b32 s68, 128
    buffer_load_dwordx4 v2, s[32:35], s68 offen nt sc1 lds
    s_add_u32 m0, s31, 52224
    s_mov_b32 s68, 128
    buffer_load_dwordx4 v3, s[32:35], s68 offen nt sc1 lds
    s_add_u32 m0, s31, 56320
    s_mov_b32 s68, 128
    buffer_load_dwordx4 v4, s[32:35], s68 offen nt sc1 lds
    s_mov_b32 m0, 60416
    s_mov_b64 exec, s[58:59]
    s_mov_b32 s68, 128
    buffer_load_dwordx4 v5, s[32:35], s68 offen nt sc1 lds
    s_mov_b64 exec, -1
    s_add_u32 m0, s31, 61440
    s_mov_b32 s68, 163840
    buffer_load_dwordx4 v21, s[36:39], s68 offen sc1 lds
    s_add_u32 m0, s31, 65536
    s_mov_b32 s68, 425984
    buffer_load_dwordx4 v21, s[36:39], s68 offen sc1 lds
    s_add_u32 m0, s31, 69632
    s_mov_b32 s68, 688128
    buffer_load_dwordx4 v21, s[36:39], s68 offen sc1 lds
    s_add_u32 m0, s31, 73728
    s_mov_b32 s68, 950272
    buffer_load_dwordx4 v21, s[36:39], s68 offen sc1 lds
    s_add_u32 m0, s31, 77824
    s_mov_b32 s68, 1212416
    buffer_load_dwordx4 v21, s[36:39], s68 offen sc1 lds
    s_add_u32 m0, s31, 81920
    s_mov_b32 s68, 1474560
    buffer_load_dwordx4 v21, s[36:39], s68 offen sc1 lds
    s_add_u32 m0, s31, 86016
    s_mov_b32 s68, 1736704
    buffer_load_dwordx4 v21, s[36:39], s68 offen sc1 lds
    s_cmp_eq_u32 s79, 0
    s_cselect_b32 s68, 0, 0x40000000
    buffer_atomic_add v38, v47, s[92:95], s68 offen sc1
    s_load_dword s78, s[74:75], 2688
    s_load_dword s78, s[74:75], 2752
    s_load_dword s78, s[74:75], 3712
    s_load_dword s78, s[74:75], 3776
    s_load_dword s78, s[74:75], 4736
    s_load_dword s78, s[74:75], 4800
    s_load_dword s78, s[74:75], 5760
    s_load_dword s78, s[74:75], 5824
    s_load_dword s78, s[74:75], 6784
    s_load_dword s78, s[74:75], 6848
    s_barrier
    s_mov_b32 s32, s4
    s_mov_b32 s33, s5
    s_add_u32 m0, s31, 144384
    s_mov_b32 s68, 128
    buffer_load_dwordx4 v6, s[32:35], s68 offen nt sc1 lds
    s_add_u32 m0, s31, 148480
    s_mov_b32 s68, 128
    buffer_load_dwordx4 v7, s[32:35], s68 offen nt sc1 lds
    s_add_u32 m0, s31, 152576
    s_mov_b32 s68, 128
    buffer_load_dwordx4 v8, s[32:35], s68 offen nt sc1 lds
    s_add_u32 m0, s31, 156672
    s_mov_b32 s68, 128
    buffer_load_dwordx4 v9, s[32:35], s68 offen nt sc1 lds
    s_mov_b32 m0, 160768
    s_mov_b64 exec, s[58:59]
    s_mov_b32 s68, 128
    buffer_load_dwordx4 v10, s[32:35], s68 offen nt sc1 lds
    s_mov_b64 exec, -1
    s_cmp_eq_u32 s79, 1
    s_cselect_b32 s68, 0, 0x40000000
    buffer_atomic_add v38, v47, s[92:95], s68 offen sc1
    s_load_dword s78, s[74:75], 7808
    s_load_dword s78, s[74:75], 7872
    s_load_dword s78, s[74:75], 8832
    s_load_dword s78, s[74:75], 8896
    s_load_dword s78, s[76:77], 640
    s_load_dword s78, s[76:77], 704
    s_load_dword s78, s[76:77], 1664
    s_load_dword s78, s[76:77], 1728
    s_load_dword s78, s[76:77], 2688
    s_load_dword s78, s[76:77], 2752
    s_waitcnt vmcnt(14)
    s_barrier
    s_add_u32 m0, s31, 94208
    s_mov_b32 s68, 180224
    buffer_load_dwordx4 v21, s[36:39], s68 offen sc1 lds
    s_add_u32 m0, s31, 98304
    s_mov_b32 s68, 442368
    buffer_load_dwordx4 v21, s[36:39], s68 offen sc1 lds
    s_add_u32 m0, s31, 102400
    s_mov_b32 s68, 704512
    buffer_load_dwordx4 v21, s[36:39], s68 offen sc1 lds
    s_add_u32 m0, s31, 106496
    s_mov_b32 s68, 966656
    buffer_load_dwordx4 v21, s[36:39], s68 offen sc1 lds
    s_add_u32 m0, s31, 110592
    s_mov_b32 s68, 1228800
    buffer_load_dwordx4 v21, s[36:39], s68 offen sc1 lds
    s_add_u32 m0, s31, 114688
    s_mov_b32 s68, 1490944
    buffer_load_dwordx4 v21, s[36:39], s68 offen sc1 lds
    s_add_u32 m0, s31, 118784
    s_mov_b32 s68, 1753088
    buffer_load_dwordx4 v21, s[36:39], s68 offen sc1 lds
    s_cmp_eq_u32 s79, 2
    s_cselect_b32 s68, 0, 0x40000000
    buffer_atomic_add v38, v47, s[92:95], s68 offen sc1
    s_load_dword s82, s[60:61], 98304
    s_load_dword s82, s[60:61], 97280
    s_load_dword s82, s[60:61], 98368
    s_load_dword s82, s[60:61], 97344
    s_load_dword s82, s[60:61], 98432
    s_load_dword s82, s[60:61], 97408
    s_load_dword s82, s[60:61], 98496
    s_load_dword s82, s[60:61], 97472
    s_barrier
    s_lshl_b32 s68, s29, 8
    s_lshl_b32 s69, s28, 3
    s_add_u32 s68, s68, s69
    s_add_u32 s68, s68, s25
    s_lshl_b32 s68, s68, 10
    s_add_u32 s68, s68, 8388608
    buffer_store_dwordx4 v[12:15], v31, s[40:43], s68 offen sc1
    s_mov_b64 exec, 0
    s_branch L_pg4
L_pb4:
    s_mov_b64 exec, -1
    s_mov_b64 exec, 0
    s_branch L_pg5
L_pb5:
    s_mov_b64 exec, -1
    s_mov_b64 exec, 0
    s_branch L_pg6
L_pb6:
    s_mov_b64 exec, -1
    s_load_dword s78, s[76:77], 3712
    s_load_dword s78, s[76:77], 3776
    s_load_dword s78, s[76:77], 4736
    s_load_dword s78, s[76:77], 4800
    s_load_dword s78, s[76:77], 5760
    s_load_dword s78, s[76:77], 5824
    s_load_dword s78, s[76:77], 6784
    s_load_dword s78, s[76:77], 6848
    s_load_dword s78, s[76:77], 7808
    s_load_dword s78, s[76:77], 7872
    s_barrier
    s_lshl_b32 s68, s29, 8
    s_lshl_b32 s69, s28, 3
    s_add_u32 s68, s68, s69
    s_add_u32 s68, s68, s25
    s_lshl_b32 s68, s68, 10
    s_add_u32 s68, s68, 8392704
    buffer_store_dwordx4 v[12:15], v31, s[40:43], s68 offen sc1
    s_add_u32 s32, s4, 8192000
    s_addc_u32 s33, s5, 0
    s_add_u32 m0, s31, 126976
    s_mov_b32 s68, 128
    buffer_load_dwordx4 v6, s[32:35], s68 offen nt sc1 lds
    s_add_u32 m0, s31, 131072
    s_mov_b32 s68, 128
    buffer_load_dwordx4 v7, s[32:35], s68 offen nt sc1 lds
    s_add_u32 m0, s31, 135168
    s_mov_b32 s68, 128
    buffer_load_dwordx4 v8, s[32:35], s68 offen nt sc1 lds
    s_add_u32 m0, s31, 139264
    s_mov_b32 s68, 128
    buffer_load_dwordx4 v9, s[32:35], s68 offen nt sc1 lds
    s_mov_b32 m0, 143360
    s_mov_b64 exec, s[58:59]
    s_mov_b32 s68, 128
    buffer_load_dwordx4 v10, s[32:35], s68 offen nt sc1 lds
    s_mov_b64 exec, -1
    s_add_u32 m0, s31, 0
    s_mov_b32 s68, 65536
    buffer_load_dwordx4 v21, s[36:39], s68 offen sc1 lds
    s_add_u32 m0, s31, 4096
    s_mov_b32 s68, 327680
    buffer_load_dwordx4 v21, s[36:39], s68 offen sc1 lds
    s_add_u32 m0, s31, 8192
    s_mov_b32 s68, 589824
    buffer_load_dwordx4 v21, s[36:39], s68 offen sc1 lds
    s_add_u32 m0, s31, 12288
    s_mov_b32 s68, 851968
    buffer_load_dwordx4 v21, s[36:39], s68 offen sc1 lds
    s_add_u32 m0, s31, 16384
    s_mov_b32 s68, 1114112
    buffer_load_dwordx4 v21, s[36:39], s68 offen sc1 lds
    s_add_u32 m0, s31, 20480
    s_mov_b32 s68, 1376256
    buffer_load_dwordx4 v21, s[36:39], s68 offen sc1 lds
    s_add_u32 m0, s31, 24576
    s_mov_b32 s68, 1638400
    buffer_load_dwordx4 v21, s[36:39], s68 offen sc1 lds
    s_add_u32 m0, s31, 28672
    s_mov_b32 s68, 1900544
    buffer_load_dwordx4 v21, s[36:39], s68 offen sc1 lds
    s_load_dword s78, s[76:77], 8832
    s_load_dword s78, s[76:77], 8896
    s_load_dword s78, s[74:75], 256
    s_load_dword s78, s[74:75], 320
    s_load_dword s78, s[74:75], 1280
    s_load_dword s78, s[74:75], 1344
    s_load_dword s78, s[74:75], 2304
    s_load_dword s78, s[74:75], 2368
    s_load_dword s78, s[74:75], 3328
    s_load_dword s78, s[74:75], 3392
    s_waitcnt vmcnt(24)
    s_barrier
    s_lshl_b32 s68, s29, 8
    s_lshl_b32 s69, s28, 3
    s_add_u32 s68, s68, s69
    s_add_u32 s68, s68, s25
    s_lshl_b32 s68, s68, 10
    s_add_u32 s68, s68, 10485760
    buffer_store_dwordx4 v[12:15], v31, s[40:43], s68 offen sc1
    s_mov_b32 s32, s4
    s_mov_b32 s33, s5
    s_add_u32 m0, s31, 44032
    s_mov_b32 s68, 256
    buffer_load_dwordx4 v1, s[32:35], s68 offen nt sc1 lds
    s_add_u32 m0, s31, 48128
    s_mov_b32 s68, 256
    buffer_load_dwordx4 v2, s[32:35], s68 offen nt sc1 lds
    s_add_u32 m0, s31, 52224
    s_mov_b32 s68, 256
    buffer_load_dwordx4 v3, s[32:35], s68 offen nt sc1 lds
    s_add_u32 m0, s31, 56320
    s_mov_b32 s68, 256
    buffer_load_dwordx4 v4, s[32:35], s68 offen nt sc1 lds
    s_mov_b32 m0, 60416
    s_mov_b64 exec, s[58:59]
    s_mov_b32 s68, 256
    buffer_load_dwordx4 v5, s[32:35], s68 offen nt sc1 lds
    s_mov_b64 exec, -1
    s_mov_b64 exec, 0
    s_branch L_pg3
L_pb3:
    s_mov_b64 exec, -1
    s_load_dword s78, s[74:75], 4352
    s_load_dword s78, s[74:75], 4416
    s_load_dword s78, s[74:75], 5376
    s_load_dword s78, s[74:75], 5440
    s_load_dword s78, s[74:75], 6400
    s_load_dword s78, s[74:75], 6464
    s_load_dword s78, s[74:75], 7424
    s_load_dword s78, s[74:75], 7488
    s_load_dword s78, s[74:75], 8448
    s_load_dword s78, s[74:75], 8512
    s_waitcnt vmcnt(14)
    s_barrier
    buffer_load_dword v45, v41, s[92:95], 0 offen offset:0 sc1
    s_lshl_b32 s68, s29, 8
    s_lshl_b32 s69, s28, 3
    s_add_u32 s68, s68, s69
    s_add_u32 s68, s68, s25
    s_lshl_b32 s68, s68, 10
    s_add_u32 s68, s68, 10489856
    buffer_store_dwordx4 v[12:15], v31, s[40:43], s68 offen sc1
    s_add_u32 m0, s31, 61440
    s_mov_b32 s68, 81920
    buffer_load_dwordx4 v21, s[36:39], s68 offen sc1 lds
    s_add_u32 m0, s31, 65536
    s_mov_b32 s68, 344064
    buffer_load_dwordx4 v21, s[36:39], s68 offen sc1 lds
    s_add_u32 m0, s31, 69632
    s_mov_b32 s68, 606208
    buffer_load_dwordx4 v21, s[36:39], s68 offen sc1 lds
    s_add_u32 m0, s31, 73728
    s_mov_b32 s68, 868352
    buffer_load_dwordx4 v21, s[36:39], s68 offen sc1 lds
    s_add_u32 m0, s31, 77824
    s_mov_b32 s68, 1130496
    buffer_load_dwordx4 v21, s[36:39], s68 offen sc1 lds
    s_add_u32 m0, s31, 81920
    s_mov_b32 s68, 1392640
    buffer_load_dwordx4 v21, s[36:39], s68 offen sc1 lds
    s_add_u32 m0, s31, 86016
    s_mov_b32 s68, 1654784
    buffer_load_dwordx4 v21, s[36:39], s68 offen sc1 lds
    s_add_u32 m0, s31, 90112
    s_mov_b32 s68, 1916928
    buffer_load_dwordx4 v21, s[36:39], s68 offen sc1 lds
    s_load_dword s78, s[74:75], 768
    s_load_dword s78, s[74:75], 832
    s_load_dword s78, s[74:75], 1792
    s_load_dword s78, s[74:75], 1856
    s_load_dword s78, s[74:75], 2816
    s_load_dword s78, s[74:75], 2880
    s_load_dword s78, s[74:75], 3840
    s_load_dword s78, s[74:75], 3904
    s_load_dword s78, s[74:75], 4864
    s_load_dword s78, s[74:75], 4928
    s_waitcnt vmcnt(9)
    s_mov_b32 s54, 0
L_poll0:
    v_cmp_le_u32 vcc, 0x100, v45
    s_nop 1
    s_andn2_b64 s[68:69], s[62:63], vcc
    s_cbranch_scc1 L_spin0
L_pok0:
    s_barrier
    s_lshl_b32 s68, s25, 15
    s_add_u32 s68, s68, 14680064
    buffer_load_dwordx4 v[128:131], v31, s[40:43], s68 offen sc1
    s_lshl_b32 s68, s25, 15
    s_add_u32 s68, s68, 14681088
    buffer_load_dwordx4 v[132:135], v31, s[40:43], s68 offen sc1
    s_lshl_b32 s68, s25, 15
    s_add_u32 s68, s68, 14682112
    buffer_load_dwordx4 v[136:139], v31, s[40:43], s68 offen sc1
    s_lshl_b32 s68, s25, 15
    s_add_u32 s68, s68, 14683136
    buffer_load_dwordx4 v[140:143], v31, s[40:43], s68 offen sc1
    s_lshl_b32 s68, s25, 15
    s_add_u32 s68, s68, 14684160
    buffer_load_dwordx4 v[144:147], v31, s[40:43], s68 offen sc1
    s_lshl_b32 s68, s25, 15
    s_add_u32 s68, s68, 14685184
    buffer_load_dwordx4 v[148:151], v31, s[40:43], s68 offen sc1
    s_lshl_b32 s68, s25, 15
    s_add_u32 s68, s68, 14686208
    buffer_load_dwordx4 v[152:155], v31, s[40:43], s68 offen sc1
    s_lshl_b32 s68, s25, 15
    s_add_u32 s68, s68, 14687232
    buffer_load_dwordx4 v[156:159], v31, s[40:43], s68 offen sc1
    s_lshl_b32 s68, s25, 15
    s_add_u32 s68, s68, 14688256
    buffer_load_dwordx4 v[160:163], v31, s[40:43], s68 offen sc1
    s_lshl_b32 s68, s25, 15
    s_add_u32 s68, s68, 14689280
    buffer_load_dwordx4 v[164:167], v31, s[40:43], s68 offen sc1
    s_lshl_b32 s68, s25, 15
    s_add_u32 s68, s68, 14690304
    buffer_load_dwordx4 v[168:171], v31, s[40:43], s68 offen sc1
    s_lshl_b32 s68, s25, 15
    s_add_u32 s68, s68, 14691328
    buffer_load_dwordx4 v[172:175], v31, s[40:43], s68 offen sc1
    s_load_dword s78, s[74:75], 5888
    s_load_dword s78, s[74:75], 5952
    s_load_dword s78, s[74:75], 6912
    s_load_dword s78, s[74:75], 6976
    s_load_dword s78, s[74:75], 7936
    s_load_dword s78, s[74:75], 8000
    s_load_dword s78, s[74:75], 8960
    s_load_dword s78, s[74:75], 9024
    s_load_dword s78, s[74:75], 384
    s_load_dword s78, s[74:75], 448
    s_barrier
    s_add_u32 m0, s31, 94208
    s_mov_b32 s68, 196608
    buffer_load_dwordx4 v21, s[36:39], s68 offen sc1 lds
    s_add_u32 m0, s31, 98304
    s_mov_b32 s68, 458752
    buffer_load_dwordx4 v21, s[36:39], s68 offen sc1 lds
    s_add_u32 m0, s31, 102400
    s_mov_b32 s68, 720896
    buffer_load_dwordx4 v21, s[36:39], s68 offen sc1 lds
    s_add_u32 m0, s31, 106496
    s_mov_b32 s68, 983040
    buffer_load_dwordx4 v21, s[36:39], s68 offen sc1 lds
    s_add_u32 m0, s31, 110592
    s_mov_b32 s68, 1245184
    buffer_load_dwordx4 v21, s[36:39], s68 offen sc1 lds
    s_add_u32 m0, s31, 114688
    s_mov_b32 s68, 1507328
    buffer_load_dwordx4 v21, s[36:39], s68 offen sc1 lds
    s_add_u32 m0, s31, 118784
    s_mov_b32 s68, 1769472
    buffer_load_dwordx4 v21, s[36:39], s68 offen sc1 lds
    s_lshl_b32 s68, s25, 15
    s_add_u32 s68, s68, 14692352
    buffer_load_dwordx4 v[176:179], v31, s[40:43], s68 offen sc1
    s_lshl_b32 s68, s25, 15
    s_add_u32 s68, s68, 14693376
    buffer_load_dwordx4 v[180:183], v31, s[40:43], s68 offen sc1
    s_lshl_b32 s68, s25, 15
    s_add_u32 s68, s68, 14694400
    buffer_load_dwordx4 v[184:187], v31, s[40:43], s68 offen sc1
    s_lshl_b32 s68, s25, 15
    s_add_u32 s68, s68, 14695424
    buffer_load_dwordx4 v[188:191], v31, s[40:43], s68 offen sc1
    s_load_dword s78, s[74:75], 1408
    s_load_dword s78, s[74:75], 1472
    s_load_dword s78, s[74:75], 2432
    s_load_dword s78, s[74:75], 2496
    s_load_dword s78, s[74:75], 3456
    s_load_dword s78, s[74:75], 3520
    s_load_dword s78, s[74:75], 4480
    s_load_dword s78, s[74:75], 4544
    s_load_dword s78, s[74:75], 5504
    s_load_dword s78, s[74:75], 5568
    s_barrier
L_h_join:
    s_mov_b32 s32, s4
    s_mov_b32 s33, s5
    s_add_u32 m0, s31, 144384
    s_mov_b32 s68, 256
    buffer_load_dwordx4 v6, s[32:35], s68 offen nt sc1 lds
    s_add_u32 m0, s31, 148480
    s_mov_b32 s68, 256
    buffer_load_dwordx4 v7, s[32:35], s68 offen nt sc1 lds
    s_add_u32 m0, s31, 152576
    s_mov_b32 s68, 256
    buffer_load_dwordx4 v8, s[32:35], s68 offen nt sc1 lds
    s_add_u32 m0, s31, 156672
    s_mov_b32 s68, 256
    buffer_load_dwordx4 v9, s[32:35], s68 offen nt sc1 lds
    s_mov_b32 m0, 160768
    s_mov_b64 exec, s[58:59]
    s_mov_b32 s68, 256
    buffer_load_dwordx4 v10, s[32:35], s68 offen nt sc1 lds
    s_mov_b64 exec, -1
    s_load_dword s78, s[74:75], 6528
    s_load_dword s78, s[74:75], 6592
    s_load_dword s78, s[74:75], 7552
    s_load_dword s78, s[74:75], 7616
    s_load_dword s78, s[74:75], 8576
    s_load_dword s78, s[74:75], 8640
    s_load_dword s78, s[74:75], 896
    s_load_dword s78, s[74:75], 960
    s_load_dword s78, s[74:75], 1920
    s_load_dword s78, s[74:75], 1984
    s_waitcnt vmcnt(28)
    s_barrier
    s_add_u32 m0, s31, 0
    s_mov_b32 s68, 212992
    buffer_load_dwordx4 v21, s[36:39], s68 offen sc1 lds
    s_add_u32 m0, s31, 4096
    s_mov_b32 s68, 475136
    buffer_load_dwordx4 v21, s[36:39], s68 offen sc1 lds
    s_add_u32 m0, s31, 8192
    s_mov_b32 s68, 737280
    buffer_load_dwordx4 v21, s[36:39], s68 offen sc1 lds
    s_add_u32 m0, s31, 12288
    s_mov_b32 s68, 999424
    buffer_load_dwordx4 v21, s[36:39], s68 offen sc1 lds
    s_add_u32 m0, s31, 16384
    s_mov_b32 s68, 1261568
    buffer_load_dwordx4 v21, s[36:39], s68 offen sc1 lds
    s_add_u32 m0, s31, 20480
    s_mov_b32 s68, 1523712
    buffer_load_dwordx4 v21, s[36:39], s68 offen sc1 lds
    s_add_u32 m0, s31, 24576
    s_mov_b32 s68, 1785856
    buffer_load_dwordx4 v21, s[36:39], s68 offen sc1 lds
    s_lshl_b32 s68, s25, 15
    s_add_u32 s68, s68, 14696448
    buffer_load_dwordx4 v[192:195], v31, s[40:43], s68 offen sc1
    s_lshl_b32 s68, s25, 15
    s_add_u32 s68, s68, 14697472
    buffer_load_dwordx4 v[196:199], v31, s[40:43], s68 offen sc1
    s_lshl_b32 s68, s25, 15
    s_add_u32 s68, s68, 14698496
    buffer_load_dwordx4 v[200:203], v31, s[40:43], s68 offen sc1
    s_lshl_b32 s68, s25, 15
    s_add_u32 s68, s68, 14699520
    buffer_load_dwordx4 v[204:207], v31, s[40:43], s68 offen sc1
    s_load_dword s78, s[74:75], 2944
    s_load_dword s78, s[74:75], 3008
    s_load_dword s78, s[74:75], 3968
    s_load_dword s78, s[74:75], 4032
    s_load_dword s78, s[74:75], 4992
    s_load_dword s78, s[74:75], 5056
    s_load_dword s78, s[74:75], 6016
    s_load_dword s78, s[74:75], 6080
    s_load_dword s78, s[74:75], 7040
    s_load_dword s78, s[74:75], 7104
    s_waitcnt vmcnt(11)
    s_barrier
    s_mov_b32 s32, s4
    s_mov_b32 s33, s5
    s_add_u32 m0, s31, 126976
    s_mov_b32 s68, 384
    buffer_load_dwordx4 v1, s[32:35], s68 offen nt sc1 lds
    s_add_u32 m0, s31, 131072
    s_mov_b32 s68, 384
    buffer_load_dwordx4 v2, s[32:35], s68 offen nt sc1 lds
    s_add_u32 m0, s31, 135168
    s_mov_b32 s68, 384
    buffer_load_dwordx4 v3, s[32:35], s68 offen nt sc1 lds
    s_add_u32 m0, s31, 139264
    s_mov_b32 s68, 384
    buffer_load_dwordx4 v4, s[32:35], s68 offen nt sc1 lds
    s_mov_b32 m0, 143360
    s_mov_b64 exec, s[58:59]
    s_mov_b32 s68, 384
    buffer_load_dwordx4 v5, s[32:35], s68 offen nt sc1 lds
    s_mov_b64 exec, -1
    s_add_u32 m0, s31, 61440
    s_mov_b32 s68, 98304
    buffer_load_dwordx4 v21, s[36:39], s68 offen sc1 lds
    s_add_u32 m0, s31, 65536
    s_mov_b32 s68, 360448
    buffer_load_dwordx4 v21, s[36:39], s68 offen sc1 lds
    s_add_u32 m0, s31, 69632
    s_mov_b32 s68, 622592
    buffer_load_dwordx4 v21, s[36:39], s68 offen sc1 lds
    s_add_u32 m0, s31, 73728
    s_mov_b32 s68, 884736
    buffer_load_dwordx4 v21, s[36:39], s68 offen sc1 lds
    s_add_u32 m0, s31, 77824
    s_mov_b32 s68, 1146880
    buffer_load_dwordx4 v21, s[36:39], s68 offen sc1 lds
    s_add_u32 m0, s31, 81920
    s_mov_b32 s68, 1409024
    buffer_load_dwordx4 v21, s[36:39], s68 offen sc1 lds
    s_add_u32 m0, s31, 86016
    s_mov_b32 s68, 1671168
    buffer_load_dwordx4 v21, s[36:39], s68 offen sc1 lds
    s_add_u32 m0, s31, 90112
    s_mov_b32 s68, 1933312
    buffer_load_dwordx4 v21, s[36:39], s68 offen sc1 lds
    s_load_dword s78, s[74:75], 8064
    s_load_dword s78, s[74:75], 8128
    s_load_dword s78, s[74:75], 9088
    s_load_dword s78, s[74:75], 9152
    s_load_dword s78, s[76:77], 896
    s_load_dword s78, s[76:77], 960
    s_load_dword s78, s[76:77], 1920
    s_load_dword s78, s[76:77], 1984
    s_load_dword s78, s[76:77], 2944
    s_load_dword s78, s[76:77], 3008
    s_waitcnt vmcnt(17)
    s_barrier
    s_add_u32 m0, s31, 94208
    s_mov_b32 s68, 114688
    buffer_load_dwordx4 v21, s[36:39], s68 offen sc1 lds
    s_add_u32 m0, s31, 98304
    s_mov_b32 s68, 376832
    buffer_load_dwordx4 v21, s[36:39], s68 offen sc1 lds
    s_add_u32 m0, s31, 102400
    s_mov_b32 s68, 638976
    buffer_load_dwordx4 v21, s[36:39], s68 offen sc1 lds
    s_add_u32 m0, s31, 106496
    s_mov_b32 s68, 901120
    buffer_load_dwordx4 v21, s[36:39], s68 offen sc1 lds
    s_add_u32 m0, s31, 110592
    s_mov_b32 s68, 1163264
    buffer_load_dwordx4 v21, s[36:39], s68 offen sc1 lds
    s_add_u32 m0, s31, 114688
    s_mov_b32 s68, 1425408
    buffer_load_dwordx4 v21, s[36:39], s68 offen sc1 lds
    s_add_u32 m0, s31, 118784
    s_mov_b32 s68, 1687552
    buffer_load_dwordx4 v21, s[36:39], s68 offen sc1 lds
    s_add_u32 m0, s31, 122880
    s_mov_b32 s68, 1949696
    buffer_load_dwordx4 v21, s[36:39], s68 offen sc1 lds
    s_lshl_b32 s68, s25, 15
    s_add_u32 s68, s68, 14700544
    buffer_load_dwordx4 v[208:211], v31, s[40:43], s68 offen sc1
    s_lshl_b32 s68, s25, 15
    s_add_u32 s68, s68, 14701568
    buffer_load_dwordx4 v[212:215], v31, s[40:43], s68 offen sc1
    s_lshl_b32 s68, s25, 15
    s_add_u32 s68, s68, 14702592
    buffer_load_dwordx4 v[216:219], v31, s[40:43], s68 offen sc1
    s_lshl_b32 s68, s25, 15
    s_add_u32 s68, s68, 14703616
    buffer_load_dwordx4 v[220:223], v31, s[40:43], s68 offen sc1
    s_load_dword s78, s[76:77], 3968
    s_load_dword s78, s[76:77], 4032
    s_load_dword s78, s[76:77], 4992
    s_load_dword s78, s[76:77], 5056
    s_load_dword s78, s[76:77], 6016
    s_load_dword s78, s[76:77], 6080
    s_load_dword s78, s[76:77], 7040
    s_load_dword s78, s[76:77], 7104
    s_load_dword s78, s[76:77], 8064
    s_load_dword s78, s[76:77], 8128
    s_waitcnt vmcnt(12)
    s_barrier
    s_mov_b32 s32, s4
    s_mov_b32 s33, s5
    s_add_u32 m0, s31, 144384
    s_mov_b32 s68, 384
    buffer_load_dwordx4 v6, s[32:35], s68 offen nt sc1 lds
    s_add_u32 m0, s31, 148480
    s_mov_b32 s68, 384
    buffer_load_dwordx4 v7, s[32:35], s68 offen nt sc1 lds
    s_add_u32 m0, s31, 152576
    s_mov_b32 s68, 384
    buffer_load_dwordx4 v8, s[32:35], s68 offen nt sc1 lds
    s_add_u32 m0, s31, 156672
    s_mov_b32 s68, 384
    buffer_load_dwordx4 v9, s[32:35], s68 offen nt sc1 lds
    s_mov_b32 m0, 160768
    s_mov_b64 exec, s[58:59]
    s_mov_b32 s68, 384
    buffer_load_dwordx4 v10, s[32:35], s68 offen nt sc1 lds
    s_mov_b64 exec, -1
    s_add_u32 m0, s31, 0
    s_mov_b32 s68, 229376
    buffer_load_dwordx4 v21, s[36:39], s68 offen sc1 lds
    s_add_u32 m0, s31, 4096
    s_mov_b32 s68, 491520
    buffer_load_dwordx4 v21, s[36:39], s68 offen sc1 lds
    s_add_u32 m0, s31, 8192
    s_mov_b32 s68, 753664
    buffer_load_dwordx4 v21, s[36:39], s68 offen sc1 lds
    s_add_u32 m0, s31, 12288
    s_mov_b32 s68, 1015808
    buffer_load_dwordx4 v21, s[36:39], s68 offen sc1 lds
    s_add_u32 m0, s31, 16384
    s_mov_b32 s68, 1277952
    buffer_load_dwordx4 v21, s[36:39], s68 offen sc1 lds
    s_add_u32 m0, s31, 20480
    s_mov_b32 s68, 1540096
    buffer_load_dwordx4 v21, s[36:39], s68 offen sc1 lds
    s_add_u32 m0, s31, 24576
    s_mov_b32 s68, 1802240
    buffer_load_dwordx4 v21, s[36:39], s68 offen sc1 lds
    s_load_dword s78, s[76:77], 9088
    s_load_dword s78, s[76:77], 9152
    s_load_dword s78, s[76:77], 384
    s_load_dword s78, s[76:77], 448
    s_load_dword s78, s[76:77], 1408
    s_load_dword s78, s[76:77], 1472
    s_load_dword s78, s[76:77], 2432
    s_load_dword s78, s[76:77], 2496
    s_load_dword s78, s[76:77], 3456
    s_load_dword s78, s[76:77], 3520
    s_waitcnt vmcnt(16)
    s_barrier
    s_add_u32 m0, s31, 61440
    s_mov_b32 s68, 245760
    buffer_load_dwordx4 v21, s[36:39], s68 offen sc1 lds
    s_add_u32 m0, s31, 65536
    s_mov_b32 s68, 507904
    buffer_load_dwordx4 v21, s[36:39], s68 offen sc1 lds
    s_add_u32 m0, s31, 69632
    s_mov_b32 s68, 770048
    buffer_load_dwordx4 v21, s[36:39], s68 offen sc1 lds
    s_add_u32 m0, s31, 73728
    s_mov_b32 s68, 1032192
    buffer_load_dwordx4 v21, s[36:39], s68 offen sc1 lds
    s_add_u32 m0, s31, 77824
    s_mov_b32 s68, 1294336
    buffer_load_dwordx4 v21, s[36:39], s68 offen sc1 lds
    s_add_u32 m0, s31, 81920
    s_mov_b32 s68, 1556480
    buffer_load_dwordx4 v21, s[36:39], s68 offen sc1 lds
    s_add_u32 m0, s31, 86016
    s_mov_b32 s68, 1818624
    buffer_load_dwordx4 v21, s[36:39], s68 offen sc1 lds
    s_lshl_b32 s68, s25, 15
    s_add_u32 s68, s68, 14704640
    buffer_load_dwordx4 v[224:227], v31, s[40:43], s68 offen sc1
    s_lshl_b32 s68, s25, 15
    s_add_u32 s68, s68, 14705664
    buffer_load_dwordx4 v[228:231], v31, s[40:43], s68 offen sc1
    s_lshl_b32 s68, s25, 15
    s_add_u32 s68, s68, 14706688
    buffer_load_dwordx4 v[232:235], v31, s[40:43], s68 offen sc1
    s_lshl_b32 s68, s25, 15
    s_add_u32 s68, s68, 14707712
    buffer_load_dwordx4 v[236:239], v31, s[40:43], s68 offen sc1
    s_load_dword s78, s[76:77], 4480
    s_load_dword s78, s[76:77], 4544
    s_load_dword s78, s[76:77], 5504
    s_load_dword s78, s[76:77], 5568
    s_load_dword s78, s[76:77], 6528
    s_load_dword s78, s[76:77], 6592
    s_load_dword s78, s[76:77], 7552
    s_load_dword s78, s[76:77], 7616
    s_load_dword s78, s[76:77], 8576
    s_load_dword s78, s[76:77], 8640
    s_waitcnt vmcnt(11)
    s_barrier
    s_add_u32 s32, s4, 8192000
    s_addc_u32 s33, s5, 0
    s_add_u32 m0, s31, 126976
    s_mov_b32 s68, 384
    buffer_load_dwordx4 v6, s[32:35], s68 offen nt sc1 lds
    s_add_u32 m0, s31, 131072
    s_mov_b32 s68, 384
    buffer_load_dwordx4 v7, s[32:35], s68 offen nt sc1 lds
    s_add_u32 m0, s31, 135168
    s_mov_b32 s68, 384
    buffer_load_dwordx4 v8, s[32:35], s68 offen nt sc1 lds
    s_add_u32 m0, s31, 139264
    s_mov_b32 s68, 384
    buffer_load_dwordx4 v9, s[32:35], s68 offen nt sc1 lds
    s_mov_b32 m0, 143360
    s_mov_b64 exec, s[58:59]
    s_mov_b32 s68, 384
    buffer_load_dwordx4 v10, s[32:35], s68 offen nt sc1 lds
    s_mov_b64 exec, -1
    s_load_dword s78, s[76:77], 768
    s_load_dword s78, s[76:77], 832
    s_load_dword s78, s[76:77], 1792
    s_load_dword s78, s[76:77], 1856
    s_load_dword s78, s[76:77], 2816
    s_load_dword s78, s[76:77], 2880
    s_load_dword s78, s[76:77], 3840
    s_load_dword s78, s[76:77], 3904
    s_load_dword s78, s[76:77], 4864
    s_load_dword s78, s[76:77], 4928
    s_waitcnt vmcnt(9)
    s_barrier
    s_lshl_b32 s68, s25, 15
    s_add_u32 s68, s68, 14708736
    buffer_load_dwordx4 v[240:243], v31, s[40:43], s68 offen sc1
    s_lshl_b32 s68, s25, 15
    s_add_u32 s68, s68, 14709760
    buffer_load_dwordx4 v[244:247], v31, s[40:43], s68 offen sc1
    s_lshl_b32 s68, s25, 15
    s_add_u32 s68, s68, 14710784
    buffer_load_dwordx4 v[248:251], v31, s[40:43], s68 offen sc1
    s_lshl_b32 s68, s25, 15
    s_add_u32 s68, s68, 14711808
    buffer_load_dwordx4 v[252:255], v31, s[40:43], s68 offen sc1
    s_waitcnt vmcnt(4)
    s_barrier
    ds_read_b128 v[48:51], v22 offset:53248
    ds_read_b128 v[52:55], v23 offset:53248
    s_add_u32 s68, s27, 0
    s_lshl_b32 s68, s68, 20
    s_add_u32 s44, s22, s68
    s_addc_u32 s45, s23, 0
    s_mov_b32 s46, 1048576
    s_mov_b32 s47, 0x20000
    s_waitcnt lgkmcnt(0)
    v_mul_f32 v80, v48, v48
    v_mul_f32 v81, v49, v49
    v_mul_f32 v82, v50, v50
    v_mul_f32 v83, v51, v51
    v_mul_f32 v84, v52, v52
    v_mul_f32 v85, v53, v53
    v_mul_f32 v86, v54, v54
    v_mul_f32 v87, v55, v55
    v_fma_f32 v80, v80, v35, s49
    v_fma_f32 v81, v81, v35, s49
    v_fma_f32 v82, v82, v35, s49
    v_fma_f32 v83, v83, v35, s49
    v_fma_f32 v84, v84, v35, s49
    v_fma_f32 v85, v85, v35, s49
    v_fma_f32 v86, v86, v35, s49
    v_fma_f32 v87, v87, v35, s49
    v_mul_f32 v80, v80, v48
    v_mul_f32 v81, v81, v49
    v_mul_f32 v82, v82, v50
    v_mul_f32 v83, v83, v51
    v_mul_f32 v84, v84, v52
    v_mul_f32 v85, v85, v53
    v_mul_f32 v86, v86, v54
    v_mul_f32 v87, v87, v55
    v_exp_f32 v80, v80
    v_exp_f32 v81, v81
    v_exp_f32 v82, v82
    v_exp_f32 v83, v83
    v_exp_f32 v84, v84
    v_exp_f32 v85, v85
    v_exp_f32 v86, v86
    v_exp_f32 v87, v87
    v_add_f32 v80, 1.0, v80
    v_add_f32 v81, 1.0, v81
    v_add_f32 v82, 1.0, v82
    v_add_f32 v83, 1.0, v83
    v_add_f32 v84, 1.0, v84
    v_add_f32 v85, 1.0, v85
    v_add_f32 v86, 1.0, v86
    v_add_f32 v87, 1.0, v87
    v_rcp_f32 v80, v80
    v_rcp_f32 v81, v81
    v_rcp_f32 v82, v82
    v_rcp_f32 v83, v83
    v_rcp_f32 v84, v84
    v_rcp_f32 v85, v85
    v_rcp_f32 v86, v86
    v_rcp_f32 v87, v87
    v_mul_f32 v48, v48, v80
    v_mul_f32 v49, v49, v81
    v_mul_f32 v50, v50, v82
    v_mul_f32 v51, v51, v83
    v_mul_f32 v52, v52, v84
    v_mul_f32 v53, v53, v85
    v_mul_f32 v54, v54, v86
    v_mul_f32 v55, v55, v87
    v_cvt_pk_bf16_f32 v96, v48, v49
    v_cvt_pk_bf16_f32 v97, v50, v51
    v_cvt_pk_bf16_f32 v98, v52, v53
    v_cvt_pk_bf16_f32 v99, v54, v55
    buffer_store_dwordx4 v[96:99], v26, s[44:47], 0 offen offset:0 sc1
    s_barrier
    ds_read_b128 v[56:59], v22 offset:45056
    ds_read_b128 v[60:63], v23 offset:45056
    ds_read_b128 v[64:67], v22 offset:36864
    ds_read_b128 v[68:71], v23 offset:36864
    s_waitcnt lgkmcnt(2)
    v_mul_f32 v80, v56, v56
    v_mul_f32 v81, v57, v57
    v_mul_f32 v82, v58, v58
    v_mul_f32 v83, v59, v59
    v_mul_f32 v84, v60, v60
    v_mul_f32 v85, v61, v61
    v_mul_f32 v86, v62, v62
    v_mul_f32 v87, v63, v63
    v_fma_f32 v80, v80, v35, s49
    v_fma_f32 v81, v81, v35, s49
    v_fma_f32 v82, v82, v35, s49
    v_fma_f32 v83, v83, v35, s49
    v_fma_f32 v84, v84, v35, s49
    v_fma_f32 v85, v85, v35, s49
    v_fma_f32 v86, v86, v35, s49
    v_fma_f32 v87, v87, v35, s49
    v_mul_f32 v80, v80, v56
    v_mul_f32 v81, v81, v57
    v_mul_f32 v82, v82, v58
    v_mul_f32 v83, v83, v59
    v_mul_f32 v84, v84, v60
    v_mul_f32 v85, v85, v61
    v_mul_f32 v86, v86, v62
    v_mul_f32 v87, v87, v63
    v_exp_f32 v80, v80
    v_exp_f32 v81, v81
    v_exp_f32 v82, v82
    v_exp_f32 v83, v83
    v_exp_f32 v84, v84
    v_exp_f32 v85, v85
    v_exp_f32 v86, v86
    v_exp_f32 v87, v87
    v_add_f32 v80, 1.0, v80
    v_add_f32 v81, 1.0, v81
    v_add_f32 v82, 1.0, v82
    v_add_f32 v83, 1.0, v83
    v_add_f32 v84, 1.0, v84
    v_add_f32 v85, 1.0, v85
    v_add_f32 v86, 1.0, v86
    v_add_f32 v87, 1.0, v87
    v_rcp_f32 v80, v80
    v_rcp_f32 v81, v81
    v_rcp_f32 v82, v82
    v_rcp_f32 v83, v83
    v_rcp_f32 v84, v84
    v_rcp_f32 v85, v85
    v_rcp_f32 v86, v86
    v_rcp_f32 v87, v87
    v_mul_f32 v56, v56, v80
    v_mul_f32 v57, v57, v81
    v_mul_f32 v58, v58, v82
    v_mul_f32 v59, v59, v83
    v_mul_f32 v60, v60, v84
    v_mul_f32 v61, v61, v85
    v_mul_f32 v62, v62, v86
    v_mul_f32 v63, v63, v87
    v_cvt_pk_bf16_f32 v100, v56, v57
    v_cvt_pk_bf16_f32 v101, v58, v59
    v_cvt_pk_bf16_f32 v102, v60, v61
    v_cvt_pk_bf16_f32 v103, v62, v63
    buffer_store_dwordx4 v[100:103], v26, s[44:47], 0 offen offset:256 sc1
    s_waitcnt lgkmcnt(0)
    v_mul_f32 v80, v64, v64
    v_mul_f32 v81, v65, v65
    v_mul_f32 v82, v66, v66
    v_mul_f32 v83, v67, v67
    v_mul_f32 v84, v68, v68
    v_mul_f32 v85, v69, v69
    v_mul_f32 v86, v70, v70
    v_mul_f32 v87, v71, v71
    v_fma_f32 v80, v80, v35, s49
    v_fma_f32 v81, v81, v35, s49
    v_fma_f32 v82, v82, v35, s49
    v_fma_f32 v83, v83, v35, s49
    v_fma_f32 v84, v84, v35, s49
    v_fma_f32 v85, v85, v35, s49
    v_fma_f32 v86, v86, v35, s49
    v_fma_f32 v87, v87, v35, s49
    v_mul_f32 v80, v80, v64
    v_mul_f32 v81, v81, v65
    v_mul_f32 v82, v82, v66
    v_mul_f32 v83, v83, v67
    v_mul_f32 v84, v84, v68
    v_mul_f32 v85, v85, v69
    v_mul_f32 v86, v86, v70
    v_mul_f32 v87, v87, v71
    v_exp_f32 v80, v80
    v_exp_f32 v81, v81
    v_exp_f32 v82, v82
    s_barrier
    ds_read_b128 v[72:75], v22 offset:28672
    ds_read_b128 v[76:79], v23 offset:28672
    v_exp_f32 v83, v83
    v_exp_f32 v84, v84
    v_exp_f32 v85, v85
    v_exp_f32 v86, v86
    v_exp_f32 v87, v87
    v_add_f32 v80, 1.0, v80
    v_add_f32 v81, 1.0, v81
    v_add_f32 v82, 1.0, v82
    v_add_f32 v83, 1.0, v83
    v_add_f32 v84, 1.0, v84
    v_add_f32 v85, 1.0, v85
    v_add_f32 v86, 1.0, v86
    v_add_f32 v87, 1.0, v87
    v_rcp_f32 v80, v80
    v_rcp_f32 v81, v81
    v_rcp_f32 v82, v82
    v_rcp_f32 v83, v83
    v_rcp_f32 v84, v84
    v_rcp_f32 v85, v85
    v_rcp_f32 v86, v86
    v_rcp_f32 v87, v87
    v_mul_f32 v64, v64, v80
    v_mul_f32 v65, v65, v81
    v_mul_f32 v66, v66, v82
    v_mul_f32 v67, v67, v83
    v_mul_f32 v68, v68, v84
    v_mul_f32 v69, v69, v85
    v_mul_f32 v70, v70, v86
    v_mul_f32 v71, v71, v87
    v_cvt_pk_bf16_f32 v104, v64, v65
    v_cvt_pk_bf16_f32 v105, v66, v67
    v_cvt_pk_bf16_f32 v106, v68, v69
    v_cvt_pk_bf16_f32 v107, v70, v71
    buffer_store_dwordx4 v[104:107], v26, s[44:47], 0 offen offset:512 sc1
    s_waitcnt lgkmcnt(0)
    v_mul_f32 v80, v72, v72
    v_mul_f32 v81, v73, v73
    v_mul_f32 v82, v74, v74
    v_mul_f32 v83, v75, v75
    v_mul_f32 v84, v76, v76
    v_mul_f32 v85, v77, v77
    v_mul_f32 v86, v78, v78
    v_mul_f32 v87, v79, v79
    v_fma_f32 v80, v80, v35, s49
    v_fma_f32 v81, v81, v35, s49
    v_fma_f32 v82, v82, v35, s49
    v_fma_f32 v83, v83, v35, s49
    v_fma_f32 v84, v84, v35, s49
    v_fma_f32 v85, v85, v35, s49
    v_fma_f32 v86, v86, v35, s49
    v_fma_f32 v87, v87, v35, s49
    v_mul_f32 v80, v80, v72
    v_mul_f32 v81, v81, v73
    v_mul_f32 v82, v82, v74
    v_mul_f32 v83, v83, v75
    v_mul_f32 v84, v84, v76
    v_mul_f32 v85, v85, v77
    v_mul_f32 v86, v86, v78
    v_mul_f32 v87, v87, v79
    v_exp_f32 v80, v80
    v_exp_f32 v81, v81
    v_exp_f32 v82, v82
    v_exp_f32 v83, v83
    v_exp_f32 v84, v84
    v_exp_f32 v85, v85
    v_exp_f32 v86, v86
    v_exp_f32 v87, v87
    v_add_f32 v80, 1.0, v80
    v_add_f32 v81, 1.0, v81
    v_add_f32 v82, 1.0, v82
    v_add_f32 v83, 1.0, v83
    v_add_f32 v84, 1.0, v84
    v_add_f32 v85, 1.0, v85
    v_add_f32 v86, 1.0, v86
    v_add_f32 v87, 1.0, v87
    v_rcp_f32 v80, v80
    v_rcp_f32 v81, v81
    v_rcp_f32 v82, v82
    v_rcp_f32 v83, v83
    v_rcp_f32 v84, v84
    v_rcp_f32 v85, v85
    v_rcp_f32 v86, v86
    v_rcp_f32 v87, v87
    v_mul_f32 v72, v72, v80
    v_mul_f32 v73, v73, v81
    v_mul_f32 v74, v74, v82
    v_mul_f32 v75, v75, v83
    s_load_dword s78, s[76:77], 5888
    s_load_dword s78, s[76:77], 5952
    s_load_dword s78, s[76:77], 6912
    s_load_dword s78, s[76:77], 6976
    s_load_dword s78, s[76:77], 7936
    s_load_dword s78, s[76:77], 8000
    s_load_dword s78, s[76:77], 8960
    s_load_dword s78, s[76:77], 9024
    s_load_dword s78, s[76:77], 256
    s_load_dword s78, s[76:77], 320
    s_barrier
    v_mul_f32 v76, v76, v84
    v_mul_f32 v77, v77, v85
    v_mul_f32 v78, v78, v86
    v_mul_f32 v79, v79, v87
    v_cvt_pk_bf16_f32 v108, v72, v73
    v_cvt_pk_bf16_f32 v109, v74, v75
    v_cvt_pk_bf16_f32 v110, v76, v77
    v_cvt_pk_bf16_f32 v111, v78, v79
    buffer_store_dwordx4 v[108:111], v26, s[44:47], 0 offen offset:768 sc1
    s_waitcnt vmcnt(0)
    s_mov_b64 exec, 1
    buffer_store_dword v38, v32, s[40:43], 0 offen sc1
    s_mov_b64 exec, -1
    s_load_dword s78, s[76:77], 1280
    s_load_dword s78, s[76:77], 1344
    s_load_dword s78, s[76:77], 2304
    s_load_dword s78, s[76:77], 2368
    s_load_dword s78, s[76:77], 3328
    s_load_dword s78, s[76:77], 3392
    s_load_dword s78, s[76:77], 4352
    s_load_dword s78, s[76:77], 4416
    s_load_dword s78, s[76:77], 5376
    s_load_dword s78, s[76:77], 5440
    s_barrier
L_pg13:
    s_cbranch_execz L_pb13
    s_add_u32 s32, s4, 8192000
    s_addc_u32 s33, s5, 0
    s_add_u32 m0, s31, 144384
    s_mov_b32 s68, 256
    buffer_load_dwordx4 v1, s[32:35], s68 offen nt sc1 lds
    s_add_u32 m0, s31, 148480
    s_mov_b32 s68, 256
    buffer_load_dwordx4 v2, s[32:35], s68 offen nt sc1 lds
    s_add_u32 m0, s31, 152576
    s_mov_b32 s68, 256
    buffer_load_dwordx4 v3, s[32:35], s68 offen nt sc1 lds
    s_add_u32 m0, s31, 156672
    s_mov_b32 s68, 256
    buffer_load_dwordx4 v4, s[32:35], s68 offen nt sc1 lds
    s_mov_b32 m0, 160768
    s_mov_b64 exec, s[58:59]
    s_mov_b32 s68, 256
    buffer_load_dwordx4 v5, s[32:35], s68 offen nt sc1 lds
    s_mov_b64 exec, -1
    s_add_u32 m0, s31, 61440
    s_mov_b32 s68, 81920
    buffer_load_dwordx4 v21, s[36:39], s68 offen sc1 lds
    s_add_u32 m0, s31, 65536
    s_mov_b32 s68, 344064
    buffer_load_dwordx4 v21, s[36:39], s68 offen sc1 lds
    s_add_u32 m0, s31, 69632
    s_mov_b32 s68, 606208
    buffer_load_dwordx4 v21, s[36:39], s68 offen sc1 lds
    s_add_u32 m0, s31, 73728
    s_mov_b32 s68, 868352
    buffer_load_dwordx4 v21, s[36:39], s68 offen sc1 lds
    s_add_u32 m0, s31, 77824
    s_mov_b32 s68, 1130496
    buffer_load_dwordx4 v21, s[36:39], s68 offen sc1 lds
    s_add_u32 m0, s31, 81920
    s_mov_b32 s68, 1392640
    buffer_load_dwordx4 v21, s[36:39], s68 offen sc1 lds
    s_add_u32 m0, s31, 86016
    s_mov_b32 s68, 1654784
    buffer_load_dwordx4 v21, s[36:39], s68 offen sc1 lds
    s_add_u32 m0, s31, 90112
    s_mov_b32 s68, 1916928
    buffer_load_dwordx4 v21, s[36:39], s68 offen sc1 lds
    s_load_dword s78, s[76:77], 6400
    s_load_dword s78, s[76:77], 6464
    s_load_dword s78, s[76:77], 7424
    s_load_dword s78, s[76:77], 7488
    s_load_dword s78, s[76:77], 8448
    s_load_dword s78, s[76:77], 8512
    s_barrier
    s_add_u32 m0, s31, 0
    s_mov_b32 s68, 65536
    buffer_load_dwordx4 v21, s[36:39], s68 offen sc1 lds
    s_add_u32 m0, s31, 4096
    s_mov_b32 s68, 327680
    buffer_load_dwordx4 v21, s[36:39], s68 offen sc1 lds
    s_add_u32 m0, s31, 8192
    s_mov_b32 s68, 589824
    buffer_load_dwordx4 v21, s[36:39], s68 offen sc1 lds
    s_add_u32 m0, s31, 12288
    s_mov_b32 s68, 851968
    buffer_load_dwordx4 v21, s[36:39], s68 offen sc1 lds
    s_add_u32 m0, s31, 16384
    s_mov_b32 s68, 1114112
    buffer_load_dwordx4 v21, s[36:39], s68 offen sc1 lds
    s_add_u32 m0, s31, 20480
    s_mov_b32 s68, 1376256
    buffer_load_dwordx4 v21, s[36:39], s68 offen sc1 lds
    s_add_u32 m0, s31, 24576
    s_mov_b32 s68, 1638400
    buffer_load_dwordx4 v21, s[36:39], s68 offen sc1 lds
    s_add_u32 m0, s31, 28672
    s_mov_b32 s68, 1900544
    buffer_load_dwordx4 v21, s[36:39], s68 offen sc1 lds
    s_waitcnt vmcnt(8)
    s_barrier
    s_mov_b32 s67, 0
    buffer_load_dword v45, v33, s[40:43], s67 offen sc1
    s_waitcnt vmcnt(0)
    s_mov_b32 s54, 0
L_poll1:
    v_cmp_eq_u32 vcc, 1, v45
    s_nop 1
    s_andn2_b64 s[68:69], s[56:57], vcc
    s_cbranch_scc1 L_spin1
L_pok1:
    s_barrier
    s_mov_b64 exec, 0
    s_branch L_pg7
L_pb7:
    s_mov_b64 exec, -1
    s_barrier
    ds_read_b128 v[48:51], v22 offset:53248
    ds_read_b128 v[52:55], v23 offset:53248
    s_add_u32 s68, s27, 4
    s_lshl_b32 s68, s68, 20
    s_add_u32 s44, s22, s68
    s_addc_u32 s45, s23, 0
    s_mov_b32 s46, 1048576
    s_mov_b32 s47, 0x20000
    s_waitcnt lgkmcnt(0)
    v_mul_f32 v80, v48, v48
    v_mul_f32 v81, v49, v49
    v_mul_f32 v82, v50, v50
    v_mul_f32 v83, v51, v51
    v_mul_f32 v84, v52, v52
    v_mul_f32 v85, v53, v53
    v_mul_f32 v86, v54, v54
    v_mul_f32 v87, v55, v55
    v_fma_f32 v80, v80, v35, s49
    v_fma_f32 v81, v81, v35, s49
    v_fma_f32 v82, v82, v35, s49
    v_fma_f32 v83, v83, v35, s49
    v_fma_f32 v84, v84, v35, s49
    v_fma_f32 v85, v85, v35, s49
    v_fma_f32 v86, v86, v35, s49
    v_fma_f32 v87, v87, v35, s49
    v_mul_f32 v80, v80, v48
    v_mul_f32 v81, v81, v49
    v_mul_f32 v82, v82, v50
    v_mul_f32 v83, v83, v51
    v_mul_f32 v84, v84, v52
    v_mul_f32 v85, v85, v53
    v_mul_f32 v86, v86, v54
    v_mul_f32 v87, v87, v55
    v_exp_f32 v80, v80
    v_exp_f32 v81, v81
    v_exp_f32 v82, v82
    v_exp_f32 v83, v83
    v_exp_f32 v84, v84
    v_exp_f32 v85, v85
    v_exp_f32 v86, v86
    v_exp_f32 v87, v87
    v_add_f32 v80, 1.0, v80
    v_add_f32 v81, 1.0, v81
    v_add_f32 v82, 1.0, v82
    v_add_f32 v83, 1.0, v83
    v_add_f32 v84, 1.0, v84
    v_add_f32 v85, 1.0, v85
    v_add_f32 v86, 1.0, v86
    v_add_f32 v87, 1.0, v87
    v_rcp_f32 v80, v80
    v_rcp_f32 v81, v81
    v_rcp_f32 v82, v82
    v_rcp_f32 v83, v83
    v_rcp_f32 v84, v84
    v_rcp_f32 v85, v85
    v_rcp_f32 v86, v86
    v_rcp_f32 v87, v87
    v_mul_f32 v48, v48, v80
    v_mul_f32 v49, v49, v81
    v_mul_f32 v50, v50, v82
    v_mul_f32 v51, v51, v83
    v_mul_f32 v52, v52, v84
    v_mul_f32 v53, v53, v85
    v_mul_f32 v54, v54, v86
    v_mul_f32 v55, v55, v87
    v_cvt_pk_bf16_f32 v96, v48, v49
    v_cvt_pk_bf16_f32 v97, v50, v51
    v_cvt_pk_bf16_f32 v98, v52, v53
    v_cvt_pk_bf16_f32 v99, v54, v55
    buffer_store_dwordx4 v[96:99], v26, s[44:47], 0 offen offset:0 sc1
    s_barrier
    ds_read_b128 v[56:59], v22 offset:45056
    ds_read_b128 v[60:63], v23 offset:45056
    ds_read_b128 v[64:67], v22 offset:36864
    ds_read_b128 v[68:71], v23 offset:36864
    ds_read_b128 v[72:75], v22 offset:28672
    ds_read_b128 v[76:79], v23 offset:28672
    s_waitcnt lgkmcnt(4)
    v_mul_f32 v80, v56, v56
    v_mul_f32 v81, v57, v57
    v_mul_f32 v82, v58, v58
    v_mul_f32 v83, v59, v59
    v_mul_f32 v84, v60, v60
    v_mul_f32 v85, v61, v61
    v_mul_f32 v86, v62, v62
    v_mul_f32 v87, v63, v63
    v_fma_f32 v80, v80, v35, s49
    v_fma_f32 v81, v81, v35, s49
    v_fma_f32 v82, v82, v35, s49
    v_fma_f32 v83, v83, v35, s49
    v_fma_f32 v84, v84, v35, s49
    v_fma_f32 v85, v85, v35, s49
    v_fma_f32 v86, v86, v35, s49
    v_fma_f32 v87, v87, v35, s49
    v_mul_f32 v80, v80, v56
    v_mul_f32 v81, v81, v57
    v_mul_f32 v82, v82, v58
    v_mul_f32 v83, v83, v59
    v_mul_f32 v84, v84, v60
    v_mul_f32 v85, v85, v61
    v_mul_f32 v86, v86, v62
    v_mul_f32 v87, v87, v63
    v_exp_f32 v80, v80
    v_exp_f32 v81, v81
    v_exp_f32 v82, v82
    v_exp_f32 v83, v83
    v_exp_f32 v84, v84
    v_exp_f32 v85, v85
    v_exp_f32 v86, v86
    v_exp_f32 v87, v87
    v_add_f32 v80, 1.0, v80
    v_add_f32 v81, 1.0, v81
    v_add_f32 v82, 1.0, v82
    v_add_f32 v83, 1.0, v83
    v_add_f32 v84, 1.0, v84
    v_add_f32 v85, 1.0, v85
    v_add_f32 v86, 1.0, v86
    v_add_f32 v87, 1.0, v87
    v_rcp_f32 v80, v80
    v_rcp_f32 v81, v81
    v_rcp_f32 v82, v82
    v_rcp_f32 v83, v83
    v_rcp_f32 v84, v84
    v_rcp_f32 v85, v85
    v_rcp_f32 v86, v86
    v_rcp_f32 v87, v87
    v_mul_f32 v56, v56, v80
    v_mul_f32 v57, v57, v81
    v_mul_f32 v58, v58, v82
    v_mul_f32 v59, v59, v83
    v_mul_f32 v60, v60, v84
    v_mul_f32 v61, v61, v85
    v_mul_f32 v62, v62, v86
    v_mul_f32 v63, v63, v87
    v_cvt_pk_bf16_f32 v100, v56, v57
    v_cvt_pk_bf16_f32 v101, v58, v59
    v_cvt_pk_bf16_f32 v102, v60, v61
    v_cvt_pk_bf16_f32 v103, v62, v63
    buffer_store_dwordx4 v[100:103], v26, s[44:47], 0 offen offset:256 sc1
    s_waitcnt lgkmcnt(2)
    v_mul_f32 v80, v64, v64
    v_mul_f32 v81, v65, v65
    v_mul_f32 v82, v66, v66
    v_mul_f32 v83, v67, v67
    v_mul_f32 v84, v68, v68
    v_mul_f32 v85, v69, v69
    v_mul_f32 v86, v70, v70
    v_mul_f32 v87, v71, v71
    v_fma_f32 v80, v80, v35, s49
    v_fma_f32 v81, v81, v35, s49
    v_fma_f32 v82, v82, v35, s49
    v_fma_f32 v83, v83, v35, s49
    v_fma_f32 v84, v84, v35, s49
    v_fma_f32 v85, v85, v35, s49
    v_fma_f32 v86, v86, v35, s49
    v_fma_f32 v87, v87, v35, s49
    v_mul_f32 v80, v80, v64
    v_mul_f32 v81, v81, v65
    v_mul_f32 v82, v82, v66
    v_mul_f32 v83, v83, v67
    v_mul_f32 v84, v84, v68
    v_mul_f32 v85, v85, v69
    v_mul_f32 v86, v86, v70
    v_mul_f32 v87, v87, v71
    v_exp_f32 v80, v80
    v_exp_f32 v81, v81
    v_exp_f32 v82, v82
    v_exp_f32 v83, v83
    v_exp_f32 v84, v84
    v_exp_f32 v85, v85
    v_exp_f32 v86, v86
    s_waitcnt lgkmcnt(0)
    s_barrier
    v_exp_f32 v87, v87
    v_add_f32 v80, 1.0, v80
    v_add_f32 v81, 1.0, v81
    v_add_f32 v82, 1.0, v82
    v_add_f32 v83, 1.0, v83
    v_add_f32 v84, 1.0, v84
    v_add_f32 v85, 1.0, v85
    v_add_f32 v86, 1.0, v86
    v_add_f32 v87, 1.0, v87
    v_rcp_f32 v80, v80
    v_rcp_f32 v81, v81
    v_rcp_f32 v82, v82
    v_rcp_f32 v83, v83
    v_rcp_f32 v84, v84
    v_rcp_f32 v85, v85
    v_rcp_f32 v86, v86
    v_rcp_f32 v87, v87
    v_mul_f32 v64, v64, v80
    v_mul_f32 v65, v65, v81
    v_mul_f32 v66, v66, v82
    v_mul_f32 v67, v67, v83
    v_mul_f32 v68, v68, v84
    v_mul_f32 v69, v69, v85
    v_mul_f32 v70, v70, v86
    v_mul_f32 v71, v71, v87
    v_cvt_pk_bf16_f32 v104, v64, v65
    v_cvt_pk_bf16_f32 v105, v66, v67
    v_cvt_pk_bf16_f32 v106, v68, v69
    v_cvt_pk_bf16_f32 v107, v70, v71
    buffer_store_dwordx4 v[104:107], v26, s[44:47], 0 offen offset:512 sc1
    v_mul_f32 v80, v72, v72
    v_mul_f32 v81, v73, v73
    v_mul_f32 v82, v74, v74
    v_mul_f32 v83, v75, v75
    v_mul_f32 v84, v76, v76
    v_mul_f32 v85, v77, v77
    v_mul_f32 v86, v78, v78
    v_mul_f32 v87, v79, v79
    v_fma_f32 v80, v80, v35, s49
    v_fma_f32 v81, v81, v35, s49
    v_fma_f32 v82, v82, v35, s49
    v_fma_f32 v83, v83, v35, s49
    v_fma_f32 v84, v84, v35, s49
    v_fma_f32 v85, v85, v35, s49
    v_fma_f32 v86, v86, v35, s49
    v_fma_f32 v87, v87, v35, s49
    v_mul_f32 v80, v80, v72
    v_mul_f32 v81, v81, v73
    v_mul_f32 v82, v82, v74
    v_mul_f32 v83, v83, v75
    v_mul_f32 v84, v84, v76
    v_mul_f32 v85, v85, v77
    v_mul_f32 v86, v86, v78
    v_mul_f32 v87, v87, v79
    v_exp_f32 v80, v80
    v_exp_f32 v81, v81
    v_exp_f32 v82, v82
    v_exp_f32 v83, v83
    v_exp_f32 v84, v84
    v_exp_f32 v85, v85
    v_exp_f32 v86, v86
    v_exp_f32 v87, v87
    v_add_f32 v80, 1.0, v80
    v_add_f32 v81, 1.0, v81
    v_add_f32 v82, 1.0, v82
    v_add_f32 v83, 1.0, v83
    v_add_f32 v84, 1.0, v84
    v_add_f32 v85, 1.0, v85
    v_add_f32 v86, 1.0, v86
    v_add_f32 v87, 1.0, v87
    v_rcp_f32 v80, v80
    v_rcp_f32 v81, v81
    v_rcp_f32 v82, v82
    v_rcp_f32 v83, v83
    v_rcp_f32 v84, v84
    v_rcp_f32 v85, v85
    v_rcp_f32 v86, v86
    v_rcp_f32 v87, v87
    v_mul_f32 v72, v72, v80
    v_mul_f32 v73, v73, v81
    v_mul_f32 v74, v74, v82
    v_mul_f32 v75, v75, v83
    v_mul_f32 v76, v76, v84
    v_mul_f32 v77, v77, v85
    v_mul_f32 v78, v78, v86
    v_mul_f32 v79, v79, v87
    v_cvt_pk_bf16_f32 v108, v72, v73
    v_cvt_pk_bf16_f32 v109, v74, v75
    v_cvt_pk_bf16_f32 v110, v76, v77
    v_cvt_pk_bf16_f32 v111, v78, v79
    buffer_store_dwordx4 v[108:111], v26, s[44:47], 0 offen offset:768 sc1
    s_barrier
    buffer_load_dword v45, v41, s[92:95], 0 offen offset:128 sc1
    s_waitcnt vmcnt(1)
    s_mov_b64 exec, 2
    buffer_store_dword v38, v32, s[40:43], 0 offen sc1
    s_mov_b64 exec, -1
    s_waitcnt vmcnt(1)
    s_mov_b32 s54, 0
L_poll2:
    v_cmp_le_u32 vcc, 4, v45
    s_nop 1
    s_andn2_b64 s[68:69], s[62:63], vcc
    s_cbranch_scc1 L_spin2
L_pok2:
    s_barrier
    s_lshl_b32 s68, s25, 12
    s_add_u32 m0, s68, 62464
    s_add_u32 s68, s68, 14942208
    buffer_load_dwordx4 v31, s[40:43], s68 offen sc1 lds
    s_lshl_b32 s68, s25, 12
    s_add_u32 m0, s68, 63488
    s_add_u32 s68, s68, 14943232
    buffer_load_dwordx4 v31, s[40:43], s68 offen sc1 lds
    s_barrier
    s_lshl_b32 s68, s25, 12
    s_add_u32 m0, s68, 64512
    s_add_u32 s68, s68, 14944256
    buffer_load_dwordx4 v31, s[40:43], s68 offen sc1 lds
    s_lshl_b32 s68, s25, 12
    s_add_u32 m0, s68, 65536
    s_add_u32 s68, s68, 14945280
    buffer_load_dwordx4 v31, s[40:43], s68 offen sc1 lds
    s_and_b32 s68, s30, 31
    s_lshl_b32 s68, s68, 2
    s_add_u32 s68, s68, s25
    s_lshl_b32 s68, s68, 10
    s_add_u32 s68, s68, 14811136
    s_add_u32 s70, s22, s68
    s_addc_u32 s71, s23, 0
    s_load_dword s78, s[70:71], 0
    s_load_dword s78, s[70:71], 64
    s_load_dword s78, s[70:71], 128
    s_load_dword s78, s[70:71], 192
    s_load_dword s78, s[70:71], 256
    s_load_dword s78, s[70:71], 320
    s_load_dword s78, s[70:71], 384
    s_load_dword s78, s[70:71], 448
    s_load_dword s78, s[70:71], 512
    s_load_dword s78, s[70:71], 576
    s_load_dword s78, s[70:71], 640
    s_load_dword s78, s[70:71], 704
    s_load_dword s78, s[70:71], 768
    s_load_dword s78, s[70:71], 832
    s_load_dword s78, s[70:71], 896
    s_load_dword s78, s[70:71], 960
    s_barrier
    s_mov_b32 s67, 131072
    buffer_load_dword v45, v33, s[40:43], s67 offen sc1
    s_lshl_b32 s68, s25, 2
    s_add_u32 s68, s68, 14974976
    buffer_load_dword v37, v40, s[40:43], s68 offen sc1
    s_mov_b64 exec, 0
    s_branch L_pg16
L_pb16:
    s_mov_b64 exec, -1
    s_waitcnt vmcnt(1)
    s_mov_b32 s54, 0
L_poll3:
    v_cmp_eq_u32 vcc, 1, v45
    s_nop 1
    s_andn2_b64 s[68:69], s[56:57], vcc
    s_cbranch_scc1 L_spin3
L_pok3:
    s_barrier
    s_mov_b64 exec, 0
    s_branch L_pg8
L_pb8:
    s_mov_b64 exec, -1
    s_mov_b64 exec, 0
    s_branch L_pg15
L_pb15:
    s_mov_b64 exec, -1
    s_barrier
    ds_read_b128 v[48:51], v27 offset:28672
    ds_read_b128 v[52:55], v28 offset:28672
    ds_read_b128 v[56:59], v27 offset:45312
    ds_read_b128 v[60:63], v28 offset:45312
    s_add_u32 s68, s29, 0
    s_lshl_b32 s68, s68, 8
    s_lshl_b32 s69, s28, 3
    s_add_u32 s68, s68, s69
    s_add_u32 s68, s68, s25
    s_lshl_b32 s68, s68, 10
    s_add_u32 s65, s68, 8388608
    s_waitcnt vmcnt(0)
    v_readfirstlane_b32 s53, v37
    s_waitcnt lgkmcnt(0)
    v_add_f32 v48, v48, v56
    v_add_f32 v49, v49, v57
    v_add_f32 v50, v50, v58
    v_add_f32 v51, v51, v59
    v_add_f32 v52, v52, v60
    v_add_f32 v53, v53, v61
    v_add_f32 v54, v54, v62
    v_add_f32 v55, v55, v63
    v_mul_f32 v2, v48, v48
    v_mul_f32 v3, v49, v49
    v_mul_f32 v4, v50, v50
    v_mul_f32 v5, v51, v51
    v_mul_f32 v6, v52, v52
    v_mul_f32 v7, v53, v53
    v_mul_f32 v8, v54, v54
    v_mul_f32 v9, v55, v55
    v_fma_f32 v2, v2, v35, s49
    v_fma_f32 v3, v3, v35, s49
    v_fma_f32 v4, v4, v35, s49
    v_fma_f32 v5, v5, v35, s49
    v_fma_f32 v6, v6, v35, s49
    v_fma_f32 v7, v7, v35, s49
    v_fma_f32 v8, v8, v35, s49
    v_fma_f32 v9, v9, v35, s49
    v_mul_f32 v2, v2, v48
    v_mul_f32 v3, v3, v49
    v_mul_f32 v4, v4, v50
    v_mul_f32 v5, v5, v51
    v_mul_f32 v6, v6, v52
    v_mul_f32 v7, v7, v53
    v_mul_f32 v8, v8, v54
    v_mul_f32 v9, v9, v55
    v_exp_f32 v2, v2
    v_exp_f32 v3, v3
    v_exp_f32 v4, v4
    v_exp_f32 v5, v5
    v_exp_f32 v6, v6
    v_exp_f32 v7, v7
    v_exp_f32 v8, v8
    v_exp_f32 v9, v9
    v_add_f32 v2, 1.0, v2
    v_add_f32 v3, 1.0, v3
    v_add_f32 v4, 1.0, v4
    v_add_f32 v5, 1.0, v5
    v_add_f32 v6, 1.0, v6
    v_add_f32 v7, 1.0, v7
    v_add_f32 v8, 1.0, v8
    v_add_f32 v9, 1.0, v9
    v_rcp_f32 v2, v2
    v_rcp_f32 v3, v3
    v_rcp_f32 v4, v4
    v_rcp_f32 v5, v5
    v_rcp_f32 v6, v6
    v_rcp_f32 v7, v7
    v_rcp_f32 v8, v8
    v_rcp_f32 v9, v9
    v_mul_f32 v48, v48, v2
    v_mul_f32 v49, v49, v3
    v_mul_f32 v50, v50, v4
    v_mul_f32 v51, v51, v5
    v_mul_f32 v52, v52, v6
    v_mul_f32 v53, v53, v7
    v_mul_f32 v54, v54, v8
    v_mul_f32 v55, v55, v9
    v_cvt_pk_bf16_f32 v56, v48, v49
    v_cvt_pk_bf16_f32 v57, v50, v51
    v_cvt_pk_bf16_f32 v58, v52, v53
    v_cvt_pk_bf16_f32 v59, v54, v55
    v_min_u32 v56, -2, v56
    v_min_u32 v57, -2, v57
    v_min_u32 v58, -2, v58
    v_min_u32 v59, -2, v59
    buffer_store_dwordx4 v[56:59], v31, s[40:43], s65 offen sc1
    s_barrier
    ds_read_b128 v[64:67], v27 offset:36992
    ds_read_b128 v[68:71], v28 offset:36992
    ds_read_b128 v[72:75], v27 offset:53632
    ds_read_b128 v[76:79], v28 offset:53632
    s_add_u32 s65, s65, 4096
    s_waitcnt lgkmcnt(0)
    v_add_f32 v64, v64, v72
    v_add_f32 v65, v65, v73
    v_add_f32 v66, v66, v74
    v_add_f32 v67, v67, v75
    v_add_f32 v68, v68, v76
    v_add_f32 v69, v69, v77
    v_add_f32 v70, v70, v78
    v_add_f32 v71, v71, v79
    v_mul_f32 v2, v64, v64
    v_mul_f32 v3, v65, v65
    v_mul_f32 v4, v66, v66
    v_mul_f32 v5, v67, v67
    v_mul_f32 v6, v68, v68
    v_mul_f32 v7, v69, v69
    v_mul_f32 v8, v70, v70
    v_mul_f32 v9, v71, v71
    v_fma_f32 v2, v2, v35, s49
    v_fma_f32 v3, v3, v35, s49
    v_fma_f32 v4, v4, v35, s49
    v_fma_f32 v5, v5, v35, s49
    v_fma_f32 v6, v6, v35, s49
    v_fma_f32 v7, v7, v35, s49
    v_fma_f32 v8, v8, v35, s49
    v_fma_f32 v9, v9, v35, s49
    v_mul_f32 v2, v2, v64
    v_mul_f32 v3, v3, v65
    v_mul_f32 v4, v4, v66
    v_mul_f32 v5, v5, v67
    v_mul_f32 v6, v6, v68
    v_mul_f32 v7, v7, v69
    v_mul_f32 v8, v8, v70
    v_mul_f32 v9, v9, v71
    v_exp_f32 v2, v2
    v_exp_f32 v3, v3
    v_exp_f32 v4, v4
    v_exp_f32 v5, v5
    v_exp_f32 v6, v6
    v_exp_f32 v7, v7
    v_exp_f32 v8, v8
    v_exp_f32 v9, v9
    v_add_f32 v2, 1.0, v2
    v_add_f32 v3, 1.0, v3
    v_add_f32 v4, 1.0, v4
    v_add_f32 v5, 1.0, v5
    v_add_f32 v6, 1.0, v6
    v_add_f32 v7, 1.0, v7
    v_add_f32 v8, 1.0, v8
    v_add_f32 v9, 1.0, v9
    v_rcp_f32 v2, v2
    v_rcp_f32 v3, v3
    v_rcp_f32 v4, v4
    v_rcp_f32 v5, v5
    v_rcp_f32 v6, v6
    v_rcp_f32 v7, v7
    v_rcp_f32 v8, v8
    v_rcp_f32 v9, v9
    v_mul_f32 v64, v64, v2
    v_mul_f32 v65, v65, v3
    v_mul_f32 v66, v66, v4
    v_mul_f32 v67, v67, v5
    v_mul_f32 v68, v68, v6
    v_mul_f32 v69, v69, v7
    v_mul_f32 v70, v70, v8
    v_mul_f32 v71, v71, v9
    v_cvt_pk_bf16_f32 v72, v64, v65
    v_cvt_pk_bf16_f32 v73, v66, v67
    v_cvt_pk_bf16_f32 v74, v68, v69
    v_cvt_pk_bf16_f32 v75, v70, v71
    v_min_u32 v72, -2, v72
    v_min_u32 v73, -2, v73
    v_min_u32 v74, -2, v74
    v_min_u32 v75, -2, v75
    buffer_store_dwordx4 v[72:75], v31, s[40:43], s65 offen sc1
    s_barrier
    s_mov_b64 exec, 0
    s_branch L_pg10
L_pb10:
    s_mov_b64 exec, -1
    s_mov_b64 exec, 0
    s_branch L_pg14
L_pb14:
    s_mov_b64 exec, -1
    s_barrier
    s_lshl_b32 s69, s30, 10
    s_add_u32 s68, s69, 8388608
    buffer_load_dwordx4 v[48:51], v31, s[40:43], s68 offen
    s_add_u32 s68, s69, 8650752
    buffer_load_dwordx4 v[52:55], v31, s[40:43], s68 offen
    s_add_u32 s68, s69, 8912896
    buffer_load_dwordx4 v[56:59], v31, s[40:43], s68 offen
    s_add_u32 s68, s69, 9175040
    buffer_load_dwordx4 v[60:63], v31, s[40:43], s68 offen
    s_add_u32 s68, s69, 9437184
    buffer_load_dwordx4 v[64:67], v31, s[40:43], s68 offen
    s_add_u32 s68, s69, 9699328
    buffer_load_dwordx4 v[68:71], v31, s[40:43], s68 offen
    s_add_u32 s68, s69, 9961472
    buffer_load_dwordx4 v[72:75], v31, s[40:43], s68 offen
    s_add_u32 s68, s69, 10223616
    buffer_load_dwordx4 v[76:79], v31, s[40:43], s68 offen
    s_mov_b64 exec, 0
    s_branch L_pg9
L_pb9:
    s_mov_b64 exec, -1
    s_barrier
    s_waitcnt vmcnt(0)
    s_mov_b32 s54, 0
L_fchk0:
    v_max3_u32 v18, v48, v49, v50
    v_max3_u32 v18, v51, v52, v18
    v_max3_u32 v18, v53, v54, v18
    v_max3_u32 v18, v55, v56, v18
    v_max3_u32 v18, v57, v58, v18
    v_max3_u32 v18, v59, v60, v18
    v_max3_u32 v18, v61, v62, v18
    v_max3_u32 v18, v63, v64, v18
    v_max3_u32 v18, v65, v66, v18
    v_max3_u32 v18, v67, v68, v18
    v_max3_u32 v18, v69, v70, v18
    v_max3_u32 v18, v71, v72, v18
    v_max3_u32 v18, v73, v74, v18
    v_max3_u32 v18, v75, v76, v18
    v_max3_u32 v18, v77, v78, v18
    v_max_u32 v18, v79, v18
    v_cmp_eq_u32 vcc, -1, v18
    s_nop 1
    s_cmp_lg_u64 vcc, 0
    s_cbranch_scc1 L_fspin0
L_fok0:
    v_mfma_f32_16x16x32_bf16 v[112:115], v[128:131], v[48:51], 0
    v_mfma_f32_16x16x32_bf16 v[112:115], v[132:135], v[52:55], v[112:115]
    v_mfma_f32_16x16x32_bf16 v[112:115], v[136:139], v[56:59], v[112:115]
    v_mfma_f32_16x16x32_bf16 v[112:115], v[140:143], v[60:63], v[112:115]
    v_mfma_f32_16x16x32_bf16 v[112:115], v[144:147], v[64:67], v[112:115]
    v_mfma_f32_16x16x32_bf16 v[112:115], v[148:151], v[68:71], v[112:115]
    v_mfma_f32_16x16x32_bf16 v[112:115], v[152:155], v[72:75], v[112:115]
    v_mfma_f32_16x16x32_bf16 v[112:115], v[156:159], v[76:79], v[112:115]
    v_mfma_f32_16x16x32_bf16 v[116:119], v[160:163], v[48:51], 0
    v_mfma_f32_16x16x32_bf16 v[116:119], v[164:167], v[52:55], v[116:119]
    v_mfma_f32_16x16x32_bf16 v[116:119], v[168:171], v[56:59], v[116:119]
    v_mfma_f32_16x16x32_bf16 v[116:119], v[172:175], v[60:63], v[116:119]
    v_mfma_f32_16x16x32_bf16 v[116:119], v[176:179], v[64:67], v[116:119]
    v_mfma_f32_16x16x32_bf16 v[116:119], v[180:183], v[68:71], v[116:119]
    v_mfma_f32_16x16x32_bf16 v[116:119], v[184:187], v[72:75], v[116:119]
    v_mfma_f32_16x16x32_bf16 v[116:119], v[188:191], v[76:79], v[116:119]
    v_mfma_f32_16x16x32_bf16 v[120:123], v[192:195], v[48:51], 0
    v_mfma_f32_16x16x32_bf16 v[120:123], v[196:199], v[52:55], v[120:123]
    v_mfma_f32_16x16x32_bf16 v[120:123], v[200:203], v[56:59], v[120:123]
    v_mfma_f32_16x16x32_bf16 v[120:123], v[204:207], v[60:63], v[120:123]
    v_mfma_f32_16x16x32_bf16 v[120:123], v[208:211], v[64:67], v[120:123]
    v_mfma_f32_16x16x32_bf16 v[120:123], v[212:215], v[68:71], v[120:123]
    v_mfma_f32_16x16x32_bf16 v[120:123], v[216:219], v[72:75], v[120:123]
    v_mfma_f32_16x16x32_bf16 v[120:123], v[220:223], v[76:79], v[120:123]
    v_mfma_f32_16x16x32_bf16 v[124:127], v[224:227], v[48:51], 0
    v_mfma_f32_16x16x32_bf16 v[124:127], v[228:231], v[52:55], v[124:127]
    v_mfma_f32_16x16x32_bf16 v[124:127], v[232:235], v[56:59], v[124:127]
    v_mfma_f32_16x16x32_bf16 v[124:127], v[236:239], v[60:63], v[124:127]
    v_mfma_f32_16x16x32_bf16 v[124:127], v[240:243], v[64:67], v[124:127]
    v_mfma_f32_16x16x32_bf16 v[124:127], v[244:247], v[68:71], v[124:127]
    v_mfma_f32_16x16x32_bf16 v[124:127], v[248:251], v[72:75], v[124:127]
    v_mfma_f32_16x16x32_bf16 v[124:127], v[252:255], v[76:79], v[124:127]
    s_nop 7
    s_mov_b32 s55, 0x4038aa3b
    v_mul_f32 v112, s55, v112
    v_mul_f32 v113, s55, v113
    v_mul_f32 v114, s55, v114
    v_mul_f32 v115, s55, v115
    v_mul_f32 v116, s55, v116
    v_mul_f32 v117, s55, v117
    v_mul_f32 v118, s55, v118
    v_mul_f32 v119, s55, v119
    v_mul_f32 v120, s55, v120
    v_mul_f32 v121, s55, v121
    v_mul_f32 v122, s55, v122
    v_mul_f32 v123, s55, v123
    v_mul_f32 v124, s55, v124
    v_mul_f32 v125, s55, v125
    v_mul_f32 v126, s55, v126
    v_mul_f32 v127, s55, v127
    v_max3_f32 v18, |v112|, |v113|, 0
    v_max3_f32 v18, |v114|, |v115|, v18
    v_max3_f32 v18, |v116|, |v117|, v18
    v_max3_f32 v18, |v118|, |v119|, v18
    v_max3_f32 v18, |v120|, |v121|, v18
    v_max3_f32 v18, |v122|, |v123|, v18
    v_max3_f32 v18, |v124|, |v125|, v18
    v_max3_f32 v18, |v126|, |v127|, v18
    v_cmp_lt_f32 vcc, 0x42fc0000, v18
    s_nop 1
    s_cmp_lg_u64 vcc, 0
    s_cselect_b32 s52, 1, s53
    s_cmp_lg_u32 s52, 0
    s_cbranch_scc1 L_noexp0
    v_exp_f32 v112, v112
    v_exp_f32 v113, v113
    v_exp_f32 v114, v114
    v_exp_f32 v115, v115
    v_exp_f32 v116, v116
    v_exp_f32 v117, v117
    v_exp_f32 v118, v118
    v_exp_f32 v119, v119
    v_exp_f32 v120, v120
    v_exp_f32 v121, v121
    v_exp_f32 v122, v122
    v_exp_f32 v123, v123
    v_exp_f32 v124, v124
    v_exp_f32 v125, v125
    v_exp_f32 v126, v126
    v_exp_f32 v127, v127
L_noexp0:
    ds_read_b128 v[96:99], v36 offset:0
    ds_read_b128 v[100:103], v36 offset:16
    ds_read_b128 v[104:107], v36 offset:32
    ds_read_b128 v[108:111], v36 offset:48
    s_barrier
    s_waitcnt lgkmcnt(0)
    s_cmp_lg_u32 s52, 0
    s_cbranch_scc1 L_js0
    v_fma_f32 v80, v112, v96, 1.0
    v_fma_f32 v81, v113, v97, 1.0
    v_fma_f32 v82, v114, v98, 1.0
    v_fma_f32 v83, v115, v99, 1.0
L_pg14:
    s_cbranch_execz L_pb14
    v_fma_f32 v84, v116, v100, 1.0
    v_fma_f32 v85, v117, v101, 1.0
    v_fma_f32 v86, v118, v102, 1.0
    v_fma_f32 v87, v119, v103, 1.0
    v_fma_f32 v88, v120, v104, 1.0
    v_fma_f32 v89, v121, v105, 1.0
    v_fma_f32 v90, v122, v106, 1.0
    v_fma_f32 v91, v123, v107, 1.0
    v_fma_f32 v92, v124, v108, 1.0
    v_fma_f32 v93, v125, v109, 1.0
    v_fma_f32 v94, v126, v110, 1.0
    v_fma_f32 v95, v127, v111, 1.0
L_jb0:
    ds_read_b128 v[96:99], v36 offset:1024
    ds_read_b128 v[100:103], v36 offset:1040
    ds_read_b128 v[104:107], v36 offset:1056
    ds_read_b128 v[108:111], v36 offset:1072
    v_rcp_f32 v80, v80
    v_rcp_f32 v81, v81
    v_rcp_f32 v82, v82
    v_rcp_f32 v83, v83
    v_rcp_f32 v84, v84
    v_rcp_f32 v85, v85
    v_rcp_f32 v86, v86
    v_rcp_f32 v87, v87
    v_fma_f32 v80, v80, -2.0, 1.0
    v_fma_f32 v81, v81, -2.0, 1.0
    v_fma_f32 v82, v82, -2.0, 1.0
    v_fma_f32 v83, v83, -2.0, 1.0
    v_fma_f32 v84, v84, -2.0, 1.0
    v_fma_f32 v85, v85, -2.0, 1.0
    v_fma_f32 v86, v86, -2.0, 1.0
    v_fma_f32 v87, v87, -2.0, 1.0
    v_cvt_pk_bf16_f32 v80, v80, v81
    v_cvt_pk_bf16_f32 v81, v82, v83
    v_cvt_pk_bf16_f32 v82, v84, v85
    v_cvt_pk_bf16_f32 v83, v86, v87
    ds_write_b128 v39, v[80:83] offset:0
    v_rcp_f32 v88, v88
    v_rcp_f32 v89, v89
    v_rcp_f32 v90, v90
    v_rcp_f32 v91, v91
    v_rcp_f32 v92, v92
    v_rcp_f32 v93, v93
    v_rcp_f32 v94, v94
    v_rcp_f32 v95, v95
    v_fma_f32 v88, v88, -2.0, 1.0
    v_fma_f32 v89, v89, -2.0, 1.0
    v_fma_f32 v90, v90, -2.0, 1.0
    v_fma_f32 v91, v91, -2.0, 1.0
    v_fma_f32 v92, v92, -2.0, 1.0
    v_fma_f32 v93, v93, -2.0, 1.0
    v_fma_f32 v94, v94, -2.0, 1.0
    v_fma_f32 v95, v95, -2.0, 1.0
    v_cvt_pk_bf16_f32 v88, v88, v89
    v_cvt_pk_bf16_f32 v89, v90, v91
    v_cvt_pk_bf16_f32 v90, v92, v93
    v_cvt_pk_bf16_f32 v91, v94, v95
    ds_write_b128 v39, v[88:91] offset:1024
    s_waitcnt lgkmcnt(2)
    s_cmp_lg_u32 s52, 0
    s_cbranch_scc1 L_js1
    v_fma_f32 v80, v112, v96, 1.0
    v_fma_f32 v81, v113, v97, 1.0
    v_fma_f32 v82, v114, v98, 1.0
    v_fma_f32 v83, v115, v99, 1.0
    v_fma_f32 v84, v116, v100, 1.0
    v_fma_f32 v85, v117, v101, 1.0
    v_fma_f32 v86, v118, v102, 1.0
    v_fma_f32 v87, v119, v103, 1.0
    v_fma_f32 v88, v120, v104, 1.0
    v_fma_f32 v89, v121, v105, 1.0
    v_fma_f32 v90, v122, v106, 1.0
    v_fma_f32 v91, v123, v107, 1.0
    v_fma_f32 v92, v124, v108, 1.0
    v_fma_f32 v93, v125, v109, 1.0
    v_fma_f32 v94, v126, v110, 1.0
    v_fma_f32 v95, v127, v111, 1.0
L_jb1:
    ds_read_b128 v[96:99], v36 offset:2048
    ds_read_b128 v[100:103], v36 offset:2064
    ds_read_b128 v[104:107], v36 offset:2080
    ds_read_b128 v[108:111], v36 offset:2096
    v_rcp_f32 v80, v80
    v_rcp_f32 v81, v81
    v_rcp_f32 v82, v82
    v_rcp_f32 v83, v83
    v_rcp_f32 v84, v84
    v_rcp_f32 v85, v85
    v_rcp_f32 v86, v86
    v_rcp_f32 v87, v87
    v_fma_f32 v80, v80, -2.0, 1.0
    v_fma_f32 v81, v81, -2.0, 1.0
    v_fma_f32 v82, v82, -2.0, 1.0
    v_fma_f32 v83, v83, -2.0, 1.0
    v_fma_f32 v84, v84, -2.0, 1.0
    v_fma_f32 v85, v85, -2.0, 1.0
    v_fma_f32 v86, v86, -2.0, 1.0
    v_fma_f32 v87, v87, -2.0, 1.0
    v_cvt_pk_bf16_f32 v80, v80, v81
    v_cvt_pk_bf16_f32 v81, v82, v83
    s_barrier
    v_cvt_pk_bf16_f32 v82, v84, v85
    v_cvt_pk_bf16_f32 v83, v86, v87
    ds_write_b128 v39, v[80:83] offset:8192
    v_rcp_f32 v88, v88
    v_rcp_f32 v89, v89
    v_rcp_f32 v90, v90
    v_rcp_f32 v91, v91
    v_rcp_f32 v92, v92
    v_rcp_f32 v93, v93
    v_rcp_f32 v94, v94
    v_rcp_f32 v95, v95
    v_fma_f32 v88, v88, -2.0, 1.0
    v_fma_f32 v89, v89, -2.0, 1.0
    v_fma_f32 v90, v90, -2.0, 1.0
    v_fma_f32 v91, v91, -2.0, 1.0
    v_fma_f32 v92, v92, -2.0, 1.0
    v_fma_f32 v93, v93, -2.0, 1.0
    v_fma_f32 v94, v94, -2.0, 1.0
    v_fma_f32 v95, v95, -2.0, 1.0
    v_cvt_pk_bf16_f32 v88, v88, v89
    v_cvt_pk_bf16_f32 v89, v90, v91
    v_cvt_pk_bf16_f32 v90, v92, v93
    v_cvt_pk_bf16_f32 v91, v94, v95
    ds_write_b128 v39, v[88:91] offset:9216
    s_waitcnt lgkmcnt(2)
    s_cmp_lg_u32 s52, 0
    s_cbranch_scc1 L_js2
    v_fma_f32 v80, v112, v96, 1.0
    v_fma_f32 v81, v113, v97, 1.0
    v_fma_f32 v82, v114, v98, 1.0
    v_fma_f32 v83, v115, v99, 1.0
    v_fma_f32 v84, v116, v100, 1.0
    v_fma_f32 v85, v117, v101, 1.0
    v_fma_f32 v86, v118, v102, 1.0
    v_fma_f32 v87, v119, v103, 1.0
    v_fma_f32 v88, v120, v104, 1.0
    v_fma_f32 v89, v121, v105, 1.0
    v_fma_f32 v90, v122, v106, 1.0
    v_fma_f32 v91, v123, v107, 1.0
    v_fma_f32 v92, v124, v108, 1.0
    v_fma_f32 v93, v125, v109, 1.0
    v_fma_f32 v94, v126, v110, 1.0
    v_fma_f32 v95, v127, v111, 1.0
L_jb2:
    ds_read_b128 v[96:99], v36 offset:3072
    ds_read_b128 v[100:103], v36 offset:3088
    ds_read_b128 v[104:107], v36 offset:3104
    ds_read_b128 v[108:111], v36 offset:3120
    v_rcp_f32 v80, v80
    v_rcp_f32 v81, v81
    v_rcp_f32 v82, v82
    v_rcp_f32 v83, v83
    v_rcp_f32 v84, v84
    v_rcp_f32 v85, v85
    v_rcp_f32 v86, v86
    v_rcp_f32 v87, v87
    v_fma_f32 v80, v80, -2.0, 1.0
    v_fma_f32 v81, v81, -2.0, 1.0
    v_fma_f32 v82, v82, -2.0, 1.0
    v_fma_f32 v83, v83, -2.0, 1.0
    v_fma_f32 v84, v84, -2.0, 1.0
    v_fma_f32 v85, v85, -2.0, 1.0
    v_fma_f32 v86, v86, -2.0, 1.0
    v_fma_f32 v87, v87, -2.0, 1.0
    v_cvt_pk_bf16_f32 v80, v80, v81
    v_cvt_pk_bf16_f32 v81, v82, v83
    v_cvt_pk_bf16_f32 v82, v84, v85
    v_cvt_pk_bf16_f32 v83, v86, v87
    ds_write_b128 v39, v[80:83] offset:16384
    v_rcp_f32 v88, v88
    v_rcp_f32 v89, v89
    v_rcp_f32 v90, v90
    v_rcp_f32 v91, v91
    v_rcp_f32 v92, v92
    v_rcp_f32 v93, v93
    v_rcp_f32 v94, v94
    v_rcp_f32 v95, v95
    v_fma_f32 v88, v88, -2.0, 1.0
    v_fma_f32 v89, v89, -2.0, 1.0
    v_fma_f32 v90, v90, -2.0, 1.0
    v_fma_f32 v91, v91, -2.0, 1.0
    v_fma_f32 v92, v92, -2.0, 1.0
    v_fma_f32 v93, v93, -2.0, 1.0
    v_fma_f32 v94, v94, -2.0, 1.0
    v_fma_f32 v95, v95, -2.0, 1.0
    v_cvt_pk_bf16_f32 v88, v88, v89
    v_cvt_pk_bf16_f32 v89, v90, v91
    v_cvt_pk_bf16_f32 v90, v92, v93
    v_cvt_pk_bf16_f32 v91, v94, v95
    ds_write_b128 v39, v[88:91] offset:17408
    s_waitcnt lgkmcnt(2)
    s_cmp_lg_u32 s52, 0
    s_cbranch_scc1 L_js3
    v_fma_f32 v80, v112, v96, 1.0
    v_fma_f32 v81, v113, v97, 1.0
    v_fma_f32 v82, v114, v98, 1.0
    v_fma_f32 v83, v115, v99, 1.0
    v_fma_f32 v84, v116, v100, 1.0
    v_fma_f32 v85, v117, v101, 1.0
    v_fma_f32 v86, v118, v102, 1.0
    v_fma_f32 v87, v119, v103, 1.0
    v_fma_f32 v88, v120, v104, 1.0
    v_fma_f32 v89, v121, v105, 1.0
    v_fma_f32 v90, v122, v106, 1.0
    v_fma_f32 v91, v123, v107, 1.0
    v_fma_f32 v92, v124, v108, 1.0
    v_fma_f32 v93, v125, v109, 1.0
    v_fma_f32 v94, v126, v110, 1.0
    v_fma_f32 v95, v127, v111, 1.0
L_jb3:
    ds_read_b128 v[96:99], v36 offset:4096
    ds_read_b128 v[100:103], v36 offset:4112
    ds_read_b128 v[104:107], v36 offset:4128
    ds_read_b128 v[108:111], v36 offset:4144
    s_barrier
    v_rcp_f32 v80, v80
    v_rcp_f32 v81, v81
    v_rcp_f32 v82, v82
    v_rcp_f32 v83, v83
    v_rcp_f32 v84, v84
    v_rcp_f32 v85, v85
    v_rcp_f32 v86, v86
    v_rcp_f32 v87, v87
    v_fma_f32 v80, v80, -2.0, 1.0
    v_fma_f32 v81, v81, -2.0, 1.0
    v_fma_f32 v82, v82, -2.0, 1.0
    v_fma_f32 v83, v83, -2.0, 1.0
    v_fma_f32 v84, v84, -2.0, 1.0
    v_fma_f32 v85, v85, -2.0, 1.0
    v_fma_f32 v86, v86, -2.0, 1.0
    v_fma_f32 v87, v87, -2.0, 1.0
    v_cvt_pk_bf16_f32 v80, v80, v81
    v_cvt_pk_bf16_f32 v81, v82, v83
    v_cvt_pk_bf16_f32 v82, v84, v85
    v_cvt_pk_bf16_f32 v83, v86, v87
    ds_write_b128 v46, v[80:83] offset:0
    v_rcp_f32 v88, v88
    v_rcp_f32 v89, v89
    v_rcp_f32 v90, v90
    v_rcp_f32 v91, v91
    v_rcp_f32 v92, v92
    v_rcp_f32 v93, v93
    v_rcp_f32 v94, v94
    v_rcp_f32 v95, v95
    v_fma_f32 v88, v88, -2.0, 1.0
    v_fma_f32 v89, v89, -2.0, 1.0
    v_fma_f32 v90, v90, -2.0, 1.0
    v_fma_f32 v91, v91, -2.0, 1.0
    v_fma_f32 v92, v92, -2.0, 1.0
    v_fma_f32 v93, v93, -2.0, 1.0
    v_fma_f32 v94, v94, -2.0, 1.0
    v_fma_f32 v95, v95, -2.0, 1.0
    v_cvt_pk_bf16_f32 v88, v88, v89
    v_cvt_pk_bf16_f32 v89, v90, v91
    v_cvt_pk_bf16_f32 v90, v92, v93
    v_cvt_pk_bf16_f32 v91, v94, v95
    ds_write_b128 v46, v[88:91] offset:1024
    s_waitcnt lgkmcnt(2)
    s_cmp_lg_u32 s52, 0
    s_cbranch_scc1 L_js4
    v_fma_f32 v80, v112, v96, 1.0
    v_fma_f32 v81, v113, v97, 1.0
    v_fma_f32 v82, v114, v98, 1.0
    v_fma_f32 v83, v115, v99, 1.0
    v_fma_f32 v84, v116, v100, 1.0
    v_fma_f32 v85, v117, v101, 1.0
    v_fma_f32 v86, v118, v102, 1.0
    v_fma_f32 v87, v119, v103, 1.0
    v_fma_f32 v88, v120, v104, 1.0
    v_fma_f32 v89, v121, v105, 1.0
    v_fma_f32 v90, v122, v106, 1.0
    v_fma_f32 v91, v123, v107, 1.0
    v_fma_f32 v92, v124, v108, 1.0
    v_fma_f32 v93, v125, v109, 1.0
    v_fma_f32 v94, v126, v110, 1.0
    v_fma_f32 v95, v127, v111, 1.0
L_jb4:
    ds_read_b128 v[96:99], v36 offset:5120
    ds_read_b128 v[100:103], v36 offset:5136
    ds_read_b128 v[104:107], v36 offset:5152
    ds_read_b128 v[108:111], v36 offset:5168
    v_rcp_f32 v80, v80
    v_rcp_f32 v81, v81
    v_rcp_f32 v82, v82
    v_rcp_f32 v83, v83
    v_rcp_f32 v84, v84
    v_rcp_f32 v85, v85
    v_rcp_f32 v86, v86
    v_rcp_f32 v87, v87
    v_fma_f32 v80, v80, -2.0, 1.0
    v_fma_f32 v81, v81, -2.0, 1.0
    v_fma_f32 v82, v82, -2.0, 1.0
    v_fma_f32 v83, v83, -2.0, 1.0
    v_fma_f32 v84, v84, -2.0, 1.0
    v_fma_f32 v85, v85, -2.0, 1.0
    v_fma_f32 v86, v86, -2.0, 1.0
    v_fma_f32 v87, v87, -2.0, 1.0
    v_cvt_pk_bf16_f32 v80, v80, v81
    v_cvt_pk_bf16_f32 v81, v82, v83
    v_cvt_pk_bf16_f32 v82, v84, v85
    v_cvt_pk_bf16_f32 v83, v86, v87
    ds_write_b128 v46, v[80:83] offset:48128
    v_rcp_f32 v88, v88
    v_rcp_f32 v89, v89
    v_rcp_f32 v90, v90
    v_rcp_f32 v91, v91
    v_rcp_f32 v92, v92
    v_rcp_f32 v93, v93
    v_rcp_f32 v94, v94
    s_barrier
    s_setprio 3
    ds_read_b128 v[48:51], v27 offset:28672
    ds_read_b128 v[52:55], v28 offset:28672
    ds_read_b128 v[56:59], v27 offset:45312
    ds_read_b128 v[60:63], v28 offset:45312
    s_add_u32 s68, s29, 8
    s_lshl_b32 s68, s68, 8
    s_lshl_b32 s69, s28, 3
    s_add_u32 s68, s68, s69
    s_add_u32 s68, s68, s25
    s_lshl_b32 s68, s68, 10
    s_add_u32 s65, s68, 8388608
    s_waitcnt lgkmcnt(0)
    v_add_f32 v48, v48, v56
    v_add_f32 v49, v49, v57
    v_add_f32 v50, v50, v58
    v_add_f32 v51, v51, v59
    v_add_f32 v52, v52, v60
    v_add_f32 v53, v53, v61
    v_add_f32 v54, v54, v62
    v_add_f32 v55, v55, v63
    v_mul_f32 v2, v48, v48
    v_mul_f32 v3, v49, v49
    v_mul_f32 v4, v50, v50
    v_mul_f32 v5, v51, v51
    v_mul_f32 v6, v52, v52
    v_mul_f32 v7, v53, v53
    v_mul_f32 v8, v54, v54
    v_mul_f32 v9, v55, v55
    v_fma_f32 v2, v2, v35, s49
    v_fma_f32 v3, v3, v35, s49
    v_fma_f32 v4, v4, v35, s49
    v_fma_f32 v5, v5, v35, s49
    v_fma_f32 v6, v6, v35, s49
    v_fma_f32 v7, v7, v35, s49
    v_fma_f32 v8, v8, v35, s49
    v_fma_f32 v9, v9, v35, s49
    v_mul_f32 v2, v2, v48
    v_mul_f32 v3, v3, v49
    v_mul_f32 v4, v4, v50
    v_mul_f32 v5, v5, v51
    v_mul_f32 v6, v6, v52
    v_mul_f32 v7, v7, v53
    v_mul_f32 v8, v8, v54
    v_mul_f32 v9, v9, v55
    v_exp_f32 v2, v2
    v_exp_f32 v3, v3
    v_exp_f32 v4, v4
    v_exp_f32 v5, v5
    v_exp_f32 v6, v6
    v_exp_f32 v7, v7
    v_exp_f32 v8, v8
    v_exp_f32 v9, v9
    v_add_f32 v2, 1.0, v2
    v_add_f32 v3, 1.0, v3
    v_add_f32 v4, 1.0, v4
    v_add_f32 v5, 1.0, v5
    v_add_f32 v6, 1.0, v6
    v_add_f32 v7, 1.0, v7
    v_add_f32 v8, 1.0, v8
    v_add_f32 v9, 1.0, v9
    v_rcp_f32 v2, v2
    v_rcp_f32 v3, v3
    v_rcp_f32 v4, v4
    v_rcp_f32 v5, v5
    v_rcp_f32 v6, v6
    v_rcp_f32 v7, v7
    v_rcp_f32 v8, v8
    v_rcp_f32 v9, v9
    v_mul_f32 v48, v48, v2
    v_mul_f32 v49, v49, v3
    v_mul_f32 v50, v50, v4
    v_mul_f32 v51, v51, v5
    v_mul_f32 v52, v52, v6
    v_mul_f32 v53, v53, v7
    v_mul_f32 v54, v54, v8
    v_mul_f32 v55, v55, v9
    v_cvt_pk_bf16_f32 v56, v48, v49
    v_cvt_pk_bf16_f32 v57, v50, v51
    v_cvt_pk_bf16_f32 v58, v52, v53
    v_cvt_pk_bf16_f32 v59, v54, v55
    v_min_u32 v56, -2, v56
    v_min_u32 v57, -2, v57
    v_min_u32 v58, -2, v58
    v_min_u32 v59, -2, v59
    buffer_store_dwordx4 v[56:59], v31, s[40:43], s65 offen sc1
    v_rcp_f32 v95, v95
    v_fma_f32 v88, v88, -2.0, 1.0
    v_fma_f32 v89, v89, -2.0, 1.0
    v_fma_f32 v90, v90, -2.0, 1.0
    v_fma_f32 v91, v91, -2.0, 1.0
    v_fma_f32 v92, v92, -2.0, 1.0
    v_fma_f32 v93, v93, -2.0, 1.0
    s_barrier
    ds_read_b128 v[64:67], v27 offset:36992
    ds_read_b128 v[68:71], v28 offset:36992
    ds_read_b128 v[72:75], v27 offset:53632
    ds_read_b128 v[76:79], v28 offset:53632
    s_add_u32 s65, s65, 4096
    s_waitcnt lgkmcnt(0)
    v_add_f32 v64, v64, v72
    v_add_f32 v65, v65, v73
    v_add_f32 v66, v66, v74
    v_add_f32 v67, v67, v75
    v_add_f32 v68, v68, v76
    v_add_f32 v69, v69, v77
    v_add_f32 v70, v70, v78
    v_add_f32 v71, v71, v79
    v_mul_f32 v2, v64, v64
    v_mul_f32 v3, v65, v65
    v_mul_f32 v4, v66, v66
    v_mul_f32 v5, v67, v67
    v_mul_f32 v6, v68, v68
    v_mul_f32 v7, v69, v69
    v_mul_f32 v8, v70, v70
    v_mul_f32 v9, v71, v71
    v_fma_f32 v2, v2, v35, s49
    v_fma_f32 v3, v3, v35, s49
    v_fma_f32 v4, v4, v35, s49
    v_fma_f32 v5, v5, v35, s49
    v_fma_f32 v6, v6, v35, s49
    v_fma_f32 v7, v7, v35, s49
    v_fma_f32 v8, v8, v35, s49
    v_fma_f32 v9, v9, v35, s49
    v_mul_f32 v2, v2, v64
    v_mul_f32 v3, v3, v65
    v_mul_f32 v4, v4, v66
    v_mul_f32 v5, v5, v67
    v_mul_f32 v6, v6, v68
    v_mul_f32 v7, v7, v69
    v_mul_f32 v8, v8, v70
    v_mul_f32 v9, v9, v71
    v_exp_f32 v2, v2
    v_exp_f32 v3, v3
    v_exp_f32 v4, v4
    v_exp_f32 v5, v5
    v_exp_f32 v6, v6
    v_exp_f32 v7, v7
    v_exp_f32 v8, v8
    v_exp_f32 v9, v9
    v_add_f32 v2, 1.0, v2
    v_add_f32 v3, 1.0, v3
    v_add_f32 v4, 1.0, v4
    v_add_f32 v5, 1.0, v5
    v_add_f32 v6, 1.0, v6
    v_add_f32 v7, 1.0, v7
    v_add_f32 v8, 1.0, v8
    v_add_f32 v9, 1.0, v9
    v_rcp_f32 v2, v2
    v_rcp_f32 v3, v3
    v_rcp_f32 v4, v4
    v_rcp_f32 v5, v5
    v_rcp_f32 v6, v6
    v_rcp_f32 v7, v7
    v_rcp_f32 v8, v8
    v_rcp_f32 v9, v9
    v_mul_f32 v64, v64, v2
    v_mul_f32 v65, v65, v3
    v_mul_f32 v66, v66, v4
    v_mul_f32 v67, v67, v5
    v_mul_f32 v68, v68, v6
    v_mul_f32 v69, v69, v7
    v_mul_f32 v70, v70, v8
    v_mul_f32 v71, v71, v9
    v_cvt_pk_bf16_f32 v72, v64, v65
    v_cvt_pk_bf16_f32 v73, v66, v67
    v_cvt_pk_bf16_f32 v74, v68, v69
    v_cvt_pk_bf16_f32 v75, v70, v71
    v_min_u32 v72, -2, v72
    v_min_u32 v73, -2, v73
    v_min_u32 v74, -2, v74
    v_min_u32 v75, -2, v75
    buffer_store_dwordx4 v[72:75], v31, s[40:43], s65 offen sc1
    s_setprio 0
    v_fma_f32 v94, v94, -2.0, 1.0
    v_fma_f32 v95, v95, -2.0, 1.0
    v_cvt_pk_bf16_f32 v88, v88, v89
    v_cvt_pk_bf16_f32 v89, v90, v91
    v_cvt_pk_bf16_f32 v90, v92, v93
    v_cvt_pk_bf16_f32 v91, v94, v95
    ds_write_b128 v46, v[88:91] offset:49152
    s_cmp_lg_u32 s52, 0
    s_cbranch_scc1 L_js5
    v_fma_f32 v80, v112, v96, 1.0
    v_fma_f32 v81, v113, v97, 1.0
    v_fma_f32 v82, v114, v98, 1.0
    v_fma_f32 v83, v115, v99, 1.0
    v_fma_f32 v84, v116, v100, 1.0
    v_fma_f32 v85, v117, v101, 1.0
    v_fma_f32 v86, v118, v102, 1.0
    v_fma_f32 v87, v119, v103, 1.0
    v_fma_f32 v88, v120, v104, 1.0
    v_fma_f32 v89, v121, v105, 1.0
    v_fma_f32 v90, v122, v106, 1.0
    v_fma_f32 v91, v123, v107, 1.0
    v_fma_f32 v92, v124, v108, 1.0
    v_fma_f32 v93, v125, v109, 1.0
    v_fma_f32 v94, v126, v110, 1.0
    v_fma_f32 v95, v127, v111, 1.0
L_jb5:
    ds_read_b128 v[96:99], v36 offset:6144
    ds_read_b128 v[100:103], v36 offset:6160
    ds_read_b128 v[104:107], v36 offset:6176
    ds_read_b128 v[108:111], v36 offset:6192
    v_rcp_f32 v80, v80
    v_rcp_f32 v81, v81
    v_rcp_f32 v82, v82
    v_rcp_f32 v83, v83
    v_rcp_f32 v84, v84
    v_rcp_f32 v85, v85
    v_rcp_f32 v86, v86
    v_rcp_f32 v87, v87
    v_fma_f32 v80, v80, -2.0, 1.0
    v_fma_f32 v81, v81, -2.0, 1.0
    v_fma_f32 v82, v82, -2.0, 1.0
    v_fma_f32 v83, v83, -2.0, 1.0
    v_fma_f32 v84, v84, -2.0, 1.0
    v_fma_f32 v85, v85, -2.0, 1.0
    v_fma_f32 v86, v86, -2.0, 1.0
    v_fma_f32 v87, v87, -2.0, 1.0
    v_cvt_pk_bf16_f32 v80, v80, v81
    v_cvt_pk_bf16_f32 v81, v82, v83
    v_cvt_pk_bf16_f32 v82, v84, v85
    v_cvt_pk_bf16_f32 v83, v86, v87
    ds_write_b128 v46, v[80:83] offset:56320
    v_rcp_f32 v88, v88
    v_rcp_f32 v89, v89
    v_rcp_f32 v90, v90
    v_rcp_f32 v91, v91
    v_rcp_f32 v92, v92
    v_rcp_f32 v93, v93
    v_rcp_f32 v94, v94
    v_rcp_f32 v95, v95
    v_fma_f32 v88, v88, -2.0, 1.0
    v_fma_f32 v89, v89, -2.0, 1.0
    v_fma_f32 v90, v90, -2.0, 1.0
    v_fma_f32 v91, v91, -2.0, 1.0
    v_fma_f32 v92, v92, -2.0, 1.0
    v_fma_f32 v93, v93, -2.0, 1.0
    v_fma_f32 v94, v94, -2.0, 1.0
    v_fma_f32 v95, v95, -2.0, 1.0
    v_cvt_pk_bf16_f32 v88, v88, v89
    v_cvt_pk_bf16_f32 v89, v90, v91
    v_cvt_pk_bf16_f32 v90, v92, v93
    v_cvt_pk_bf16_f32 v91, v94, v95
    ds_write_b128 v46, v[88:91] offset:57344
    s_lshl_b32 s69, s30, 10
    s_add_u32 s68, s69, 10485760
    buffer_load_dwordx4 v[48:51], v31, s[40:43], s68 offen
    s_add_u32 s68, s69, 10747904
    buffer_load_dwordx4 v[52:55], v31, s[40:43], s68 offen
    s_add_u32 s68, s69, 11010048
    buffer_load_dwordx4 v[56:59], v31, s[40:43], s68 offen
    s_add_u32 s68, s69, 11272192
    buffer_load_dwordx4 v[60:63], v31, s[40:43], s68 offen
    s_add_u32 s68, s69, 11534336
    buffer_load_dwordx4 v[64:67], v31, s[40:43], s68 offen
    s_add_u32 s68, s69, 11796480
    buffer_load_dwordx4 v[68:71], v31, s[40:43], s68 offen
    s_add_u32 s68, s69, 12058624
    buffer_load_dwordx4 v[72:75], v31, s[40:43], s68 offen
    s_add_u32 s68, s69, 12320768
    buffer_load_dwordx4 v[76:79], v31, s[40:43], s68 offen
    s_waitcnt lgkmcnt(2)
    s_cmp_lg_u32 s52, 0
    s_cbranch_scc1 L_js6
    v_fma_f32 v80, v112, v96, 1.0
    v_fma_f32 v81, v113, v97, 1.0
    v_fma_f32 v82, v114, v98, 1.0
    v_fma_f32 v83, v115, v99, 1.0
    v_fma_f32 v84, v116, v100, 1.0
    v_fma_f32 v85, v117, v101, 1.0
    v_fma_f32 v86, v118, v102, 1.0
    v_fma_f32 v87, v119, v103, 1.0
    v_fma_f32 v88, v120, v104, 1.0
    v_fma_f32 v89, v121, v105, 1.0
    v_fma_f32 v90, v122, v106, 1.0
    v_fma_f32 v91, v123, v107, 1.0
    v_fma_f32 v92, v124, v108, 1.0
    v_fma_f32 v93, v125, v109, 1.0
    v_fma_f32 v94, v126, v110, 1.0
    v_fma_f32 v95, v127, v111, 1.0
L_jb6:
    ds_read_b128 v[96:99], v36 offset:7168
    ds_read_b128 v[100:103], v36 offset:7184
    ds_read_b128 v[104:107], v36 offset:7200
    ds_read_b128 v[108:111], v36 offset:7216
    s_waitcnt lgkmcnt(4)
    s_barrier
    v_rcp_f32 v80, v80
    v_rcp_f32 v81, v81
    v_rcp_f32 v82, v82
    v_rcp_f32 v83, v83
    v_rcp_f32 v84, v84
    v_rcp_f32 v85, v85
    v_rcp_f32 v86, v86
    v_rcp_f32 v87, v87
    v_fma_f32 v80, v80, -2.0, 1.0
    v_fma_f32 v81, v81, -2.0, 1.0
    v_fma_f32 v82, v82, -2.0, 1.0
    v_fma_f32 v83, v83, -2.0, 1.0
    v_fma_f32 v84, v84, -2.0, 1.0
    v_fma_f32 v85, v85, -2.0, 1.0
    v_fma_f32 v86, v86, -2.0, 1.0
    v_fma_f32 v87, v87, -2.0, 1.0
    v_cvt_pk_bf16_f32 v80, v80, v81
    v_cvt_pk_bf16_f32 v81, v82, v83
    v_cvt_pk_bf16_f32 v82, v84, v85
    v_cvt_pk_bf16_f32 v83, v86, v87
    ds_write_b128 v46, v[80:83] offset:30720
    v_rcp_f32 v88, v88
    v_rcp_f32 v89, v89
    v_rcp_f32 v90, v90
    v_rcp_f32 v91, v91
    v_rcp_f32 v92, v92
    v_rcp_f32 v93, v93
    v_rcp_f32 v94, v94
    v_rcp_f32 v95, v95
    v_fma_f32 v88, v88, -2.0, 1.0
    v_fma_f32 v89, v89, -2.0, 1.0
    v_fma_f32 v90, v90, -2.0, 1.0
    v_fma_f32 v91, v91, -2.0, 1.0
    v_fma_f32 v92, v92, -2.0, 1.0
    v_fma_f32 v93, v93, -2.0, 1.0
    v_fma_f32 v94, v94, -2.0, 1.0
    v_fma_f32 v95, v95, -2.0, 1.0
    v_cvt_pk_bf16_f32 v88, v88, v89
    v_cvt_pk_bf16_f32 v89, v90, v91
    v_cvt_pk_bf16_f32 v90, v92, v93
    v_cvt_pk_bf16_f32 v91, v94, v95
    ds_write_b128 v46, v[88:91] offset:31744
    s_waitcnt lgkmcnt(2)
    s_cmp_lg_u32 s52, 0
    s_cbranch_scc1 L_js7
    v_fma_f32 v80, v112, v96, 1.0
    v_fma_f32 v81, v113, v97, 1.0
    v_fma_f32 v82, v114, v98, 1.0
    v_fma_f32 v83, v115, v99, 1.0
    v_fma_f32 v84, v116, v100, 1.0
    v_fma_f32 v85, v117, v101, 1.0
    v_fma_f32 v86, v118, v102, 1.0
L_pg15:
    s_cbranch_execz L_pb15
    v_fma_f32 v87, v119, v103, 1.0
    v_fma_f32 v88, v120, v104, 1.0
    v_fma_f32 v89, v121, v105, 1.0
    v_fma_f32 v90, v122, v106, 1.0
    v_fma_f32 v91, v123, v107, 1.0
    v_fma_f32 v92, v124, v108, 1.0
    v_fma_f32 v93, v125, v109, 1.0
    v_fma_f32 v94, v126, v110, 1.0
    v_fma_f32 v95, v127, v111, 1.0
L_jb7:
    ds_read_b128 v[96:99], v36 offset:8192
    ds_read_b128 v[100:103], v36 offset:8208
    ds_read_b128 v[104:107], v36 offset:8224
    ds_read_b128 v[108:111], v36 offset:8240
    v_rcp_f32 v80, v80
    v_rcp_f32 v81, v81
    v_rcp_f32 v82, v82
    v_rcp_f32 v83, v83
    v_rcp_f32 v84, v84
    v_rcp_f32 v85, v85
    v_rcp_f32 v86, v86
    v_rcp_f32 v87, v87
    v_fma_f32 v80, v80, -2.0, 1.0
    v_fma_f32 v81, v81, -2.0, 1.0
    v_fma_f32 v82, v82, -2.0, 1.0
    v_fma_f32 v83, v83, -2.0, 1.0
    v_fma_f32 v84, v84, -2.0, 1.0
    v_fma_f32 v85, v85, -2.0, 1.0
    v_fma_f32 v86, v86, -2.0, 1.0
    v_fma_f32 v87, v87, -2.0, 1.0
    v_cvt_pk_bf16_f32 v80, v80, v81
    v_cvt_pk_bf16_f32 v81, v82, v83
    v_cvt_pk_bf16_f32 v82, v84, v85
    v_cvt_pk_bf16_f32 v83, v86, v87
    ds_write_b128 v46, v[80:83] offset:38912
    v_rcp_f32 v88, v88
    v_rcp_f32 v89, v89
    v_rcp_f32 v90, v90
    v_rcp_f32 v91, v91
    v_rcp_f32 v92, v92
    v_rcp_f32 v93, v93
    v_rcp_f32 v94, v94
    v_rcp_f32 v95, v95
    v_fma_f32 v88, v88, -2.0, 1.0
    v_fma_f32 v89, v89, -2.0, 1.0
    v_fma_f32 v90, v90, -2.0, 1.0
    v_fma_f32 v91, v91, -2.0, 1.0
    v_fma_f32 v92, v92, -2.0, 1.0
    v_fma_f32 v93, v93, -2.0, 1.0
    v_fma_f32 v94, v94, -2.0, 1.0
    v_fma_f32 v95, v95, -2.0, 1.0
    v_cvt_pk_bf16_f32 v88, v88, v89
    v_cvt_pk_bf16_f32 v89, v90, v91
    v_cvt_pk_bf16_f32 v90, v92, v93
    v_cvt_pk_bf16_f32 v91, v94, v95
    ds_write_b128 v46, v[88:91] offset:39936
    s_setprio 3
    s_waitcnt vmcnt(0)
    s_mov_b32 s54, 0
L_fchk1:
    v_max3_u32 v18, v48, v49, v50
    v_max3_u32 v18, v51, v52, v18
    v_max3_u32 v18, v53, v54, v18
    v_max3_u32 v18, v55, v56, v18
    v_max3_u32 v18, v57, v58, v18
    v_max3_u32 v18, v59, v60, v18
    v_max3_u32 v18, v61, v62, v18
    v_max3_u32 v18, v63, v64, v18
    v_max3_u32 v18, v65, v66, v18
    v_max3_u32 v18, v67, v68, v18
    v_max3_u32 v18, v69, v70, v18
    v_max3_u32 v18, v71, v72, v18
    v_max3_u32 v18, v73, v74, v18
    v_max3_u32 v18, v75, v76, v18
    v_max3_u32 v18, v77, v78, v18
    v_max_u32 v18, v79, v18
    v_cmp_eq_u32 vcc, -1, v18
    s_nop 1
    s_cmp_lg_u64 vcc, 0
    s_cbranch_scc1 L_fspin1
L_fok1:
    s_waitcnt lgkmcnt(0)
    s_barrier
    v_mfma_f32_16x16x32_bf16 v[2:5], v[128:131], v[48:51], 0
    v_mfma_f32_16x16x32_bf16 v[2:5], v[132:135], v[52:55], v[2:5]
    v_mfma_f32_16x16x32_bf16 v[2:5], v[136:139], v[56:59], v[2:5]
    v_mfma_f32_16x16x32_bf16 v[2:5], v[140:143], v[60:63], v[2:5]
    v_mfma_f32_16x16x32_bf16 v[2:5], v[144:147], v[64:67], v[2:5]
    v_mfma_f32_16x16x32_bf16 v[2:5], v[148:151], v[68:71], v[2:5]
    v_mfma_f32_16x16x32_bf16 v[2:5], v[152:155], v[72:75], v[2:5]
    v_mfma_f32_16x16x32_bf16 v[2:5], v[156:159], v[76:79], v[2:5]
    v_mfma_f32_16x16x32_bf16 v[6:9], v[160:163], v[48:51], 0
    v_mfma_f32_16x16x32_bf16 v[6:9], v[164:167], v[52:55], v[6:9]
    v_mfma_f32_16x16x32_bf16 v[6:9], v[168:171], v[56:59], v[6:9]
    v_mfma_f32_16x16x32_bf16 v[6:9], v[172:175], v[60:63], v[6:9]
    v_mfma_f32_16x16x32_bf16 v[6:9], v[176:179], v[64:67], v[6:9]
    v_mfma_f32_16x16x32_bf16 v[6:9], v[180:183], v[68:71], v[6:9]
    v_mfma_f32_16x16x32_bf16 v[6:9], v[184:187], v[72:75], v[6:9]
    v_mfma_f32_16x16x32_bf16 v[6:9], v[188:191], v[76:79], v[6:9]
    v_mfma_f32_16x16x32_bf16 v[10:13], v[192:195], v[48:51], 0
    v_mfma_f32_16x16x32_bf16 v[10:13], v[196:199], v[52:55], v[10:13]
    v_mfma_f32_16x16x32_bf16 v[10:13], v[200:203], v[56:59], v[10:13]
    v_mfma_f32_16x16x32_bf16 v[10:13], v[204:207], v[60:63], v[10:13]
    v_mfma_f32_16x16x32_bf16 v[10:13], v[208:211], v[64:67], v[10:13]
    v_mfma_f32_16x16x32_bf16 v[10:13], v[212:215], v[68:71], v[10:13]
    v_mfma_f32_16x16x32_bf16 v[10:13], v[216:219], v[72:75], v[10:13]
    v_mfma_f32_16x16x32_bf16 v[10:13], v[220:223], v[76:79], v[10:13]
    v_mfma_f32_16x16x32_bf16 v[14:17], v[224:227], v[48:51], 0
    v_mfma_f32_16x16x32_bf16 v[14:17], v[228:231], v[52:55], v[14:17]
    v_mfma_f32_16x16x32_bf16 v[14:17], v[232:235], v[56:59], v[14:17]
    v_mfma_f32_16x16x32_bf16 v[14:17], v[236:239], v[60:63], v[14:17]
    v_mfma_f32_16x16x32_bf16 v[14:17], v[240:243], v[64:67], v[14:17]
    v_mfma_f32_16x16x32_bf16 v[14:17], v[244:247], v[68:71], v[14:17]
    v_mfma_f32_16x16x32_bf16 v[14:17], v[248:251], v[72:75], v[14:17]
    v_mfma_f32_16x16x32_bf16 v[14:17], v[252:255], v[76:79], v[14:17]
    s_nop 7
    s_mov_b32 s55, 0x4038aa3b
    v_mul_f32 v2, s55, v2
    v_mul_f32 v3, s55, v3
    v_mul_f32 v4, s55, v4
    v_mul_f32 v5, s55, v5
    v_mul_f32 v6, s55, v6
    v_mul_f32 v7, s55, v7
    v_mul_f32 v8, s55, v8
    v_mul_f32 v9, s55, v9
    v_mul_f32 v10, s55, v10
    v_mul_f32 v11, s55, v11
    v_mul_f32 v12, s55, v12
    v_mul_f32 v13, s55, v13
    v_mul_f32 v14, s55, v14
    v_mul_f32 v15, s55, v15
    v_mul_f32 v16, s55, v16
    v_mul_f32 v17, s55, v17
    v_max3_f32 v18, |v2|, |v3|, 0
    v_max3_f32 v18, |v4|, |v5|, v18
    v_max3_f32 v18, |v6|, |v7|, v18
    v_max3_f32 v18, |v8|, |v9|, v18
    v_max3_f32 v18, |v10|, |v11|, v18
    v_max3_f32 v18, |v12|, |v13|, v18
    v_max3_f32 v18, |v14|, |v15|, v18
    v_max3_f32 v18, |v16|, |v17|, v18
    v_cmp_lt_f32 vcc, 0x42fc0000, v18
    s_nop 1
    s_cmp_lg_u64 vcc, 0
    s_cselect_b32 s73, 1, s53
    s_cmp_lg_u32 s73, 0
    s_cbranch_scc1 L_noexp1
    v_exp_f32 v2, v2
    v_exp_f32 v3, v3
    v_exp_f32 v4, v4
    v_exp_f32 v5, v5
    v_exp_f32 v6, v6
    v_exp_f32 v7, v7
    v_exp_f32 v8, v8
    v_exp_f32 v9, v9
    v_exp_f32 v10, v10
    v_exp_f32 v11, v11
    v_exp_f32 v12, v12
    v_exp_f32 v13, v13
    v_exp_f32 v14, v14
    v_exp_f32 v15, v15
    v_exp_f32 v16, v16
    v_exp_f32 v17, v17
L_noexp1:
    s_cmp_lg_u32 s73, 0
    s_cbranch_scc1 L_js8
    v_fma_f32 v80, v2, v96, 1.0
    v_fma_f32 v81, v3, v97, 1.0
    v_fma_f32 v82, v4, v98, 1.0
    v_fma_f32 v83, v5, v99, 1.0
    v_fma_f32 v84, v6, v100, 1.0
    v_fma_f32 v85, v7, v101, 1.0
    v_fma_f32 v86, v8, v102, 1.0
    v_fma_f32 v87, v9, v103, 1.0
    v_fma_f32 v88, v10, v104, 1.0
    v_fma_f32 v89, v11, v105, 1.0
    v_fma_f32 v90, v12, v106, 1.0
    v_fma_f32 v91, v13, v107, 1.0
    v_fma_f32 v92, v14, v108, 1.0
    v_fma_f32 v93, v15, v109, 1.0
    v_fma_f32 v94, v16, v110, 1.0
    v_fma_f32 v95, v17, v111, 1.0
L_jb8:
    ds_read_b128 v[96:99], v36 offset:9216
    ds_read_b128 v[100:103], v36 offset:9232
    ds_read_b128 v[104:107], v36 offset:9248
    ds_read_b128 v[108:111], v36 offset:9264
    v_rcp_f32 v80, v80
    v_rcp_f32 v81, v81
    v_rcp_f32 v82, v82
    v_rcp_f32 v83, v83
    v_rcp_f32 v84, v84
    v_rcp_f32 v85, v85
    v_rcp_f32 v86, v86
    v_rcp_f32 v87, v87
    v_fma_f32 v80, v80, -2.0, 1.0
    v_fma_f32 v81, v81, -2.0, 1.0
    v_fma_f32 v82, v82, -2.0, 1.0
    v_fma_f32 v83, v83, -2.0, 1.0
    v_fma_f32 v84, v84, -2.0, 1.0
    v_fma_f32 v85, v85, -2.0, 1.0
    v_fma_f32 v86, v86, -2.0, 1.0
    v_fma_f32 v87, v87, -2.0, 1.0
    v_cvt_pk_bf16_f32 v80, v80, v81
    v_cvt_pk_bf16_f32 v81, v82, v83
    v_cvt_pk_bf16_f32 v82, v84, v85
    v_cvt_pk_bf16_f32 v83, v86, v87
    ds_write_b128 v39, v[80:83] offset:0
    v_rcp_f32 v88, v88
    v_rcp_f32 v89, v89
    v_rcp_f32 v90, v90
    v_rcp_f32 v91, v91
    v_rcp_f32 v92, v92
    v_rcp_f32 v93, v93
    v_rcp_f32 v94, v94
    v_rcp_f32 v95, v95
    v_fma_f32 v88, v88, -2.0, 1.0
    v_fma_f32 v89, v89, -2.0, 1.0
    v_fma_f32 v90, v90, -2.0, 1.0
    v_fma_f32 v91, v91, -2.0, 1.0
    v_fma_f32 v92, v92, -2.0, 1.0
    v_fma_f32 v93, v93, -2.0, 1.0
    v_fma_f32 v94, v94, -2.0, 1.0
    v_fma_f32 v95, v95, -2.0, 1.0
    v_cvt_pk_bf16_f32 v88, v88, v89
    v_cvt_pk_bf16_f32 v89, v90, v91
    v_cvt_pk_bf16_f32 v90, v92, v93
    v_cvt_pk_bf16_f32 v91, v94, v95
    ds_write_b128 v39, v[88:91] offset:1024
    s_setprio 0
    s_waitcnt lgkmcnt(2)
    s_cmp_lg_u32 s73, 0
    s_cbranch_scc1 L_js9
    v_fma_f32 v80, v2, v96, 1.0
    v_fma_f32 v81, v3, v97, 1.0
    v_fma_f32 v82, v4, v98, 1.0
    v_fma_f32 v83, v5, v99, 1.0
    v_fma_f32 v84, v6, v100, 1.0
    v_fma_f32 v85, v7, v101, 1.0
    v_fma_f32 v86, v8, v102, 1.0
    v_fma_f32 v87, v9, v103, 1.0
    v_fma_f32 v88, v10, v104, 1.0
    v_fma_f32 v89, v11, v105, 1.0
    v_fma_f32 v90, v12, v106, 1.0
    v_fma_f32 v91, v13, v107, 1.0
    v_fma_f32 v92, v14, v108, 1.0
    v_fma_f32 v93, v15, v109, 1.0
    v_fma_f32 v94, v16, v110, 1.0
    v_fma_f32 v95, v17, v111, 1.0
L_jb9:
    ds_read_b128 v[96:99], v36 offset:10240
    ds_read_b128 v[100:103], v36 offset:10256
    ds_read_b128 v[104:107], v36 offset:10272
    ds_read_b128 v[108:111], v36 offset:10288
    v_rcp_f32 v80, v80
    v_rcp_f32 v81, v81
    v_rcp_f32 v82, v82
    v_rcp_f32 v83, v83
    v_rcp_f32 v84, v84
    v_rcp_f32 v85, v85
    s_waitcnt lgkmcnt(4)
    s_barrier
    v_rcp_f32 v86, v86
    v_rcp_f32 v87, v87
    v_fma_f32 v80, v80, -2.0, 1.0
    v_fma_f32 v81, v81, -2.0, 1.0
    v_fma_f32 v82, v82, -2.0, 1.0
    v_fma_f32 v83, v83, -2.0, 1.0
    v_fma_f32 v84, v84, -2.0, 1.0
    v_fma_f32 v85, v85, -2.0, 1.0
    v_fma_f32 v86, v86, -2.0, 1.0
    v_fma_f32 v87, v87, -2.0, 1.0
    v_cvt_pk_bf16_f32 v80, v80, v81
    v_cvt_pk_bf16_f32 v81, v82, v83
    v_cvt_pk_bf16_f32 v82, v84, v85
    v_cvt_pk_bf16_f32 v83, v86, v87
    ds_write_b128 v39, v[80:83] offset:8192
    v_rcp_f32 v88, v88
    v_rcp_f32 v89, v89
    v_rcp_f32 v90, v90
    v_rcp_f32 v91, v91
    v_rcp_f32 v92, v92
    v_rcp_f32 v93, v93
    v_rcp_f32 v94, v94
    v_rcp_f32 v95, v95
    v_fma_f32 v88, v88, -2.0, 1.0
    v_fma_f32 v89, v89, -2.0, 1.0
    v_fma_f32 v90, v90, -2.0, 1.0
    v_fma_f32 v91, v91, -2.0, 1.0
    v_fma_f32 v92, v92, -2.0, 1.0
    v_fma_f32 v93, v93, -2.0, 1.0
    v_fma_f32 v94, v94, -2.0, 1.0
    v_fma_f32 v95, v95, -2.0, 1.0
    v_cvt_pk_bf16_f32 v88, v88, v89
    v_cvt_pk_bf16_f32 v89, v90, v91
    v_cvt_pk_bf16_f32 v90, v92, v93
    v_cvt_pk_bf16_f32 v91, v94, v95
    ds_write_b128 v39, v[88:91] offset:9216
    s_waitcnt lgkmcnt(2)
    s_cmp_lg_u32 s73, 0
    s_cbranch_scc1 L_js10
    v_fma_f32 v80, v2, v96, 1.0
    v_fma_f32 v81, v3, v97, 1.0
    v_fma_f32 v82, v4, v98, 1.0
    v_fma_f32 v83, v5, v99, 1.0
    v_fma_f32 v84, v6, v100, 1.0
    v_fma_f32 v85, v7, v101, 1.0
    v_fma_f32 v86, v8, v102, 1.0
    v_fma_f32 v87, v9, v103, 1.0
    v_fma_f32 v88, v10, v104, 1.0
    v_fma_f32 v89, v11, v105, 1.0
    v_fma_f32 v90, v12, v106, 1.0
    v_fma_f32 v91, v13, v107, 1.0
    v_fma_f32 v92, v14, v108, 1.0
    v_fma_f32 v93, v15, v109, 1.0
    v_fma_f32 v94, v16, v110, 1.0
    v_fma_f32 v95, v17, v111, 1.0
L_jb10:
    ds_read_b128 v[96:99], v36 offset:11264
    ds_read_b128 v[100:103], v36 offset:11280
    ds_read_b128 v[104:107], v36 offset:11296
    ds_read_b128 v[108:111], v36 offset:11312
    v_rcp_f32 v80, v80
    v_rcp_f32 v81, v81
    v_rcp_f32 v82, v82
    v_rcp_f32 v83, v83
    v_rcp_f32 v84, v84
    v_rcp_f32 v85, v85
    s_waitcnt lgkmcnt(4)
    s_barrier
    v_rcp_f32 v86, v86
    v_rcp_f32 v87, v87
    v_fma_f32 v80, v80, -2.0, 1.0
    v_fma_f32 v81, v81, -2.0, 1.0
    v_fma_f32 v82, v82, -2.0, 1.0
    v_fma_f32 v83, v83, -2.0, 1.0
    v_fma_f32 v84, v84, -2.0, 1.0
    v_fma_f32 v85, v85, -2.0, 1.0
    v_fma_f32 v86, v86, -2.0, 1.0
    v_fma_f32 v87, v87, -2.0, 1.0
    v_cvt_pk_bf16_f32 v80, v80, v81
    v_cvt_pk_bf16_f32 v81, v82, v83
    v_cvt_pk_bf16_f32 v82, v84, v85
    v_cvt_pk_bf16_f32 v83, v86, v87
    ds_write_b128 v39, v[80:83] offset:16384
    v_rcp_f32 v88, v88
    v_rcp_f32 v89, v89
    v_rcp_f32 v90, v90
    v_rcp_f32 v91, v91
    v_rcp_f32 v92, v92
    v_rcp_f32 v93, v93
    v_rcp_f32 v94, v94
    v_rcp_f32 v95, v95
    v_fma_f32 v88, v88, -2.0, 1.0
    v_fma_f32 v89, v89, -2.0, 1.0
    v_fma_f32 v90, v90, -2.0, 1.0
    v_fma_f32 v91, v91, -2.0, 1.0
    v_fma_f32 v92, v92, -2.0, 1.0
    v_fma_f32 v93, v93, -2.0, 1.0
    v_fma_f32 v94, v94, -2.0, 1.0
    v_fma_f32 v95, v95, -2.0, 1.0
    v_cvt_pk_bf16_f32 v88, v88, v89
    v_cvt_pk_bf16_f32 v89, v90, v91
    v_cvt_pk_bf16_f32 v90, v92, v93
    v_cvt_pk_bf16_f32 v91, v94, v95
    ds_write_b128 v39, v[88:91] offset:17408
    s_waitcnt lgkmcnt(2)
    s_cmp_lg_u32 s73, 0
    s_cbranch_scc1 L_js11
    v_fma_f32 v80, v2, v96, 1.0
    v_fma_f32 v81, v3, v97, 1.0
    v_fma_f32 v82, v4, v98, 1.0
    v_fma_f32 v83, v5, v99, 1.0
    v_fma_f32 v84, v6, v100, 1.0
    v_fma_f32 v85, v7, v101, 1.0
    v_fma_f32 v86, v8, v102, 1.0
    v_fma_f32 v87, v9, v103, 1.0
    v_fma_f32 v88, v10, v104, 1.0
    v_fma_f32 v89, v11, v105, 1.0
    v_fma_f32 v90, v12, v106, 1.0
    v_fma_f32 v91, v13, v107, 1.0
    v_fma_f32 v92, v14, v108, 1.0
    v_fma_f32 v93, v15, v109, 1.0
    v_fma_f32 v94, v16, v110, 1.0
    v_fma_f32 v95, v17, v111, 1.0
L_jb11:
    ds_read_b128 v[96:99], v36 offset:12288
    ds_read_b128 v[100:103], v36 offset:12304
    ds_read_b128 v[104:107], v36 offset:12320
    ds_read_b128 v[108:111], v36 offset:12336
    v_rcp_f32 v80, v80
    v_rcp_f32 v81, v81
    v_rcp_f32 v82, v82
    v_rcp_f32 v83, v83
    v_rcp_f32 v84, v84
    v_rcp_f32 v85, v85
    s_waitcnt lgkmcnt(4)
    s_barrier
    v_rcp_f32 v86, v86
    v_rcp_f32 v87, v87
    v_fma_f32 v80, v80, -2.0, 1.0
    v_fma_f32 v81, v81, -2.0, 1.0
    v_fma_f32 v82, v82, -2.0, 1.0
    v_fma_f32 v83, v83, -2.0, 1.0
    v_fma_f32 v84, v84, -2.0, 1.0
    v_fma_f32 v85, v85, -2.0, 1.0
    v_fma_f32 v86, v86, -2.0, 1.0
    v_fma_f32 v87, v87, -2.0, 1.0
    v_cvt_pk_bf16_f32 v80, v80, v81
    v_cvt_pk_bf16_f32 v81, v82, v83
    v_cvt_pk_bf16_f32 v82, v84, v85
    v_cvt_pk_bf16_f32 v83, v86, v87
    ds_write_b128 v46, v[80:83] offset:0
    v_rcp_f32 v88, v88
    v_rcp_f32 v89, v89
    v_rcp_f32 v90, v90
    v_rcp_f32 v91, v91
    v_rcp_f32 v92, v92
    v_rcp_f32 v93, v93
    v_rcp_f32 v94, v94
    v_rcp_f32 v95, v95
    v_fma_f32 v88, v88, -2.0, 1.0
    v_fma_f32 v89, v89, -2.0, 1.0
    v_fma_f32 v90, v90, -2.0, 1.0
    v_fma_f32 v91, v91, -2.0, 1.0
    v_fma_f32 v92, v92, -2.0, 1.0
    v_fma_f32 v93, v93, -2.0, 1.0
    v_fma_f32 v94, v94, -2.0, 1.0
    v_fma_f32 v95, v95, -2.0, 1.0
    v_cvt_pk_bf16_f32 v88, v88, v89
    v_cvt_pk_bf16_f32 v89, v90, v91
    v_cvt_pk_bf16_f32 v90, v92, v93
    v_cvt_pk_bf16_f32 v91, v94, v95
    ds_write_b128 v46, v[88:91] offset:1024
    s_waitcnt lgkmcnt(2)
    s_cmp_lg_u32 s73, 0
    s_cbranch_scc1 L_js12
    v_fma_f32 v80, v2, v96, 1.0
    v_fma_f32 v81, v3, v97, 1.0
    v_fma_f32 v82, v4, v98, 1.0
    v_fma_f32 v83, v5, v99, 1.0
    v_fma_f32 v84, v6, v100, 1.0
    v_fma_f32 v85, v7, v101, 1.0
    v_fma_f32 v86, v8, v102, 1.0
    v_fma_f32 v87, v9, v103, 1.0
    v_fma_f32 v88, v10, v104, 1.0
    v_fma_f32 v89, v11, v105, 1.0
    v_fma_f32 v90, v12, v106, 1.0
    v_fma_f32 v91, v13, v107, 1.0
    v_fma_f32 v92, v14, v108, 1.0
    v_fma_f32 v93, v15, v109, 1.0
    v_fma_f32 v94, v16, v110, 1.0
    v_fma_f32 v95, v17, v111, 1.0
L_jb12:
    ds_read_b128 v[96:99], v36 offset:13312
    ds_read_b128 v[100:103], v36 offset:13328
    ds_read_b128 v[104:107], v36 offset:13344
    ds_read_b128 v[108:111], v36 offset:13360
    v_rcp_f32 v80, v80
    v_rcp_f32 v81, v81
    v_rcp_f32 v82, v82
    v_rcp_f32 v83, v83
    v_rcp_f32 v84, v84
    v_rcp_f32 v85, v85
    s_waitcnt lgkmcnt(4)
    s_barrier
    v_rcp_f32 v86, v86
    v_rcp_f32 v87, v87
    v_fma_f32 v80, v80, -2.0, 1.0
    v_fma_f32 v81, v81, -2.0, 1.0
    v_fma_f32 v82, v82, -2.0, 1.0
    v_fma_f32 v83, v83, -2.0, 1.0
    v_fma_f32 v84, v84, -2.0, 1.0
    v_fma_f32 v85, v85, -2.0, 1.0
    v_fma_f32 v86, v86, -2.0, 1.0
    v_fma_f32 v87, v87, -2.0, 1.0
    v_cvt_pk_bf16_f32 v80, v80, v81
    v_cvt_pk_bf16_f32 v81, v82, v83
    v_cvt_pk_bf16_f32 v82, v84, v85
    v_cvt_pk_bf16_f32 v83, v86, v87
    ds_write_b128 v46, v[80:83] offset:48128
    v_rcp_f32 v88, v88
    v_rcp_f32 v89, v89
    v_rcp_f32 v90, v90
    v_rcp_f32 v91, v91
    v_rcp_f32 v92, v92
    v_rcp_f32 v93, v93
    v_rcp_f32 v94, v94
    v_rcp_f32 v95, v95
    v_fma_f32 v88, v88, -2.0, 1.0
    v_fma_f32 v89, v89, -2.0, 1.0
    v_fma_f32 v90, v90, -2.0, 1.0
    v_fma_f32 v91, v91, -2.0, 1.0
    v_fma_f32 v92, v92, -2.0, 1.0
    v_fma_f32 v93, v93, -2.0, 1.0
    v_fma_f32 v94, v94, -2.0, 1.0
    v_fma_f32 v95, v95, -2.0, 1.0
    v_cvt_pk_bf16_f32 v88, v88, v89
    v_cvt_pk_bf16_f32 v89, v90, v91
    v_cvt_pk_bf16_f32 v90, v92, v93
    v_cvt_pk_bf16_f32 v91, v94, v95
    ds_write_b128 v46, v[88:91] offset:49152
    s_waitcnt lgkmcnt(2)
    s_cmp_lg_u32 s73, 0
    s_cbranch_scc1 L_js13
    v_fma_f32 v80, v2, v96, 1.0
    v_fma_f32 v81, v3, v97, 1.0
    v_fma_f32 v82, v4, v98, 1.0
    v_fma_f32 v83, v5, v99, 1.0
    v_fma_f32 v84, v6, v100, 1.0
    v_fma_f32 v85, v7, v101, 1.0
    v_fma_f32 v86, v8, v102, 1.0
    v_fma_f32 v87, v9, v103, 1.0
    v_fma_f32 v88, v10, v104, 1.0
    v_fma_f32 v89, v11, v105, 1.0
    v_fma_f32 v90, v12, v106, 1.0
    v_fma_f32 v91, v13, v107, 1.0
    v_fma_f32 v92, v14, v108, 1.0
    v_fma_f32 v93, v15, v109, 1.0
    v_fma_f32 v94, v16, v110, 1.0
    v_fma_f32 v95, v17, v111, 1.0
L_jb13:
    ds_read_b128 v[96:99], v36 offset:14336
    ds_read_b128 v[100:103], v36 offset:14352
    ds_read_b128 v[104:107], v36 offset:14368
    ds_read_b128 v[108:111], v36 offset:14384
    v_rcp_f32 v80, v80
    v_rcp_f32 v81, v81
    v_rcp_f32 v82, v82
    v_rcp_f32 v83, v83
    v_rcp_f32 v84, v84
    v_rcp_f32 v85, v85
    s_waitcnt lgkmcnt(4)
    s_barrier
    v_rcp_f32 v86, v86
    v_rcp_f32 v87, v87
    v_fma_f32 v80, v80, -2.0, 1.0
    v_fma_f32 v81, v81, -2.0, 1.0
    v_fma_f32 v82, v82, -2.0, 1.0
    v_fma_f32 v83, v83, -2.0, 1.0
    v_fma_f32 v84, v84, -2.0, 1.0
    v_fma_f32 v85, v85, -2.0, 1.0
    v_fma_f32 v86, v86, -2.0, 1.0
    v_fma_f32 v87, v87, -2.0, 1.0
    v_cvt_pk_bf16_f32 v80, v80, v81
    v_cvt_pk_bf16_f32 v81, v82, v83
    v_cvt_pk_bf16_f32 v82, v84, v85
    v_cvt_pk_bf16_f32 v83, v86, v87
    ds_write_b128 v46, v[80:83] offset:56320
    v_rcp_f32 v88, v88
    v_rcp_f32 v89, v89
    v_rcp_f32 v90, v90
    v_rcp_f32 v91, v91
    v_rcp_f32 v92, v92
    v_rcp_f32 v93, v93
    v_rcp_f32 v94, v94
    v_rcp_f32 v95, v95
    v_fma_f32 v88, v88, -2.0, 1.0
    v_fma_f32 v89, v89, -2.0, 1.0
    v_fma_f32 v90, v90, -2.0, 1.0
    v_fma_f32 v91, v91, -2.0, 1.0
    v_fma_f32 v92, v92, -2.0, 1.0
    v_fma_f32 v93, v93, -2.0, 1.0
    v_fma_f32 v94, v94, -2.0, 1.0
    v_fma_f32 v95, v95, -2.0, 1.0
    v_cvt_pk_bf16_f32 v88, v88, v89
    v_cvt_pk_bf16_f32 v89, v90, v91
    v_cvt_pk_bf16_f32 v90, v92, v93
    v_cvt_pk_bf16_f32 v91, v94, v95
    ds_write_b128 v46, v[88:91] offset:57344
    s_waitcnt lgkmcnt(2)
    s_cmp_lg_u32 s73, 0
    s_cbranch_scc1 L_js14
    v_fma_f32 v80, v2, v96, 1.0
    v_fma_f32 v81, v3, v97, 1.0
    v_fma_f32 v82, v4, v98, 1.0
    v_fma_f32 v83, v5, v99, 1.0
    v_fma_f32 v84, v6, v100, 1.0
    v_fma_f32 v85, v7, v101, 1.0
    v_fma_f32 v86, v8, v102, 1.0
    v_fma_f32 v87, v9, v103, 1.0
    v_fma_f32 v88, v10, v104, 1.0
    v_fma_f32 v89, v11, v105, 1.0
    v_fma_f32 v90, v12, v106, 1.0
    v_fma_f32 v91, v13, v107, 1.0
    v_fma_f32 v92, v14, v108, 1.0
    v_fma_f32 v93, v15, v109, 1.0
    v_fma_f32 v94, v16, v110, 1.0
    v_fma_f32 v95, v17, v111, 1.0
L_jb14:
    ds_read_b128 v[96:99], v36 offset:15360
    ds_read_b128 v[100:103], v36 offset:15376
    ds_read_b128 v[104:107], v36 offset:15392
    ds_read_b128 v[108:111], v36 offset:15408
    v_rcp_f32 v80, v80
    v_rcp_f32 v81, v81
    v_rcp_f32 v82, v82
    v_rcp_f32 v83, v83
    v_rcp_f32 v84, v84
    v_rcp_f32 v85, v85
    s_waitcnt lgkmcnt(4)
    s_barrier
    v_rcp_f32 v86, v86
    v_rcp_f32 v87, v87
    v_fma_f32 v80, v80, -2.0, 1.0
    v_fma_f32 v81, v81, -2.0, 1.0
    v_fma_f32 v82, v82, -2.0, 1.0
    v_fma_f32 v83, v83, -2.0, 1.0
    v_fma_f32 v84, v84, -2.0, 1.0
    v_fma_f32 v85, v85, -2.0, 1.0
    v_fma_f32 v86, v86, -2.0, 1.0
    v_fma_f32 v87, v87, -2.0, 1.0
    v_cvt_pk_bf16_f32 v80, v80, v81
    v_cvt_pk_bf16_f32 v81, v82, v83
    v_cvt_pk_bf16_f32 v82, v84, v85
    v_cvt_pk_bf16_f32 v83, v86, v87
    ds_write_b128 v46, v[80:83] offset:30720
    v_rcp_f32 v88, v88
    v_rcp_f32 v89, v89
    v_rcp_f32 v90, v90
    v_rcp_f32 v91, v91
    v_rcp_f32 v92, v92
    v_rcp_f32 v93, v93
    v_rcp_f32 v94, v94
    v_rcp_f32 v95, v95
    v_fma_f32 v88, v88, -2.0, 1.0
    v_fma_f32 v89, v89, -2.0, 1.0
L_pg16:
    s_cbranch_execz L_pb16
    v_fma_f32 v90, v90, -2.0, 1.0
    v_fma_f32 v91, v91, -2.0, 1.0
    v_fma_f32 v92, v92, -2.0, 1.0
    v_fma_f32 v93, v93, -2.0, 1.0
    v_fma_f32 v94, v94, -2.0, 1.0
    v_fma_f32 v95, v95, -2.0, 1.0
    v_cvt_pk_bf16_f32 v88, v88, v89
    v_cvt_pk_bf16_f32 v89, v90, v91
    v_cvt_pk_bf16_f32 v90, v92, v93
    v_cvt_pk_bf16_f32 v91, v94, v95
    ds_write_b128 v46, v[88:91] offset:31744
    s_waitcnt lgkmcnt(2)
    s_cmp_lg_u32 s73, 0
    s_cbranch_scc1 L_js15
    v_fma_f32 v80, v2, v96, 1.0
    v_fma_f32 v81, v3, v97, 1.0
    v_fma_f32 v82, v4, v98, 1.0
    v_fma_f32 v83, v5, v99, 1.0
    v_fma_f32 v84, v6, v100, 1.0
    v_fma_f32 v85, v7, v101, 1.0
    v_fma_f32 v86, v8, v102, 1.0
    v_fma_f32 v87, v9, v103, 1.0
    v_fma_f32 v88, v10, v104, 1.0
    v_fma_f32 v89, v11, v105, 1.0
    v_fma_f32 v90, v12, v106, 1.0
    v_fma_f32 v91, v13, v107, 1.0
    v_fma_f32 v92, v14, v108, 1.0
    v_fma_f32 v93, v15, v109, 1.0
    v_fma_f32 v94, v16, v110, 1.0
    v_fma_f32 v95, v17, v111, 1.0
L_jb15:
    v_rcp_f32 v80, v80
    v_rcp_f32 v81, v81
    v_rcp_f32 v82, v82
    v_rcp_f32 v83, v83
    v_rcp_f32 v84, v84
    v_rcp_f32 v85, v85
    s_waitcnt lgkmcnt(0)
    s_barrier
    v_rcp_f32 v86, v86
    v_rcp_f32 v87, v87
    v_fma_f32 v80, v80, -2.0, 1.0
    v_fma_f32 v81, v81, -2.0, 1.0
    v_fma_f32 v82, v82, -2.0, 1.0
    v_fma_f32 v83, v83, -2.0, 1.0
    v_fma_f32 v84, v84, -2.0, 1.0
    v_fma_f32 v85, v85, -2.0, 1.0
    v_fma_f32 v86, v86, -2.0, 1.0
    v_fma_f32 v87, v87, -2.0, 1.0
    v_cvt_pk_bf16_f32 v80, v80, v81
    v_cvt_pk_bf16_f32 v81, v82, v83
    v_cvt_pk_bf16_f32 v82, v84, v85
    v_cvt_pk_bf16_f32 v83, v86, v87
    ds_write_b128 v46, v[80:83] offset:38912
    v_rcp_f32 v88, v88
    v_rcp_f32 v89, v89
    v_rcp_f32 v90, v90
    v_rcp_f32 v91, v91
    v_rcp_f32 v92, v92
    v_rcp_f32 v93, v93
    v_rcp_f32 v94, v94
    v_rcp_f32 v95, v95
    v_fma_f32 v88, v88, -2.0, 1.0
    v_fma_f32 v89, v89, -2.0, 1.0
    v_fma_f32 v90, v90, -2.0, 1.0
    v_fma_f32 v91, v91, -2.0, 1.0
    v_fma_f32 v92, v92, -2.0, 1.0
    v_fma_f32 v93, v93, -2.0, 1.0
    v_fma_f32 v94, v94, -2.0, 1.0
    v_fma_f32 v95, v95, -2.0, 1.0
    v_cvt_pk_bf16_f32 v88, v88, v89
    v_cvt_pk_bf16_f32 v89, v90, v91
    v_cvt_pk_bf16_f32 v90, v92, v93
    v_cvt_pk_bf16_f32 v91, v94, v95
    ds_write_b128 v46, v[88:91] offset:39936
    s_waitcnt lgkmcnt(0)
    s_barrier
    s_endpgm
L_prep_w2:
    s_lshr_b32 s69, s68, 5
    s_lshr_b32 s70, s68, 2
    s_and_b32 s70, s70, 7
    s_and_b32 s55, s68, 3
    s_lshl_b32 s72, s55, 5
    s_add_u32 s72, s72, s70
    s_lshl_b32 s72, s72, 4
    s_and_b32 s73, s69, 1
    s_lshl_b32 s73, s73, 3
    s_add_u32 s72, s72, s73
    s_lshr_b32 s73, s69, 1
    s_add_u32 s72, s72, s73
    s_lshl_b32 s72, s72, 10
    s_add_u32 s64, s72, 12582912
    s_mov_b32 s48, 131072
    s_lshl_b32 s72, s69, 17
    s_lshl_b32 s73, s70, 14
    s_add_u32 s72, s72, s73
    s_lshl_b32 s73, s55, 7
    s_add_u32 s70, s72, s73
    v_lshl_add_u32 v233, v231, 12, v232
    s_mov_b32 s71, 512
    s_mov_b32 s72, 2048
    s_branch L_prep_done
L_prep_fo:
    s_cmp_lt_u32 s68, 512
    s_cselect_b32 s44, s12, s16
    s_cselect_b32 s45, s13, s17
    s_mov_b32 s46, 131072
    s_sub_u32 s69, s68, 480
    s_and_b32 s70, s69, 7
    s_lshr_b32 s55, s69, 3
    s_lshl_b32 s72, s55, 5
    s_add_u32 s72, s72, s70
    s_lshl_b32 s72, s72, 10
    s_add_u32 s64, s72, 14680064
    s_mov_b32 s48, 8192
    s_lshr_b32 s72, s70, 1
    s_lshl_b32 s72, s72, 15
    s_and_b32 s73, s70, 1
    s_lshl_b32 s73, s73, 10
    s_add_u32 s72, s72, s73
    s_and_b32 s73, s55, 3
    s_lshl_b32 s73, s73, 7
    s_add_u32 s70, s72, s73
    v_lshl_add_u32 v233, v231, 13, v232
    s_mov_b32 s71, 2048
    s_mov_b32 s72, 512
    s_branch L_prep_done
L_h_ge:
    s_mov_b32 s44, s10
    s_mov_b32 s45, s11
    s_mov_b32 s46, 8192
    s_mov_b32 s47, 0x20000
    v_lshlrev_b32 v37, 9, v230
    v_lshl_add_u32 v37, v231, 4, v37
    buffer_load_dwordx4 v[48:51], v37, s[44:47], 0 offen offset:0
    buffer_load_dwordx4 v[52:55], v37, s[44:47], 0 offen offset:64
    buffer_load_dwordx4 v[56:59], v37, s[44:47], 0 offen offset:128
    buffer_load_dwordx4 v[60:63], v37, s[44:47], 0 offen offset:192
    buffer_load_dwordx4 v[64:67], v37, s[44:47], 0 offen offset:256
    buffer_load_dwordx4 v[68:71], v37, s[44:47], 0 offen offset:320
    buffer_load_dwordx4 v[72:75], v37, s[44:47], 0 offen offset:384
    buffer_load_dwordx4 v[76:79], v37, s[44:47], 0 offen offset:448
    v_lshlrev_b32 v37, 3, v230
    v_lshl_add_u32 v37, v231, 12, v37
    s_mov_b32 s44, s14
    s_mov_b32 s45, s15
    s_mov_b32 s46, 131072
    s_mov_b32 s47, 0x20000
    s_lshl_b32 s69, s25, 7
    s_add_u32 s68, s69, 0
    buffer_load_dwordx2 v[128:129], v37, s[44:47], s68 offen offset:0
    buffer_load_dwordx2 v[130:131], v37, s[44:47], s68 offen offset:512
    buffer_load_dwordx2 v[132:133], v37, s[44:47], s68 offen offset:1024
    buffer_load_dwordx2 v[134:135], v37, s[44:47], s68 offen offset:1536
    buffer_load_dwordx2 v[136:137], v37, s[44:47], s68 offen offset:2048
    buffer_load_dwordx2 v[138:139], v37, s[44:47], s68 offen offset:2560
    buffer_load_dwordx2 v[140:141], v37, s[44:47], s68 offen offset:3072
    buffer_load_dwordx2 v[142:143], v37, s[44:47], s68 offen offset:3584
    s_add_u32 s68, s69, 16384
    buffer_load_dwordx2 v[144:145], v37, s[44:47], s68 offen offset:0
    buffer_load_dwordx2 v[146:147], v37, s[44:47], s68 offen offset:512
    buffer_load_dwordx2 v[148:149], v37, s[44:47], s68 offen offset:1024
    buffer_load_dwordx2 v[150:151], v37, s[44:47], s68 offen offset:1536
    buffer_load_dwordx2 v[152:153], v37, s[44:47], s68 offen offset:2048
    buffer_load_dwordx2 v[154:155], v37, s[44:47], s68 offen offset:2560
    buffer_load_dwordx2 v[156:157], v37, s[44:47], s68 offen offset:3072
    buffer_load_dwordx2 v[158:159], v37, s[44:47], s68 offen offset:3584
    s_add_u32 s68, s69, 32768
    buffer_load_dwordx2 v[160:161], v37, s[44:47], s68 offen offset:0
    buffer_load_dwordx2 v[162:163], v37, s[44:47], s68 offen offset:512
    buffer_load_dwordx2 v[164:165], v37, s[44:47], s68 offen offset:1024
    buffer_load_dwordx2 v[166:167], v37, s[44:47], s68 offen offset:1536
    buffer_load_dwordx2 v[168:169], v37, s[44:47], s68 offen offset:2048
    buffer_load_dwordx2 v[170:171], v37, s[44:47], s68 offen offset:2560
    buffer_load_dwordx2 v[172:173], v37, s[44:47], s68 offen offset:3072
    buffer_load_dwordx2 v[174:175], v37, s[44:47], s68 offen offset:3584
    s_add_u32 s68, s69, 49152
    buffer_load_dwordx2 v[176:177], v37, s[44:47], s68 offen offset:0
    buffer_load_dwordx2 v[178:179], v37, s[44:47], s68 offen offset:512
    buffer_load_dwordx2 v[180:181], v37, s[44:47], s68 offen offset:1024
    buffer_load_dwordx2 v[182:183], v37, s[44:47], s68 offen offset:1536
    buffer_load_dwordx2 v[184:185], v37, s[44:47], s68 offen offset:2048
    buffer_load_dwordx2 v[186:187], v37, s[44:47], s68 offen offset:2560
    buffer_load_dwordx2 v[188:189], v37, s[44:47], s68 offen offset:3072
    buffer_load_dwordx2 v[190:191], v37, s[44:47], s68 offen offset:3584
    s_add_u32 s68, s69, 65536
    buffer_load_dwordx2 v[192:193], v37, s[44:47], s68 offen offset:0
    buffer_load_dwordx2 v[194:195], v37, s[44:47], s68 offen offset:512
    buffer_load_dwordx2 v[196:197], v37, s[44:47], s68 offen offset:1024
    buffer_load_dwordx2 v[198:199], v37, s[44:47], s68 offen offset:1536
    buffer_load_dwordx2 v[200:201], v37, s[44:47], s68 offen offset:2048
    buffer_load_dwordx2 v[202:203], v37, s[44:47], s68 offen offset:2560
    buffer_load_dwordx2 v[204:205], v37, s[44:47], s68 offen offset:3072
    buffer_load_dwordx2 v[206:207], v37, s[44:47], s68 offen offset:3584
    s_add_u32 s68, s69, 81920
    buffer_load_dwordx2 v[208:209], v37, s[44:47], s68 offen offset:0
    buffer_load_dwordx2 v[210:211], v37, s[44:47], s68 offen offset:512
    buffer_load_dwordx2 v[212:213], v37, s[44:47], s68 offen offset:1024
    buffer_load_dwordx2 v[214:215], v37, s[44:47], s68 offen offset:1536
    buffer_load_dwordx2 v[216:217], v37, s[44:47], s68 offen offset:2048
    buffer_load_dwordx2 v[218:219], v37, s[44:47], s68 offen offset:2560
    buffer_load_dwordx2 v[220:221], v37, s[44:47], s68 offen offset:3072
    buffer_load_dwordx2 v[222:223], v37, s[44:47], s68 offen offset:3584
    s_add_u32 s68, s69, 98304
    buffer_load_dwordx2 v[224:225], v37, s[44:47], s68 offen offset:0
    buffer_load_dwordx2 v[226:227], v37, s[44:47], s68 offen offset:512
    buffer_load_dwordx2 v[228:229], v37, s[44:47], s68 offen offset:1024
    buffer_load_dwordx2 v[230:231], v37, s[44:47], s68 offen offset:1536
    buffer_load_dwordx2 v[232:233], v37, s[44:47], s68 offen offset:2048
    buffer_load_dwordx2 v[234:235], v37, s[44:47], s68 offen offset:2560
    buffer_load_dwordx2 v[236:237], v37, s[44:47], s68 offen offset:3072
    buffer_load_dwordx2 v[238:239], v37, s[44:47], s68 offen offset:3584
    s_add_u32 s68, s69, 114688
    buffer_load_dwordx2 v[240:241], v37, s[44:47], s68 offen offset:0
    buffer_load_dwordx2 v[242:243], v37, s[44:47], s68 offen offset:512
    buffer_load_dwordx2 v[244:245], v37, s[44:47], s68 offen offset:1024
    buffer_load_dwordx2 v[246:247], v37, s[44:47], s68 offen offset:1536
    buffer_load_dwordx2 v[248:249], v37, s[44:47], s68 offen offset:2048
    buffer_load_dwordx2 v[250:251], v37, s[44:47], s68 offen offset:2560
    buffer_load_dwordx2 v[252:253], v37, s[44:47], s68 offen offset:3072
    buffer_load_dwordx2 v[254:255], v37, s[44:47], s68 offen offset:3584
    s_mov_b64 exec, 3
    buffer_store_dword v40, v32, s[40:43], 0 offen sc1
    s_mov_b64 exec, -1
    s_lshl_b32 s68, s29, 8
    s_lshl_b32 s69, s28, 3
    s_add_u32 s68, s68, s69
    s_add_u32 s68, s68, s25
    s_lshl_b32 s68, s68, 10
    s_add_u32 s68, s68, 8388608
    buffer_store_dwordx4 v[12:15], v31, s[40:43], s68 offen sc1
    s_lshl_b32 s68, s29, 8
    s_lshl_b32 s69, s28, 3
    s_add_u32 s68, s68, s69
    s_add_u32 s68, s68, s25
    s_lshl_b32 s68, s68, 10
    s_add_u32 s68, s68, 8392704
    buffer_store_dwordx4 v[12:15], v31, s[40:43], s68 offen sc1
    s_lshl_b32 s68, s29, 8
    s_lshl_b32 s69, s28, 3
    s_add_u32 s68, s68, s69
    s_add_u32 s68, s68, s25
    s_lshl_b32 s68, s68, 10
    s_add_u32 s68, s68, 10485760
    buffer_store_dwordx4 v[12:15], v31, s[40:43], s68 offen sc1
    s_lshl_b32 s68, s29, 8
    s_lshl_b32 s69, s28, 3
    s_add_u32 s68, s68, s69
    s_add_u32 s68, s68, s25
    s_lshl_b32 s68, s68, 10
    s_add_u32 s68, s68, 10489856
    buffer_store_dwordx4 v[12:15], v31, s[40:43], s68 offen sc1
    s_waitcnt vmcnt(0)
    s_barrier
    buffer_atomic_add v38, v47, s[92:95], 0 offen sc1
    v_perm_b32 v80, v130, v128, s50
    v_perm_b32 v81, v134, v132, s50
    v_perm_b32 v82, v138, v136, s50
    v_perm_b32 v83, v142, v140, s50
    v_perm_b32 v84, v130, v128, s51
    v_perm_b32 v85, v134, v132, s51
    v_perm_b32 v86, v138, v136, s51
    v_perm_b32 v87, v142, v140, s51
    v_perm_b32 v88, v131, v129, s50
    v_perm_b32 v89, v135, v133, s50
    v_perm_b32 v90, v139, v137, s50
    v_perm_b32 v91, v143, v141, s50
    v_perm_b32 v92, v131, v129, s51
    v_perm_b32 v93, v135, v133, s51
    v_perm_b32 v94, v139, v137, s51
    v_perm_b32 v95, v143, v141, s51
    s_nop 1
    v_mfma_f32_16x16x32_bf16 v[96:99], v[80:83], v[48:51], 0
    v_mfma_f32_16x16x32_bf16 v[100:103], v[84:87], v[48:51], 0
    v_mfma_f32_16x16x32_bf16 v[104:107], v[88:91], v[48:51], 0
    v_mfma_f32_16x16x32_bf16 v[108:111], v[92:95], v[48:51], 0
    v_perm_b32 v80, v146, v144, s50
    v_perm_b32 v81, v150, v148, s50
    v_perm_b32 v82, v154, v152, s50
    v_perm_b32 v83, v158, v156, s50
    v_perm_b32 v84, v146, v144, s51
    v_perm_b32 v85, v150, v148, s51
    v_perm_b32 v86, v154, v152, s51
    v_perm_b32 v87, v158, v156, s51
    v_perm_b32 v88, v147, v145, s50
    v_perm_b32 v89, v151, v149, s50
    v_perm_b32 v90, v155, v153, s50
    v_perm_b32 v91, v159, v157, s50
    v_perm_b32 v92, v147, v145, s51
    v_perm_b32 v93, v151, v149, s51
    v_perm_b32 v94, v155, v153, s51
    v_perm_b32 v95, v159, v157, s51
    s_nop 1
    v_mfma_f32_16x16x32_bf16 v[96:99], v[80:83], v[52:55], v[96:99]
    v_mfma_f32_16x16x32_bf16 v[100:103], v[84:87], v[52:55], v[100:103]
    v_mfma_f32_16x16x32_bf16 v[104:107], v[88:91], v[52:55], v[104:107]
    v_mfma_f32_16x16x32_bf16 v[108:111], v[92:95], v[52:55], v[108:111]
    v_perm_b32 v80, v162, v160, s50
    v_perm_b32 v81, v166, v164, s50
    v_perm_b32 v82, v170, v168, s50
    v_perm_b32 v83, v174, v172, s50
    v_perm_b32 v84, v162, v160, s51
    v_perm_b32 v85, v166, v164, s51
    v_perm_b32 v86, v170, v168, s51
    v_perm_b32 v87, v174, v172, s51
    v_perm_b32 v88, v163, v161, s50
    v_perm_b32 v89, v167, v165, s50
    v_perm_b32 v90, v171, v169, s50
    v_perm_b32 v91, v175, v173, s50
    v_perm_b32 v92, v163, v161, s51
    v_perm_b32 v93, v167, v165, s51
    v_perm_b32 v94, v171, v169, s51
    v_perm_b32 v95, v175, v173, s51
    s_nop 1
    v_mfma_f32_16x16x32_bf16 v[96:99], v[80:83], v[56:59], v[96:99]
    v_mfma_f32_16x16x32_bf16 v[100:103], v[84:87], v[56:59], v[100:103]
    v_mfma_f32_16x16x32_bf16 v[104:107], v[88:91], v[56:59], v[104:107]
    v_mfma_f32_16x16x32_bf16 v[108:111], v[92:95], v[56:59], v[108:111]
    v_perm_b32 v80, v178, v176, s50
    v_perm_b32 v81, v182, v180, s50
    v_perm_b32 v82, v186, v184, s50
    v_perm_b32 v83, v190, v188, s50
    v_perm_b32 v84, v178, v176, s51
    v_perm_b32 v85, v182, v180, s51
    v_perm_b32 v86, v186, v184, s51
    v_perm_b32 v87, v190, v188, s51
    v_perm_b32 v88, v179, v177, s50
    v_perm_b32 v89, v183, v181, s50
    v_perm_b32 v90, v187, v185, s50
    v_perm_b32 v91, v191, v189, s50
    v_perm_b32 v92, v179, v177, s51
    v_perm_b32 v93, v183, v181, s51
    v_perm_b32 v94, v187, v185, s51
    v_perm_b32 v95, v191, v189, s51
    s_nop 1
    v_mfma_f32_16x16x32_bf16 v[96:99], v[80:83], v[60:63], v[96:99]
    v_mfma_f32_16x16x32_bf16 v[100:103], v[84:87], v[60:63], v[100:103]
    v_mfma_f32_16x16x32_bf16 v[104:107], v[88:91], v[60:63], v[104:107]
    v_mfma_f32_16x16x32_bf16 v[108:111], v[92:95], v[60:63], v[108:111]
    v_perm_b32 v80, v194, v192, s50
    v_perm_b32 v81, v198, v196, s50
    v_perm_b32 v82, v202, v200, s50
    v_perm_b32 v83, v206, v204, s50
    v_perm_b32 v84, v194, v192, s51
    v_perm_b32 v85, v198, v196, s51
    v_perm_b32 v86, v202, v200, s51
    v_perm_b32 v87, v206, v204, s51
    v_perm_b32 v88, v195, v193, s50
    v_perm_b32 v89, v199, v197, s50
    v_perm_b32 v90, v203, v201, s50
    v_perm_b32 v91, v207, v205, s50
    v_perm_b32 v92, v195, v193, s51
    v_perm_b32 v93, v199, v197, s51
    v_perm_b32 v94, v203, v201, s51
    v_perm_b32 v95, v207, v205, s51
    s_nop 1
    v_mfma_f32_16x16x32_bf16 v[96:99], v[80:83], v[64:67], v[96:99]
    v_mfma_f32_16x16x32_bf16 v[100:103], v[84:87], v[64:67], v[100:103]
    v_mfma_f32_16x16x32_bf16 v[104:107], v[88:91], v[64:67], v[104:107]
    v_mfma_f32_16x16x32_bf16 v[108:111], v[92:95], v[64:67], v[108:111]
    v_perm_b32 v80, v210, v208, s50
    v_perm_b32 v81, v214, v212, s50
    v_perm_b32 v82, v218, v216, s50
    v_perm_b32 v83, v222, v220, s50
    v_perm_b32 v84, v210, v208, s51
    v_perm_b32 v85, v214, v212, s51
    v_perm_b32 v86, v218, v216, s51
    v_perm_b32 v87, v222, v220, s51
    v_perm_b32 v88, v211, v209, s50
    v_perm_b32 v89, v215, v213, s50
    v_perm_b32 v90, v219, v217, s50
    v_perm_b32 v91, v223, v221, s50
    v_perm_b32 v92, v211, v209, s51
    v_perm_b32 v93, v215, v213, s51
    v_perm_b32 v94, v219, v217, s51
    v_perm_b32 v95, v223, v221, s51
    s_nop 1
    v_mfma_f32_16x16x32_bf16 v[96:99], v[80:83], v[68:71], v[96:99]
    v_mfma_f32_16x16x32_bf16 v[100:103], v[84:87], v[68:71], v[100:103]
    v_mfma_f32_16x16x32_bf16 v[104:107], v[88:91], v[68:71], v[104:107]
    v_mfma_f32_16x16x32_bf16 v[108:111], v[92:95], v[68:71], v[108:111]
    v_perm_b32 v80, v226, v224, s50
    v_perm_b32 v81, v230, v228, s50
    v_perm_b32 v82, v234, v232, s50
    v_perm_b32 v83, v238, v236, s50
    v_perm_b32 v84, v226, v224, s51
    v_perm_b32 v85, v230, v228, s51
    v_perm_b32 v86, v234, v232, s51
    v_perm_b32 v87, v238, v236, s51
    v_perm_b32 v88, v227, v225, s50
    v_perm_b32 v89, v231, v229, s50
    v_perm_b32 v90, v235, v233, s50
    v_perm_b32 v91, v239, v237, s50
    v_perm_b32 v92, v227, v225, s51
    v_perm_b32 v93, v231, v229, s51
    v_perm_b32 v94, v235, v233, s51
    v_perm_b32 v95, v239, v237, s51
    s_nop 1
    v_mfma_f32_16x16x32_bf16 v[96:99], v[80:83], v[72:75], v[96:99]
    v_mfma_f32_16x16x32_bf16 v[100:103], v[84:87], v[72:75], v[100:103]
    v_mfma_f32_16x16x32_bf16 v[104:107], v[88:91], v[72:75], v[104:107]
    v_mfma_f32_16x16x32_bf16 v[108:111], v[92:95], v[72:75], v[108:111]
    v_perm_b32 v80, v242, v240, s50
    v_perm_b32 v81, v246, v244, s50
    v_perm_b32 v82, v250, v248, s50
    v_perm_b32 v83, v254, v252, s50
    v_perm_b32 v84, v242, v240, s51
    v_perm_b32 v85, v246, v244, s51
    v_perm_b32 v86, v250, v248, s51
    v_perm_b32 v87, v254, v252, s51
    v_perm_b32 v88, v243, v241, s50
    v_perm_b32 v89, v247, v245, s50
    v_perm_b32 v90, v251, v249, s50
    v_perm_b32 v91, v255, v253, s50
    v_perm_b32 v92, v243, v241, s51
    v_perm_b32 v93, v247, v245, s51
    v_perm_b32 v94, v251, v249, s51
    v_perm_b32 v95, v255, v253, s51
    s_nop 1
    v_mfma_f32_16x16x32_bf16 v[96:99], v[80:83], v[76:79], v[96:99]
    v_mfma_f32_16x16x32_bf16 v[100:103], v[84:87], v[76:79], v[100:103]
    v_mfma_f32_16x16x32_bf16 v[104:107], v[88:91], v[76:79], v[104:107]
    v_mfma_f32_16x16x32_bf16 v[108:111], v[92:95], v[76:79], v[108:111]
    s_nop 7
    s_mov_b32 s68, 0x4038aa3b
    v_mul_f32 v96, s68, v96
    v_mul_f32 v97, s68, v97
    v_mul_f32 v98, s68, v98
    v_mul_f32 v99, s68, v99
    v_mul_f32 v100, s68, v100
    v_mul_f32 v101, s68, v101
    v_mul_f32 v102, s68, v102
    v_mul_f32 v103, s68, v103
    v_mul_f32 v104, s68, v104
    v_mul_f32 v105, s68, v105
    v_mul_f32 v106, s68, v106
    v_mul_f32 v107, s68, v107
    v_mul_f32 v108, s68, v108
    v_mul_f32 v109, s68, v109
    v_mul_f32 v110, s68, v110
    v_mul_f32 v111, s68, v111
    v_exp_f32 v112, v96
    v_exp_f32 v113, v97
    v_exp_f32 v114, v98
    v_exp_f32 v115, v99
    v_exp_f32 v116, v100
    v_exp_f32 v117, v101
    v_exp_f32 v118, v102
    v_exp_f32 v119, v103
    v_exp_f32 v120, v104
    v_exp_f32 v121, v105
    v_exp_f32 v122, v106
    v_exp_f32 v123, v107
    v_exp_f32 v124, v108
    v_exp_f32 v125, v109
    v_exp_f32 v126, v110
    v_exp_f32 v127, v111
    v_max3_f32 v80, |v96|, |v97|, 0
    v_max3_f32 v80, |v98|, |v99|, v80
    v_max3_f32 v80, |v100|, |v101|, v80
    v_max3_f32 v80, |v102|, |v103|, v80
    v_max3_f32 v80, |v104|, |v105|, v80
    v_max3_f32 v80, |v106|, |v107|, v80
    v_max3_f32 v80, |v108|, |v109|, v80
    v_max3_f32 v80, |v110|, |v111|, v80
    v_cmp_lt_f32 vcc, 0x42fc0000, v80
    v_and_b32 v81, 15, v0
    v_lshrrev_b32 v82, 4, v0
    v_lshlrev_b32 v81, 10, v81
    v_lshl_add_u32 v81, v82, 6, v81
    s_lshl_b32 s68, s25, 8
    s_add_u32 s68, s68, 14942208
    s_add_u32 s69, s68, 16384
    buffer_store_dwordx4 v[112:115], v81, s[40:43], s68 offen offset:0 sc1
    buffer_store_dwordx4 v[96:99], v81, s[40:43], s69 offen offset:0 sc1
    buffer_store_dwordx4 v[116:119], v81, s[40:43], s68 offen offset:16 sc1
    buffer_store_dwordx4 v[100:103], v81, s[40:43], s69 offen offset:16 sc1
    buffer_store_dwordx4 v[120:123], v81, s[40:43], s68 offen offset:32 sc1
    buffer_store_dwordx4 v[104:107], v81, s[40:43], s69 offen offset:32 sc1
    buffer_store_dwordx4 v[124:127], v81, s[40:43], s68 offen offset:48 sc1
    buffer_store_dwordx4 v[108:111], v81, s[40:43], s69 offen offset:48 sc1
    s_cmp_lg_u64 vcc, 0
    s_cselect_b32 s70, 1, 0
    v_mov_b32 v83, s70
    s_lshl_b32 s68, s25, 2
    s_add_u32 s68, s68, 14974976
    s_mov_b64 exec, 1
    buffer_store_dword v83, v40, s[40:43], s68 offen sc1
    s_waitcnt vmcnt(0)
    buffer_atomic_add v38, v40, s[92:95], 0 offen offset:128 sc1
    s_mov_b64 exec, -1
    s_mov_b32 s54, 0
L_gec:
    buffer_load_dword v45, v40, s[92:95], 0 offen sc1
    s_waitcnt vmcnt(0)
    v_cmp_le_u32 vcc, 0x100, v45
    s_nop 1
    s_cmp_lg_u64 vcc, 0
    s_cbranch_scc1 L_ged
    s_add_u32 s54, s54, 1
    s_cmp_gt_u32 s54, 32768
    s_cbranch_scc1 L_ged
    s_sleep 16
    s_branch L_gec
L_ged:
    s_lshl_b32 s68, s25, 15
    s_add_u32 s68, s68, 14680064
    buffer_load_dwordx4 v[128:131], v31, s[40:43], s68 offen sc1
    s_lshl_b32 s68, s25, 15
    s_add_u32 s68, s68, 14681088
    buffer_load_dwordx4 v[132:135], v31, s[40:43], s68 offen sc1
    s_lshl_b32 s68, s25, 15
    s_add_u32 s68, s68, 14682112
    buffer_load_dwordx4 v[136:139], v31, s[40:43], s68 offen sc1
    s_lshl_b32 s68, s25, 15
    s_add_u32 s68, s68, 14683136
    buffer_load_dwordx4 v[140:143], v31, s[40:43], s68 offen sc1
    s_lshl_b32 s68, s25, 15
    s_add_u32 s68, s68, 14684160
    buffer_load_dwordx4 v[144:147], v31, s[40:43], s68 offen sc1
    s_lshl_b32 s68, s25, 15
    s_add_u32 s68, s68, 14685184
    buffer_load_dwordx4 v[148:151], v31, s[40:43], s68 offen sc1
    s_lshl_b32 s68, s25, 15
    s_add_u32 s68, s68, 14686208
    buffer_load_dwordx4 v[152:155], v31, s[40:43], s68 offen sc1
    s_lshl_b32 s68, s25, 15
    s_add_u32 s68, s68, 14687232
    buffer_load_dwordx4 v[156:159], v31, s[40:43], s68 offen sc1
    s_lshl_b32 s68, s25, 15
    s_add_u32 s68, s68, 14688256
    buffer_load_dwordx4 v[160:163], v31, s[40:43], s68 offen sc1
    s_lshl_b32 s68, s25, 15
    s_add_u32 s68, s68, 14689280
    buffer_load_dwordx4 v[164:167], v31, s[40:43], s68 offen sc1
    s_lshl_b32 s68, s25, 15
    s_add_u32 s68, s68, 14690304
    buffer_load_dwordx4 v[168:171], v31, s[40:43], s68 offen sc1
    s_lshl_b32 s68, s25, 15
    s_add_u32 s68, s68, 14691328
    buffer_load_dwordx4 v[172:175], v31, s[40:43], s68 offen sc1
    s_lshl_b32 s68, s25, 15
    s_add_u32 s68, s68, 14692352
    buffer_load_dwordx4 v[176:179], v31, s[40:43], s68 offen sc1
    s_lshl_b32 s68, s25, 15
    s_add_u32 s68, s68, 14693376
    buffer_load_dwordx4 v[180:183], v31, s[40:43], s68 offen sc1
    s_lshl_b32 s68, s25, 15
    s_add_u32 s68, s68, 14694400
    buffer_load_dwordx4 v[184:187], v31, s[40:43], s68 offen sc1
    s_lshl_b32 s68, s25, 15
    s_add_u32 s68, s68, 14695424
    buffer_load_dwordx4 v[188:191], v31, s[40:43], s68 offen sc1
    s_branch L_h_join
L_slow0:
    s_waitcnt lgkmcnt(0)
    buffer_load_dwordx4 v[96:99], v36, s[40:43], s66 offen offset:0 sc1
    buffer_load_dwordx4 v[100:103], v36, s[40:43], s66 offen offset:16 sc1
    buffer_load_dwordx4 v[104:107], v36, s[40:43], s66 offen offset:32 sc1
    buffer_load_dwordx4 v[108:111], v36, s[40:43], s66 offen offset:48 sc1
    s_waitcnt vmcnt(0)
    v_add_f32 v80, v112, v96
    v_add_f32 v81, v113, v97
    v_add_f32 v82, v114, v98
    v_add_f32 v83, v115, v99
    v_add_f32 v84, v116, v100
    v_add_f32 v85, v117, v101
    v_add_f32 v86, v118, v102
    v_add_f32 v87, v119, v103
    v_add_f32 v88, v120, v104
    v_add_f32 v89, v121, v105
    v_add_f32 v90, v122, v106
    v_add_f32 v91, v123, v107
    v_add_f32 v92, v124, v108
    v_add_f32 v93, v125, v109
    v_add_f32 v94, v126, v110
    v_add_f32 v95, v127, v111
    v_exp_f32 v80, v80
    v_exp_f32 v81, v81
    v_exp_f32 v82, v82
    v_exp_f32 v83, v83
    v_exp_f32 v84, v84
    v_exp_f32 v85, v85
    v_exp_f32 v86, v86
    v_exp_f32 v87, v87
    v_exp_f32 v88, v88
    v_exp_f32 v89, v89
    v_exp_f32 v90, v90
    v_exp_f32 v91, v91
    v_exp_f32 v92, v92
    v_exp_f32 v93, v93
    v_exp_f32 v94, v94
    v_exp_f32 v95, v95
    v_add_f32 v80, 1.0, v80
    v_add_f32 v81, 1.0, v81
    v_add_f32 v82, 1.0, v82
    v_add_f32 v83, 1.0, v83
    v_add_f32 v84, 1.0, v84
    v_add_f32 v85, 1.0, v85
    v_add_f32 v86, 1.0, v86
    v_add_f32 v87, 1.0, v87
    v_add_f32 v88, 1.0, v88
    v_add_f32 v89, 1.0, v89
    v_add_f32 v90, 1.0, v90
    v_add_f32 v91, 1.0, v91
    v_add_f32 v92, 1.0, v92
    v_add_f32 v93, 1.0, v93
    v_add_f32 v94, 1.0, v94
    v_add_f32 v95, 1.0, v95
    s_setpc_b64 s[60:61]
L_slow1:
    s_waitcnt lgkmcnt(0)
    buffer_load_dwordx4 v[96:99], v36, s[40:43], s66 offen offset:0 sc1
    buffer_load_dwordx4 v[100:103], v36, s[40:43], s66 offen offset:16 sc1
    buffer_load_dwordx4 v[104:107], v36, s[40:43], s66 offen offset:32 sc1
    buffer_load_dwordx4 v[108:111], v36, s[40:43], s66 offen offset:48 sc1
    s_waitcnt vmcnt(0)
    v_add_f32 v80, v2, v96
    v_add_f32 v81, v3, v97
    v_add_f32 v82, v4, v98
    v_add_f32 v83, v5, v99
    v_add_f32 v84, v6, v100
    v_add_f32 v85, v7, v101
    v_add_f32 v86, v8, v102
    v_add_f32 v87, v9, v103
    v_add_f32 v88, v10, v104
    v_add_f32 v89, v11, v105
    v_add_f32 v90, v12, v106
    v_add_f32 v91, v13, v107
    v_add_f32 v92, v14, v108
    v_add_f32 v93, v15, v109
    v_add_f32 v94, v16, v110
    v_add_f32 v95, v17, v111
    v_exp_f32 v80, v80
    v_exp_f32 v81, v81
    v_exp_f32 v82, v82
    v_exp_f32 v83, v83
    v_exp_f32 v84, v84
    v_exp_f32 v85, v85
    v_exp_f32 v86, v86
    v_exp_f32 v87, v87
    v_exp_f32 v88, v88
    v_exp_f32 v89, v89
    v_exp_f32 v90, v90
    v_exp_f32 v91, v91
    v_exp_f32 v92, v92
    v_exp_f32 v93, v93
    v_exp_f32 v94, v94
    v_exp_f32 v95, v95
    v_add_f32 v80, 1.0, v80
    v_add_f32 v81, 1.0, v81
    v_add_f32 v82, 1.0, v82
    v_add_f32 v83, 1.0, v83
    v_add_f32 v84, 1.0, v84
    v_add_f32 v85, 1.0, v85
    v_add_f32 v86, 1.0, v86
    v_add_f32 v87, 1.0, v87
    v_add_f32 v88, 1.0, v88
    v_add_f32 v89, 1.0, v89
    v_add_f32 v90, 1.0, v90
    v_add_f32 v91, 1.0, v91
    v_add_f32 v92, 1.0, v92
    v_add_f32 v93, 1.0, v93
    v_add_f32 v94, 1.0, v94
    v_add_f32 v95, 1.0, v95
    s_setpc_b64 s[60:61]
L_spin0:
    s_add_u32 s54, s54, 1
    s_cmp_gt_u32 s54, 32768
    s_cbranch_scc1 L_pok0
    s_cmp_eq_u32 s54, 1
    s_cbranch_scc1 L_again0
    s_sleep 16
L_again0:
    buffer_load_dword v45, v41, s[92:95], 0 offen offset:0 sc1
    s_waitcnt vmcnt(0)
    s_branch L_poll0
L_spin1:
    s_add_u32 s54, s54, 1
    s_cmp_gt_u32 s54, 32768
    s_cbranch_scc1 L_pok1
    s_cmp_eq_u32 s54, 1
    s_cbranch_scc1 L_again1
    s_sleep 6
L_again1:
    buffer_load_dword v45, v33, s[40:43], s67 offen sc1
    s_waitcnt vmcnt(0)
    s_branch L_poll1
L_spin2:
    s_add_u32 s54, s54, 1
    s_cmp_gt_u32 s54, 32768
    s_cbranch_scc1 L_pok2
    s_cmp_eq_u32 s54, 1
    s_cbranch_scc1 L_again2
    s_sleep 16
L_again2:
    buffer_load_dword v45, v41, s[92:95], 0 offen offset:128 sc1
    s_waitcnt vmcnt(0)
    s_branch L_poll2
L_spin3:
    s_add_u32 s54, s54, 1
    s_cmp_gt_u32 s54, 32768
    s_cbranch_scc1 L_pok3
    s_cmp_eq_u32 s54, 1
    s_cbranch_scc1 L_again3
    s_sleep 6
L_again3:
    buffer_load_dword v45, v33, s[40:43], s67 offen sc1
    s_waitcnt vmcnt(0)
    s_branch L_poll3
L_js0:
    s_mov_b32 s66, 14896128
    s_call_b64 s[60:61], L_slow0
    s_branch L_jb0
L_js1:
    s_mov_b32 s66, 14897152
    s_call_b64 s[60:61], L_slow0
    s_branch L_jb1
L_js2:
    s_mov_b32 s66, 14898176
    s_call_b64 s[60:61], L_slow0
    s_branch L_jb2
L_js3:
    s_mov_b32 s66, 14899200
    s_call_b64 s[60:61], L_slow0
    s_branch L_jb3
L_js4:
    s_mov_b32 s66, 14900224
    s_call_b64 s[60:61], L_slow0
    s_branch L_jb4
L_js5:
    s_mov_b32 s66, 14901248
    s_call_b64 s[60:61], L_slow0
    s_branch L_jb5
L_js6:
    s_mov_b32 s66, 14902272
    s_call_b64 s[60:61], L_slow0
    s_branch L_jb6
L_js7:
    s_mov_b32 s66, 14903296
    s_call_b64 s[60:61], L_slow0
    s_branch L_jb7
L_fspin0:
    s_add_u32 s54, s54, 1
    s_cmp_gt_u32 s54, 32768
    s_cbranch_scc1 L_fok0
    s_sleep 6
    s_lshl_b32 s69, s30, 10
    s_add_u32 s68, s69, 8388608
    buffer_load_dwordx4 v[48:51], v31, s[40:43], s68 offen sc1
    s_add_u32 s68, s69, 8650752
    buffer_load_dwordx4 v[52:55], v31, s[40:43], s68 offen sc1
    s_add_u32 s68, s69, 8912896
    buffer_load_dwordx4 v[56:59], v31, s[40:43], s68 offen sc1
    s_add_u32 s68, s69, 9175040
    buffer_load_dwordx4 v[60:63], v31, s[40:43], s68 offen sc1
    s_add_u32 s68, s69, 9437184
    buffer_load_dwordx4 v[64:67], v31, s[40:43], s68 offen sc1
    s_add_u32 s68, s69, 9699328
    buffer_load_dwordx4 v[68:71], v31, s[40:43], s68 offen sc1
    s_add_u32 s68, s69, 9961472
    buffer_load_dwordx4 v[72:75], v31, s[40:43], s68 offen sc1
    s_add_u32 s68, s69, 10223616
    buffer_load_dwordx4 v[76:79], v31, s[40:43], s68 offen sc1
    s_waitcnt vmcnt(0)
    s_branch L_fchk0
L_js8:
    s_mov_b32 s66, 14904320
    s_call_b64 s[60:61], L_slow1
    s_branch L_jb8
L_js9:
    s_mov_b32 s66, 14905344
    s_call_b64 s[60:61], L_slow1
    s_branch L_jb9
L_js10:
    s_mov_b32 s66, 14906368
    s_call_b64 s[60:61], L_slow1
    s_branch L_jb10
L_js11:
    s_mov_b32 s66, 14907392
    s_call_b64 s[60:61], L_slow1
    s_branch L_jb11
L_js12:
    s_mov_b32 s66, 14908416
    s_call_b64 s[60:61], L_slow1
    s_branch L_jb12
L_js13:
    s_mov_b32 s66, 14909440
    s_call_b64 s[60:61], L_slow1
    s_branch L_jb13
L_js14:
    s_mov_b32 s66, 14910464
    s_call_b64 s[60:61], L_slow1
    s_branch L_jb14
L_js15:
    s_mov_b32 s66, 14911488
    s_call_b64 s[60:61], L_slow1
    s_branch L_jb15
L_fspin1:
    s_add_u32 s54, s54, 1
    s_cmp_gt_u32 s54, 32768
    s_cbranch_scc1 L_fok1
    s_sleep 6
    s_lshl_b32 s69, s30, 10
    s_add_u32 s68, s69, 10485760
    buffer_load_dwordx4 v[48:51], v31, s[40:43], s68 offen sc1
    s_add_u32 s68, s69, 10747904
    buffer_load_dwordx4 v[52:55], v31, s[40:43], s68 offen sc1
    s_add_u32 s68, s69, 11010048
    buffer_load_dwordx4 v[56:59], v31, s[40:43], s68 offen sc1
    s_add_u32 s68, s69, 11272192
    buffer_load_dwordx4 v[60:63], v31, s[40:43], s68 offen sc1
    s_add_u32 s68, s69, 11534336
    buffer_load_dwordx4 v[64:67], v31, s[40:43], s68 offen sc1
    s_add_u32 s68, s69, 11796480
    buffer_load_dwordx4 v[68:71], v31, s[40:43], s68 offen sc1
    s_add_u32 s68, s69, 12058624
    buffer_load_dwordx4 v[72:75], v31, s[40:43], s68 offen sc1
    s_add_u32 s68, s69, 12320768
    buffer_load_dwordx4 v[76:79], v31, s[40:43], s68 offen sc1
    s_waitcnt vmcnt(0)
    s_branch L_fchk1
L_exit:
    s_endpgm
.p2align 8
    s_endpgm
    s_endpgm
    s_endpgm
    s_endpgm
    s_endpgm
    s_endpgm
    s_endpgm
    s_endpgm
    s_endpgm
    s_endpgm
    s_endpgm
    s_endpgm
    s_endpgm
    s_endpgm
    s_endpgm
    s_endpgm
    s_endpgm
    s_endpgm
    s_endpgm
    s_endpgm
    s_endpgm
    s_endpgm
    s_endpgm
    s_endpgm
    s_endpgm
    s_endpgm
    s_endpgm
    s_endpgm
    s_endpgm
    s_endpgm
    s_endpgm
    s_endpgm
    s_endpgm
    s_endpgm
    s_endpgm
    s_endpgm
    s_endpgm
    s_endpgm
    s_endpgm
    s_endpgm
    s_endpgm
    s_endpgm
    s_endpgm
    s_endpgm
    s_endpgm
    s_endpgm
    s_endpgm
    s_endpgm
    s_endpgm
    s_endpgm
    s_endpgm
    s_endpgm
    s_endpgm
    s_endpgm
    s_endpgm
    s_endpgm
    s_endpgm
    s_endpgm
    s_endpgm
    s_endpgm
    s_endpgm
    s_endpgm
    s_endpgm
    s_endpgm
    s_endpgm
    s_endpgm
    s_endpgm
    s_endpgm
    s_endpgm
    s_endpgm
    s_endpgm
    s_endpgm
    s_endpgm
    s_endpgm
    s_endpgm
    s_endpgm
    s_endpgm
    s_endpgm
    s_endpgm
    s_endpgm
    s_endpgm
    s_endpgm
    s_endpgm
    s_endpgm
    s_endpgm
    s_endpgm
    s_endpgm
    s_endpgm
    s_endpgm
    s_endpgm
    s_endpgm
    s_endpgm
    s_endpgm
    s_endpgm
    s_endpgm
    s_endpgm
    s_endpgm
    s_endpgm
    s_endpgm
    s_endpgm
    s_endpgm
    s_endpgm
    s_endpgm
    s_endpgm
    s_endpgm
    s_endpgm
    s_endpgm
    s_endpgm
    s_endpgm
    s_endpgm
    s_endpgm
    s_endpgm
    s_endpgm
    s_endpgm
    s_endpgm
    s_endpgm
    s_endpgm
    s_endpgm
    s_endpgm
    s_endpgm
    s_endpgm
    s_endpgm
    s_endpgm
    s_endpgm
    s_endpgm
    s_endpgm
    s_endpgm
    s_endpgm
    s_endpgm
    s_endpgm
    s_endpgm
    s_endpgm
    s_endpgm
    s_endpgm
    s_endpgm
    s_endpgm
    s_endpgm
    s_endpgm
    s_endpgm
    s_endpgm
    s_endpgm
    s_endpgm
    s_endpgm
    s_endpgm
    s_endpgm
    s_endpgm
    s_endpgm
    s_endpgm
    s_endpgm
    s_endpgm
    s_endpgm
    s_endpgm
    s_endpgm
    s_endpgm
    s_endpgm
    s_endpgm
    s_endpgm
    s_endpgm
    s_endpgm
    s_endpgm
    s_endpgm
    s_endpgm
    s_endpgm
    s_endpgm
    s_endpgm
    s_endpgm
    s_endpgm
    s_endpgm
    s_endpgm
    s_endpgm
    s_endpgm
    s_endpgm
    s_endpgm
    s_endpgm
    s_endpgm
    s_endpgm
    s_endpgm
    s_endpgm
    s_endpgm
    s_endpgm
    s_endpgm
    s_endpgm
    s_endpgm
    s_endpgm
    s_endpgm
    s_endpgm
    s_endpgm
    s_endpgm
    s_endpgm
    s_endpgm
    s_endpgm
    s_endpgm
    s_endpgm
    s_endpgm
    s_endpgm
    s_endpgm
    s_endpgm
    s_endpgm
    s_endpgm
    s_endpgm
    s_endpgm
    s_endpgm
    s_endpgm
    s_endpgm
    s_endpgm
    s_endpgm
    s_endpgm
    s_endpgm
    s_endpgm
    s_endpgm
    s_endpgm
    s_endpgm
    s_endpgm
    s_endpgm
    s_endpgm
    s_endpgm
    s_endpgm
    s_endpgm
    s_endpgm
    s_endpgm
    s_endpgm
    s_endpgm
    s_endpgm
    s_endpgm
    s_endpgm
    s_endpgm
    s_endpgm
    s_endpgm
    s_endpgm
    s_endpgm
    s_endpgm
    s_endpgm
    s_endpgm
    s_endpgm
    s_endpgm
    s_endpgm
    s_endpgm
    s_endpgm
    s_endpgm
    s_endpgm
    s_endpgm
    s_endpgm
    s_endpgm
    s_endpgm
    s_endpgm
    s_endpgm
    s_endpgm
    s_endpgm
    s_endpgm
    s_endpgm
    s_endpgm
    s_endpgm
    s_endpgm
    s_endpgm
    s_endpgm
    s_endpgm
    s_endpgm
    s_endpgm
    s_endpgm
    s_endpgm
    s_endpgm
    s_endpgm
    s_endpgm
    s_endpgm
    s_endpgm
    s_endpgm
    s_endpgm
    s_endpgm
    s_endpgm
    s_endpgm
    s_endpgm
    s_endpgm
    s_endpgm
    s_endpgm
    s_endpgm
    s_endpgm
    s_endpgm
    s_endpgm
    s_endpgm
    s_endpgm
    s_endpgm
    s_endpgm
    s_endpgm
    s_endpgm
    s_endpgm
    s_endpgm
    s_endpgm
    s_endpgm
    s_endpgm
    s_endpgm
    s_endpgm
    s_endpgm
    s_endpgm
    s_endpgm
    s_endpgm
    s_endpgm
    s_endpgm
    s_endpgm
    s_endpgm
    s_endpgm
    s_endpgm
    s_endpgm
    s_endpgm
    s_endpgm
    s_endpgm
    s_endpgm
    s_endpgm
    s_endpgm
    s_endpgm
    s_endpgm
    s_endpgm
    s_endpgm
    s_endpgm
    s_endpgm
    s_endpgm
    s_endpgm
    s_endpgm
    s_endpgm
    s_endpgm
    s_endpgm
    s_endpgm
    s_endpgm
    s_endpgm
    s_endpgm
    s_endpgm
    s_endpgm
    s_endpgm
    s_endpgm
    s_endpgm
    s_endpgm
    s_endpgm
    s_endpgm
    s_endpgm
    s_endpgm
    s_endpgm
    s_endpgm
    s_endpgm
    s_endpgm
    s_endpgm
    s_endpgm
    s_endpgm
    s_endpgm
    s_endpgm
    s_endpgm
    s_endpgm
    s_endpgm
    s_endpgm
    s_endpgm
    s_endpgm
    s_endpgm
    s_endpgm
    s_endpgm
    s_endpgm
    s_endpgm
    s_endpgm
    s_endpgm
    s_endpgm
    s_endpgm
    s_endpgm
    s_endpgm
    s_endpgm
    s_endpgm
    s_endpgm
    s_endpgm
    s_endpgm
    s_endpgm
    s_endpgm
    s_endpgm
    s_endpgm
    s_endpgm
    s_endpgm
    s_endpgm
    s_endpgm
    s_endpgm
    s_endpgm
    s_endpgm
    s_endpgm
    s_endpgm
    s_endpgm
    s_endpgm
    s_endpgm
    s_endpgm
    s_endpgm
    s_endpgm
    s_endpgm
    s_endpgm
    s_endpgm
    s_endpgm
    s_endpgm
    s_endpgm
    s_endpgm
    s_endpgm
    s_endpgm
    s_endpgm
    s_endpgm
    s_endpgm
    s_endpgm
    s_endpgm
    s_endpgm
    s_endpgm
    s_endpgm
    s_endpgm
    s_endpgm
    s_endpgm
    s_endpgm
    s_endpgm
    s_endpgm
    s_endpgm
    s_endpgm
    s_endpgm
    s_endpgm
    s_endpgm
    s_endpgm
    s_endpgm
    s_endpgm
    s_endpgm
    s_endpgm
    s_endpgm
    s_endpgm
    s_endpgm
    s_endpgm
    s_endpgm
    s_endpgm
    s_endpgm
    s_endpgm
    s_endpgm
    s_endpgm
    s_endpgm
    s_endpgm
    s_endpgm
    s_endpgm
    s_endpgm
    s_endpgm
    s_endpgm
    s_endpgm
    s_endpgm
    s_endpgm
    s_endpgm
    s_endpgm
    s_endpgm
    s_endpgm
    s_endpgm
    s_endpgm
    s_endpgm
    s_endpgm
    s_endpgm
    s_endpgm
    s_endpgm
    s_endpgm
    s_endpgm
    s_endpgm
    s_endpgm
    s_endpgm
    s_endpgm
    s_endpgm
    s_endpgm
    s_endpgm
    s_endpgm
    s_endpgm
    s_endpgm
    s_endpgm
    s_endpgm
    s_endpgm
    s_endpgm
    s_endpgm
    s_endpgm
    s_endpgm
    s_endpgm
    s_endpgm
    s_endpgm
    s_endpgm
    s_endpgm
    s_endpgm
    s_endpgm
    s_endpgm
    s_endpgm
    s_endpgm
    s_endpgm
    s_endpgm
    s_endpgm
    s_endpgm
    s_endpgm
    s_endpgm
    s_endpgm
    s_endpgm
    s_endpgm
    s_endpgm
    s_endpgm
    s_endpgm
    s_endpgm
    s_endpgm
    s_endpgm
    s_endpgm
    s_endpgm
    s_endpgm
    s_endpgm
    s_endpgm
    s_endpgm
    s_endpgm
    s_endpgm
    s_endpgm
    s_endpgm
    s_endpgm
    s_endpgm
    s_endpgm
    s_endpgm
    s_endpgm
    s_endpgm
    s_endpgm
    s_endpgm
    s_endpgm
    s_endpgm
    s_endpgm
    s_endpgm
    s_endpgm
    s_endpgm
    s_endpgm
    s_endpgm
    s_endpgm
    s_endpgm
    s_endpgm
    s_endpgm
    s_endpgm
    s_endpgm
    s_endpgm
    s_endpgm
    s_endpgm
    s_endpgm
    s_endpgm
    s_endpgm
    s_endpgm
    s_endpgm
    s_endpgm
    s_endpgm
    s_endpgm
    s_endpgm
    s_endpgm
    s_endpgm
    s_endpgm
    s_endpgm
    s_endpgm
    s_endpgm
    s_endpgm
    s_endpgm
    s_endpgm
    s_endpgm
    s_endpgm
    s_endpgm
    s_endpgm
    s_endpgm
    s_endpgm
    s_endpgm
    s_endpgm
    s_endpgm
    s_endpgm
    s_endpgm
    s_endpgm
    s_endpgm
    s_endpgm
    s_endpgm
    s_endpgm
    s_endpgm
    s_endpgm
    s_endpgm
    s_endpgm
    s_endpgm
    s_endpgm
    s_endpgm
    s_endpgm
    s_endpgm
    s_endpgm
    s_endpgm
    s_endpgm
    s_endpgm
    s_endpgm
    s_endpgm
    s_endpgm
    s_endpgm
    s_endpgm
    s_endpgm
    s_endpgm
    s_endpgm
    s_endpgm
    s_endpgm
    s_endpgm
    s_endpgm
    s_endpgm
    s_endpgm
    s_endpgm
    s_endpgm
    s_endpgm
    s_endpgm
    s_endpgm
    s_endpgm
    s_endpgm
    s_endpgm
    s_endpgm
    s_endpgm
    s_endpgm
    s_endpgm
    s_endpgm
    s_endpgm
    s_endpgm
    s_endpgm
    s_endpgm
    s_endpgm
    s_endpgm
    s_endpgm
    s_endpgm
    s_endpgm
    s_endpgm
    s_endpgm
    s_endpgm
    s_endpgm
    s_endpgm
    s_endpgm
    s_endpgm
    s_endpgm
    s_endpgm
    s_endpgm
    s_endpgm
    s_endpgm
    s_endpgm
    s_endpgm
    s_endpgm
    s_endpgm
    s_endpgm
    s_endpgm
    s_endpgm
    s_endpgm
    s_endpgm
    s_endpgm
    s_endpgm
    s_endpgm
    s_endpgm
    s_endpgm
    s_endpgm
    s_endpgm
    s_endpgm
    s_endpgm
    s_endpgm
    s_endpgm
    s_endpgm
    s_endpgm
    s_endpgm
    s_endpgm
    s_endpgm
    s_endpgm
    s_endpgm
    s_endpgm
    s_endpgm
    s_endpgm
    s_endpgm
    s_endpgm
    s_endpgm
    s_endpgm
    s_endpgm
    s_endpgm
    s_endpgm
    s_endpgm
    s_endpgm
    s_endpgm
    s_endpgm
    s_endpgm
    s_endpgm
    s_endpgm
    s_endpgm
    s_endpgm
    s_endpgm
    s_endpgm
    s_endpgm
    s_endpgm
    s_endpgm
    s_endpgm
    s_endpgm
    s_endpgm
    s_endpgm
    s_endpgm
    s_endpgm
    s_endpgm
    s_endpgm
    s_endpgm
    s_endpgm
    s_endpgm
    s_endpgm
    s_endpgm
    s_endpgm
    s_endpgm
    s_endpgm
    s_endpgm
    s_endpgm
    s_endpgm
    s_endpgm
    s_endpgm
    s_endpgm
    s_endpgm
    s_endpgm
    s_endpgm
    s_endpgm
    s_endpgm
    s_endpgm
    s_endpgm
    s_endpgm
    s_endpgm
    s_endpgm
    s_endpgm
    s_endpgm
    s_endpgm
    s_endpgm
    s_endpgm
    s_endpgm
    s_endpgm
    s_endpgm
    s_endpgm
    s_endpgm
    s_endpgm
    s_endpgm
    s_endpgm
    s_endpgm
    s_endpgm
    s_endpgm
    s_endpgm
    s_endpgm
    s_endpgm
    s_endpgm
    s_endpgm
    s_endpgm
    s_endpgm
    s_endpgm
    s_endpgm
    s_endpgm
    s_endpgm
    s_endpgm
    s_endpgm
    s_endpgm
    s_endpgm
    s_endpgm
    s_endpgm
    s_endpgm
    s_endpgm
    s_endpgm
    s_endpgm
    s_endpgm
    s_endpgm
    s_endpgm
    s_endpgm
    s_endpgm
    s_endpgm
    s_endpgm
    s_endpgm
    s_endpgm
    s_endpgm
    s_endpgm
    s_endpgm
    s_endpgm
    s_endpgm
    s_endpgm
    s_endpgm
    s_endpgm
    s_endpgm
    s_endpgm
    s_endpgm
    s_endpgm
    s_endpgm
    s_endpgm
    s_endpgm
    s_endpgm
    s_endpgm
    s_endpgm
    s_endpgm
    s_endpgm
    s_endpgm
    s_endpgm
    s_endpgm
    s_endpgm
    s_endpgm
    s_endpgm
    s_endpgm
    s_endpgm
    s_endpgm
    s_endpgm
    s_endpgm
    s_endpgm
    s_endpgm
    s_endpgm
    s_endpgm
    s_endpgm
    s_endpgm
    s_endpgm
    s_endpgm
    s_endpgm
    s_endpgm
    s_endpgm
    s_endpgm
    s_endpgm
    s_endpgm
    s_endpgm
    s_endpgm
    s_endpgm
    s_endpgm
    s_endpgm
    s_endpgm
    s_endpgm
    s_endpgm
    s_endpgm
    s_endpgm
    s_endpgm
    s_endpgm
    s_endpgm
    s_endpgm
    s_endpgm
    s_endpgm
    s_endpgm
    s_endpgm
    s_endpgm
    s_endpgm
    s_endpgm
    s_endpgm
    s_endpgm
    s_endpgm
    s_endpgm
    s_endpgm
    s_endpgm
    s_endpgm
    s_endpgm
    s_endpgm
    s_endpgm
    s_endpgm
    s_endpgm
    s_endpgm
    s_endpgm
    s_endpgm
    s_endpgm
    s_endpgm
    s_endpgm
    s_endpgm
    s_endpgm
    s_endpgm
    s_endpgm
    s_endpgm
    s_endpgm
    s_endpgm
    s_endpgm
    s_endpgm
    s_endpgm
    s_endpgm
    s_endpgm
    s_endpgm
    s_endpgm
    s_endpgm
    s_endpgm
    s_endpgm
    s_endpgm
    s_endpgm
    s_endpgm
    s_endpgm
    s_endpgm
    s_endpgm
    s_endpgm
    s_endpgm
    s_endpgm
    s_endpgm
    s_endpgm
    s_endpgm
    s_endpgm
    s_endpgm
    s_endpgm
    s_endpgm
    s_endpgm
    s_endpgm
    s_endpgm
    s_endpgm
    s_endpgm
    s_endpgm
    s_endpgm
    s_endpgm
    s_endpgm
    s_endpgm
    s_endpgm
    s_endpgm
    s_endpgm
    s_endpgm
    s_endpgm
    s_endpgm
    s_endpgm
    s_endpgm
    s_endpgm
    s_endpgm
    s_endpgm
    s_endpgm
    s_endpgm
    s_endpgm
    s_endpgm
    s_endpgm
    s_endpgm
    s_endpgm
    s_endpgm
    s_endpgm
    s_endpgm
    s_endpgm
    s_endpgm
    s_endpgm
    s_endpgm
    s_endpgm
    s_endpgm
    s_endpgm
    s_endpgm
    s_endpgm
    s_endpgm
    s_endpgm
    s_endpgm
    s_endpgm
    s_endpgm
    s_endpgm
    s_endpgm
    s_endpgm
    s_endpgm
    s_endpgm
    s_endpgm
    s_endpgm
    s_endpgm
    s_endpgm
    s_endpgm
    s_endpgm
    s_endpgm
    s_endpgm
    s_endpgm
    s_endpgm
    s_endpgm
    s_endpgm
    s_endpgm
    s_endpgm
    s_endpgm
    s_endpgm
    s_endpgm
    s_endpgm
    s_endpgm
    s_endpgm
    s_endpgm
    s_endpgm
    s_endpgm
    s_endpgm
    s_endpgm
    s_endpgm
    s_endpgm
    s_endpgm
    s_endpgm
    s_endpgm
    s_endpgm
    s_endpgm
    s_endpgm
    s_endpgm
    s_endpgm
    s_endpgm
    s_endpgm
    s_endpgm
    s_endpgm
    s_endpgm
    s_endpgm
    s_endpgm
    s_endpgm
    s_endpgm
    s_endpgm
    s_endpgm
    s_endpgm
    s_endpgm
    s_endpgm
    s_endpgm
    s_endpgm
    s_endpgm
    s_endpgm
    s_endpgm
    s_endpgm
    s_endpgm
    s_endpgm
    s_endpgm
    s_endpgm
    s_endpgm
    s_endpgm
    s_endpgm
    s_endpgm
    s_endpgm
    s_endpgm
    s_endpgm
    s_endpgm
    s_endpgm
    s_endpgm
    s_endpgm
    s_endpgm
    s_endpgm
    s_endpgm
    s_endpgm
    s_endpgm
    s_endpgm
    s_endpgm
    s_endpgm
    s_endpgm
    s_endpgm
    s_endpgm
    s_endpgm
    s_endpgm
    s_endpgm
    s_endpgm
    s_endpgm
    s_endpgm
    s_endpgm
    s_endpgm
    s_endpgm
    s_endpgm
    s_endpgm
    s_endpgm
    s_endpgm
    s_endpgm
    s_endpgm
    s_endpgm
    s_endpgm
    s_endpgm
    s_endpgm
    s_endpgm
    s_endpgm
    s_endpgm
    s_endpgm
    s_endpgm
    s_endpgm
    s_endpgm
    s_endpgm
    s_endpgm
    s_endpgm
    s_endpgm
    s_endpgm
    s_endpgm
    s_endpgm
    s_endpgm
    s_endpgm
    s_endpgm
    s_endpgm
    s_endpgm
    s_endpgm
    s_endpgm
    s_endpgm
    s_endpgm
    s_endpgm
    s_endpgm
    s_endpgm
    s_endpgm
    s_endpgm
    s_endpgm
    s_endpgm
    s_endpgm
    s_endpgm
    s_endpgm
    s_endpgm
    s_endpgm
    s_endpgm
    s_endpgm
    s_endpgm
    s_endpgm
    s_endpgm
    s_endpgm
    s_endpgm
    s_endpgm
    s_endpgm
    s_endpgm
    s_endpgm
    s_endpgm
    s_endpgm
    s_endpgm
    s_endpgm
    s_endpgm
    s_endpgm
    s_endpgm
    s_endpgm
    s_endpgm
    s_endpgm
    s_endpgm
    s_endpgm
    s_endpgm
    s_endpgm
    s_endpgm
    s_endpgm
    s_endpgm
    s_endpgm
    s_endpgm
    s_endpgm
    s_endpgm
    s_endpgm
    s_endpgm
    s_endpgm
    s_endpgm
    s_endpgm
    s_endpgm
    s_endpgm
    s_endpgm
    s_endpgm
    s_endpgm
    s_endpgm
    s_endpgm
    s_endpgm
    s_endpgm
    s_endpgm
    s_endpgm
    s_endpgm
    s_endpgm
    s_endpgm
    s_endpgm
    s_endpgm
    s_endpgm
    s_endpgm
    s_endpgm
    s_endpgm
    s_endpgm
    s_endpgm
    s_endpgm
    s_endpgm
    s_endpgm
    s_endpgm
    s_endpgm
    s_endpgm
    s_endpgm
    s_endpgm
    s_endpgm
    s_endpgm
    s_endpgm
    s_endpgm
    s_endpgm
    s_endpgm
    s_endpgm
    s_endpgm
    s_endpgm
    s_endpgm
    s_endpgm
    s_endpgm
    s_endpgm
    s_endpgm
    s_endpgm
    s_endpgm
    s_endpgm
    s_endpgm
    s_endpgm
    s_endpgm
    s_endpgm
    s_endpgm
    s_endpgm
    s_endpgm
    s_endpgm
    s_endpgm
    s_endpgm
    s_endpgm
    s_endpgm
    s_endpgm
    s_endpgm
    s_endpgm
    s_endpgm
    s_endpgm
    s_endpgm
    s_endpgm
    s_endpgm
    s_endpgm
    s_endpgm
    s_endpgm
    s_endpgm
    s_endpgm
    s_endpgm
    s_endpgm
    s_endpgm
    s_endpgm
    s_endpgm
    s_endpgm
    s_endpgm
    s_endpgm
    s_endpgm
    s_endpgm
    s_endpgm
    s_endpgm
    s_endpgm
    s_endpgm
    s_endpgm
    s_endpgm
    s_endpgm
    s_endpgm
    s_endpgm
    s_endpgm
    s_endpgm
    s_endpgm
    s_endpgm
    s_endpgm
    s_endpgm
    s_endpgm
    s_endpgm
    s_endpgm
    s_endpgm
    s_endpgm
    s_endpgm
    s_endpgm
    s_endpgm
    s_endpgm
    s_endpgm
    s_endpgm
    s_endpgm
    s_endpgm
    s_endpgm
    s_endpgm
    s_endpgm
    s_endpgm
    s_endpgm
    s_endpgm
    s_endpgm
    s_endpgm
    s_endpgm
    s_endpgm
    s_endpgm
    s_endpgm
    s_endpgm
    s_endpgm
    s_endpgm
    s_endpgm
    s_endpgm
    s_endpgm
    s_endpgm
    s_endpgm
    s_endpgm
    s_endpgm
    s_endpgm
    s_endpgm
    s_endpgm
    s_endpgm
    s_endpgm
    s_endpgm
    s_endpgm
    s_endpgm
    s_endpgm
    s_endpgm
    s_endpgm
    s_endpgm
    s_endpgm
    s_endpgm
    s_endpgm
    s_endpgm
    s_endpgm
    s_endpgm
    s_endpgm
    s_endpgm
    s_endpgm
    s_endpgm
    s_endpgm
    s_endpgm
    s_endpgm
    s_endpgm
    s_endpgm
    s_endpgm
    s_endpgm
    s_endpgm
    s_endpgm
    s_endpgm
    s_endpgm
    s_endpgm
    s_endpgm
    s_endpgm
    s_endpgm
    s_endpgm
    s_endpgm
    s_endpgm
    s_endpgm
    s_endpgm
    s_endpgm
    s_endpgm
    s_endpgm
    s_endpgm
    s_endpgm
    s_endpgm
    s_endpgm
    s_endpgm
    s_endpgm
    s_endpgm
    s_endpgm
    s_endpgm
    s_endpgm
    s_endpgm
    s_endpgm
    s_endpgm
    s_endpgm
    s_endpgm
    s_endpgm
    s_endpgm
    s_endpgm
    s_endpgm
    s_endpgm
    s_endpgm
    s_endpgm
    s_endpgm
    s_endpgm
    s_endpgm
    s_endpgm
    s_endpgm
    s_endpgm
    s_endpgm
    s_endpgm
    s_endpgm
    s_endpgm
    s_endpgm
    s_endpgm
    s_endpgm
    s_endpgm
    s_endpgm
    s_endpgm
    s_endpgm
    s_endpgm
    s_endpgm
    s_endpgm
    s_endpgm
    s_endpgm
    s_endpgm
    s_endpgm
    s_endpgm
    s_endpgm
    s_endpgm
    s_endpgm
    s_endpgm
    s_endpgm
    s_endpgm
    s_endpgm
    s_endpgm
    s_endpgm
    s_endpgm
    s_endpgm
    s_endpgm
    s_endpgm
    s_endpgm
    s_endpgm
    s_endpgm
    s_endpgm
    s_endpgm
    s_endpgm
    s_endpgm
    s_endpgm
    s_endpgm
    s_endpgm
    s_endpgm
    s_endpgm
    s_endpgm
    s_endpgm
    s_endpgm
    s_endpgm
    s_endpgm
    s_endpgm
    s_endpgm
    s_endpgm
    s_endpgm
    s_endpgm
    s_endpgm
    s_endpgm
    s_endpgm
    s_endpgm
    s_endpgm
    s_endpgm
    s_endpgm
    s_endpgm
    s_endpgm
    s_endpgm
    s_endpgm
    s_endpgm
    s_endpgm
    s_endpgm
    s_endpgm
    s_endpgm
    s_endpgm
    s_endpgm
    s_endpgm
    s_endpgm
    s_endpgm
    s_endpgm
    s_endpgm
    s_endpgm
    s_endpgm
    s_endpgm
    s_endpgm
    s_endpgm
    s_endpgm
    s_endpgm
    s_endpgm
    s_endpgm
    s_endpgm
    s_endpgm
    s_endpgm
    s_endpgm
    s_endpgm
    s_endpgm
    s_endpgm
    s_endpgm
    s_endpgm
    s_endpgm
    s_endpgm
    s_endpgm
    s_endpgm
    s_endpgm
    s_endpgm
    s_endpgm
    s_endpgm
    s_endpgm
    s_endpgm
    s_endpgm
    s_endpgm
    s_endpgm
    s_endpgm
    s_endpgm
    s_endpgm
    s_endpgm
    s_endpgm
    s_endpgm
    s_endpgm
    s_endpgm
    s_endpgm
    s_endpgm
    s_endpgm
    s_endpgm
    s_endpgm
    s_endpgm
    s_endpgm
    s_endpgm
    s_endpgm
    s_endpgm
    s_endpgm
    s_endpgm
    s_endpgm
    s_endpgm
    s_endpgm
    s_endpgm
    s_endpgm
    s_endpgm
    s_endpgm
    s_endpgm
    s_endpgm
    s_endpgm
    s_endpgm
    s_endpgm
    s_endpgm
    s_endpgm
    s_endpgm
    s_endpgm
    s_endpgm
    s_endpgm
    s_endpgm
    s_endpgm
    s_endpgm
    s_endpgm
    s_endpgm
    s_endpgm
    s_endpgm
    s_endpgm
    s_endpgm
    s_endpgm
    s_endpgm
    s_endpgm
    s_endpgm
    s_endpgm
    s_endpgm
    s_endpgm
    s_endpgm
    s_endpgm
    s_endpgm
    s_endpgm
    s_endpgm
    s_endpgm
    s_endpgm
    s_endpgm
    s_endpgm
    s_endpgm
    s_endpgm
    s_endpgm
    s_endpgm
    s_endpgm
    s_endpgm
    s_endpgm
    s_endpgm
    s_endpgm
    s_endpgm
    s_endpgm
    s_endpgm
    s_endpgm
    s_endpgm
    s_endpgm
    s_endpgm
    s_endpgm
    s_endpgm
    s_endpgm
    s_endpgm
    s_endpgm
    s_endpgm
    s_endpgm
    s_endpgm
    s_endpgm
    s_endpgm
    s_endpgm
    s_endpgm
    s_endpgm
    s_endpgm
    s_endpgm
    s_endpgm
    s_endpgm
    s_endpgm
    s_endpgm
    s_endpgm
    s_endpgm
    s_endpgm
    s_endpgm
    s_endpgm
    s_endpgm
    s_endpgm
    s_endpgm
    s_endpgm
    s_endpgm
    s_endpgm
    s_endpgm
    s_endpgm
    s_endpgm
    s_endpgm
    s_endpgm
    s_endpgm
    s_endpgm
    s_endpgm
    s_endpgm
    s_endpgm
    s_endpgm
    s_endpgm
    s_endpgm
    s_endpgm
    s_endpgm
    s_endpgm
    s_endpgm
    s_endpgm
    s_endpgm
    s_endpgm
    s_endpgm
    s_endpgm
    s_endpgm
    s_endpgm
    s_endpgm
    s_endpgm
    s_endpgm
    s_endpgm
    s_endpgm
    s_endpgm
    s_endpgm
    s_endpgm
    s_endpgm
    s_endpgm
    s_endpgm
    s_endpgm
    s_endpgm
    s_endpgm
    s_endpgm
    s_endpgm
    s_endpgm
    s_endpgm
    s_endpgm
    s_endpgm
    s_endpgm
    s_endpgm
    s_endpgm
    s_endpgm
    s_endpgm
    s_endpgm
    s_endpgm
    s_endpgm
    s_endpgm
    s_endpgm
    s_endpgm
    s_endpgm
    s_endpgm
    s_endpgm
    s_endpgm
    s_endpgm
    s_endpgm
    s_endpgm
    s_endpgm
    s_endpgm
    s_endpgm
    s_endpgm
    s_endpgm
    s_endpgm
    s_endpgm
    s_endpgm
    s_endpgm
    s_endpgm
    s_endpgm
    s_endpgm
    s_endpgm
    s_endpgm
    s_endpgm
    s_endpgm
    s_endpgm
    s_endpgm
    s_endpgm
    s_endpgm
    s_endpgm
    s_endpgm
    s_endpgm
    s_endpgm
    s_endpgm
    s_endpgm
    s_endpgm
    s_endpgm
    s_endpgm
    s_endpgm
    s_endpgm
    s_endpgm
    s_endpgm
    s_endpgm
    s_endpgm
    s_endpgm
    s_endpgm
    s_endpgm
    s_endpgm
    s_endpgm
    s_endpgm
    s_endpgm
    s_endpgm
    s_endpgm
    s_endpgm
    s_endpgm
    s_endpgm
    s_endpgm
    s_endpgm
    s_endpgm
    s_endpgm
    s_endpgm
    s_endpgm
    s_endpgm
    s_endpgm
    s_endpgm
    s_endpgm
    s_endpgm
    s_endpgm
    s_endpgm
    s_endpgm
    s_endpgm
    s_endpgm
    s_endpgm
    s_endpgm
    s_endpgm
    s_endpgm
    s_endpgm
    s_endpgm
    s_endpgm
    s_endpgm
    s_endpgm
    s_endpgm
    s_endpgm
    s_endpgm
    s_endpgm
    s_endpgm
    s_endpgm
    s_endpgm
    s_endpgm
    s_endpgm
    s_endpgm
    s_endpgm
    s_endpgm
    s_endpgm
    s_endpgm
    s_endpgm
    s_endpgm
    s_endpgm
    s_endpgm
    s_endpgm
    s_endpgm
    s_endpgm
    s_endpgm
    s_endpgm
    s_endpgm
    s_endpgm
    s_endpgm
    s_endpgm
    s_endpgm
    s_endpgm
    s_endpgm
    s_endpgm
    s_endpgm
    s_endpgm
    s_endpgm
    s_endpgm
    s_endpgm
    s_endpgm
    s_endpgm
    s_endpgm
    s_endpgm
    s_endpgm
    s_endpgm
    s_endpgm
    s_endpgm
    s_endpgm
    s_endpgm
    s_endpgm
    s_endpgm
    s_endpgm
    s_endpgm
    s_endpgm
    s_endpgm
    s_endpgm
    s_endpgm
    s_endpgm
    s_endpgm
    s_endpgm
    s_endpgm
    s_endpgm
    s_endpgm
    s_endpgm
    s_endpgm
    s_endpgm
    s_endpgm
    s_endpgm
    s_endpgm
    s_endpgm
    s_endpgm
    s_endpgm
    s_endpgm
    s_endpgm
    s_endpgm
    s_endpgm
    s_endpgm
    s_endpgm
    s_endpgm
    s_endpgm
    s_endpgm
    s_endpgm
    s_endpgm
    s_endpgm
    s_endpgm
    s_endpgm
    s_endpgm
    s_endpgm
    s_endpgm
    s_endpgm
    s_endpgm
    s_endpgm
    s_endpgm
    s_endpgm
    s_endpgm
    s_endpgm
    s_endpgm
    s_endpgm
    s_endpgm
    s_endpgm
    s_endpgm
    s_endpgm
    s_endpgm
    s_endpgm
    s_endpgm
    s_endpgm
    s_endpgm
    s_endpgm
    s_endpgm
    s_endpgm
    s_endpgm
    s_endpgm
    s_endpgm
    s_endpgm
    s_endpgm
    s_endpgm
    s_endpgm
    s_endpgm
    s_endpgm
    s_endpgm
    s_endpgm
    s_endpgm
    s_endpgm
    s_endpgm
    s_endpgm
    s_endpgm
    s_endpgm
    s_endpgm
    s_endpgm
    s_endpgm
    s_endpgm
    s_endpgm
    s_endpgm
    s_endpgm
    s_endpgm
    s_endpgm
    s_endpgm
    s_endpgm
    s_endpgm
    s_endpgm
    s_endpgm
    s_endpgm
    s_endpgm
    s_endpgm
    s_endpgm
    s_endpgm
    s_endpgm
    s_endpgm
    s_endpgm
    s_endpgm
    s_endpgm
    s_endpgm
    s_endpgm
    s_endpgm
    s_endpgm
    s_endpgm
    s_endpgm
    s_endpgm
    s_endpgm
    s_endpgm
    s_endpgm
    s_endpgm
    s_endpgm
    s_endpgm
    s_endpgm
    s_endpgm
    s_endpgm
    s_endpgm
    s_endpgm
    s_endpgm
    s_endpgm
    s_endpgm
    s_endpgm
    s_endpgm
    s_endpgm
    s_endpgm
    s_endpgm
    s_endpgm
    s_endpgm
    s_endpgm
    s_endpgm
    s_endpgm
    s_endpgm
    s_endpgm
    s_endpgm
    s_endpgm
    s_endpgm
    s_endpgm
    s_endpgm
    s_endpgm
    s_endpgm
    s_endpgm
    s_endpgm
    s_endpgm
    s_endpgm
    s_endpgm
    s_endpgm
    s_endpgm
    s_endpgm
    s_endpgm
    s_endpgm
    s_endpgm
    s_endpgm
    s_endpgm
    s_endpgm
    s_endpgm
    s_endpgm
    s_endpgm
    s_endpgm
    s_endpgm
    s_endpgm
    s_endpgm
    s_endpgm
    s_endpgm
    s_endpgm
    s_endpgm
    s_endpgm
    s_endpgm
    s_endpgm
    s_endpgm
    s_endpgm
    s_endpgm
    s_endpgm
    s_endpgm
    s_endpgm
    s_endpgm
    s_endpgm
    s_endpgm
    s_endpgm
    s_endpgm
    s_endpgm
    s_endpgm
    s_endpgm
    s_endpgm
    s_endpgm
    s_endpgm
    s_endpgm
    s_endpgm
    s_endpgm
    s_endpgm
    s_endpgm
    s_endpgm
    s_endpgm
    s_endpgm
    s_endpgm
    s_endpgm
    s_endpgm
    s_endpgm
    s_endpgm
    s_endpgm
    s_endpgm
    s_endpgm
    s_endpgm
    s_endpgm
    s_endpgm
    s_endpgm
    s_endpgm
    s_endpgm
    s_endpgm
    s_endpgm
    s_endpgm
    s_endpgm
    s_endpgm
    s_endpgm
    s_endpgm
    s_endpgm
    s_endpgm
    s_endpgm
    s_endpgm
    s_endpgm
    s_endpgm
    s_endpgm
    s_endpgm
    s_endpgm
    s_endpgm
    s_endpgm
    s_endpgm
    s_endpgm
    s_endpgm
    s_endpgm
    s_endpgm
    s_endpgm
    s_endpgm
    s_endpgm
    s_endpgm
    s_endpgm
    s_endpgm
    s_endpgm
    s_endpgm
    s_endpgm
    s_endpgm
    s_endpgm
    s_endpgm
    s_endpgm
    s_endpgm
    s_endpgm
    s_endpgm
    s_endpgm
    s_endpgm
    s_endpgm
    s_endpgm
    s_endpgm
    s_endpgm
    s_endpgm
    s_endpgm
    s_endpgm
    s_endpgm
    s_endpgm
    s_endpgm
    s_endpgm
    s_endpgm
    s_endpgm
    s_endpgm
    s_endpgm
    s_endpgm
    s_endpgm
    s_endpgm
    s_endpgm
    s_endpgm
    s_endpgm
    s_endpgm
    s_endpgm
    s_endpgm
    s_endpgm
    s_endpgm
    s_endpgm
    s_endpgm
    s_endpgm
    s_endpgm
    s_endpgm
    s_endpgm
    s_endpgm
    s_endpgm
    s_endpgm
    s_endpgm
    s_endpgm
    s_endpgm
    s_endpgm
    s_endpgm
    s_endpgm
    s_endpgm
    s_endpgm
    s_endpgm
    s_endpgm
    s_endpgm
    s_endpgm
    s_endpgm
    s_endpgm
    s_endpgm
    s_endpgm
    s_endpgm
    s_endpgm
    s_endpgm
    s_endpgm
    s_endpgm
    s_endpgm
    s_endpgm
    s_endpgm
    s_endpgm
    s_endpgm
    s_endpgm
    s_endpgm
    s_endpgm
    s_endpgm
    s_endpgm
    s_endpgm
    s_endpgm
    s_endpgm
    s_endpgm
    s_endpgm
    s_endpgm
    s_endpgm
    s_endpgm
    s_endpgm
    s_endpgm
    s_endpgm
    s_endpgm
    s_endpgm
    s_endpgm
    s_endpgm
    s_endpgm
    s_endpgm
    s_endpgm
    s_endpgm
    s_endpgm
    s_endpgm
    s_endpgm
    s_endpgm
    s_endpgm
    s_endpgm
    s_endpgm
    s_endpgm
    s_endpgm
    s_endpgm
    s_endpgm
    s_endpgm
    s_endpgm
    s_endpgm
    s_endpgm
    s_endpgm
    s_endpgm
    s_endpgm
    s_endpgm
    s_endpgm
    s_endpgm
    s_endpgm
    s_endpgm
    s_endpgm
    s_endpgm
    s_endpgm
    s_endpgm
    s_endpgm
    s_endpgm
    s_endpgm
    s_endpgm
    s_endpgm
    s_endpgm
    s_endpgm
    s_endpgm
    s_endpgm
    s_endpgm
    s_endpgm
    s_endpgm
    s_endpgm
    s_endpgm
    s_endpgm
    s_endpgm
    s_endpgm
    s_endpgm
    s_endpgm
    s_endpgm
    s_endpgm
    s_endpgm
    s_endpgm
    s_endpgm
    s_endpgm
    s_endpgm
    s_endpgm
    s_endpgm
    s_endpgm
    s_endpgm
    s_endpgm
    s_endpgm
    s_endpgm
    s_endpgm
    s_endpgm
    s_endpgm
    s_endpgm
    s_endpgm
    s_endpgm
    s_endpgm
    s_endpgm
    s_endpgm
    s_endpgm
    s_endpgm
    s_endpgm
    s_endpgm
    s_endpgm
    s_endpgm
    s_endpgm
    s_endpgm
    s_endpgm
    s_endpgm
    s_endpgm
    s_endpgm
    s_endpgm
    s_endpgm
    s_endpgm
    s_endpgm
    s_endpgm
    s_endpgm
    s_endpgm
    s_endpgm
    s_endpgm
    s_endpgm
    s_endpgm
    s_endpgm
    s_endpgm
    s_endpgm
    s_endpgm
    s_endpgm
    s_endpgm
    s_endpgm
    s_endpgm
    s_endpgm
    s_endpgm
    s_endpgm
    s_endpgm
    s_endpgm
    s_endpgm
    s_endpgm
    s_endpgm
    s_endpgm
    s_endpgm
    s_endpgm
    s_endpgm
    s_endpgm
    s_endpgm
    s_endpgm
    s_endpgm
    s_endpgm
    s_endpgm
    s_endpgm
    s_endpgm
    s_endpgm
    s_endpgm
    s_endpgm
    s_endpgm
    s_endpgm
    s_endpgm
    s_endpgm
    s_endpgm
    s_endpgm
    s_endpgm
    s_endpgm
    s_endpgm
    s_endpgm
    s_endpgm
    s_endpgm
    s_endpgm
    s_endpgm
    s_endpgm
    s_endpgm
    s_endpgm
    s_endpgm
    s_endpgm
    s_endpgm
    s_endpgm
    s_endpgm
    s_endpgm
    s_endpgm
    s_endpgm
    s_endpgm
    s_endpgm
    s_endpgm
    s_endpgm
    s_endpgm
    s_endpgm
    s_endpgm
    s_endpgm
    s_endpgm
    s_endpgm
    s_endpgm
    s_endpgm
    s_endpgm
    s_endpgm
    s_endpgm
    s_endpgm
    s_endpgm
    s_endpgm
    s_endpgm
    s_endpgm
    s_endpgm
    s_endpgm
    s_endpgm
    s_endpgm
    s_endpgm
    s_endpgm
    s_endpgm
    s_endpgm
    s_endpgm
    s_endpgm
    s_endpgm
    s_endpgm
    s_endpgm
    s_endpgm
    s_endpgm
    s_endpgm
    s_endpgm
    s_endpgm
    s_endpgm
    s_endpgm
    s_endpgm
    s_endpgm
    s_endpgm
    s_endpgm
    s_endpgm
    s_endpgm
    s_endpgm
    s_endpgm
    s_endpgm
    s_endpgm
    s_endpgm
    s_endpgm
    s_endpgm
    s_endpgm
    s_endpgm
    s_endpgm
    s_endpgm
    s_endpgm
    s_endpgm
    s_endpgm
    s_endpgm
    s_endpgm
    s_endpgm
    s_endpgm
    s_endpgm
    s_endpgm
    s_endpgm
    s_endpgm
    s_endpgm
    s_endpgm
    s_endpgm
    s_endpgm
    s_endpgm
    s_endpgm
    s_endpgm
    s_endpgm
    s_endpgm
    s_endpgm
    s_endpgm
    s_endpgm
    s_endpgm
    s_endpgm
    s_endpgm
    s_endpgm
    s_endpgm
    s_endpgm
    s_endpgm
    s_endpgm
    s_endpgm
    s_endpgm
    s_endpgm
    s_endpgm
    s_endpgm
    s_endpgm
    s_endpgm
    s_endpgm
    s_endpgm
    s_endpgm
    s_endpgm
    s_endpgm
    s_endpgm
    s_endpgm
    s_endpgm
    s_endpgm
    s_endpgm
    s_endpgm
    s_endpgm
    s_endpgm
    s_endpgm
    s_endpgm
    s_endpgm
    s_endpgm
    s_endpgm
    s_endpgm
    s_endpgm
    s_endpgm
    s_endpgm
    s_endpgm
    s_endpgm
    s_endpgm
    s_endpgm
    s_endpgm
    s_endpgm
    s_endpgm
    s_endpgm
    s_endpgm
    s_endpgm
    s_endpgm
    s_endpgm
    s_endpgm
    s_endpgm
    s_endpgm
    s_endpgm
    s_endpgm
    s_endpgm
    s_endpgm
    s_endpgm
    s_endpgm
    s_endpgm
    s_endpgm
    s_endpgm
    s_endpgm
    s_endpgm
    s_endpgm
    s_endpgm
    s_endpgm
    s_endpgm
    s_endpgm
    s_endpgm
    s_endpgm
    s_endpgm
    s_endpgm
    s_endpgm
    s_endpgm
    s_endpgm
    s_endpgm
    s_endpgm
    s_endpgm
    s_endpgm
    s_endpgm
    s_endpgm
    s_endpgm
    s_endpgm
    s_endpgm
    s_endpgm
    s_endpgm
    s_endpgm
    s_endpgm
    s_endpgm
    s_endpgm
    s_endpgm
    s_endpgm
    s_endpgm
    s_endpgm
    s_endpgm
    s_endpgm
    s_endpgm
    s_endpgm
    s_endpgm
    s_endpgm
    s_endpgm
    s_endpgm
    s_endpgm
    s_endpgm
    s_endpgm
    s_endpgm
    s_endpgm
    s_endpgm
    s_endpgm
    s_endpgm
    s_endpgm
    s_endpgm
    s_endpgm
    s_endpgm
    s_endpgm
    s_endpgm
    s_endpgm
    s_endpgm
    s_endpgm
    s_endpgm
    s_endpgm
    s_endpgm
    s_endpgm
    s_endpgm
    s_endpgm
    s_endpgm
    s_endpgm
    s_endpgm
    s_endpgm
    s_endpgm
    s_endpgm
    s_endpgm
    s_endpgm
    s_endpgm
    s_endpgm
    s_endpgm
    s_endpgm
    s_endpgm
    s_endpgm
    s_endpgm
    s_endpgm
    s_endpgm
    s_endpgm
    s_endpgm
    s_endpgm
    s_endpgm
    s_endpgm
    s_endpgm
    s_endpgm
    s_endpgm
    s_endpgm
    s_endpgm
    s_endpgm
    s_endpgm
    s_endpgm
    s_endpgm
    s_endpgm
    s_endpgm
    s_endpgm
    s_endpgm
    s_endpgm
    s_endpgm
    s_endpgm
    s_endpgm
    s_endpgm
    s_endpgm
    s_endpgm
    s_endpgm
    s_endpgm
    s_endpgm
    s_endpgm
    s_endpgm
    s_endpgm
    s_endpgm
    s_endpgm
    s_endpgm
    s_endpgm
    s_endpgm
    s_endpgm
    s_endpgm
    s_endpgm
    s_endpgm
    s_endpgm
    s_endpgm
    s_endpgm
    s_endpgm
    s_endpgm
    s_endpgm
    s_endpgm
    s_endpgm
    s_endpgm
    s_endpgm
    s_endpgm
    s_endpgm
    s_endpgm
    s_endpgm
    s_endpgm
    s_endpgm
    s_endpgm
    s_endpgm
    s_endpgm
    s_endpgm
    s_endpgm
    s_endpgm
    s_endpgm
    s_endpgm
    s_endpgm
    s_endpgm
    s_endpgm
    s_endpgm
    s_endpgm
    s_endpgm
    s_endpgm
    s_endpgm
    s_endpgm
    s_endpgm
    s_endpgm
    s_endpgm
    s_endpgm
    s_endpgm
    s_endpgm
    s_endpgm
    s_endpgm
    s_endpgm
    s_endpgm
    s_endpgm
    s_endpgm
    s_endpgm
    s_endpgm
    s_endpgm
    s_endpgm
    s_endpgm
    s_endpgm
    s_endpgm
    s_endpgm
    s_endpgm
    s_endpgm
    s_endpgm
    s_endpgm
    s_endpgm
    s_endpgm
    s_endpgm
    s_endpgm
    s_endpgm
    s_endpgm
    s_endpgm
    s_endpgm
    s_endpgm
    s_endpgm
    s_endpgm
    s_endpgm
    s_endpgm
    s_endpgm
    s_endpgm
    s_endpgm
    s_endpgm
    s_endpgm
    s_endpgm
    s_endpgm
    s_endpgm
    s_endpgm
    s_endpgm
    s_endpgm
    s_endpgm
    s_endpgm
    s_endpgm
    s_endpgm
    s_endpgm
    s_endpgm
    s_endpgm
    s_endpgm
    s_endpgm
    s_endpgm
    s_endpgm
    s_endpgm
    s_endpgm
    s_endpgm
    s_endpgm
    s_endpgm
    s_endpgm
    s_endpgm
    s_endpgm
    s_endpgm
    s_endpgm
    s_endpgm
    s_endpgm
    s_endpgm
    s_endpgm
    s_endpgm
    s_endpgm
    s_endpgm
    s_endpgm
    s_endpgm
    s_endpgm
    s_endpgm
    s_endpgm
    s_endpgm
    s_endpgm
    s_endpgm
    s_endpgm
    s_endpgm
    s_endpgm
    s_endpgm
    s_endpgm
    s_endpgm
    s_endpgm
    s_endpgm
    s_endpgm
    s_endpgm
    s_endpgm
    s_endpgm
    s_endpgm
    s_endpgm
    s_endpgm
    s_endpgm
    s_endpgm
    s_endpgm
    s_endpgm
    s_endpgm
    s_endpgm
    s_endpgm
    s_endpgm
    s_endpgm
    s_endpgm
    s_endpgm
    s_endpgm
    s_endpgm
    s_endpgm
    s_endpgm
    s_endpgm
    s_endpgm
    s_endpgm
    s_endpgm
    s_endpgm
    s_endpgm
    s_endpgm
    s_endpgm
    s_endpgm
    s_endpgm
    s_endpgm
    s_endpgm
    s_endpgm
    s_endpgm
    s_endpgm
    s_endpgm
    s_endpgm
    s_endpgm
    s_endpgm
    s_endpgm
    s_endpgm
    s_endpgm
    s_endpgm
    s_endpgm
    s_endpgm
    s_endpgm
    s_endpgm
    s_endpgm
    s_endpgm
    s_endpgm
    s_endpgm
    s_endpgm
    s_endpgm
    s_endpgm
    s_endpgm
    s_endpgm
    s_endpgm
    s_endpgm
    s_endpgm
    s_endpgm
    s_endpgm
    s_endpgm
    s_endpgm
    s_endpgm
    s_endpgm
    s_endpgm
    s_endpgm
    s_endpgm
    s_endpgm
    s_endpgm
    s_endpgm
    s_endpgm
    s_endpgm
    s_endpgm
    s_endpgm
    s_endpgm
    s_endpgm
    s_endpgm
    s_endpgm
    s_endpgm
    s_endpgm
    s_endpgm
    s_endpgm
    s_endpgm
    s_endpgm
    s_endpgm
    s_endpgm
    s_endpgm
    s_endpgm
    s_endpgm
    s_endpgm
    s_endpgm
    s_endpgm
    s_endpgm
    s_endpgm
    s_endpgm
    s_endpgm
    s_endpgm
    s_endpgm
    s_endpgm
    s_endpgm
    s_endpgm
    s_endpgm
    s_endpgm
    s_endpgm
    s_endpgm
    s_endpgm
    s_endpgm
    s_endpgm
    s_endpgm
    s_endpgm
    s_endpgm
    s_endpgm
    s_endpgm
    s_endpgm
    s_endpgm
    s_endpgm
    s_endpgm
    s_endpgm
    s_endpgm
    s_endpgm
    s_endpgm
    s_endpgm
    s_endpgm
    s_endpgm
    s_endpgm
    s_endpgm
    s_endpgm
    s_endpgm
    s_endpgm
    s_endpgm
    s_endpgm
    s_endpgm
    s_endpgm
    s_endpgm
    s_endpgm
    s_endpgm
    s_endpgm
    s_endpgm
    s_endpgm
    s_endpgm
    s_endpgm
    s_endpgm
    s_endpgm
    s_endpgm
    s_endpgm
    s_endpgm
    s_endpgm
    s_endpgm
    s_endpgm
    s_endpgm
    s_endpgm
    s_endpgm
    s_endpgm
    s_endpgm
    s_endpgm
    s_endpgm
    s_endpgm
    s_endpgm
    s_endpgm
    s_endpgm
    s_endpgm
    s_endpgm
    s_endpgm
    s_endpgm
    s_endpgm
    s_endpgm
    s_endpgm
    s_endpgm
    s_endpgm
    s_endpgm
    s_endpgm
    s_endpgm
    s_endpgm
    s_endpgm
    s_endpgm
    s_endpgm
    s_endpgm
    s_endpgm
    s_endpgm
    s_endpgm
    s_endpgm
    s_endpgm
    s_endpgm
    s_endpgm
    s_endpgm
    s_endpgm
    s_endpgm
    s_endpgm
    s_endpgm
    s_endpgm
    s_endpgm
    s_endpgm
    s_endpgm
    s_endpgm
    s_endpgm
    s_endpgm
    s_endpgm
    s_endpgm
    s_endpgm
    s_endpgm
    s_endpgm
    s_endpgm
    s_endpgm
    s_endpgm
    s_endpgm
    s_endpgm
    s_endpgm
    s_endpgm
    s_endpgm
    s_endpgm
    s_endpgm
    s_endpgm
    s_endpgm
    s_endpgm
    s_endpgm
    s_endpgm
    s_endpgm
    s_endpgm
    s_endpgm
    s_endpgm
    s_endpgm
    s_endpgm
    s_endpgm
    s_endpgm
    s_endpgm
    s_endpgm
    s_endpgm
    s_endpgm
    s_endpgm
    s_endpgm
    s_endpgm
    s_endpgm
    s_endpgm
    s_endpgm
    s_endpgm
    s_endpgm
    s_endpgm
    s_endpgm
    s_endpgm
    s_endpgm
    s_endpgm
    s_endpgm
    s_endpgm
    s_endpgm
    s_endpgm
    s_endpgm
    s_endpgm
    s_endpgm
    s_endpgm
    s_endpgm
    s_endpgm
.section .rodata,"a"
.p2align 6
.amdhsa_kernel standalone__seq2seq_rnn_t_joint__speech_kernel
  .amdhsa_next_free_vgpr 256
  .amdhsa_next_free_sgpr 96
  .amdhsa_accum_offset 256
  .amdhsa_group_segment_fixed_size 0
  .amdhsa_kernarg_size 80
  .amdhsa_user_sgpr_count 2
  .amdhsa_user_sgpr_kernarg_segment_ptr 1
  .amdhsa_system_sgpr_workgroup_id_x 1
.end_amdhsa_kernel
```
